```python
import torch

def _softmax(x, axis=-1):
    return torch.softmax(x, dim=axis)
def _gelu(x):
    return torch.nn.functional.gelu(x, approximate="tanh")
def _silu(x):
    return torch.nn.functional.silu(x)
def _sigmoid(x):
    return torch.sigmoid(x)
def _layernorm(x, axis=-1, eps=1e-5):
    m = x.mean(dim=axis, keepdim=True)
    v = x.var(dim=axis, keepdim=True, unbiased=False)
    return (x - m) / torch.sqrt(v + eps)
def _scatter_add(tgt, idx, src, axis=0):
    return tgt.clone().index_add_(axis, idx, src)
def _segment_sum(src, seg, n):
    out = torch.zeros((n,) + src.shape[1:], dtype=src.dtype)
    return out.index_add_(0, seg, src)
def _pad(x, pw):
    flat = tuple(v for pair in reversed(pw) for v in pair)
    return torch.nn.functional.pad(x, flat)

kernel_name = 'interleave_layers__ssm_conv_s4d__grouped_kv_mqa__prompt'

def setup_inputs():

    _w = (lambda a: (lambda t: t.to(torch.bfloat16) if t.is_floating_point() else t)(torch.as_tensor(a)))
    def _A_setup():
        Bsz, L, D, N = 1, 2048, 640, 128
        return {
            "u": _w((lambda *s: torch.randn(*s, dtype=torch.bfloat16) * 0.05)(Bsz, L, D)),
            "log_A_real": _w((lambda *s: torch.randn(*s, dtype=torch.bfloat16) * 3.2)(D, N) * 0.5),
            "A_imag": _w((lambda *s: torch.randn(*s, dtype=torch.bfloat16) * 0.05)(D, N) * 3.14),
            "C_real": _w((lambda *s: torch.randn(*s, dtype=torch.bfloat16) * 0.05)(D, N) / N ** 0.5),
            "C_imag": _w((lambda *s: torch.randn(*s, dtype=torch.bfloat16) * 0.05)(D, N) / N ** 0.5),
            "log_dt": _w((lambda *s: torch.randn(*s, dtype=torch.bfloat16) * 0.05)(D) * 0.5 - 4.0),
            "D_skip": _w((lambda *s: torch.randn(*s, dtype=torch.bfloat16) * 0.05)(D)),
        }
    _A_in = _A_setup()

    def _B_setup():
        B, S, D, H = 1, 2048, 640, 32
        Dh = D // H
        return {
            "x": _w((lambda *s: torch.randn(*s, dtype=torch.bfloat16) * 0.05)(B, S, D)),
            "wq": _w((lambda *s: torch.randn(*s, dtype=torch.bfloat16) * 0.05)(D, H * Dh)),
            "wk": _w((lambda *s: torch.randn(*s, dtype=torch.bfloat16) * 0.05)(D, Dh)),
            "wv": _w((lambda *s: torch.randn(*s, dtype=torch.bfloat16) * 0.05)(D, Dh)),
            "wo": _w((lambda *s: torch.randn(*s, dtype=torch.bfloat16) * 0.05)(H * Dh, D)),
        }
    _B_in = _B_setup()

    return {
        "A_u": _A_in["u"],
        "A_log_A_real": _A_in["log_A_real"],
        "A_A_imag": _A_in["A_imag"],
        "A_C_real": _A_in["C_real"],
        "A_C_imag": _A_in["C_imag"],
        "A_log_dt": _A_in["log_dt"],
        "A_D_skip": _A_in["D_skip"],
        "B_x": _B_in["x"],
        "B_wq": _B_in["wq"],
        "B_wk": _B_in["wk"],
        "B_wv": _B_in["wv"],
        "B_wo": _B_in["wo"],
    }

def reference(A_u, A_log_A_real, A_A_imag, A_C_real, A_C_imag, A_log_dt, A_D_skip, B_x, B_wq, B_wk, B_wv, B_wo):
    def _A_ref(u, log_A_real, A_imag, C_real, C_imag, log_dt, D_skip):
        L = u.shape[1]
        dt = torch.exp(log_dt)
        A = -torch.exp(log_A_real) + 1j * A_imag
        C = (C_real + 1j * C_imag) * dt[:, None]
        pos = (lambda x, dt: x.to(dt))(torch.arange(L), log_dt.dtype)
        P = torch.exp((A * dt[:, None])[:, :, None] * pos[None, None, :])
        K = 2.0 * torch.einsum("dn,dnl->dl", C, P).real
        L2 = 2 * L
        u_t = (lambda x, *d: x.permute(*d))(u, 0, 2, 1)
        Kf = (lambda x, *a, **k: torch.fft.rfft(x.float(), *a, **k))(K, L2)
        Uf = (lambda x, *a, **k: torch.fft.rfft(x.float(), *a, **k))(u_t, L2)
        y = (lambda x, *a, **k: torch.fft.irfft(x, *a, **k).to(torch.bfloat16))(Uf * Kf[None, :, :], L2)[:, :, :L]
        y = (lambda x, *d: x.permute(*d))(y, 0, 2, 1)
        return y + u * D_skip[None, None, :]

    def _B_ref(x, wq, wk, wv, wo):
        B, S, D = x.shape
        H = 32
        Dh = D // H
        q = (lambda x, *d: x.permute(*d))((x @ wq).reshape(B, S, H, Dh), 0, 2, 1, 3)
        k = x @ wk
        v = x @ wv
        scores = torch.einsum("bhqd,bkd->bhqk", q, k) * (Dh ** -0.5)
        p = _softmax(scores, axis=-1)
        o = torch.einsum("bhqk,bkd->bhqd", p, v)
        return (lambda x, *d: x.permute(*d))(o, 0, 2, 1, 3).reshape(B, S, H * Dh) @ wo

    x = A_u
    x = x + _A_ref(_layernorm(x, axis=-1), A_log_A_real, A_A_imag, A_C_real, A_C_imag, A_log_dt, A_D_skip)
    x = x + _B_ref(_layernorm(x, axis=-1), B_wq, B_wk, B_wv, B_wo)
    x = x + _A_ref(_layernorm(x, axis=-1), A_log_A_real, A_A_imag, A_C_real, A_C_imag, A_log_dt, A_D_skip)
    x = x + _B_ref(_layernorm(x, axis=-1), B_wq, B_wk, B_wv, B_wo)
    return x
```

```asm
; @launch kernel=pc_kernel grid=(911,1,1) block=(256,1,1) lds=40960
; @launch kernel=fused1_kernel grid=(256,1,1) block=(512,1,1) lds=163840
; @launch kernel=conv2_kernel grid=(768,1,1) block=(256,1,1) lds=40960
; @launch kernel=fused2_kernel grid=(256,1,1) block=(512,1,1) lds=163840
.amdgcn_target "amdgcn-amd-amdhsa--gfx950"
.text
.globl pc_kernel
.p2align 8
.type pc_kernel,@function
pc_kernel:
    s_load_dwordx16 s[16:31], s[0:1], 0
    s_load_dwordx8 s[32:39], s[0:1], 64
    s_load_dwordx4 s[40:43], s[0:1], 104
    s_cmp_ge_u32 s2, 911
    s_cbranch_scc1 pc_end
    s_sub_u32 s2, s2, 1
    s_mov_b32 s83, s2
    s_mov_b32 s78, 0
    s_waitcnt lgkmcnt(0)
    s_mov_b32 s68, s40
    s_mov_b32 s69, s41
    s_mov_b32 s70, 0x100
    s_mov_b32 s71, 0x00020000
    s_add_u32 s96, s42, 0x1570000
    s_addc_u32 s97, s43, 0
    s_mov_b32 s98, 0x4000
    s_mov_b32 s99, 0x00020000
    s_cmp_eq_u32 s2, -1
    s_cbranch_scc1 pc_zero
    s_cmp_lt_u32 s2, 128
    s_cbranch_scc1 pc_x0
    s_cmp_lt_u32 s2, 228
    s_cbranch_scc1 pc_tile
    s_cmp_lt_u32 s2, 248
    s_cbranch_scc1 pc_kv
    s_cmp_ge_u32 s2, 888
    s_cbranch_scc1 pc_cs
    s_sub_u32 s2, s2, 248
    s_and_b32 s3, s2, 7
    s_mul_i32 s3, s3, 80
    s_lshr_b32 s2, s2, 3
    s_add_u32 s2, s2, s3
pc_kgen:
    s_setprio 1
    s_mov_b32 s44, s18
    s_mov_b32 s45, s19
    s_mov_b32 s46, 0x28000
    s_mov_b32 s47, 0x00020000
    s_mov_b32 s48, s20
    s_mov_b32 s49, s21
    s_mov_b32 s50, 0x28000
    s_mov_b32 s51, 0x00020000
    s_mov_b32 s52, s22
    s_mov_b32 s53, s23
    s_mov_b32 s54, 0x28000
    s_mov_b32 s55, 0x00020000
    s_mov_b32 s56, s24
    s_mov_b32 s57, s25
    s_mov_b32 s58, 0x28000
    s_mov_b32 s59, 0x00020000
    s_mov_b32 s60, s26
    s_mov_b32 s61, s27
    s_mov_b32 s62, 0x500
    s_mov_b32 s63, 0x00020000
    s_lshl_b32 s3, s2, 8
    s_lshl_b32 s4, s2, 1
    v_and_b32 v1, 127, v0
    v_lshlrev_b32 v1, 1, v1
    v_mov_b32 v2, 0
    buffer_load_ushort v4, v1, s[44:47], s3 offen
    buffer_load_ushort v5, v1, s[48:51], s3 offen
    buffer_load_ushort v6, v1, s[52:55], s3 offen
    buffer_load_ushort v7, v1, s[56:59], s3 offen
    buffer_load_ushort v8, v2, s[60:63], s4 offen
    s_lshr_b32 s30, s2, 1
    s_lshl_b32 s30, s30, 2
    s_load_dword s80, s[28:29], s30
    s_add_u32 s64, s42, 0xa00000
    s_addc_u32 s65, s43, 0
    s_mov_b32 s66, 0x294000
    s_mov_b32 s67, 0x00020000
    s_add_u32 s72, s42, 0x1430000
    s_addc_u32 s73, s43, 0
    s_mov_b32 s74, 0x4000
    s_mov_b32 s75, 0x00020000
    s_mov_b32 s16, s42
    s_mov_b32 s17, s43
    s_mov_b32 s18, 0x280000
    s_mov_b32 s19, 0x00020000
    s_add_u32 s12, s42, 0x280000
    s_addc_u32 s13, s43, 0
    s_mov_b32 s14, 0x280000
    s_mov_b32 s15, 0x00020000
    s_mov_b32 s5, 0x3fb8aa3b
    s_mov_b32 s6, 0x3e22f983
    v_lshrrev_b32 v30, 6, v0
    s_nop 1
    v_readfirstlane_b32 s7, v30
    v_lshlrev_b32 v3, 3, v0
    v_mov_b32 v31, 33280
    v_sub_u32 v48, 2047, v3
    v_cvt_f32_i32 v2, v48
    v_cvt_pk_bf16_f32 v2, v2, v2
    v_cmp_gt_i32 vcc, 256, v48
    v_and_b32 v2, 0xffff, v2
    v_add_u32 v2, -17024, v2
    v_cndmask_b32 v2, v2, v48, vcc
    v_lshl_add_u32 v48, v2, 2, v31
    v_mov_b32 v59, 28704
    v_sub_u32 v49, 2046, v3
    v_cvt_f32_i32 v2, v49
    v_cvt_pk_bf16_f32 v2, v2, v2
    v_cmp_gt_i32 vcc, 256, v49
    v_and_b32 v2, 0xffff, v2
    v_add_u32 v2, -17024, v2
    v_cndmask_b32 v2, v2, v49, vcc
    v_lshl_add_u32 v49, v2, 2, v31
    v_sub_u32 v50, 2045, v3
    v_cvt_f32_i32 v2, v50
    v_cvt_pk_bf16_f32 v2, v2, v2
    v_cmp_gt_i32 vcc, 256, v50
    v_and_b32 v2, 0xffff, v2
    v_add_u32 v2, -17024, v2
    v_cndmask_b32 v2, v2, v50, vcc
    v_lshl_add_u32 v50, v2, 2, v31
    v_sub_u32 v51, 2044, v3
    v_cvt_f32_i32 v2, v51
    v_cvt_pk_bf16_f32 v2, v2, v2
    v_cmp_gt_i32 vcc, 256, v51
    v_and_b32 v2, 0xffff, v2
    v_add_u32 v2, -17024, v2
    v_cndmask_b32 v2, v2, v51, vcc
    v_lshl_add_u32 v51, v2, 2, v31
    v_sub_u32 v52, 2043, v3
    v_cvt_f32_i32 v2, v52
    v_cvt_pk_bf16_f32 v2, v2, v2
    v_cmp_gt_i32 vcc, 256, v52
    v_and_b32 v2, 0xffff, v2
    v_add_u32 v2, -17024, v2
    v_cndmask_b32 v2, v2, v52, vcc
    v_lshl_add_u32 v52, v2, 2, v31
    v_sub_u32 v53, 2042, v3
    v_cvt_f32_i32 v2, v53
    v_cvt_pk_bf16_f32 v2, v2, v2
    v_cmp_gt_i32 vcc, 256, v53
    v_and_b32 v2, 0xffff, v2
    v_add_u32 v2, -17024, v2
    v_cndmask_b32 v2, v2, v53, vcc
    v_lshl_add_u32 v53, v2, 2, v31
    v_sub_u32 v54, 2041, v3
    v_cvt_f32_i32 v2, v54
    v_cvt_pk_bf16_f32 v2, v2, v2
    v_cmp_gt_i32 vcc, 256, v54
    v_and_b32 v2, 0xffff, v2
    v_add_u32 v2, -17024, v2
    v_cndmask_b32 v2, v2, v54, vcc
    v_lshl_add_u32 v54, v2, 2, v31
    v_sub_u32 v55, 2040, v3
    v_cvt_f32_i32 v2, v55
    v_cvt_pk_bf16_f32 v2, v2, v2
    v_cmp_gt_i32 vcc, 256, v55
    v_and_b32 v2, 0xffff, v2
    v_add_u32 v2, -17024, v2
    v_cndmask_b32 v2, v2, v55, vcc
    v_lshl_add_u32 v55, v2, 2, v31
    v_sub_u32 v120, 2039, v3
    v_cvt_f32_i32 v2, v120
    v_cvt_pk_bf16_f32 v2, v2, v2
    v_cmp_gt_i32 vcc, 256, v120
    v_and_b32 v2, 0xffff, v2
    v_add_u32 v2, -17024, v2
    v_cndmask_b32 v2, v2, v120, vcc
    v_cmp_gt_i32 vcc, 0, v120
    v_lshl_add_u32 v120, v2, 2, v31
    v_cndmask_b32 v120, v120, v59, vcc
    v_sub_u32 v121, 2038, v3
    v_cvt_f32_i32 v2, v121
    v_cvt_pk_bf16_f32 v2, v2, v2
    v_cmp_gt_i32 vcc, 256, v121
    v_and_b32 v2, 0xffff, v2
    v_add_u32 v2, -17024, v2
    v_cndmask_b32 v2, v2, v121, vcc
    v_cmp_gt_i32 vcc, 0, v121
    v_lshl_add_u32 v121, v2, 2, v31
    v_cndmask_b32 v121, v121, v59, vcc
    v_sub_u32 v122, 2037, v3
    v_cvt_f32_i32 v2, v122
    v_cvt_pk_bf16_f32 v2, v2, v2
    v_cmp_gt_i32 vcc, 256, v122
    v_and_b32 v2, 0xffff, v2
    v_add_u32 v2, -17024, v2
    v_cndmask_b32 v2, v2, v122, vcc
    v_cmp_gt_i32 vcc, 0, v122
    v_lshl_add_u32 v122, v2, 2, v31
    v_cndmask_b32 v122, v122, v59, vcc
    v_sub_u32 v123, 2036, v3
    v_cvt_f32_i32 v2, v123
    v_cvt_pk_bf16_f32 v2, v2, v2
    v_cmp_gt_i32 vcc, 256, v123
    v_and_b32 v2, 0xffff, v2
    v_add_u32 v2, -17024, v2
    v_cndmask_b32 v2, v2, v123, vcc
    v_cmp_gt_i32 vcc, 0, v123
    v_lshl_add_u32 v123, v2, 2, v31
    v_cndmask_b32 v123, v123, v59, vcc
    v_sub_u32 v124, 2035, v3
    v_cvt_f32_i32 v2, v124
    v_cvt_pk_bf16_f32 v2, v2, v2
    v_cmp_gt_i32 vcc, 256, v124
    v_and_b32 v2, 0xffff, v2
    v_add_u32 v2, -17024, v2
    v_cndmask_b32 v2, v2, v124, vcc
    v_cmp_gt_i32 vcc, 0, v124
    v_lshl_add_u32 v124, v2, 2, v31
    v_cndmask_b32 v124, v124, v59, vcc
    v_sub_u32 v125, 2034, v3
    v_cvt_f32_i32 v2, v125
    v_cvt_pk_bf16_f32 v2, v2, v2
    v_cmp_gt_i32 vcc, 256, v125
    v_and_b32 v2, 0xffff, v2
    v_add_u32 v2, -17024, v2
    v_cndmask_b32 v2, v2, v125, vcc
    v_cmp_gt_i32 vcc, 0, v125
    v_lshl_add_u32 v125, v2, 2, v31
    v_cndmask_b32 v125, v125, v59, vcc
    v_sub_u32 v126, 2033, v3
    v_cvt_f32_i32 v2, v126
    v_cvt_pk_bf16_f32 v2, v2, v2
    v_cmp_gt_i32 vcc, 256, v126
    v_and_b32 v2, 0xffff, v2
    v_add_u32 v2, -17024, v2
    v_cndmask_b32 v2, v2, v126, vcc
    v_cmp_gt_i32 vcc, 0, v126
    v_lshl_add_u32 v126, v2, 2, v31
    v_cndmask_b32 v126, v126, v59, vcc
    v_lshlrev_b32 v57, 6, v0
    v_and_b32 v56, 31, v0
    v_lshlrev_b32 v56, 7, v56
    v_lshl_add_u32 v56, v30, 12, v56
    v_mov_b32 v16, 0
    v_mov_b32 v17, 0
    v_mov_b32 v18, 0
    v_mov_b32 v19, 0
    v_lshlrev_b32 v58, 4, v0
    v_cmp_gt_u32 vcc, 30, v0
    s_and_saveexec_b64 s[10:11], vcc
    ds_write_b128 v58, v[16:19] offset:33280
    s_mov_b64 exec, s[10:11]
    s_mul_i32 s8, s2, 4224
    s_waitcnt vmcnt(0)
    v_cmp_gt_u32 vcc, 8, v0
    s_and_saveexec_b64 s[10:11], vcc
    s_add_u32 s9, s8, 4096
    buffer_store_dwordx4 v[16:19], v58, s[64:67], s9 offen sc0 sc1
    s_mov_b64 exec, s[10:11]
    v_lshlrev_b32 v4, 16, v4
    v_lshlrev_b32 v5, 16, v5
    v_lshlrev_b32 v6, 16, v6
    v_lshlrev_b32 v7, 16, v7
    v_lshlrev_b32 v8, 16, v8
    v_mul_f32 v8, s5, v8
    v_exp_f32 v8, v8
    v_mul_f32 v4, s5, v4
    v_exp_f32 v4, v4
    s_nop 1
    v_cvt_pk_bf16_f32 v8, v8, v8
    v_lshlrev_b32 v8, 16, v8
    v_cvt_pk_bf16_f32 v4, v4, v4
    v_lshlrev_b32 v4, 16, v4
    v_mul_f32 v10, v4, v8
    v_mul_f32 v11, v5, v8
    v_mul_f32 v12, v6, v8
    v_mul_f32 v13, v7, v8
    v_mul_f32 v10, s5, v10
    v_sub_f32 v10, 0, v10
    v_mul_f32 v11, s6, v11
    v_mul_f32 v12, 0x45000000, v12
    v_mul_f32 v13, 0x45000000, v13
    v_mul_f32 v30, 0x43800000, v10
    v_mul_f32 v34, 0x43800000, v11
    v_mul_f32 v31, 0x44800000, v10
    v_mul_f32 v35, 0x44800000, v11
    v_mul_f32 v32, 0x45000000, v10
    v_mul_f32 v36, 0x45000000, v11
    v_exp_f32 v30, v30
    v_fract_f32 v34, v34
    v_exp_f32 v31, v31
    v_fract_f32 v35, v35
    v_exp_f32 v32, v32
    v_fract_f32 v36, v36
    v_cos_f32 v38, v34
    v_sin_f32 v34, v34
    v_cos_f32 v39, v35
    v_sin_f32 v35, v35
    v_cos_f32 v40, v36
    v_sin_f32 v36, v36
    s_nop 0
    v_mul_f32 v14, v12, v38
    v_mul_f32 v15, v13, v38
    v_fma_f32 v14, -v13, v34, v14
    v_fmac_f32 v15, v12, v34
    v_mul_f32 v14, v30, v14
    v_mul_f32 v15, v30, v15
    v_mul_f32 v16, v12, v39
    v_mul_f32 v17, v13, v39
    v_fma_f32 v16, -v13, v35, v16
    v_fmac_f32 v17, v12, v35
    v_mul_f32 v16, v31, v16
    v_mul_f32 v17, v31, v17
    v_mul_f32 v46, v12, v40
    v_mul_f32 v47, v13, v40
    v_fma_f32 v46, -v13, v36, v46
    v_fmac_f32 v47, v12, v36
    v_mul_f32 v46, v32, v46
    v_mul_f32 v47, v32, v47
    v_mov_b32 v44, v12
    v_mov_b32 v45, v13
    v_mul_u32_u24 v1, 24, v1
    ds_write_b128 v1, v[10:13]
    ds_write_b128 v1, v[14:17] offset:16
    ds_write_b128 v1, v[44:47] offset:32
    v_and_b32 v2, 15, v0
    v_cvt_f32_u32 v20, v2
    v_cmp_gt_u32 vcc, 8, v2
    v_mov_b32 v21, 1.0
    v_mov_b32 v22, 0
    v_lshrrev_b32 v3, 6, v0
    v_mul_u32_u24 v3, 1536, v3
    v_bfe_u32 v4, v0, 4, 2
    v_mul_u32_u24 v4, 192, v4
    v_add_u32 v9, v3, v4
    v_lshrrev_b32 v3, 3, v2
    v_lshl_add_u32 v23, v3, 4, v9
    v_mov_b32 v96, 0
    v_mov_b32 v97, 0
    v_mov_b32 v98, 0
    v_mov_b32 v99, 0
    v_mov_b32 v100, 0
    v_mov_b32 v101, 0
    v_mov_b32 v102, 0
    v_mov_b32 v103, 0
    v_mov_b32 v104, 0
    v_mov_b32 v105, 0
    v_mov_b32 v106, 0
    v_mov_b32 v107, 0
    v_mov_b32 v108, 0
    v_mov_b32 v109, 0
    v_mov_b32 v110, 0
    v_mov_b32 v111, 0
    s_waitcnt lgkmcnt(0)
    s_barrier
    ds_read_b128 v[64:67], v9 offset:0
    ds_read_b128 v[68:71], v23 offset:16
    ds_read_b128 v[72:75], v9 offset:48
    ds_read_b128 v[76:79], v23 offset:64
    ds_read_b128 v[80:83], v9 offset:96
    ds_read_b128 v[84:87], v23 offset:112
    ds_read_b128 v[88:91], v9 offset:144
    ds_read_b128 v[92:95], v23 offset:160
    s_waitcnt lgkmcnt(4)
    v_pk_mul_f32 v[36:37], v[64:65], v[20:21] op_sel:[0,0] op_sel_hi:[1,0]
    v_pk_mul_f32 v[46:47], v[72:73], v[20:21] op_sel:[0,0] op_sel_hi:[1,0]
    v_exp_f32 v36, v36
    v_exp_f32 v46, v46
    v_fract_f32 v37, v37
    v_fract_f32 v47, v47
    v_cos_f32 v28, v37
    v_cos_f32 v38, v47
    v_sin_f32 v29, v37
    v_sin_f32 v39, v47
    v_pk_mul_f32 v[28:29], v[28:29], v[36:37] op_sel:[0,0] op_sel_hi:[1,0]
    v_pk_mul_f32 v[38:39], v[38:39], v[46:47] op_sel:[0,0] op_sel_hi:[1,0]
    v_pk_mul_f32 v[30:31], v[28:29], v[28:29] op_sel:[0,0] op_sel_hi:[0,1]
    v_pk_mul_f32 v[40:41], v[38:39], v[38:39] op_sel:[0,0] op_sel_hi:[0,1]
    v_cvt_pk_f16_f32 v24, v28, v29
    v_cvt_pk_f16_f32 v25, v38, v39
    v_pk_fma_f32 v[30:31], v[28:29], v[28:29], v[30:31] op_sel:[1,1,0] op_sel_hi:[0,1,1] neg_lo:[1,0,0]
    v_pk_fma_f32 v[40:41], v[38:39], v[38:39], v[40:41] op_sel:[1,1,0] op_sel_hi:[0,1,1] neg_lo:[1,0,0]
    v_pk_mul_f32 v[28:29], v[30:31], v[30:31] op_sel:[0,0] op_sel_hi:[0,1]
    v_pk_mul_f32 v[38:39], v[40:41], v[40:41] op_sel:[0,0] op_sel_hi:[0,1]
    v_cvt_pk_f16_f32 v60, v30, v31
    v_cvt_pk_f16_f32 v61, v40, v41
    v_pk_fma_f32 v[28:29], v[30:31], v[30:31], v[28:29] op_sel:[1,1,0] op_sel_hi:[0,1,1] neg_lo:[1,0,0]
    v_pk_fma_f32 v[38:39], v[40:41], v[40:41], v[38:39] op_sel:[1,1,0] op_sel_hi:[0,1,1] neg_lo:[1,0,0]
    v_pk_mul_f32 v[30:31], v[28:29], v[28:29] op_sel:[0,0] op_sel_hi:[0,1]
    v_pk_mul_f32 v[40:41], v[38:39], v[38:39] op_sel:[0,0] op_sel_hi:[0,1]
    v_cvt_pk_f16_f32 v112, v28, v29
    v_cvt_pk_f16_f32 v113, v38, v39
    v_pk_fma_f32 v[30:31], v[28:29], v[28:29], v[30:31] op_sel:[1,1,0] op_sel_hi:[0,1,1] neg_lo:[1,0,0]
    v_pk_fma_f32 v[40:41], v[38:39], v[38:39], v[40:41] op_sel:[1,1,0] op_sel_hi:[0,1,1] neg_lo:[1,0,0]
    v_pk_mul_f32 v[28:29], v[30:31], v[30:31] op_sel:[0,0] op_sel_hi:[0,1]
    v_pk_mul_f32 v[38:39], v[40:41], v[40:41] op_sel:[0,0] op_sel_hi:[0,1]
    v_cvt_pk_f16_f32 v116, v30, v31
    v_cvt_pk_f16_f32 v117, v40, v41
    v_pk_fma_f32 v[28:29], v[30:31], v[30:31], v[28:29] op_sel:[1,1,0] op_sel_hi:[0,1,1] neg_lo:[1,0,0]
    v_pk_fma_f32 v[38:39], v[40:41], v[40:41], v[38:39] op_sel:[1,1,0] op_sel_hi:[0,1,1] neg_lo:[1,0,0]
    v_pk_mul_f32 v[32:33], v[28:29], v[28:29] op_sel:[0,0] op_sel_hi:[0,1]
    v_pk_mul_f32 v[42:43], v[38:39], v[38:39] op_sel:[0,0] op_sel_hi:[0,1]
    v_pk_mul_f32 v[34:35], v[66:67], v[28:29] op_sel:[0,0] op_sel_hi:[1,0]
    v_pk_mul_f32 v[44:45], v[74:75], v[38:39] op_sel:[0,0] op_sel_hi:[1,0]
    v_pk_fma_f32 v[32:33], v[28:29], v[28:29], v[32:33] op_sel:[1,1,0] op_sel_hi:[0,1,1] neg_lo:[1,0,0]
    v_pk_fma_f32 v[42:43], v[38:39], v[38:39], v[42:43] op_sel:[1,1,0] op_sel_hi:[0,1,1] neg_lo:[1,0,0]
    v_pk_fma_f32 v[34:35], v[66:67], v[28:29], v[34:35] op_sel:[1,1,0] op_sel_hi:[0,1,1] neg_lo:[1,0,0]
    v_pk_fma_f32 v[44:45], v[74:75], v[38:39], v[44:45] op_sel:[1,1,0] op_sel_hi:[0,1,1] neg_lo:[1,0,0]
    v_pk_mul_f32 v[30:31], v[32:33], v[32:33] op_sel:[0,0] op_sel_hi:[0,1]
    v_pk_mul_f32 v[40:41], v[42:43], v[42:43] op_sel:[0,0] op_sel_hi:[0,1]
    v_pk_fma_f32 v[30:31], v[32:33], v[32:33], v[30:31] op_sel:[1,1,0] op_sel_hi:[0,1,1] neg_lo:[1,0,0]
    v_pk_fma_f32 v[40:41], v[42:43], v[42:43], v[40:41] op_sel:[1,1,0] op_sel_hi:[0,1,1] neg_lo:[1,0,0]
    v_cvt_pk_f16_f32 v4, v34, -v35
    v_cvt_pk_f16_f32 v5, v44, -v45
    v_pk_mul_f32 v[28:29], v[30:31], v[30:31] op_sel:[0,0] op_sel_hi:[0,1]
    v_pk_mul_f32 v[38:39], v[40:41], v[40:41] op_sel:[0,0] op_sel_hi:[0,1]
    v_pk_fma_f32 v[28:29], v[30:31], v[30:31], v[28:29] op_sel:[1,1,0] op_sel_hi:[0,1,1] neg_lo:[1,0,0]
    v_pk_fma_f32 v[38:39], v[40:41], v[40:41], v[38:39] op_sel:[1,1,0] op_sel_hi:[0,1,1] neg_lo:[1,0,0]
    v_cndmask_b32 v30, v30, v32, vcc
    v_cndmask_b32 v40, v40, v42, vcc
    v_cndmask_b32 v31, v31, v33, vcc
    v_cndmask_b32 v41, v41, v43, vcc
    v_cndmask_b32 v28, v21, v28, vcc
    v_cndmask_b32 v38, v21, v38, vcc
    v_cndmask_b32 v29, v22, v29, vcc
    v_cndmask_b32 v39, v22, v39, vcc
    v_pk_mul_f32 v[34:35], v[68:69], v[30:31] op_sel:[0,0] op_sel_hi:[1,0]
    v_pk_mul_f32 v[44:45], v[76:77], v[40:41] op_sel:[0,0] op_sel_hi:[1,0]
    v_pk_mul_f32 v[36:37], v[70:71], v[28:29] op_sel:[0,0] op_sel_hi:[1,0]
    v_pk_mul_f32 v[46:47], v[78:79], v[38:39] op_sel:[0,0] op_sel_hi:[1,0]
    v_pk_fma_f32 v[34:35], v[68:69], v[30:31], v[34:35] op_sel:[1,1,0] op_sel_hi:[0,1,1] neg_lo:[1,0,0]
    v_pk_fma_f32 v[44:45], v[76:77], v[40:41], v[44:45] op_sel:[1,1,0] op_sel_hi:[0,1,1] neg_lo:[1,0,0]
    v_pk_fma_f32 v[36:37], v[70:71], v[28:29], v[36:37] op_sel:[1,1,0] op_sel_hi:[0,1,1] neg_lo:[1,0,0]
    v_pk_fma_f32 v[46:47], v[78:79], v[38:39], v[46:47] op_sel:[1,1,0] op_sel_hi:[0,1,1] neg_lo:[1,0,0]
    v_cvt_pk_f16_f32 v12, v34, -v35
    v_cvt_pk_f16_f32 v13, v44, -v45
    v_cvt_pk_f16_f32 v16, v36, -v37
    v_cvt_pk_f16_f32 v17, v46, -v47
    ds_read_b128 v[64:67], v9 offset:768
    ds_read_b128 v[68:71], v23 offset:784
    ds_read_b128 v[72:75], v9 offset:816
    ds_read_b128 v[76:79], v23 offset:832
    s_waitcnt lgkmcnt(4)
    v_pk_mul_f32 v[36:37], v[80:81], v[20:21] op_sel:[0,0] op_sel_hi:[1,0]
    v_pk_mul_f32 v[46:47], v[88:89], v[20:21] op_sel:[0,0] op_sel_hi:[1,0]
    v_exp_f32 v36, v36
    v_exp_f32 v46, v46
    v_fract_f32 v37, v37
    v_fract_f32 v47, v47
    v_cos_f32 v28, v37
    v_cos_f32 v38, v47
    v_sin_f32 v29, v37
    v_sin_f32 v39, v47
    v_pk_mul_f32 v[28:29], v[28:29], v[36:37] op_sel:[0,0] op_sel_hi:[1,0]
    v_pk_mul_f32 v[38:39], v[38:39], v[46:47] op_sel:[0,0] op_sel_hi:[1,0]
    v_pk_mul_f32 v[30:31], v[28:29], v[28:29] op_sel:[0,0] op_sel_hi:[0,1]
    v_pk_mul_f32 v[40:41], v[38:39], v[38:39] op_sel:[0,0] op_sel_hi:[0,1]
    v_cvt_pk_f16_f32 v26, v28, v29
    v_cvt_pk_f16_f32 v27, v38, v39
    v_pk_fma_f32 v[30:31], v[28:29], v[28:29], v[30:31] op_sel:[1,1,0] op_sel_hi:[0,1,1] neg_lo:[1,0,0]
    v_pk_fma_f32 v[40:41], v[38:39], v[38:39], v[40:41] op_sel:[1,1,0] op_sel_hi:[0,1,1] neg_lo:[1,0,0]
    v_pk_mul_f32 v[28:29], v[30:31], v[30:31] op_sel:[0,0] op_sel_hi:[0,1]
    v_pk_mul_f32 v[38:39], v[40:41], v[40:41] op_sel:[0,0] op_sel_hi:[0,1]
    v_cvt_pk_f16_f32 v62, v30, v31
    v_cvt_pk_f16_f32 v63, v40, v41
    v_pk_fma_f32 v[28:29], v[30:31], v[30:31], v[28:29] op_sel:[1,1,0] op_sel_hi:[0,1,1] neg_lo:[1,0,0]
    v_pk_fma_f32 v[38:39], v[40:41], v[40:41], v[38:39] op_sel:[1,1,0] op_sel_hi:[0,1,1] neg_lo:[1,0,0]
    v_pk_mul_f32 v[30:31], v[28:29], v[28:29] op_sel:[0,0] op_sel_hi:[0,1]
    v_pk_mul_f32 v[40:41], v[38:39], v[38:39] op_sel:[0,0] op_sel_hi:[0,1]
    v_cvt_pk_f16_f32 v114, v28, v29
    v_cvt_pk_f16_f32 v115, v38, v39
    v_pk_fma_f32 v[30:31], v[28:29], v[28:29], v[30:31] op_sel:[1,1,0] op_sel_hi:[0,1,1] neg_lo:[1,0,0]
    v_pk_fma_f32 v[40:41], v[38:39], v[38:39], v[40:41] op_sel:[1,1,0] op_sel_hi:[0,1,1] neg_lo:[1,0,0]
    v_pk_mul_f32 v[28:29], v[30:31], v[30:31] op_sel:[0,0] op_sel_hi:[0,1]
    v_pk_mul_f32 v[38:39], v[40:41], v[40:41] op_sel:[0,0] op_sel_hi:[0,1]
    v_cvt_pk_f16_f32 v118, v30, v31
    v_cvt_pk_f16_f32 v119, v40, v41
    v_pk_fma_f32 v[28:29], v[30:31], v[30:31], v[28:29] op_sel:[1,1,0] op_sel_hi:[0,1,1] neg_lo:[1,0,0]
    v_pk_fma_f32 v[38:39], v[40:41], v[40:41], v[38:39] op_sel:[1,1,0] op_sel_hi:[0,1,1] neg_lo:[1,0,0]
    v_pk_mul_f32 v[32:33], v[28:29], v[28:29] op_sel:[0,0] op_sel_hi:[0,1]
    v_pk_mul_f32 v[42:43], v[38:39], v[38:39] op_sel:[0,0] op_sel_hi:[0,1]
    v_pk_mul_f32 v[34:35], v[82:83], v[28:29] op_sel:[0,0] op_sel_hi:[1,0]
    v_pk_mul_f32 v[44:45], v[90:91], v[38:39] op_sel:[0,0] op_sel_hi:[1,0]
    v_pk_fma_f32 v[32:33], v[28:29], v[28:29], v[32:33] op_sel:[1,1,0] op_sel_hi:[0,1,1] neg_lo:[1,0,0]
    v_pk_fma_f32 v[42:43], v[38:39], v[38:39], v[42:43] op_sel:[1,1,0] op_sel_hi:[0,1,1] neg_lo:[1,0,0]
    v_pk_fma_f32 v[34:35], v[82:83], v[28:29], v[34:35] op_sel:[1,1,0] op_sel_hi:[0,1,1] neg_lo:[1,0,0]
    v_pk_fma_f32 v[44:45], v[90:91], v[38:39], v[44:45] op_sel:[1,1,0] op_sel_hi:[0,1,1] neg_lo:[1,0,0]
    v_pk_mul_f32 v[30:31], v[32:33], v[32:33] op_sel:[0,0] op_sel_hi:[0,1]
    v_pk_mul_f32 v[40:41], v[42:43], v[42:43] op_sel:[0,0] op_sel_hi:[0,1]
    v_pk_fma_f32 v[30:31], v[32:33], v[32:33], v[30:31] op_sel:[1,1,0] op_sel_hi:[0,1,1] neg_lo:[1,0,0]
    v_pk_fma_f32 v[40:41], v[42:43], v[42:43], v[40:41] op_sel:[1,1,0] op_sel_hi:[0,1,1] neg_lo:[1,0,0]
    v_cvt_pk_f16_f32 v6, v34, -v35
    v_cvt_pk_f16_f32 v7, v44, -v45
    v_pk_mul_f32 v[28:29], v[30:31], v[30:31] op_sel:[0,0] op_sel_hi:[0,1]
    v_pk_mul_f32 v[38:39], v[40:41], v[40:41] op_sel:[0,0] op_sel_hi:[0,1]
    v_pk_fma_f32 v[28:29], v[30:31], v[30:31], v[28:29] op_sel:[1,1,0] op_sel_hi:[0,1,1] neg_lo:[1,0,0]
    v_pk_fma_f32 v[38:39], v[40:41], v[40:41], v[38:39] op_sel:[1,1,0] op_sel_hi:[0,1,1] neg_lo:[1,0,0]
    v_cndmask_b32 v30, v30, v32, vcc
    v_cndmask_b32 v40, v40, v42, vcc
    v_cndmask_b32 v31, v31, v33, vcc
    v_cndmask_b32 v41, v41, v43, vcc
    v_cndmask_b32 v28, v21, v28, vcc
    v_cndmask_b32 v38, v21, v38, vcc
    v_cndmask_b32 v29, v22, v29, vcc
    v_cndmask_b32 v39, v22, v39, vcc
    v_pk_mul_f32 v[34:35], v[84:85], v[30:31] op_sel:[0,0] op_sel_hi:[1,0]
    v_pk_mul_f32 v[44:45], v[92:93], v[40:41] op_sel:[0,0] op_sel_hi:[1,0]
    v_pk_mul_f32 v[36:37], v[86:87], v[28:29] op_sel:[0,0] op_sel_hi:[1,0]
    v_pk_mul_f32 v[46:47], v[94:95], v[38:39] op_sel:[0,0] op_sel_hi:[1,0]
    v_pk_fma_f32 v[34:35], v[84:85], v[30:31], v[34:35] op_sel:[1,1,0] op_sel_hi:[0,1,1] neg_lo:[1,0,0]
    v_pk_fma_f32 v[44:45], v[92:93], v[40:41], v[44:45] op_sel:[1,1,0] op_sel_hi:[0,1,1] neg_lo:[1,0,0]
    v_pk_fma_f32 v[36:37], v[86:87], v[28:29], v[36:37] op_sel:[1,1,0] op_sel_hi:[0,1,1] neg_lo:[1,0,0]
    v_pk_fma_f32 v[46:47], v[94:95], v[38:39], v[46:47] op_sel:[1,1,0] op_sel_hi:[0,1,1] neg_lo:[1,0,0]
    v_cvt_pk_f16_f32 v14, v34, -v35
    v_cvt_pk_f16_f32 v15, v44, -v45
    v_cvt_pk_f16_f32 v18, v36, -v37
    v_cvt_pk_f16_f32 v19, v46, -v47
    ds_read_b128 v[80:83], v9 offset:864
    ds_read_b128 v[84:87], v23 offset:880
    ds_read_b128 v[88:91], v9 offset:912
    ds_read_b128 v[92:95], v23 offset:928
    s_nop 1
    v_mfma_f32_16x16x32_f16 v[96:99], v[4:7], v[24:27], v[96:99]
    v_mfma_f32_16x16x32_f16 v[100:103], v[12:15], v[60:63], v[100:103]
    v_mfma_f32_16x16x32_f16 v[104:107], v[12:15], v[112:115], v[104:107]
    v_mfma_f32_16x16x32_f16 v[108:111], v[16:19], v[116:119], v[108:111]
    s_nop 3
    buffer_load_dword v127, v22, s[68:71], 0 offen sc1
    s_waitcnt lgkmcnt(4)
    v_pk_mul_f32 v[36:37], v[64:65], v[20:21] op_sel:[0,0] op_sel_hi:[1,0]
    v_pk_mul_f32 v[46:47], v[72:73], v[20:21] op_sel:[0,0] op_sel_hi:[1,0]
    v_exp_f32 v36, v36
    v_exp_f32 v46, v46
    v_fract_f32 v37, v37
    v_fract_f32 v47, v47
    v_cos_f32 v28, v37
    v_cos_f32 v38, v47
    v_sin_f32 v29, v37
    v_sin_f32 v39, v47
    v_pk_mul_f32 v[28:29], v[28:29], v[36:37] op_sel:[0,0] op_sel_hi:[1,0]
    v_pk_mul_f32 v[38:39], v[38:39], v[46:47] op_sel:[0,0] op_sel_hi:[1,0]
    v_pk_mul_f32 v[30:31], v[28:29], v[28:29] op_sel:[0,0] op_sel_hi:[0,1]
    v_pk_mul_f32 v[40:41], v[38:39], v[38:39] op_sel:[0,0] op_sel_hi:[0,1]
    v_cvt_pk_f16_f32 v24, v28, v29
    v_cvt_pk_f16_f32 v25, v38, v39
    v_pk_fma_f32 v[30:31], v[28:29], v[28:29], v[30:31] op_sel:[1,1,0] op_sel_hi:[0,1,1] neg_lo:[1,0,0]
    v_pk_fma_f32 v[40:41], v[38:39], v[38:39], v[40:41] op_sel:[1,1,0] op_sel_hi:[0,1,1] neg_lo:[1,0,0]
    v_pk_mul_f32 v[28:29], v[30:31], v[30:31] op_sel:[0,0] op_sel_hi:[0,1]
    v_pk_mul_f32 v[38:39], v[40:41], v[40:41] op_sel:[0,0] op_sel_hi:[0,1]
    v_cvt_pk_f16_f32 v60, v30, v31
    v_cvt_pk_f16_f32 v61, v40, v41
    v_pk_fma_f32 v[28:29], v[30:31], v[30:31], v[28:29] op_sel:[1,1,0] op_sel_hi:[0,1,1] neg_lo:[1,0,0]
    v_pk_fma_f32 v[38:39], v[40:41], v[40:41], v[38:39] op_sel:[1,1,0] op_sel_hi:[0,1,1] neg_lo:[1,0,0]
    v_pk_mul_f32 v[30:31], v[28:29], v[28:29] op_sel:[0,0] op_sel_hi:[0,1]
    v_pk_mul_f32 v[40:41], v[38:39], v[38:39] op_sel:[0,0] op_sel_hi:[0,1]
    v_cvt_pk_f16_f32 v112, v28, v29
    v_cvt_pk_f16_f32 v113, v38, v39
    v_pk_fma_f32 v[30:31], v[28:29], v[28:29], v[30:31] op_sel:[1,1,0] op_sel_hi:[0,1,1] neg_lo:[1,0,0]
    v_pk_fma_f32 v[40:41], v[38:39], v[38:39], v[40:41] op_sel:[1,1,0] op_sel_hi:[0,1,1] neg_lo:[1,0,0]
    v_pk_mul_f32 v[28:29], v[30:31], v[30:31] op_sel:[0,0] op_sel_hi:[0,1]
    v_pk_mul_f32 v[38:39], v[40:41], v[40:41] op_sel:[0,0] op_sel_hi:[0,1]
    v_cvt_pk_f16_f32 v116, v30, v31
    v_cvt_pk_f16_f32 v117, v40, v41
    v_pk_fma_f32 v[28:29], v[30:31], v[30:31], v[28:29] op_sel:[1,1,0] op_sel_hi:[0,1,1] neg_lo:[1,0,0]
    v_pk_fma_f32 v[38:39], v[40:41], v[40:41], v[38:39] op_sel:[1,1,0] op_sel_hi:[0,1,1] neg_lo:[1,0,0]
    v_pk_mul_f32 v[32:33], v[28:29], v[28:29] op_sel:[0,0] op_sel_hi:[0,1]
    v_pk_mul_f32 v[42:43], v[38:39], v[38:39] op_sel:[0,0] op_sel_hi:[0,1]
    v_pk_mul_f32 v[34:35], v[66:67], v[28:29] op_sel:[0,0] op_sel_hi:[1,0]
    v_pk_mul_f32 v[44:45], v[74:75], v[38:39] op_sel:[0,0] op_sel_hi:[1,0]
    v_pk_fma_f32 v[32:33], v[28:29], v[28:29], v[32:33] op_sel:[1,1,0] op_sel_hi:[0,1,1] neg_lo:[1,0,0]
    v_pk_fma_f32 v[42:43], v[38:39], v[38:39], v[42:43] op_sel:[1,1,0] op_sel_hi:[0,1,1] neg_lo:[1,0,0]
    v_pk_fma_f32 v[34:35], v[66:67], v[28:29], v[34:35] op_sel:[1,1,0] op_sel_hi:[0,1,1] neg_lo:[1,0,0]
    v_pk_fma_f32 v[44:45], v[74:75], v[38:39], v[44:45] op_sel:[1,1,0] op_sel_hi:[0,1,1] neg_lo:[1,0,0]
    v_pk_mul_f32 v[30:31], v[32:33], v[32:33] op_sel:[0,0] op_sel_hi:[0,1]
    v_pk_mul_f32 v[40:41], v[42:43], v[42:43] op_sel:[0,0] op_sel_hi:[0,1]
    v_pk_fma_f32 v[30:31], v[32:33], v[32:33], v[30:31] op_sel:[1,1,0] op_sel_hi:[0,1,1] neg_lo:[1,0,0]
    v_pk_fma_f32 v[40:41], v[42:43], v[42:43], v[40:41] op_sel:[1,1,0] op_sel_hi:[0,1,1] neg_lo:[1,0,0]
    v_cvt_pk_f16_f32 v4, v34, -v35
    v_cvt_pk_f16_f32 v5, v44, -v45
    v_pk_mul_f32 v[28:29], v[30:31], v[30:31] op_sel:[0,0] op_sel_hi:[0,1]
    v_pk_mul_f32 v[38:39], v[40:41], v[40:41] op_sel:[0,0] op_sel_hi:[0,1]
    v_pk_fma_f32 v[28:29], v[30:31], v[30:31], v[28:29] op_sel:[1,1,0] op_sel_hi:[0,1,1] neg_lo:[1,0,0]
    v_pk_fma_f32 v[38:39], v[40:41], v[40:41], v[38:39] op_sel:[1,1,0] op_sel_hi:[0,1,1] neg_lo:[1,0,0]
    v_cndmask_b32 v30, v30, v32, vcc
    v_cndmask_b32 v40, v40, v42, vcc
    v_cndmask_b32 v31, v31, v33, vcc
    v_cndmask_b32 v41, v41, v43, vcc
    v_cndmask_b32 v28, v21, v28, vcc
    v_cndmask_b32 v38, v21, v38, vcc
    v_cndmask_b32 v29, v22, v29, vcc
    v_cndmask_b32 v39, v22, v39, vcc
    v_pk_mul_f32 v[34:35], v[68:69], v[30:31] op_sel:[0,0] op_sel_hi:[1,0]
    v_pk_mul_f32 v[44:45], v[76:77], v[40:41] op_sel:[0,0] op_sel_hi:[1,0]
    v_pk_mul_f32 v[36:37], v[70:71], v[28:29] op_sel:[0,0] op_sel_hi:[1,0]
    v_pk_mul_f32 v[46:47], v[78:79], v[38:39] op_sel:[0,0] op_sel_hi:[1,0]
    v_pk_fma_f32 v[34:35], v[68:69], v[30:31], v[34:35] op_sel:[1,1,0] op_sel_hi:[0,1,1] neg_lo:[1,0,0]
    v_pk_fma_f32 v[44:45], v[76:77], v[40:41], v[44:45] op_sel:[1,1,0] op_sel_hi:[0,1,1] neg_lo:[1,0,0]
    v_pk_fma_f32 v[36:37], v[70:71], v[28:29], v[36:37] op_sel:[1,1,0] op_sel_hi:[0,1,1] neg_lo:[1,0,0]
    v_pk_fma_f32 v[46:47], v[78:79], v[38:39], v[46:47] op_sel:[1,1,0] op_sel_hi:[0,1,1] neg_lo:[1,0,0]
    v_cvt_pk_f16_f32 v12, v34, -v35
    v_cvt_pk_f16_f32 v13, v44, -v45
    v_cvt_pk_f16_f32 v16, v36, -v37
    v_cvt_pk_f16_f32 v17, v46, -v47
    s_waitcnt lgkmcnt(0)
    v_pk_mul_f32 v[36:37], v[80:81], v[20:21] op_sel:[0,0] op_sel_hi:[1,0]
    v_pk_mul_f32 v[46:47], v[88:89], v[20:21] op_sel:[0,0] op_sel_hi:[1,0]
    v_exp_f32 v36, v36
    v_exp_f32 v46, v46
    v_fract_f32 v37, v37
    v_fract_f32 v47, v47
    v_cos_f32 v28, v37
    v_cos_f32 v38, v47
    v_sin_f32 v29, v37
    v_sin_f32 v39, v47
    v_pk_mul_f32 v[28:29], v[28:29], v[36:37] op_sel:[0,0] op_sel_hi:[1,0]
    v_pk_mul_f32 v[38:39], v[38:39], v[46:47] op_sel:[0,0] op_sel_hi:[1,0]
    v_pk_mul_f32 v[30:31], v[28:29], v[28:29] op_sel:[0,0] op_sel_hi:[0,1]
    v_pk_mul_f32 v[40:41], v[38:39], v[38:39] op_sel:[0,0] op_sel_hi:[0,1]
    v_cvt_pk_f16_f32 v26, v28, v29
    v_cvt_pk_f16_f32 v27, v38, v39
    v_pk_fma_f32 v[30:31], v[28:29], v[28:29], v[30:31] op_sel:[1,1,0] op_sel_hi:[0,1,1] neg_lo:[1,0,0]
    v_pk_fma_f32 v[40:41], v[38:39], v[38:39], v[40:41] op_sel:[1,1,0] op_sel_hi:[0,1,1] neg_lo:[1,0,0]
    v_pk_mul_f32 v[28:29], v[30:31], v[30:31] op_sel:[0,0] op_sel_hi:[0,1]
    v_pk_mul_f32 v[38:39], v[40:41], v[40:41] op_sel:[0,0] op_sel_hi:[0,1]
    v_cvt_pk_f16_f32 v62, v30, v31
    v_cvt_pk_f16_f32 v63, v40, v41
    v_pk_fma_f32 v[28:29], v[30:31], v[30:31], v[28:29] op_sel:[1,1,0] op_sel_hi:[0,1,1] neg_lo:[1,0,0]
    v_pk_fma_f32 v[38:39], v[40:41], v[40:41], v[38:39] op_sel:[1,1,0] op_sel_hi:[0,1,1] neg_lo:[1,0,0]
    v_pk_mul_f32 v[30:31], v[28:29], v[28:29] op_sel:[0,0] op_sel_hi:[0,1]
    v_pk_mul_f32 v[40:41], v[38:39], v[38:39] op_sel:[0,0] op_sel_hi:[0,1]
    v_cvt_pk_f16_f32 v114, v28, v29
    v_cvt_pk_f16_f32 v115, v38, v39
    v_pk_fma_f32 v[30:31], v[28:29], v[28:29], v[30:31] op_sel:[1,1,0] op_sel_hi:[0,1,1] neg_lo:[1,0,0]
    v_pk_fma_f32 v[40:41], v[38:39], v[38:39], v[40:41] op_sel:[1,1,0] op_sel_hi:[0,1,1] neg_lo:[1,0,0]
    v_pk_mul_f32 v[28:29], v[30:31], v[30:31] op_sel:[0,0] op_sel_hi:[0,1]
    v_pk_mul_f32 v[38:39], v[40:41], v[40:41] op_sel:[0,0] op_sel_hi:[0,1]
    v_cvt_pk_f16_f32 v118, v30, v31
    v_cvt_pk_f16_f32 v119, v40, v41
    v_pk_fma_f32 v[28:29], v[30:31], v[30:31], v[28:29] op_sel:[1,1,0] op_sel_hi:[0,1,1] neg_lo:[1,0,0]
    v_pk_fma_f32 v[38:39], v[40:41], v[40:41], v[38:39] op_sel:[1,1,0] op_sel_hi:[0,1,1] neg_lo:[1,0,0]
    v_pk_mul_f32 v[32:33], v[28:29], v[28:29] op_sel:[0,0] op_sel_hi:[0,1]
    v_pk_mul_f32 v[42:43], v[38:39], v[38:39] op_sel:[0,0] op_sel_hi:[0,1]
    v_pk_mul_f32 v[34:35], v[82:83], v[28:29] op_sel:[0,0] op_sel_hi:[1,0]
    v_pk_mul_f32 v[44:45], v[90:91], v[38:39] op_sel:[0,0] op_sel_hi:[1,0]
    v_pk_fma_f32 v[32:33], v[28:29], v[28:29], v[32:33] op_sel:[1,1,0] op_sel_hi:[0,1,1] neg_lo:[1,0,0]
    v_pk_fma_f32 v[42:43], v[38:39], v[38:39], v[42:43] op_sel:[1,1,0] op_sel_hi:[0,1,1] neg_lo:[1,0,0]
    v_pk_fma_f32 v[34:35], v[82:83], v[28:29], v[34:35] op_sel:[1,1,0] op_sel_hi:[0,1,1] neg_lo:[1,0,0]
    v_pk_fma_f32 v[44:45], v[90:91], v[38:39], v[44:45] op_sel:[1,1,0] op_sel_hi:[0,1,1] neg_lo:[1,0,0]
    v_pk_mul_f32 v[30:31], v[32:33], v[32:33] op_sel:[0,0] op_sel_hi:[0,1]
    v_pk_mul_f32 v[40:41], v[42:43], v[42:43] op_sel:[0,0] op_sel_hi:[0,1]
    v_pk_fma_f32 v[30:31], v[32:33], v[32:33], v[30:31] op_sel:[1,1,0] op_sel_hi:[0,1,1] neg_lo:[1,0,0]
    v_pk_fma_f32 v[40:41], v[42:43], v[42:43], v[40:41] op_sel:[1,1,0] op_sel_hi:[0,1,1] neg_lo:[1,0,0]
    v_cvt_pk_f16_f32 v6, v34, -v35
    v_cvt_pk_f16_f32 v7, v44, -v45
    v_pk_mul_f32 v[28:29], v[30:31], v[30:31] op_sel:[0,0] op_sel_hi:[0,1]
    v_pk_mul_f32 v[38:39], v[40:41], v[40:41] op_sel:[0,0] op_sel_hi:[0,1]
    v_pk_fma_f32 v[28:29], v[30:31], v[30:31], v[28:29] op_sel:[1,1,0] op_sel_hi:[0,1,1] neg_lo:[1,0,0]
    v_pk_fma_f32 v[38:39], v[40:41], v[40:41], v[38:39] op_sel:[1,1,0] op_sel_hi:[0,1,1] neg_lo:[1,0,0]
    v_cndmask_b32 v30, v30, v32, vcc
    v_cndmask_b32 v40, v40, v42, vcc
    v_cndmask_b32 v31, v31, v33, vcc
    v_cndmask_b32 v41, v41, v43, vcc
    v_cndmask_b32 v28, v21, v28, vcc
    v_cndmask_b32 v38, v21, v38, vcc
    v_cndmask_b32 v29, v22, v29, vcc
    v_cndmask_b32 v39, v22, v39, vcc
    v_pk_mul_f32 v[34:35], v[84:85], v[30:31] op_sel:[0,0] op_sel_hi:[1,0]
    v_pk_mul_f32 v[44:45], v[92:93], v[40:41] op_sel:[0,0] op_sel_hi:[1,0]
    v_pk_mul_f32 v[36:37], v[86:87], v[28:29] op_sel:[0,0] op_sel_hi:[1,0]
    v_pk_mul_f32 v[46:47], v[94:95], v[38:39] op_sel:[0,0] op_sel_hi:[1,0]
    v_pk_fma_f32 v[34:35], v[84:85], v[30:31], v[34:35] op_sel:[1,1,0] op_sel_hi:[0,1,1] neg_lo:[1,0,0]
    v_pk_fma_f32 v[44:45], v[92:93], v[40:41], v[44:45] op_sel:[1,1,0] op_sel_hi:[0,1,1] neg_lo:[1,0,0]
    v_pk_fma_f32 v[36:37], v[86:87], v[28:29], v[36:37] op_sel:[1,1,0] op_sel_hi:[0,1,1] neg_lo:[1,0,0]
    v_pk_fma_f32 v[46:47], v[94:95], v[38:39], v[46:47] op_sel:[1,1,0] op_sel_hi:[0,1,1] neg_lo:[1,0,0]
    v_cvt_pk_f16_f32 v14, v34, -v35
    v_cvt_pk_f16_f32 v15, v44, -v45
    v_cvt_pk_f16_f32 v18, v36, -v37
    v_cvt_pk_f16_f32 v19, v46, -v47
    s_nop 1
    v_mfma_f32_16x16x32_f16 v[96:99], v[4:7], v[24:27], v[96:99]
    v_mfma_f32_16x16x32_f16 v[100:103], v[12:15], v[60:63], v[100:103]
    v_mfma_f32_16x16x32_f16 v[104:107], v[12:15], v[112:115], v[104:107]
    v_mfma_f32_16x16x32_f16 v[108:111], v[16:19], v[116:119], v[108:111]
    s_nop 3
    v_and_b32 v28, 63, v0
    v_cmp_gt_u32 vcc, 32, v28
    v_lshrrev_b32 v29, 6, v0
    v_mul_u32_u24 v29, 3072, v29
    v_bfe_u32 v30, v0, 4, 2
    v_lshl_add_u32 v29, v30, 8, v29
    v_and_b32 v30, 15, v0
    v_lshl_add_u32 v29, v30, 2, v29
    v_lshlrev_b32 v31, 2, v0
    v_lshrrev_b32 v59, 1, v0
    v_mul_u32_u24 v59, 20480, v59
    v_and_b32 v30, 1, v0
    v_lshl_add_u32 v59, v30, 4, v59
    s_lshl_b32 s29, s2, 5
    s_waitcnt vmcnt(0)
    v_readfirstlane_b32 s78, v127
    buffer_load_dword v11, v56, s[72:75], 0 offen offset:4 sc1
    s_nop 4
    v_cndmask_b32 v100, v104, v100, vcc
    v_cndmask_b32 v101, v105, v101, vcc
    v_cndmask_b32 v102, v106, v102, vcc
    v_cndmask_b32 v103, v107, v103, vcc
    ds_write_b32 v29, v96 offset:6144
    ds_write_b32 v29, v100 offset:7168
    ds_write_b32 v29, v108 offset:8192
    ds_write_b32 v29, v97 offset:6208
    ds_write_b32 v29, v101 offset:7232
    ds_write_b32 v29, v109 offset:8256
    ds_write_b32 v29, v98 offset:6272
    ds_write_b32 v29, v102 offset:7296
    ds_write_b32 v29, v110 offset:8320
    ds_write_b32 v29, v99 offset:6336
    ds_write_b32 v29, v103 offset:7360
    ds_write_b32 v29, v111 offset:8384
    s_waitcnt lgkmcnt(0)
    s_barrier
    ds_read_b32 v32, v31 offset:6144
    ds_read_b32 v33, v31 offset:9216
    ds_read_b32 v34, v31 offset:12288
    ds_read_b32 v35, v31 offset:15360
    ds_read_b32 v36, v31 offset:7168
    ds_read_b32 v37, v31 offset:10240
    ds_read_b32 v38, v31 offset:13312
    ds_read_b32 v39, v31 offset:16384
    ds_read_b32 v40, v31 offset:8192
    ds_read_b32 v41, v31 offset:11264
    ds_read_b32 v42, v31 offset:14336
    ds_read_b32 v43, v31 offset:17408
    s_waitcnt lgkmcnt(0)
    v_add_f32 v32, v32, v33
    v_add_f32 v34, v34, v35
    v_add_f32 v36, v36, v37
    v_add_f32 v38, v38, v39
    v_add_f32 v40, v40, v41
    v_add_f32 v42, v42, v43
    v_add_f32 v32, v32, v34
    v_add_f32 v36, v36, v38
    v_add_f32 v40, v40, v42
    v_mul_f32 v32, 0x3a800000, v32
    ds_write_b32 v31, v32 offset:37856
    v_mul_f32 v36, 0x3a800000, v36
    ds_write_b32 v31, v36 offset:38880
    v_mul_f32 v40, 0x3a800000, v40
    ds_write_b32 v31, v40 offset:39904
    v_and_b32 v25, 15, v0
    v_bfe_u32 v26, v0, 4, 2
    v_lshrrev_b32 v24, 3, v25
    v_sub_u32 v24, v26, v24
    v_lshlrev_b32 v15, 4, v24
    v_sub_u32 v24, 7, v25
    v_and_b32 v24, 7, v24
    v_mul_u32_u24 v24, 4160, v24
    v_add_u32 v15, v15, v24
    s_lshl_b32 s31, s7, 6
    s_sub_u32 s35, 208, s31
    v_add_u32 v15, s35, v15
    v_mov_b32 v16, 0
    v_mov_b32 v17, 0
    v_mov_b32 v18, 0
    v_mov_b32 v19, 0
    v_mul_u32_u24 v24, 4160, v0
    v_cmp_gt_u32 vcc, 8, v0
    s_waitcnt vmcnt(0)
    v_cmp_eq_u32 s[76:77], 0, v11
    s_cmp_eq_u32 s78, 1
    s_cselect_b64 s[76:77], s[76:77], -1
    s_cmp_eq_u64 s[76:77], 0
    s_cselect_b32 s82, 1, 0
    s_cbranch_scc0 pc_kernel_nx1
    buffer_load_dwordx4 v[64:67], v57, s[72:75], 0 offen offset:0 sc1
    buffer_load_dwordx4 v[68:71], v57, s[72:75], 0 offen offset:16 sc1
    buffer_load_dwordx4 v[72:75], v57, s[72:75], 0 offen offset:32 sc1
    buffer_load_dwordx4 v[76:79], v57, s[72:75], 0 offen offset:48 sc1
    buffer_load_dwordx4 v[4:7], v59, s[16:19], s29 offen sc1
pc_kernel_nx1:
    s_waitcnt lgkmcnt(0)
    s_barrier
    s_and_saveexec_b64 s[32:33], vcc
    ds_write_b128 v24, v[16:19] offset:4096
    s_mov_b64 exec, s[32:33]
    ds_read_b32 v32, v48 offset:4576
    ds_read_b32 v33, v49 offset:4576
    ds_read_b32 v34, v50 offset:4576
    ds_read_b32 v35, v51 offset:4576
    ds_read_b32 v36, v52 offset:4576
    ds_read_b32 v37, v53 offset:4576
    ds_read_b32 v38, v54 offset:4576
    ds_read_b32 v39, v55 offset:4576
    ds_read_b32 v40, v120 offset:4576
    ds_read_b32 v41, v121 offset:4576
    ds_read_b32 v42, v122 offset:4576
    ds_read_b32 v43, v123 offset:4576
    ds_read_b32 v44, v124 offset:4576
    ds_read_b32 v45, v125 offset:4576
    ds_read_b32 v46, v126 offset:4576
    s_setprio 0
    v_lshlrev_b32 v1, 5, v25
    v_lshl_add_u32 v1, v26, 4, v1
    s_sub_u32 s35, 33472, s31
    v_add_u32 v1, s35, v1
    v_mul_u32_u24 v2, 80, v25
    v_lshl_add_u32 v2, v26, 4, v2
    s_mul_i32 s35, s7, 10240
    v_add_u32 v2, s35, v2
    s_mov_b32 s3, s2
    s_mov_b32 s44, s80
    s_movk_i32 s26, 0x3f80
    s_mov_b32 s27, 0x3f800000
    s_lshl_b32 s28, s3, 6
    s_waitcnt lgkmcnt(7)
    v_cvt_pk_bf16_f32 v96, v32, v33
    v_cvt_pk_bf16_f32 v97, v34, v35
    v_cvt_pk_bf16_f32 v98, v36, v37
    v_cvt_pk_bf16_f32 v99, v38, v39
    ds_write_b128 v58, v[96:99] offset:0
    s_waitcnt lgkmcnt(1)
    v_cvt_pk_bf16_f32 v108, v33, v34
    v_cvt_pk_bf16_f32 v109, v35, v36
    v_cvt_pk_bf16_f32 v110, v37, v38
    v_cvt_pk_bf16_f32 v111, v39, v40
    ds_write_b128 v58, v[108:111] offset:4160
    v_cvt_pk_bf16_f32 v102, v34, v35
    v_cvt_pk_bf16_f32 v103, v36, v37
    v_cvt_pk_bf16_f32 v104, v38, v39
    v_cvt_pk_bf16_f32 v105, v40, v41
    ds_write_b128 v58, v[102:105] offset:8320
    v_cvt_pk_bf16_f32 v114, v35, v36
    v_cvt_pk_bf16_f32 v115, v37, v38
    v_cvt_pk_bf16_f32 v116, v39, v40
    v_cvt_pk_bf16_f32 v117, v41, v42
    ds_write_b128 v58, v[114:117] offset:12480
    v_cvt_pk_bf16_f32 v100, v40, v41
    v_cvt_pk_bf16_f32 v101, v42, v43
    ds_write_b128 v58, v[98:101] offset:16640
    v_cvt_pk_bf16_f32 v112, v41, v42
    v_cvt_pk_bf16_f32 v113, v43, v44
    ds_write_b128 v58, v[110:113] offset:20800
    v_cvt_pk_bf16_f32 v106, v42, v43
    v_cvt_pk_bf16_f32 v107, v44, v45
    ds_write_b128 v58, v[104:107] offset:24960
    v_cvt_pk_bf16_f32 v118, v43, v44
    v_cvt_pk_bf16_f32 v119, v45, v46
    ds_write_b128 v58, v[116:119] offset:29120
    s_cmp_eq_u32 s82, 1
    s_cbranch_scc1 pc_kernel_hx2
    s_mov_b32 s81, 0
pc_kernel_al6:
    s_cmp_eq_u32 s78, 1
    s_cbranch_scc1 pc_kernel_ad7
    buffer_load_dword v80, v22, s[68:71], 0 offen sc1
    s_waitcnt vmcnt(0)
    v_readfirstlane_b32 s78, v80
    s_add_u32 s81, s81, 1
    s_cmp_lt_u32 s81, 0x80000
    s_cbranch_scc1 pc_kernel_al6
pc_kernel_ad7:
pc_kernel_rx3:
    buffer_load_dword v11, v56, s[72:75], 0 offen offset:4 sc1
    s_waitcnt vmcnt(0)
    v_cmp_eq_u32 s[76:77], 0, v11
    s_cmp_eq_u32 s78, 1
    s_cselect_b64 s[76:77], s[76:77], -1
    s_cmp_eq_u64 s[76:77], 0
    s_cbranch_scc1 pc_kernel_gx4
    s_sleep 6
    s_add_u32 s82, s82, 1
    s_cmp_lt_u32 s82, 0x40000
    s_cbranch_scc1 pc_kernel_rx3
pc_kernel_gx4:
    buffer_load_dwordx4 v[64:67], v57, s[72:75], 0 offen offset:0 sc1
    buffer_load_dwordx4 v[68:71], v57, s[72:75], 0 offen offset:16 sc1
    buffer_load_dwordx4 v[72:75], v57, s[72:75], 0 offen offset:32 sc1
    buffer_load_dwordx4 v[76:79], v57, s[72:75], 0 offen offset:48 sc1
    buffer_load_dwordx4 v[4:7], v59, s[16:19], s29 offen sc1
pc_kernel_gy5:
    s_waitcnt vmcnt(0)
pc_kernel_hx2:
    s_waitcnt vmcnt(0)
    v_min3_u32 v80, v65, v67, v69
    v_min3_u32 v81, v71, v73, v75
    v_min3_u32 v80, v80, v77, v79
    v_min_u32 v80, v80, v81
    v_cmp_eq_u32 vcc, 0, v80
    s_add_u32 s82, s82, 0x100
    s_cmp_lt_u32 s82, 0x40000
    s_cselect_b64 vcc, vcc, 0
    s_cbranch_vccnz pc_kernel_gx4
    v_dot2_f32_bf16 v80, v4, s26, v64
    v_dot2_f32_bf16 v81, v4, s27, v66
    v_dot2_f32_bf16 v82, v5, s26, v68
    v_dot2_f32_bf16 v83, v5, s27, v70
    v_dot2_f32_bf16 v84, v6, s26, v72
    v_dot2_f32_bf16 v85, v6, s27, v74
    v_dot2_f32_bf16 v86, v7, s26, v76
    v_dot2_f32_bf16 v87, v7, s27, v78
    v_cvt_pk_bf16_f32 v8, v80, v81
    v_cvt_pk_bf16_f32 v9, v82, v83
    v_cvt_pk_bf16_f32 v10, v84, v85
    v_cvt_pk_bf16_f32 v11, v86, v87
    v_lshlrev_b32 v80, 16, v8
    v_and_b32 v81, 0xffff0000, v8
    v_lshlrev_b32 v82, 16, v9
    v_and_b32 v83, 0xffff0000, v9
    v_lshlrev_b32 v84, 16, v10
    v_and_b32 v85, 0xffff0000, v10
    v_lshlrev_b32 v86, 16, v11
    v_and_b32 v87, 0xffff0000, v11
    v_mul_f32 v80, v80, v65
    v_mul_f32 v81, v81, v67
    v_mul_f32 v82, v82, v69
    v_mul_f32 v83, v83, v71
    v_mul_f32 v84, v84, v73
    v_mul_f32 v85, v85, v75
    v_mul_f32 v86, v86, v77
    v_mul_f32 v87, v87, v79
    v_cvt_pk_bf16_f32 v8, v80, v81
    v_cvt_pk_bf16_f32 v9, v82, v83
    v_cvt_pk_bf16_f32 v10, v84, v85
    v_cvt_pk_bf16_f32 v11, v86, v87
    ds_write_b128 v58, v[8:11] offset:33760
    buffer_store_dwordx4 v[96:99], v58, s[64:67], s8 offen sc0 sc1
    s_lshl_b32 s34, s2, 12
    s_add_u32 s36, s42, 0x1180000
    s_addc_u32 s37, s43, 0
    s_mov_b32 s38, 0x280000
    s_mov_b32 s39, 0x00020000
    v_mov_b32 v20, -1
    v_mov_b32 v21, -1
    v_mov_b32 v22, -1
    v_mov_b32 v23, -1
    buffer_store_dwordx4 v[20:23], v58, s[36:39], s34 offen sc0 sc1
    s_cmp_ge_u32 s2, 56
    s_cbranch_scc1 pc_kernel_ka8
    s_lshl_b32 s34, s2, 12
    v_mov_b32 v20, -1
    v_mov_b32 v21, -1
    v_mov_b32 v22, -1
    v_mov_b32 v23, -1
    s_mov_b32 s35, 0x1400000
    s_mov_b32 s33, 0x1418000
    s_cmp_lt_u32 s2, 40
    s_cselect_b32 s35, s35, s33
    s_add_u32 s34, s34, s35
    s_mov_b32 s36, s42
    s_mov_b32 s37, s43
    s_mov_b32 s38, 0x1780000
    s_mov_b32 s39, 0x00020000
    buffer_store_dwordx4 v[20:23], v58, s[36:39], s34 offen sc0 sc1
pc_kernel_ka8:
    s_waitcnt expcnt(0) lgkmcnt(0)
    s_barrier
    ds_read_b128 v[16:19], v15 offset:0
    ds_read_b128 v[32:35], v1 offset:0
    ds_read_b128 v[20:23], v15 offset:256
    ds_read_b128 v[36:39], v1 offset:256
    ds_read_b128 v[24:27], v15 offset:512
    ds_read_b128 v[40:43], v1 offset:512
    ds_read_b128 v[44:47], v1 offset:768
    ds_read_b128 v[48:51], v1 offset:1024
    ds_read_b128 v[52:55], v1 offset:1280
    s_waitcnt lgkmcnt(7)
    v_mfma_f32_16x16x32_bf16 v[124:127], v[16:19], v[32:35], 0
    ds_read_b128 v[28:31], v15 offset:768
    ds_read_b128 v[56:59], v1 offset:1536
    s_waitcnt lgkmcnt(7)
    v_mfma_f32_16x16x32_bf16 v[124:127], v[20:23], v[36:39], v[124:127]
    ds_read_b128 v[16:19], v15 offset:1024
    ds_read_b128 v[60:63], v1 offset:1792
    s_waitcnt lgkmcnt(7)
    v_mfma_f32_16x16x32_bf16 v[120:123], v[24:27], v[32:35], 0
    ds_read_b128 v[20:23], v15 offset:1280
    ds_read_b128 v[64:67], v1 offset:2048
    v_mfma_f32_16x16x32_bf16 v[124:127], v[24:27], v[40:43], v[124:127]
    s_waitcnt lgkmcnt(5)
    v_mfma_f32_16x16x32_bf16 v[120:123], v[28:31], v[36:39], v[120:123]
    ds_read_b128 v[24:27], v15 offset:1536
    ds_read_b128 v[68:71], v1 offset:2304
    v_mfma_f32_16x16x32_bf16 v[124:127], v[28:31], v[44:47], v[124:127]
    s_waitcnt lgkmcnt(5)
    v_mfma_f32_16x16x32_bf16 v[116:119], v[16:19], v[32:35], 0
    ds_read_b128 v[28:31], v15 offset:1792
    ds_read_b128 v[72:75], v1 offset:2560
    v_mfma_f32_16x16x32_bf16 v[120:123], v[16:19], v[40:43], v[120:123]
    v_mfma_f32_16x16x32_bf16 v[124:127], v[16:19], v[48:51], v[124:127]
    s_waitcnt lgkmcnt(5)
    v_mfma_f32_16x16x32_bf16 v[116:119], v[20:23], v[36:39], v[116:119]
    ds_read_b128 v[16:19], v15 offset:2048
    ds_read_b128 v[76:79], v1 offset:2816
    v_mfma_f32_16x16x32_bf16 v[120:123], v[20:23], v[44:47], v[120:123]
    v_mfma_f32_16x16x32_bf16 v[124:127], v[20:23], v[52:55], v[124:127]
    s_waitcnt lgkmcnt(5)
    v_mfma_f32_16x16x32_bf16 v[112:115], v[24:27], v[32:35], 0
    ds_read_b128 v[20:23], v15 offset:2304
    ds_read_b128 v[80:83], v1 offset:3072
    v_mfma_f32_16x16x32_bf16 v[116:119], v[24:27], v[40:43], v[116:119]
    v_mfma_f32_16x16x32_bf16 v[120:123], v[24:27], v[48:51], v[120:123]
    v_mfma_f32_16x16x32_bf16 v[124:127], v[24:27], v[56:59], v[124:127]
    s_waitcnt lgkmcnt(5)
    v_mfma_f32_16x16x32_bf16 v[112:115], v[28:31], v[36:39], v[112:115]
    ds_read_b128 v[24:27], v15 offset:2560
    ds_read_b128 v[84:87], v1 offset:3328
    v_mfma_f32_16x16x32_bf16 v[116:119], v[28:31], v[44:47], v[116:119]
    v_mfma_f32_16x16x32_bf16 v[120:123], v[28:31], v[52:55], v[120:123]
    v_mfma_f32_16x16x32_bf16 v[124:127], v[28:31], v[60:63], v[124:127]
    s_waitcnt lgkmcnt(5)
    v_mfma_f32_16x16x32_bf16 v[108:111], v[16:19], v[32:35], 0
    ds_read_b128 v[28:31], v15 offset:2816
    ds_read_b128 v[88:91], v1 offset:3584
    v_mfma_f32_16x16x32_bf16 v[112:115], v[16:19], v[40:43], v[112:115]
    v_mfma_f32_16x16x32_bf16 v[116:119], v[16:19], v[48:51], v[116:119]
    v_mfma_f32_16x16x32_bf16 v[120:123], v[16:19], v[56:59], v[120:123]
    v_mfma_f32_16x16x32_bf16 v[124:127], v[16:19], v[64:67], v[124:127]
    s_waitcnt lgkmcnt(5)
    v_mfma_f32_16x16x32_bf16 v[108:111], v[20:23], v[36:39], v[108:111]
    ds_read_b128 v[16:19], v15 offset:3072
    ds_read_b128 v[92:95], v1 offset:3840
    v_mfma_f32_16x16x32_bf16 v[112:115], v[20:23], v[44:47], v[112:115]
    v_mfma_f32_16x16x32_bf16 v[116:119], v[20:23], v[52:55], v[116:119]
    v_mfma_f32_16x16x32_bf16 v[120:123], v[20:23], v[60:63], v[120:123]
    v_mfma_f32_16x16x32_bf16 v[124:127], v[20:23], v[68:71], v[124:127]
    s_waitcnt lgkmcnt(5)
    v_mfma_f32_16x16x32_bf16 v[104:107], v[24:27], v[32:35], 0
    ds_read_b128 v[20:23], v15 offset:3328
    v_mfma_f32_16x16x32_bf16 v[108:111], v[24:27], v[40:43], v[108:111]
    v_mfma_f32_16x16x32_bf16 v[112:115], v[24:27], v[48:51], v[112:115]
    v_mfma_f32_16x16x32_bf16 v[116:119], v[24:27], v[56:59], v[116:119]
    v_mfma_f32_16x16x32_bf16 v[120:123], v[24:27], v[64:67], v[120:123]
    v_mfma_f32_16x16x32_bf16 v[124:127], v[24:27], v[72:75], v[124:127]
    s_waitcnt lgkmcnt(4)
    v_mfma_f32_16x16x32_bf16 v[104:107], v[28:31], v[36:39], v[104:107]
    ds_read_b128 v[24:27], v15 offset:3584
    v_mfma_f32_16x16x32_bf16 v[108:111], v[28:31], v[44:47], v[108:111]
    v_mfma_f32_16x16x32_bf16 v[112:115], v[28:31], v[52:55], v[112:115]
    v_mfma_f32_16x16x32_bf16 v[116:119], v[28:31], v[60:63], v[116:119]
    v_mfma_f32_16x16x32_bf16 v[120:123], v[28:31], v[68:71], v[120:123]
    v_mfma_f32_16x16x32_bf16 v[124:127], v[28:31], v[76:79], v[124:127]
    s_waitcnt lgkmcnt(3)
    v_mfma_f32_16x16x32_bf16 v[100:103], v[16:19], v[32:35], 0
    ds_read_b128 v[28:31], v15 offset:3840
    v_mfma_f32_16x16x32_bf16 v[104:107], v[16:19], v[40:43], v[104:107]
    v_mfma_f32_16x16x32_bf16 v[108:111], v[16:19], v[48:51], v[108:111]
    v_mfma_f32_16x16x32_bf16 v[112:115], v[16:19], v[56:59], v[112:115]
    v_mfma_f32_16x16x32_bf16 v[116:119], v[16:19], v[64:67], v[116:119]
    v_mfma_f32_16x16x32_bf16 v[120:123], v[16:19], v[72:75], v[120:123]
    v_mfma_f32_16x16x32_bf16 v[124:127], v[16:19], v[80:83], v[124:127]
    s_waitcnt lgkmcnt(2)
    v_mfma_f32_16x16x32_bf16 v[100:103], v[20:23], v[36:39], v[100:103]
    v_mfma_f32_16x16x32_bf16 v[104:107], v[20:23], v[44:47], v[104:107]
    v_mfma_f32_16x16x32_bf16 v[108:111], v[20:23], v[52:55], v[108:111]
    v_mfma_f32_16x16x32_bf16 v[112:115], v[20:23], v[60:63], v[112:115]
    v_mfma_f32_16x16x32_bf16 v[116:119], v[20:23], v[68:71], v[116:119]
    v_mfma_f32_16x16x32_bf16 v[120:123], v[20:23], v[76:79], v[120:123]
    v_mfma_f32_16x16x32_bf16 v[124:127], v[20:23], v[84:87], v[124:127]
    s_waitcnt lgkmcnt(1)
    v_mfma_f32_16x16x32_bf16 v[96:99], v[24:27], v[32:35], 0
    v_mfma_f32_16x16x32_bf16 v[100:103], v[24:27], v[40:43], v[100:103]
    v_mfma_f32_16x16x32_bf16 v[104:107], v[24:27], v[48:51], v[104:107]
    v_mfma_f32_16x16x32_bf16 v[108:111], v[24:27], v[56:59], v[108:111]
    v_mfma_f32_16x16x32_bf16 v[112:115], v[24:27], v[64:67], v[112:115]
    v_mfma_f32_16x16x32_bf16 v[116:119], v[24:27], v[72:75], v[116:119]
    v_mfma_f32_16x16x32_bf16 v[120:123], v[24:27], v[80:83], v[120:123]
    v_mfma_f32_16x16x32_bf16 v[124:127], v[24:27], v[88:91], v[124:127]
    s_waitcnt lgkmcnt(0)
    v_mfma_f32_16x16x32_bf16 v[96:99], v[28:31], v[36:39], v[96:99]
    v_mfma_f32_16x16x32_bf16 v[100:103], v[28:31], v[44:47], v[100:103]
    v_mfma_f32_16x16x32_bf16 v[104:107], v[28:31], v[52:55], v[104:107]
    v_mfma_f32_16x16x32_bf16 v[108:111], v[28:31], v[60:63], v[108:111]
    v_mfma_f32_16x16x32_bf16 v[112:115], v[28:31], v[68:71], v[112:115]
    v_mfma_f32_16x16x32_bf16 v[116:119], v[28:31], v[76:79], v[116:119]
    v_mfma_f32_16x16x32_bf16 v[120:123], v[28:31], v[84:87], v[120:123]
    v_mfma_f32_16x16x32_bf16 v[124:127], v[28:31], v[92:95], v[124:127]
    s_barrier
    s_nop 7
    ds_write_b128 v2, v[96:99] offset:0
    ds_write_b128 v2, v[100:103] offset:1280
    ds_write_b128 v2, v[104:107] offset:2560
    ds_write_b128 v2, v[108:111] offset:3840
    ds_write_b128 v2, v[112:115] offset:5120
    ds_write_b128 v2, v[116:119] offset:6400
    ds_write_b128 v2, v[120:123] offset:7680
    ds_write_b128 v2, v[124:127] offset:8960
    v_lshrrev_b32 v30, 1, v0
    v_mul_u32_u24 v30, 80, v30
    v_and_b32 v31, 1, v0
    v_lshl_add_u32 v30, v31, 5, v30
    v_lshrrev_b32 v28, 2, v0
    v_mul_u32_u24 v28, 40960, v28
    v_and_b32 v31, 3, v0
    v_lshl_add_u32 v28, v31, 4, v28
    s_lshr_b32 s45, s44, 16
    s_and_b32 s44, s44, 0xffff
    s_bitcmp1_b32 s3, 0
    s_cselect_b32 s44, s45, s44
    s_lshl_b32 s45, s44, 16
    v_dot2_f32_bf16 v72, v8, s44, 0
    v_dot2_f32_bf16 v73, v8, s45, 0
    v_dot2_f32_bf16 v74, v9, s44, 0
    v_dot2_f32_bf16 v75, v9, s45, 0
    v_dot2_f32_bf16 v76, v10, s44, 0
    v_dot2_f32_bf16 v77, v10, s45, 0
    v_dot2_f32_bf16 v78, v11, s44, 0
    v_dot2_f32_bf16 v79, v11, s45, 0
    v_lshlrev_b32 v64, 16, v4
    v_and_b32 v65, 0xffff0000, v4
    v_lshlrev_b32 v66, 16, v5
    v_and_b32 v67, 0xffff0000, v5
    v_lshlrev_b32 v68, 16, v6
    v_and_b32 v69, 0xffff0000, v6
    v_lshlrev_b32 v70, 16, v7
    v_and_b32 v71, 0xffff0000, v7
    v_cvt_pk_bf16_f32 v8, v72, v73
    v_cvt_pk_bf16_f32 v9, v74, v75
    v_cvt_pk_bf16_f32 v10, v76, v77
    v_cvt_pk_bf16_f32 v11, v78, v79
    v_lshlrev_b32 v72, 16, v8
    v_and_b32 v73, 0xffff0000, v8
    v_lshlrev_b32 v74, 16, v9
    v_and_b32 v75, 0xffff0000, v9
    v_lshlrev_b32 v76, 16, v10
    v_and_b32 v77, 0xffff0000, v10
    v_lshlrev_b32 v78, 16, v11
    v_and_b32 v79, 0xffff0000, v11
    s_waitcnt lgkmcnt(0)
    s_barrier
    ds_read_b128 v[32:35], v30 offset:0
    ds_read_b128 v[36:39], v30 offset:16
    ds_read_b128 v[40:43], v30 offset:10240
    ds_read_b128 v[44:47], v30 offset:10256
    ds_read_b128 v[48:51], v30 offset:20480
    ds_read_b128 v[52:55], v30 offset:20496
    ds_read_b128 v[56:59], v30 offset:30720
    ds_read_b128 v[60:63], v30 offset:30736
    s_waitcnt lgkmcnt(4)
    v_pk_add_f32 v[32:33], v[32:33], v[40:41]
    v_pk_add_f32 v[34:35], v[34:35], v[42:43]
    v_pk_add_f32 v[36:37], v[36:37], v[44:45]
    v_pk_add_f32 v[38:39], v[38:39], v[46:47]
    s_waitcnt lgkmcnt(0)
    v_pk_add_f32 v[48:49], v[48:49], v[56:57]
    v_pk_add_f32 v[50:51], v[50:51], v[58:59]
    v_pk_add_f32 v[52:53], v[52:53], v[60:61]
    v_pk_add_f32 v[54:55], v[54:55], v[62:63]
    v_pk_add_f32 v[32:33], v[32:33], v[48:49]
    v_pk_add_f32 v[34:35], v[34:35], v[50:51]
    v_pk_add_f32 v[36:37], v[36:37], v[52:53]
    v_pk_add_f32 v[38:39], v[38:39], v[54:55]
    v_cvt_pk_bf16_f32 v40, v32, v33
    v_cvt_pk_bf16_f32 v41, v34, v35
    v_cvt_pk_bf16_f32 v42, v36, v37
    v_cvt_pk_bf16_f32 v43, v38, v39
    v_dot2_f32_bf16 v32, v40, s26, v72
    v_dot2_f32_bf16 v33, v40, s27, v73
    v_dot2_f32_bf16 v34, v41, s26, v74
    v_dot2_f32_bf16 v35, v41, s27, v75
    v_dot2_f32_bf16 v36, v42, s26, v76
    v_dot2_f32_bf16 v37, v42, s27, v77
    v_dot2_f32_bf16 v38, v43, s26, v78
    v_dot2_f32_bf16 v39, v43, s27, v79
    v_cvt_pk_bf16_f32 v40, v32, v33
    v_cvt_pk_bf16_f32 v41, v34, v35
    v_cvt_pk_bf16_f32 v42, v36, v37
    v_cvt_pk_bf16_f32 v43, v38, v39
    v_dot2_f32_bf16 v32, v40, s26, v64
    v_dot2_f32_bf16 v33, v40, s27, v65
    v_dot2_f32_bf16 v34, v41, s26, v66
    v_dot2_f32_bf16 v35, v41, s27, v67
    v_dot2_f32_bf16 v36, v42, s26, v68
    v_dot2_f32_bf16 v37, v42, s27, v69
    v_dot2_f32_bf16 v38, v43, s26, v70
    v_dot2_f32_bf16 v39, v43, s27, v71
    s_nop 2
    v_cvt_pk_bf16_f32 v24, v32, v33
    v_cvt_pk_bf16_f32 v25, v34, v35
    v_cvt_pk_bf16_f32 v26, v36, v37
    v_cvt_pk_bf16_f32 v27, v38, v39
    buffer_store_dwordx4 v[24:27], v28, s[12:15], s28 offen sc0 sc1
    s_endpgm
pc_tile:
    s_sleep 64
    s_setprio 3
    s_cmp_ge_u32 s2, 192
    s_cbranch_scc1 pc_kernel_tz11
    s_add_u32 s56, s42, 0x1510000
    s_addc_u32 s57, s43, 0
    s_mov_b32 s58, 0x40000
    s_mov_b32 s59, 0x00020000
    s_sub_u32 s8, s2, 128
    s_lshl_b32 s8, s8, 12
    v_mov_b32 v2, 0
    v_mov_b32 v3, 0
    v_mov_b32 v4, 0
    v_mov_b32 v5, 0
    v_lshlrev_b32 v1, 4, v0
    buffer_store_dwordx4 v[2:5], v1, s[56:59], s8 offen sc0 sc1
    s_nop 0
pc_kernel_tz11:
    s_cmp_lt_u32 s2, 178
    s_cbranch_scc1 pc_kernel_tq9
    s_mov_b32 s44, s38
    s_mov_b32 s45, s39
    s_mov_b32 s46, 0xc8000
    s_mov_b32 s47, 0x00020000
    s_add_u32 s48, s42, 0xe00000
    s_addc_u32 s49, s43, 0
    s_mov_b32 s50, 0xc8000
    s_mov_b32 s51, 0x00020000
    s_sub_u32 s13, s2, 178
    s_branch pc_kernel_tgo10
pc_kernel_tq9:
    s_mov_b32 s44, s32
    s_mov_b32 s45, s33
    s_mov_b32 s46, 0xc8000
    s_mov_b32 s47, 0x00020000
    s_add_u32 s48, s42, 0xd00000
    s_addc_u32 s49, s43, 0
    s_mov_b32 s50, 0xdc000
    s_mov_b32 s51, 0x00020000
    s_sub_u32 s13, s2, 128
pc_kernel_tgo10:
    s_mul_i32 s3, s13, 52429
    s_lshr_b32 s3, s3, 18
    s_mul_i32 s4, s3, 5
    s_sub_u32 s4, s13, s4
    s_mul_i32 s5, s3, 81920
    s_lshl_b32 s6, s4, 8
    s_add_u32 s5, s5, s6
    s_mul_i32 s6, s4, 163840
    s_lshl_b32 s7, s3, 12
    s_add_u32 s6, s6, s7
    v_lshrrev_b32 v1, 4, v0
    v_and_b32 v2, 15, v0
    v_mul_u32_u24 v3, 1280, v1
    v_lshl_add_u32 v3, v2, 4, v3
    v_mul_u32_u24 v4, 272, v1
    v_lshl_add_u32 v4, v2, 4, v4
    s_add_u32 s8, s5, 0
    buffer_load_dwordx4 v[8:11], v3, s[44:47], s8 offen
    s_add_u32 s8, s5, 20480
    buffer_load_dwordx4 v[12:15], v3, s[44:47], s8 offen
    s_add_u32 s8, s5, 40960
    buffer_load_dwordx4 v[16:19], v3, s[44:47], s8 offen
    s_add_u32 s8, s5, 61440
    buffer_load_dwordx4 v[20:23], v3, s[44:47], s8 offen
    s_waitcnt vmcnt(0)
    ds_write_b128 v4, v[8:11] offset:0
    ds_write_b128 v4, v[12:15] offset:4352
    ds_write_b128 v4, v[16:19] offset:8704
    ds_write_b128 v4, v[20:23] offset:13056
    s_waitcnt lgkmcnt(0)
    s_barrier
    v_lshrrev_b32 v1, 6, v0
    v_bfe_u32 v2, v0, 4, 2
    v_and_b32 v3, 15, v0
    v_lshrrev_b32 v4, 2, v3
    v_and_b32 v5, 3, v3
    v_lshl_add_u32 v6, v1, 4, v4
    v_mul_u32_u24 v6, 272, v6
    v_lshlrev_b32 v7, 5, v2
    v_lshl_add_u32 v7, v5, 3, v7
    v_add_u32 v6, v6, v7
    ds_read_b64_tr_b16 v[8:9], v6 offset:0
    ds_read_b64_tr_b16 v[10:11], v6 offset:1088
    ds_read_b64_tr_b16 v[12:13], v6 offset:2176
    ds_read_b64_tr_b16 v[14:15], v6 offset:3264
    ds_read_b64_tr_b16 v[16:17], v6 offset:128
    ds_read_b64_tr_b16 v[18:19], v6 offset:1216
    ds_read_b64_tr_b16 v[20:21], v6 offset:2304
    ds_read_b64_tr_b16 v[22:23], v6 offset:3392
    v_lshrrev_b32 v7, 1, v2
    v_mul_u32_u24 v7, 40960, v7
    v_lshl_add_u32 v7, v1, 10, v7
    v_and_b32 v5, 31, v0
    v_lshl_add_u32 v7, v5, 4, v7
    s_add_u32 s9, s6, 81920
    s_waitcnt lgkmcnt(0)
    buffer_store_dwordx4 v[8:11], v7, s[48:51], s6 offen offset:0 sc0 sc1
    buffer_store_dwordx4 v[12:15], v7, s[48:51], s6 offen offset:512 sc0 sc1
    buffer_store_dwordx4 v[16:19], v7, s[48:51], s9 offen offset:0 sc0 sc1
    buffer_store_dwordx4 v[20:23], v7, s[48:51], s9 offen offset:512 sc0 sc1
    s_branch pc_flag
pc_x0:
    s_setprio 3
    s_mov_b32 s44, s16
    s_mov_b32 s45, s17
    s_mov_b32 s46, 0x280000
    s_mov_b32 s47, 0x00020000
    s_add_u32 s48, s42, 0x1430000
    s_addc_u32 s49, s43, 0
    s_mov_b32 s50, 0x4000
    s_mov_b32 s51, 0x00020000
    s_mov_b32 s52, s42
    s_mov_b32 s53, s43
    s_mov_b32 s54, 0x280000
    s_mov_b32 s55, 0x00020000
    s_mul_i32 s5, s83, 20480
    v_lshrrev_b32 v1, 4, v0
    v_and_b32 v2, 15, v0
    v_mul_u32_u24 v3, 1280, v1
    v_lshl_add_u32 v5, v2, 4, v3
    buffer_load_dwordx4 v[8:11], v5, s[44:47], s5 offen offset:0
    buffer_load_dwordx4 v[12:15], v5, s[44:47], s5 offen offset:256
    buffer_load_dwordx4 v[16:19], v5, s[44:47], s5 offen offset:512
    buffer_load_dwordx4 v[20:23], v5, s[44:47], s5 offen offset:768
    buffer_load_dwordx4 v[24:27], v5, s[44:47], s5 offen offset:1024
    v_lshlrev_b32 v7, 3, v1
    s_lshl_b32 s6, s83, 7
    v_mov_b32 v6, 0
    v_and_b32 v60, 3, v1
    v_lshlrev_b32 v60, 1, v60
    v_and_b32 v61, 8, v1
    v_or_b32 v60, v60, v61
    v_xor_b32 v60, v60, v2
    v_lshl_add_u32 v60, v60, 4, v3
    v_lshrrev_b32 v28, 6, v0
    v_bfe_u32 v29, v0, 4, 1
    v_bfe_u32 v30, v0, 5, 1
    v_lshrrev_b32 v31, 2, v2
    v_lshl_add_u32 v61, v29, 3, v31
    v_mul_u32_u24 v61, 1280, v61
    v_lshlrev_b32 v31, 1, v31
    v_lshl_or_b32 v31, v29, 3, v31
    v_bfe_u32 v32, v2, 1, 1
    v_lshl_or_b32 v32, v30, 1, v32
    v_lshl_or_b32 v32, v28, 2, v32
    v_xor_b32 v32, v32, v31
    v_lshl_add_u32 v61, v32, 4, v61
    v_and_b32 v32, 1, v2
    v_lshl_add_u32 v61, v32, 3, v61
    v_lshl_or_b32 v62, v30, 4, v2
    v_lshl_or_b32 v62, v28, 5, v62
    v_lshlrev_b32 v62, 5, v62
    v_lshl_or_b32 v62, v29, 4, v62
    s_mov_b32 s4, 0x3f803f80
    s_movk_i32 s26, 0x3f80
    s_mov_b32 s27, 0x3f800000
    v_mov_b32 v50, 0
    v_mov_b32 v51, 0
    v_mov_b32 v52, 0
    v_mov_b32 v53, 0
    s_waitcnt vmcnt(4)
    ds_write_b128 v60, v[8:11] offset:0
    s_waitcnt vmcnt(3)
    ds_write_b128 v60, v[12:15] offset:256
    s_waitcnt vmcnt(2)
    ds_write_b128 v60, v[16:19] offset:512
    s_waitcnt vmcnt(1)
    ds_write_b128 v60, v[20:23] offset:768
    s_waitcnt vmcnt(0)
    ds_write_b128 v60, v[24:27] offset:1024
    s_waitcnt lgkmcnt(0)
    s_barrier
    ds_read_b64_tr_b16 v[64:65], v61 offset:0
    ds_read_b64_tr_b16 v[66:67], v61 offset:5120
    ds_read_b64_tr_b16 v[68:69], v61 offset:256
    ds_read_b64_tr_b16 v[70:71], v61 offset:5376
    ds_read_b64_tr_b16 v[72:73], v61 offset:512
    ds_read_b64_tr_b16 v[74:75], v61 offset:5632
    ds_read_b64_tr_b16 v[76:77], v61 offset:768
    ds_read_b64_tr_b16 v[78:79], v61 offset:5888
    ds_read_b64_tr_b16 v[80:81], v61 offset:1024
    ds_read_b64_tr_b16 v[82:83], v61 offset:6144
    s_waitcnt lgkmcnt(8)
    buffer_store_dwordx4 v[64:67], v62, s[52:55], s5 offen sc0 sc1
    s_add_u32 s5, s5, 4096
    s_waitcnt lgkmcnt(6)
    buffer_store_dwordx4 v[68:71], v62, s[52:55], s5 offen sc0 sc1
    s_add_u32 s5, s5, 4096
    s_waitcnt lgkmcnt(4)
    buffer_store_dwordx4 v[72:75], v62, s[52:55], s5 offen sc0 sc1
    s_add_u32 s5, s5, 4096
    s_waitcnt lgkmcnt(2)
    buffer_store_dwordx4 v[76:79], v62, s[52:55], s5 offen sc0 sc1
    s_add_u32 s5, s5, 4096
    s_waitcnt lgkmcnt(0)
    buffer_store_dwordx4 v[80:83], v62, s[52:55], s5 offen sc0 sc1
    buffer_load_dword v4, v6, s[68:71], 0 offen sc1
    v_dot2_f32_bf16 v50, v8, s4, v50
    v_dot2_f32_bf16 v52, v8, v8, v52
    v_dot2_f32_bf16 v51, v9, s4, v51
    v_dot2_f32_bf16 v53, v9, v9, v53
    v_dot2_f32_bf16 v50, v10, s4, v50
    v_dot2_f32_bf16 v52, v10, v10, v52
    v_dot2_f32_bf16 v51, v11, s4, v51
    v_dot2_f32_bf16 v53, v11, v11, v53
    v_dot2_f32_bf16 v50, v12, s4, v50
    v_dot2_f32_bf16 v52, v12, v12, v52
    v_dot2_f32_bf16 v51, v13, s4, v51
    v_dot2_f32_bf16 v53, v13, v13, v53
    v_dot2_f32_bf16 v50, v14, s4, v50
    v_dot2_f32_bf16 v52, v14, v14, v52
    v_dot2_f32_bf16 v51, v15, s4, v51
    v_dot2_f32_bf16 v53, v15, v15, v53
    v_dot2_f32_bf16 v50, v16, s4, v50
    v_dot2_f32_bf16 v52, v16, v16, v52
    v_dot2_f32_bf16 v51, v17, s4, v51
    v_dot2_f32_bf16 v53, v17, v17, v53
    v_dot2_f32_bf16 v50, v18, s4, v50
    v_dot2_f32_bf16 v52, v18, v18, v52
    v_dot2_f32_bf16 v51, v19, s4, v51
    v_dot2_f32_bf16 v53, v19, v19, v53
    v_dot2_f32_bf16 v50, v20, s4, v50
    v_dot2_f32_bf16 v52, v20, v20, v52
    v_dot2_f32_bf16 v51, v21, s4, v51
    v_dot2_f32_bf16 v53, v21, v21, v53
    v_dot2_f32_bf16 v50, v22, s4, v50
    v_dot2_f32_bf16 v52, v22, v22, v52
    v_dot2_f32_bf16 v51, v23, s4, v51
    v_dot2_f32_bf16 v53, v23, v23, v53
    v_dot2_f32_bf16 v50, v24, s4, v50
    v_dot2_f32_bf16 v52, v24, v24, v52
    v_dot2_f32_bf16 v51, v25, s4, v51
    v_dot2_f32_bf16 v53, v25, v25, v53
    v_dot2_f32_bf16 v50, v26, s4, v50
    v_dot2_f32_bf16 v52, v26, v26, v52
    v_dot2_f32_bf16 v51, v27, s4, v51
    v_dot2_f32_bf16 v53, v27, v27, v53
    s_nop 4
    v_add_f32 v56, v50, v51
    v_add_f32 v57, v52, v53
    s_nop 0
    v_add_f32_dpp v56, v56, v56 quad_perm:[1,0,3,2] row_mask:0xf bank_mask:0xf
    v_add_f32_dpp v57, v57, v57 quad_perm:[1,0,3,2] row_mask:0xf bank_mask:0xf
    s_nop 0
    v_add_f32_dpp v56, v56, v56 quad_perm:[2,3,0,1] row_mask:0xf bank_mask:0xf
    v_add_f32_dpp v57, v57, v57 quad_perm:[2,3,0,1] row_mask:0xf bank_mask:0xf
    s_nop 0
    v_add_f32_dpp v56, v56, v56 row_half_mirror row_mask:0xf bank_mask:0xf
    v_add_f32_dpp v57, v57, v57 row_half_mirror row_mask:0xf bank_mask:0xf
    s_nop 0
    v_add_f32_dpp v56, v56, v56 row_mirror row_mask:0xf bank_mask:0xf
    v_add_f32_dpp v57, v57, v57 row_mirror row_mask:0xf bank_mask:0xf
    v_mul_f32 v56, 0x3acccccd, v56
    v_mul_f32 v57, 0x3acccccd, v57
    v_fma_f32 v57, -v56, v56, v57
    v_max_f32 v57, 0, v57
    v_cvt_pk_bf16_f32 v56, v56, v56
    v_lshlrev_b32 v56, 16, v56
    v_cvt_pk_bf16_f32 v57, v57, v57
    v_lshlrev_b32 v57, 16, v57
    v_add_f32 v57, 0x3727c5ac, v57
    v_cvt_pk_bf16_f32 v57, v57, v57
    v_lshlrev_b32 v57, 16, v57
    v_sqrt_f32 v57, v57
    s_nop 0
    v_cvt_pk_bf16_f32 v57, v57, v57
    v_lshlrev_b32 v57, 16, v57
    v_rcp_f32 v57, v57
    v_sub_f32 v56, 0, v56
    s_waitcnt vmcnt(0)
    v_readfirstlane_b32 s78, v4
    ds_write_b64 v7, v[56:57] offset:20480
    v_lshlrev_b32 v7, 3, v0
    s_mov_b32 s81, 0
pc_kernel_al12:
    s_cmp_eq_u32 s78, 1
    s_cbranch_scc1 pc_kernel_ad13
    buffer_load_dword v4, v6, s[68:71], 0 offen sc1
    s_waitcnt vmcnt(0)
    v_readfirstlane_b32 s78, v4
    s_add_u32 s81, s81, 1
    s_cmp_lt_u32 s81, 0x80000
    s_cbranch_scc1 pc_kernel_al12
pc_kernel_ad13:
    s_waitcnt lgkmcnt(0)
    s_barrier
    v_cmp_gt_u32 vcc, 16, v0
    s_and_saveexec_b64 s[10:11], vcc
    ds_read_b64 v[56:57], v7 offset:20480
    s_waitcnt lgkmcnt(0)
    buffer_store_dwordx2 v[56:57], v7, s[48:51], s6 offen sc0 sc1
    s_mov_b64 exec, s[10:11]
    s_setprio 0
    s_cmp_ge_u32 s83, 16
    s_cbranch_scc1 pc_kernel_xps15
    s_getpc_b64 s[36:37]
pc_kernel_xpc14:
    s_add_u32 s36, s36, fused1_kernel-pc_kernel_xpc14
    s_addc_u32 s37, s37, 0
    s_mov_b32 s38, fused1_kernel_end-fused1_kernel
    s_mov_b32 s39, 0x00020000
    s_bfe_u32 s31, s83, 0x10003
    s_lshl_b32 s31, s31, 15
    v_lshlrev_b32 v18, 7, v0
    v_add_u32 v18, s31, v18
    buffer_load_dword v18, v18, s[36:39], 0 offen
pc_kernel_xps15:
    s_mov_b32 s81, 0
pc_kernel_wl16:
    buffer_load_dword v8, v6, s[68:71], 0 offen offset:128 sc1
    s_waitcnt vmcnt(0)
    v_readfirstlane_b32 s79, v8
    s_cmp_eq_u32 s79, 1
    s_cbranch_scc1 pc_kernel_wd17
    s_sleep 8
    s_add_u32 s81, s81, 1
    s_cmp_lt_u32 s81, 0x40000
    s_cbranch_scc1 pc_kernel_wl16
pc_kernel_wd17:
    s_add_u32 s36, s42, 0xd00000
    s_addc_u32 s37, s43, 0
    s_mov_b32 s38, 0xdc000
    s_mov_b32 s39, 0x00020000
    s_lshr_b32 s31, s83, 3
    s_mul_i32 s31, s31, 56320
    v_lshlrev_b32 v13, 6, v0
    buffer_load_dword v14, v13, s[36:39], s31 offen
    s_add_u32 s31, s31, 16384
    buffer_load_dword v15, v13, s[36:39], s31 offen
    s_add_u32 s31, s31, 16384
    buffer_load_dword v16, v13, s[36:39], s31 offen
    s_add_u32 s31, s31, 16384
    v_cmp_gt_u32 vcc, 112, v0
    s_and_b64 exec, exec, vcc
    buffer_load_dword v17, v13, s[36:39], s31 offen
    s_add_u32 s31, s31, 16384
    s_waitcnt vmcnt(0)
    s_endpgm
pc_flag:
    v_mov_b32 v1, 0
    buffer_load_dword v1, v1, s[68:71], 0 offen sc1
    s_waitcnt vmcnt(0)
    v_readfirstlane_b32 s78, v1
    s_barrier
    v_cmp_eq_u32 vcc, 0, v0
    s_and_b64 exec, exec, vcc
    s_cbranch_execz pc_end
    s_mov_b32 s81, 0
pc_kernel_al18:
    s_cmp_eq_u32 s78, 1
    s_cbranch_scc1 pc_kernel_ad19
    buffer_load_dword v1, v0, s[68:71], 0 offen sc1
    s_waitcnt vmcnt(0)
    v_readfirstlane_b32 s78, v1
    s_add_u32 s81, s81, 1
    s_cmp_lt_u32 s81, 0x80000
    s_cbranch_scc1 pc_kernel_al18
pc_kernel_ad19:
    s_lshr_b32 s4, s83, 2
    s_mul_i32 s4, s4, 256
    s_and_b32 s5, s83, 3
    s_lshl_b32 s5, s5, 2
    s_add_u32 s4, s4, s5
    v_mov_b32 v1, 1
    buffer_store_dword v1, v0, s[96:99], s4 offen sc0 sc1
    s_endpgm
pc_kv:
    s_setprio 3
    s_sub_u32 s13, s2, 228
    s_cmp_lt_u32 s13, 10
    s_cbranch_scc0 pc_kernel_kvv20
    s_mov_b32 s44, s34
    s_mov_b32 s45, s35
    s_mov_b32 s46, 0x6400
    s_mov_b32 s47, 0x00020000
    s_branch pc_kernel_kvg21
pc_kernel_kvv20:
    s_mov_b32 s44, s36
    s_mov_b32 s45, s37
    s_mov_b32 s46, 0x6400
    s_mov_b32 s47, 0x00020000
pc_kernel_kvg21:
    s_add_u32 s52, s42, 0xd00000
    s_addc_u32 s53, s43, 0
    s_mov_b32 s54, 0xdc000
    s_mov_b32 s55, 0x00020000
    s_sub_u32 s4, s13, 10
    s_cmp_lt_u32 s13, 10
    s_cselect_b32 s3, s13, s4
    s_mul_i32 s5, s3, 2560
    v_lshrrev_b32 v1, 5, v0
    v_and_b32 v2, 31, v0
    v_mul_u32_u24 v3, 320, v1
    v_lshl_add_u32 v3, v2, 1, v3
    v_mov_b32 v12, 0
    v_mov_b32 v13, 0
    v_mov_b32 v14, 0
    v_mov_b32 v15, 0
    v_mov_b32 v16, 0
    v_mov_b32 v17, 0
    v_mov_b32 v18, 0
    v_mov_b32 v19, 0
    v_cmp_gt_u32 vcc, 20, v2
    s_and_saveexec_b64 s[10:11], vcc
    buffer_load_ushort v12, v3, s[44:47], s5 offen offset:0
    buffer_load_ushort v13, v3, s[44:47], s5 offen offset:40
    buffer_load_ushort v14, v3, s[44:47], s5 offen offset:80
    buffer_load_ushort v15, v3, s[44:47], s5 offen offset:120
    buffer_load_ushort v16, v3, s[44:47], s5 offen offset:160
    buffer_load_ushort v17, v3, s[44:47], s5 offen offset:200
    buffer_load_ushort v18, v3, s[44:47], s5 offen offset:240
    buffer_load_ushort v19, v3, s[44:47], s5 offen offset:280
    s_mov_b64 exec, s[10:11]
    s_lshl_b32 s6, s13, 12
    s_add_u32 s6, s6, 819200
    v_lshlrev_b32 v4, 4, v0
    s_waitcnt vmcnt(0)
    v_lshl_or_b32 v8, v13, 16, v12
    v_lshl_or_b32 v9, v15, 16, v14
    v_lshl_or_b32 v10, v17, 16, v16
    v_lshl_or_b32 v11, v19, 16, v18
    buffer_store_dwordx4 v[8:11], v4, s[52:55], s6 offen sc0 sc1
    s_branch pc_flag
pc_cs:
    s_sub_u32 s3, s2, 888
    s_mul_i32 s4, s3, 40960
    v_lshrrev_b32 v1, 6, v0
    v_mul_u32_u24 v1, 10240, v1
    v_and_b32 v2, 63, v0
    v_lshl_add_u32 v1, v2, 4, v1
    v_mul_u32_u24 v2, 256, v2
    v_mov_b32 v3, 0
    s_add_u32 s8, s42, 0xd00000
    s_addc_u32 s9, s43, 0
    s_mov_b32 s10, 0xdc000
    s_mov_b32 s11, 0x00020000
    s_add_u32 s12, s42, 0x1560000
    s_addc_u32 s13, s43, 0
    s_mov_b32 s14, 0xb00
    s_mov_b32 s15, 0x00020000
    s_sleep 64
    s_mov_b32 s81, 0
pc_kernel_wl22:
    buffer_load_dword v4, v3, s[68:71], 0 offen offset:128 sc1
    s_waitcnt vmcnt(0)
    v_readfirstlane_b32 s79, v4
    s_cmp_eq_u32 s79, 1
    s_cbranch_scc1 pc_kernel_wd23
    s_sleep 8
    s_add_u32 s81, s81, 1
    s_cmp_lt_u32 s81, 0x40000
    s_cbranch_scc1 pc_kernel_wl22
pc_kernel_wd23:
    buffer_load_dwordx4 v[8:11], v1, s[8:11], s4 offen offset:0 sc1
    buffer_load_dwordx4 v[12:15], v1, s[8:11], s4 offen offset:1024 sc1
    buffer_load_dwordx4 v[16:19], v1, s[8:11], s4 offen offset:2048 sc1
    buffer_load_dwordx4 v[20:23], v1, s[8:11], s4 offen offset:3072 sc1
    s_add_u32 s4, s4, 4096
    buffer_load_dwordx4 v[24:27], v1, s[8:11], s4 offen offset:0 sc1
    buffer_load_dwordx4 v[28:31], v1, s[8:11], s4 offen offset:1024 sc1
    buffer_load_dwordx4 v[32:35], v1, s[8:11], s4 offen offset:2048 sc1
    buffer_load_dwordx4 v[36:39], v1, s[8:11], s4 offen offset:3072 sc1
    s_add_u32 s4, s4, 4096
    buffer_load_dwordx4 v[40:43], v1, s[8:11], s4 offen offset:0 sc1
    buffer_load_dwordx4 v[44:47], v1, s[8:11], s4 offen offset:1024 sc1
    s_mov_b32 s5, 0x3f803f80
    v_mov_b32 v4, 0
    v_mov_b32 v5, 0
    s_waitcnt vmcnt(0)
    v_dot2_f32_bf16 v4, v8, s5, v4
    v_dot2_f32_bf16 v5, v9, s5, v5
    v_dot2_f32_bf16 v4, v10, s5, v4
    v_dot2_f32_bf16 v5, v11, s5, v5
    v_dot2_f32_bf16 v4, v12, s5, v4
    v_dot2_f32_bf16 v5, v13, s5, v5
    v_dot2_f32_bf16 v4, v14, s5, v4
    v_dot2_f32_bf16 v5, v15, s5, v5
    v_dot2_f32_bf16 v4, v16, s5, v4
    v_dot2_f32_bf16 v5, v17, s5, v5
    v_dot2_f32_bf16 v4, v18, s5, v4
    v_dot2_f32_bf16 v5, v19, s5, v5
    v_dot2_f32_bf16 v4, v20, s5, v4
    v_dot2_f32_bf16 v5, v21, s5, v5
    v_dot2_f32_bf16 v4, v22, s5, v4
    v_dot2_f32_bf16 v5, v23, s5, v5
    v_dot2_f32_bf16 v4, v24, s5, v4
    v_dot2_f32_bf16 v5, v25, s5, v5
    v_dot2_f32_bf16 v4, v26, s5, v4
    v_dot2_f32_bf16 v5, v27, s5, v5
    v_dot2_f32_bf16 v4, v28, s5, v4
    v_dot2_f32_bf16 v5, v29, s5, v5
    v_dot2_f32_bf16 v4, v30, s5, v4
    v_dot2_f32_bf16 v5, v31, s5, v5
    v_dot2_f32_bf16 v4, v32, s5, v4
    v_dot2_f32_bf16 v5, v33, s5, v5
    v_dot2_f32_bf16 v4, v34, s5, v4
    v_dot2_f32_bf16 v5, v35, s5, v5
    v_dot2_f32_bf16 v4, v36, s5, v4
    v_dot2_f32_bf16 v5, v37, s5, v5
    v_dot2_f32_bf16 v4, v38, s5, v4
    v_dot2_f32_bf16 v5, v39, s5, v5
    v_dot2_f32_bf16 v4, v40, s5, v4
    v_dot2_f32_bf16 v5, v41, s5, v5
    v_dot2_f32_bf16 v4, v42, s5, v4
    v_dot2_f32_bf16 v5, v43, s5, v5
    v_dot2_f32_bf16 v4, v44, s5, v4
    v_dot2_f32_bf16 v5, v45, s5, v5
    v_dot2_f32_bf16 v4, v46, s5, v4
    v_dot2_f32_bf16 v5, v47, s5, v5
    s_nop 4
    v_add_f32 v4, v4, v5
    v_mov_b32 v5, v4
    s_nop 1
    v_permlane32_swap_b32 v4, v5
    s_nop 1
    v_add_f32 v4, v4, v5
    v_lshrrev_b32 v6, 6, v0
    v_lshlrev_b32 v6, 7, v6
    v_and_b32 v7, 31, v0
    v_lshl_add_u32 v6, v7, 2, v6
    ds_write_b32 v6, v4
    s_waitcnt lgkmcnt(0)
    s_barrier
    v_lshlrev_b32 v7, 2, v7
    ds_read_b32 v8, v7 offset:0
    ds_read_b32 v9, v7 offset:128
    ds_read_b32 v10, v7 offset:256
    ds_read_b32 v11, v7 offset:384
    s_waitcnt lgkmcnt(0)
    v_add_f32 v8, v8, v9
    v_add_f32 v10, v10, v11
    v_add_f32 v8, v8, v10
    s_lshl_b32 s4, s3, 7
    v_cmp_gt_u32 vcc, 32, v0
    s_and_b64 exec, exec, vcc
    buffer_store_dword v8, v7, s[12:15], s4 offen sc0 sc1
    s_endpgm
pc_zero:
    s_setprio 3
    s_add_u32 s48, s42, 0x1430000
    s_addc_u32 s49, s43, 0
    s_mov_b32 s50, 0x4000
    s_mov_b32 s51, 0x00020000
    v_and_b32 v1, 63, v0
    v_mul_u32_u24 v1, 256, v1
    v_lshlrev_b32 v7, 4, v0
    v_mov_b32 v2, 0
    v_mov_b32 v3, 0
    v_mov_b32 v4, 0
    v_mov_b32 v5, 0
    v_mov_b32 v6, 1
    s_movk_i32 s4, 0x1000
    s_movk_i32 s5, 0x2000
    s_movk_i32 s6, 0x3000
    buffer_store_dwordx4 v[2:5], v7, s[48:51], 0 offen sc0 sc1
    buffer_store_dwordx4 v[2:5], v7, s[48:51], s4 offen sc0 sc1
    buffer_store_dwordx4 v[2:5], v7, s[48:51], s5 offen sc0 sc1
    buffer_store_dwordx4 v[2:5], v7, s[48:51], s6 offen sc0 sc1
    v_cmp_gt_u32 vcc, 64, v0
    s_and_saveexec_b64 s[10:11], vcc
    buffer_store_dwordx4 v[2:5], v1, s[96:99], 0 offen sc0 sc1
    s_waitcnt vmcnt(0)
    s_barrier
    s_cbranch_execz pc_end
    s_mov_b64 exec, 1
    buffer_store_dword v6, v2, s[68:71], 0 offen sc0 sc1
    s_mov_b32 exec_lo, 0
    s_mov_b32 exec_hi, -1
    s_mov_b32 s78, 1
    s_sleep 64
    s_mov_b32 s81, 0
pc_kernel_al24:
    s_cmp_eq_u32 s78, 1
    s_cbranch_scc1 pc_kernel_ad25
    buffer_load_dword v8, v2, s[68:71], 0 offen sc1
    s_waitcnt vmcnt(0)
    v_readfirstlane_b32 s78, v8
    s_add_u32 s81, s81, 1
    s_cmp_lt_u32 s81, 0x80000
    s_cbranch_scc1 pc_kernel_al24
pc_kernel_ad25:
    s_mov_b32 s81, 0
pc_kernel_pl26:
    buffer_load_dwordx4 v[8:11], v1, s[96:99], 0 offen sc1
    s_waitcnt vmcnt(0)
    v_and_b32 v8, v8, v9
    v_and_b32 v10, v10, v11
    v_and_b32 v8, v8, v10
    v_cmp_eq_u32 s[76:77], 1, v8
    s_nop 3
    s_cmp_eq_u32 s76, -1
    s_cselect_b32 s82, 1, 0
    s_or_b32 s77, s77, 0xc0000000
    s_cmp_eq_u32 s77, -1
    s_cselect_b32 s79, 2, 0
    s_or_b32 s82, s82, s79
    s_cmp_eq_u32 s78, 1
    s_cselect_b32 s82, s82, 0
    s_bitcmp1_b32 s82, 1
    s_cbranch_scc1 pc_kernel_pd27
    s_sleep 6
    s_add_u32 s81, s81, 1
    s_cmp_lt_u32 s81, 0x40000
    s_cbranch_scc1 pc_kernel_pl26
pc_kernel_pd27:
    s_mov_b64 exec, 1
    buffer_store_dword v6, v2, s[68:71], 0 offen offset:128 sc0 sc1
pc_end:
    s_endpgm
.globl fused1_kernel
.p2align 8
.type fused1_kernel,@function
fused1_kernel:
    s_cmp_ge_u32 s2, 256
    s_cbranch_scc1 fused1_kernel_end
    s_load_dwordx2 s[6:7], s[0:1], 112
    v_lshrrev_b32 v1, 6, v0
    s_nop 0
    v_readfirstlane_b32 s40, v1
    s_and_b32 s5, s2, 7
    s_lshr_b32 s3, s2, 5
    s_lshl_b32 s3, s3, 3
    s_add_u32 s3, s3, s5
    s_bfe_u32 s4, s2, 0x20003
    s_mul_i32 s41, s4, 5
    s_add_u32 s41, s41, s40
    s_cmp_lt_u32 s4, 2
    s_cselect_b32 s42, 1, 0
    s_setprio 3
    s_waitcnt lgkmcnt(0)
    s_add_u32 s48, s6, 0x280000
    s_addc_u32 s49, s7, 0
    s_mov_b32 s50, 0x280000
    s_mov_b32 s51, 0x00020000
    v_and_b32 v5, 3, v0
    v_lshrrev_b32 v6, 2, v0
    v_lshlrev_b32 v7, 4, v0
    s_mul_i32 s26, s3, 40960
    s_add_u32 s27, s26, 0
    buffer_load_dwordx4 v[8:11], v7, s[48:51], s27 offen
    s_add_u32 s27, s26, 8192
    buffer_load_dwordx4 v[12:15], v7, s[48:51], s27 offen
    s_add_u32 s27, s26, 16384
    buffer_load_dwordx4 v[16:19], v7, s[48:51], s27 offen
    s_add_u32 s27, s26, 24576
    buffer_load_dwordx4 v[20:23], v7, s[48:51], s27 offen
    s_add_u32 s27, s26, 32768
    buffer_load_dwordx4 v[24:27], v7, s[48:51], s27 offen
    s_setprio 2
    s_add_u32 s52, s6, 0xd00000
    s_addc_u32 s53, s7, 0
    s_mov_b32 s54, 0xdc000
    s_mov_b32 s55, 0x00020000
    s_add_u32 s56, s6, 0x1400000
    s_addc_u32 s57, s7, 0
    s_mov_b32 s58, 0x28000
    s_mov_b32 s59, 0x00020000
    s_add_u32 s60, s6, 0x1180000
    s_addc_u32 s61, s7, 0
    s_mov_b32 s62, 0x280000
    s_mov_b32 s63, 0x00020000
    s_add_u32 s64, s6, 0xe00000
    s_addc_u32 s65, s7, 0
    s_mov_b32 s66, 0xc8000
    s_mov_b32 s67, 0x00020000
    s_add_u32 s68, s6, 0x1510000
    s_addc_u32 s69, s7, 0
    s_mov_b32 s70, 0x40000
    s_mov_b32 s71, 0x00020000
    s_add_u32 s8, s6, 0x1560000
    s_addc_u32 s9, s7, 0
    s_mov_b32 s10, 0xb00
    s_mov_b32 s11, 0x00020000
    s_add_u32 s72, s6, 0x500000
    s_addc_u32 s73, s7, 0
    s_mov_b32 s74, 0x280000
    s_mov_b32 s75, 0x00020000
    s_add_u32 s76, s6, 0x1440000
    s_addc_u32 s77, s7, 0
    s_mov_b32 s78, 0x50000
    s_mov_b32 s79, 0x00020000
    s_add_u32 s80, s6, 0x1438000
    s_addc_u32 s81, s7, 0
    s_mov_b32 s82, 0x4000
    s_mov_b32 s83, 0x00020000
    v_and_b32 v2, 63, v0
    v_lshlrev_b32 v4, 4, v2
    v_lshlrev_b32 v7, 6, v6
    v_lshl_add_u32 v7, v5, 4, v7
    v_add_u32 v7, 122880, v7
    s_add_u32 s43, s3, s40
    s_add_u32 s5, s43, 0
    s_and_b32 s5, s5, 3
    s_lshl_b32 s5, s5, 10
    v_add_u32 v92, s5, v4
    s_add_u32 s5, s43, 1
    s_and_b32 s5, s5, 3
    s_lshl_b32 s5, s5, 10
    v_add_u32 v93, s5, v4
    s_add_u32 s5, s43, 2
    s_and_b32 s5, s5, 3
    s_lshl_b32 s5, s5, 10
    v_add_u32 v94, s5, v4
    s_add_u32 s5, s43, 3
    s_and_b32 s5, s5, 3
    s_lshl_b32 s5, s5, 10
    v_add_u32 v95, s5, v4
    s_mul_i32 s21, s41, 40960
    s_add_u32 s20, s21, 40960
    s_mov_b32 s22, 0
    s_lshl_b32 s35, s22, 12
    s_add_u32 s27, s21, s35
    s_sub_u32 s22, 10, s22
    s_cmp_eq_u32 s42, 1
    s_cbranch_scc1 fused1_kernel_kv01
    s_cmp_ge_u32 s40, 5
    s_cbranch_scc1 fused1_kernel_nq3
    s_setprio 0
    buffer_load_dwordx4 v[96:99], v92, s[52:55], s27 offen
    buffer_load_dwordx4 v[100:103], v93, s[52:55], s27 offen
    buffer_load_dwordx4 v[104:107], v94, s[52:55], s27 offen
    buffer_load_dwordx4 v[108:111], v95, s[52:55], s27 offen
    s_add_u32 s27, s27, 4096
    s_cmp_eq_u32 s27, s20
    s_cselect_b32 s27, s21, s27
    s_setprio 3
    s_waitcnt vmcnt(8)
    ds_write_b128 v7, v[8:11] offset:0
    s_waitcnt vmcnt(7)
    ds_write_b128 v7, v[12:15] offset:8192
    s_waitcnt vmcnt(6)
    ds_write_b128 v7, v[16:19] offset:16384
    s_waitcnt vmcnt(5)
    ds_write_b128 v7, v[20:23] offset:24576
    s_waitcnt vmcnt(4)
    ds_write_b128 v7, v[24:27] offset:32768
    s_branch fused1_kernel_j02
fused1_kernel_nq3:
    s_setprio 3
    s_waitcnt vmcnt(4)
    ds_write_b128 v7, v[8:11] offset:0
    s_waitcnt vmcnt(3)
    ds_write_b128 v7, v[12:15] offset:8192
    s_waitcnt vmcnt(2)
    ds_write_b128 v7, v[16:19] offset:16384
    s_waitcnt vmcnt(1)
    ds_write_b128 v7, v[20:23] offset:24576
    s_waitcnt vmcnt(0)
    ds_write_b128 v7, v[24:27] offset:32768
    s_branch fused1_kernel_j02
fused1_kernel_kv01:
    s_add_u32 s5, s4, 20
    s_mul_i32 s5, s5, 40960
    s_lshl_b32 s28, s40, 10
    s_add_u32 s5, s5, s28
    buffer_load_dwordx4 v[32:35], v4, s[52:55], s5 offen
    s_add_u32 s5, s5, 8192
    buffer_load_dwordx4 v[36:39], v4, s[52:55], s5 offen
    s_add_u32 s5, s5, 8192
    buffer_load_dwordx4 v[40:43], v4, s[52:55], s5 offen
    s_add_u32 s5, s5, 8192
    buffer_load_dwordx4 v[44:47], v4, s[52:55], s5 offen
    s_add_u32 s5, s5, 8192
    buffer_load_dwordx4 v[48:51], v4, s[52:55], s5 offen
    s_cmp_ge_u32 s40, 5
    s_cbranch_scc1 fused1_kernel_nq4
    s_setprio 0
    buffer_load_dwordx4 v[96:99], v92, s[52:55], s27 offen
    buffer_load_dwordx4 v[100:103], v93, s[52:55], s27 offen
    buffer_load_dwordx4 v[104:107], v94, s[52:55], s27 offen
    buffer_load_dwordx4 v[108:111], v95, s[52:55], s27 offen
    s_add_u32 s27, s27, 4096
    s_cmp_eq_u32 s27, s20
    s_cselect_b32 s27, s21, s27
    s_setprio 3
    s_waitcnt vmcnt(13)
    ds_write_b128 v7, v[8:11] offset:0
    s_waitcnt vmcnt(12)
    ds_write_b128 v7, v[12:15] offset:8192
    s_waitcnt vmcnt(11)
    ds_write_b128 v7, v[16:19] offset:16384
    s_waitcnt vmcnt(10)
    ds_write_b128 v7, v[20:23] offset:24576
    s_waitcnt vmcnt(9)
    ds_write_b128 v7, v[24:27] offset:32768
    s_waitcnt vmcnt(4)
    s_branch fused1_kernel_j02
fused1_kernel_nq4:
    v_bfe_u32 v3, v2, 5, 1
    v_lshlrev_b32 v6, 4, v3
    s_mov_b32 s5, 2560
    buffer_load_dwordx4 v[224:227], v6, s[8:11], s5 offen offset:0
    buffer_load_dwordx4 v[228:231], v6, s[8:11], s5 offen offset:32
    buffer_load_dwordx4 v[232:235], v6, s[8:11], s5 offen offset:64
    buffer_load_dwordx4 v[236:239], v6, s[8:11], s5 offen offset:96
    v_and_b32 v6, 31, v0
    v_lshlrev_b32 v6, 2, v6
    buffer_load_dword v240, v6, s[8:11], 0 offen offset:2688
    s_setprio 3
    s_waitcnt vmcnt(14)
    ds_write_b128 v7, v[8:11] offset:0
    s_waitcnt vmcnt(13)
    ds_write_b128 v7, v[12:15] offset:8192
    s_waitcnt vmcnt(12)
    ds_write_b128 v7, v[16:19] offset:16384
    s_waitcnt vmcnt(11)
    ds_write_b128 v7, v[20:23] offset:24576
    s_waitcnt vmcnt(10)
    ds_write_b128 v7, v[24:27] offset:32768
    s_waitcnt vmcnt(5)
    s_branch fused1_kernel_j02
fused1_kernel_j02:
    v_bfe_u32 v3, v2, 5, 1
    v_bfe_u32 v5, v2, 2, 2
    v_lshl_add_u32 v5, v3, 3, v5
    v_lshlrev_b32 v5, 6, v5
    v_bfe_u32 v6, v2, 4, 1
    v_lshl_add_u32 v5, v6, 5, v5
    v_and_b32 v6, 3, v2
    v_lshl_add_u32 v5, v6, 3, v5
    v_add_u32 v5, 122880, v5
    v_sub_u32 v6, v5, v4
    v_add_u32 v6, s35, v6
    v_add_u32 v88, v6, v92
    v_add_u32 v89, v6, v93
    v_add_u32 v90, v6, v94
    v_add_u32 v91, v6, v95
    v_lshl_add_u32 v5, v1, 10, v5
    s_waitcnt lgkmcnt(0)
    ds_read_b64_tr_b16 v[8:9], v5 offset:0
    ds_read_b64_tr_b16 v[10:11], v5 offset:256
    ds_read_b64_tr_b16 v[12:13], v5 offset:8192
    ds_read_b64_tr_b16 v[14:15], v5 offset:8448
    ds_read_b64_tr_b16 v[16:17], v5 offset:16384
    ds_read_b64_tr_b16 v[18:19], v5 offset:16640
    ds_read_b64_tr_b16 v[20:21], v5 offset:24576
    ds_read_b64_tr_b16 v[22:23], v5 offset:24832
    ds_read_b64_tr_b16 v[24:25], v5 offset:32768
    ds_read_b64_tr_b16 v[26:27], v5 offset:33024
    s_mov_b32 s5, 0x3f803f80
    v_mov_b32 v72, 0
    v_mov_b32 v73, 0
    v_mov_b32 v74, 0
    v_mov_b32 v75, 0
    s_waitcnt lgkmcnt(0)
    s_cmp_eq_u32 s42, 0
    s_cbranch_scc1 fused1_kernel_nkv5
    s_cmp_eq_u32 s4, 1
    s_cbranch_scc1 fused1_kernel_vv6
    v_mfma_f32_32x32x16_bf16 v[56:71], v[32:35], v[8:11], 0
    v_mfma_f32_32x32x16_bf16 v[56:71], v[36:39], v[12:15], v[56:71]
    v_mfma_f32_32x32x16_bf16 v[56:71], v[40:43], v[16:19], v[56:71]
    v_mfma_f32_32x32x16_bf16 v[56:71], v[44:47], v[20:23], v[56:71]
    v_mfma_f32_32x32x16_bf16 v[56:71], v[48:51], v[24:27], v[56:71]
    s_branch fused1_kernel_nkv5
fused1_kernel_vv6:
    v_mfma_f32_32x32x16_bf16 v[56:71], v[8:11], v[32:35], 0
    v_mfma_f32_32x32x16_bf16 v[56:71], v[12:15], v[36:39], v[56:71]
    v_mfma_f32_32x32x16_bf16 v[56:71], v[16:19], v[40:43], v[56:71]
    v_mfma_f32_32x32x16_bf16 v[56:71], v[20:23], v[44:47], v[56:71]
    v_mfma_f32_32x32x16_bf16 v[56:71], v[24:27], v[48:51], v[56:71]
fused1_kernel_nkv5:
    s_cmp_ge_u32 s40, 5
    s_cbranch_scc1 fused1_kernel_nm8
    buffer_load_dwordx4 v[112:115], v92, s[52:55], s27 offen
    buffer_load_dwordx4 v[116:119], v93, s[52:55], s27 offen
    buffer_load_dwordx4 v[120:123], v94, s[52:55], s27 offen
    buffer_load_dwordx4 v[124:127], v95, s[52:55], s27 offen
    s_add_u32 s27, s27, 4096
    s_cmp_eq_u32 s27, s20
    s_cselect_b32 s27, s21, s27
    buffer_load_dwordx4 v[128:131], v92, s[52:55], s27 offen
    buffer_load_dwordx4 v[132:135], v93, s[52:55], s27 offen
    buffer_load_dwordx4 v[136:139], v94, s[52:55], s27 offen
    buffer_load_dwordx4 v[140:143], v95, s[52:55], s27 offen
    s_add_u32 s27, s27, 4096
    s_cmp_eq_u32 s27, s20
    s_cselect_b32 s27, s21, s27
fused1_kernel_nm8:
    v_dot2_f32_bf16 v72, v8, s5, v72
    v_dot2_f32_bf16 v73, v8, v8, v73
    v_dot2_f32_bf16 v74, v9, s5, v74
    v_dot2_f32_bf16 v75, v9, v9, v75
    v_dot2_f32_bf16 v72, v10, s5, v72
    v_dot2_f32_bf16 v73, v10, v10, v73
    v_dot2_f32_bf16 v74, v11, s5, v74
    v_dot2_f32_bf16 v75, v11, v11, v75
    v_dot2_f32_bf16 v72, v12, s5, v72
    v_dot2_f32_bf16 v73, v12, v12, v73
    v_dot2_f32_bf16 v74, v13, s5, v74
    v_dot2_f32_bf16 v75, v13, v13, v75
    v_dot2_f32_bf16 v72, v14, s5, v72
    v_dot2_f32_bf16 v73, v14, v14, v73
    v_dot2_f32_bf16 v74, v15, s5, v74
    v_dot2_f32_bf16 v75, v15, v15, v75
    v_dot2_f32_bf16 v72, v16, s5, v72
    v_dot2_f32_bf16 v73, v16, v16, v73
    v_dot2_f32_bf16 v74, v17, s5, v74
    v_dot2_f32_bf16 v75, v17, v17, v75
    v_dot2_f32_bf16 v72, v18, s5, v72
    v_dot2_f32_bf16 v73, v18, v18, v73
    v_dot2_f32_bf16 v74, v19, s5, v74
    v_dot2_f32_bf16 v75, v19, v19, v75
    v_dot2_f32_bf16 v72, v20, s5, v72
    v_dot2_f32_bf16 v73, v20, v20, v73
    v_dot2_f32_bf16 v74, v21, s5, v74
    v_dot2_f32_bf16 v75, v21, v21, v75
    v_dot2_f32_bf16 v72, v22, s5, v72
    v_dot2_f32_bf16 v73, v22, v22, v73
    v_dot2_f32_bf16 v74, v23, s5, v74
    v_dot2_f32_bf16 v75, v23, v23, v75
    v_dot2_f32_bf16 v72, v24, s5, v72
    v_dot2_f32_bf16 v73, v24, v24, v73
    v_dot2_f32_bf16 v74, v25, s5, v74
    v_dot2_f32_bf16 v75, v25, v25, v75
    v_dot2_f32_bf16 v72, v26, s5, v72
    v_dot2_f32_bf16 v73, v26, v26, v73
    v_dot2_f32_bf16 v74, v27, s5, v74
    v_dot2_f32_bf16 v75, v27, v27, v75
    s_nop 4
    v_add_f32 v72, v72, v74
    v_add_f32 v73, v73, v75
    v_mov_b32 v74, v72
    v_mov_b32 v75, v73
    s_nop 1
    v_permlane32_swap_b32 v72, v74
    v_permlane32_swap_b32 v73, v75
    s_nop 1
    v_add_f32 v72, v72, v74
    v_add_f32 v73, v73, v75
    v_and_b32 v74, 31, v0
    v_lshlrev_b32 v74, 3, v74
    v_add_u32 v74, 81920, v74
    v_lshl_add_u32 v75, v1, 8, v74
    ds_write_b64 v75, v[72:73]
    s_cmp_eq_u32 s42, 0
    s_cbranch_scc1 fused1_kernel_kvd7
    v_lshl_add_u32 v6, v1, 12, v4
    v_add_u32 v6, 40960, v6
    ds_write_b128 v6, v[56:59] offset:0
    ds_write_b128 v6, v[60:63] offset:1024
    ds_write_b128 v6, v[64:67] offset:2048
    ds_write_b128 v6, v[68:71] offset:3072
fused1_kernel_kvd7:
    s_waitcnt lgkmcnt(0)
    s_barrier
    s_cmp_ge_u32 s40, 6
    s_cbranch_scc1 fused1_kernel_poll9
    s_cmp_eq_u32 s40, 5
    s_cbranch_scc1 fused1_kernel_red14
    s_setprio 0
    buffer_load_dwordx4 v[144:147], v92, s[52:55], s27 offen
    buffer_load_dwordx4 v[148:151], v93, s[52:55], s27 offen
    buffer_load_dwordx4 v[152:155], v94, s[52:55], s27 offen
    buffer_load_dwordx4 v[156:159], v95, s[52:55], s27 offen
    s_add_u32 s27, s27, 4096
    s_cmp_eq_u32 s27, s20
    s_cselect_b32 s27, s21, s27
    buffer_load_dwordx4 v[160:163], v92, s[52:55], s27 offen
    buffer_load_dwordx4 v[164:167], v93, s[52:55], s27 offen
    buffer_load_dwordx4 v[168:171], v94, s[52:55], s27 offen
    buffer_load_dwordx4 v[172:175], v95, s[52:55], s27 offen
    s_add_u32 s27, s27, 4096
    s_cmp_eq_u32 s27, s20
    s_cselect_b32 s27, s21, s27
    v_lshlrev_b32 v6, 4, v3
    s_lshl_b32 s5, s41, 7
    buffer_load_dwordx4 v[32:35], v6, s[8:11], s5 offen offset:0
    buffer_load_dwordx4 v[36:39], v6, s[8:11], s5 offen offset:32
    buffer_load_dwordx4 v[40:43], v6, s[8:11], s5 offen offset:64
    buffer_load_dwordx4 v[44:47], v6, s[8:11], s5 offen offset:96
    ds_read_b64 v[56:57], v74 offset:0
    ds_read_b64 v[58:59], v74 offset:256
    ds_read_b64 v[60:61], v74 offset:512
    ds_read_b64 v[62:63], v74 offset:768
    ds_read_b64 v[64:65], v74 offset:1024
    ds_read_b64 v[66:67], v74 offset:1280
    ds_read_b64 v[68:69], v74 offset:1536
    ds_read_b64 v[70:71], v74 offset:1792
    s_waitcnt lgkmcnt(0)
    v_pk_add_f32 v[56:57], v[56:57], v[58:59]
    v_pk_add_f32 v[60:61], v[60:61], v[62:63]
    v_pk_add_f32 v[64:65], v[64:65], v[66:67]
    v_pk_add_f32 v[68:69], v[68:69], v[70:71]
    v_pk_add_f32 v[56:57], v[56:57], v[60:61]
    v_pk_add_f32 v[64:65], v[64:65], v[68:69]
    v_pk_add_f32 v[56:57], v[56:57], v[64:65]
    v_mul_f32 v48, 0x3acccccd, v56
    v_mul_f32 v49, 0x3acccccd, v57
    v_fma_f32 v49, -v48, v48, v49
    v_max_f32 v49, 0, v49
    v_cvt_pk_bf16_f32 v48, v48, v48
    v_lshlrev_b32 v48, 16, v48
    v_cvt_pk_bf16_f32 v49, v49, v49
    v_lshlrev_b32 v49, 16, v49
    v_add_f32 v49, 0x3727c5ac, v49
    v_cvt_pk_bf16_f32 v49, v49, v49
    v_lshlrev_b32 v49, 16, v49
    v_sqrt_f32 v49, v49
    s_nop 0
    v_cvt_pk_bf16_f32 v49, v49, v49
    v_lshlrev_b32 v49, 16, v49
    v_rcp_f32 v49, v49
    s_nop 0
    v_mul_f32 v49, 0x3ea52b5c, v49
    v_mov_b32 v56, 0
    v_mov_b32 v57, 0
    v_mov_b32 v58, 0
    v_mov_b32 v59, 0
    v_mov_b32 v60, 0
    v_mov_b32 v61, 0
    v_mov_b32 v62, 0
    v_mov_b32 v63, 0
    v_mov_b32 v64, 0
    v_mov_b32 v65, 0
    v_mov_b32 v66, 0
    v_mov_b32 v67, 0
    v_mov_b32 v68, 0
    v_mov_b32 v69, 0
    v_mov_b32 v70, 0
    v_mov_b32 v71, 0
    v_mov_b32 v72, 0
    v_mov_b32 v73, 0
    v_mov_b32 v74, 0
    v_mov_b32 v75, 0
    v_mov_b32 v76, 0
    v_mov_b32 v77, 0
    v_mov_b32 v78, 0
    v_mov_b32 v79, 0
    v_mov_b32 v80, 0
    v_mov_b32 v81, 0
    v_mov_b32 v82, 0
    v_mov_b32 v83, 0
    v_mov_b32 v84, 0
    v_mov_b32 v85, 0
    v_mov_b32 v86, 0
    v_mov_b32 v87, 0
    ds_read_b64_tr_b16 v[8:9], v88 offset:0
    ds_read_b64_tr_b16 v[10:11], v88 offset:256
    ds_read_b64_tr_b16 v[12:13], v89 offset:0
    ds_read_b64_tr_b16 v[14:15], v89 offset:256
    ds_read_b64_tr_b16 v[16:17], v90 offset:0
    ds_read_b64_tr_b16 v[18:19], v90 offset:256
    ds_read_b64_tr_b16 v[20:21], v91 offset:0
    ds_read_b64_tr_b16 v[22:23], v91 offset:256
    s_cmp_eq_u32 s22, 1
    s_cselect_b32 s23, 40960, 0
    v_subrev_u32 v88, s23, v88
    v_subrev_u32 v89, s23, v89
    v_subrev_u32 v90, s23, v90
    v_subrev_u32 v91, s23, v91
    ds_read_b64_tr_b16 v[24:25], v88 offset:4096
    ds_read_b64_tr_b16 v[26:27], v88 offset:4352
    ds_read_b64_tr_b16 v[28:29], v89 offset:4096
    ds_read_b64_tr_b16 v[30:31], v89 offset:4352
    s_waitcnt vmcnt(23) lgkmcnt(10)
    v_mfma_f32_32x32x16_bf16 v[56:71], v[96:99], v[8:11], v[56:71]
    ds_read_b64_tr_b16 v[8:9], v90 offset:4096
    ds_read_b64_tr_b16 v[10:11], v90 offset:4352
    s_waitcnt vmcnt(22) lgkmcnt(10)
    v_mfma_f32_32x32x16_bf16 v[72:87], v[100:103], v[12:15], v[72:87]
    ds_read_b64_tr_b16 v[12:13], v91 offset:4096
    ds_read_b64_tr_b16 v[14:15], v91 offset:4352
    s_waitcnt vmcnt(21) lgkmcnt(10)
    v_mfma_f32_32x32x16_bf16 v[56:71], v[104:107], v[16:19], v[56:71]
    s_cmp_eq_u32 s22, 2
    s_cselect_b32 s23, 40960, 0
    v_subrev_u32 v88, s23, v88
    v_subrev_u32 v89, s23, v89
    v_subrev_u32 v90, s23, v90
    v_subrev_u32 v91, s23, v91
    ds_read_b64_tr_b16 v[16:17], v88 offset:8192
    ds_read_b64_tr_b16 v[18:19], v88 offset:8448
    s_waitcnt vmcnt(20) lgkmcnt(10)
    v_mfma_f32_32x32x16_bf16 v[72:87], v[108:111], v[20:23], v[72:87]
    ds_read_b64_tr_b16 v[20:21], v89 offset:8192
    ds_read_b64_tr_b16 v[22:23], v89 offset:8448
    s_waitcnt vmcnt(19) lgkmcnt(10)
    v_mfma_f32_32x32x16_bf16 v[56:71], v[112:115], v[24:27], v[56:71]
    ds_read_b64_tr_b16 v[24:25], v90 offset:8192
    ds_read_b64_tr_b16 v[26:27], v90 offset:8448
    s_waitcnt vmcnt(18) lgkmcnt(10)
    v_mfma_f32_32x32x16_bf16 v[72:87], v[116:119], v[28:31], v[72:87]
    ds_read_b64_tr_b16 v[28:29], v91 offset:8192
    ds_read_b64_tr_b16 v[30:31], v91 offset:8448
    s_waitcnt vmcnt(17) lgkmcnt(10)
    v_mfma_f32_32x32x16_bf16 v[56:71], v[120:123], v[8:11], v[56:71]
    s_cmp_eq_u32 s22, 3
    s_cselect_b32 s23, 40960, 0
    v_subrev_u32 v88, s23, v88
    v_subrev_u32 v89, s23, v89
    v_subrev_u32 v90, s23, v90
    v_subrev_u32 v91, s23, v91
    ds_read_b64_tr_b16 v[8:9], v88 offset:12288
    ds_read_b64_tr_b16 v[10:11], v88 offset:12544
    s_waitcnt vmcnt(16) lgkmcnt(10)
    v_mfma_f32_32x32x16_bf16 v[72:87], v[124:127], v[12:15], v[72:87]
    ds_read_b64_tr_b16 v[12:13], v89 offset:12288
    ds_read_b64_tr_b16 v[14:15], v89 offset:12544
    s_waitcnt vmcnt(15) lgkmcnt(10)
    v_mfma_f32_32x32x16_bf16 v[56:71], v[128:131], v[16:19], v[56:71]
    ds_read_b64_tr_b16 v[16:17], v90 offset:12288
    ds_read_b64_tr_b16 v[18:19], v90 offset:12544
    s_waitcnt vmcnt(14) lgkmcnt(10)
    v_mfma_f32_32x32x16_bf16 v[72:87], v[132:135], v[20:23], v[72:87]
    ds_read_b64_tr_b16 v[20:21], v91 offset:12288
    ds_read_b64_tr_b16 v[22:23], v91 offset:12544
    s_waitcnt vmcnt(13) lgkmcnt(10)
    v_mfma_f32_32x32x16_bf16 v[56:71], v[136:139], v[24:27], v[56:71]
    s_cmp_eq_u32 s22, 4
    s_cselect_b32 s23, 40960, 0
    v_subrev_u32 v88, s23, v88
    v_subrev_u32 v89, s23, v89
    v_subrev_u32 v90, s23, v90
    v_subrev_u32 v91, s23, v91
    ds_read_b64_tr_b16 v[24:25], v88 offset:16384
    ds_read_b64_tr_b16 v[26:27], v88 offset:16640
    s_waitcnt vmcnt(12) lgkmcnt(10)
    v_mfma_f32_32x32x16_bf16 v[72:87], v[140:143], v[28:31], v[72:87]
    s_cmp_eq_u32 s42, 0
    s_cbranch_scc1 fused1_kernel_qb15
    s_barrier
fused1_kernel_qb15:
    buffer_load_dwordx4 v[176:179], v92, s[52:55], s27 offen
    ds_read_b64_tr_b16 v[28:29], v89 offset:16384
    ds_read_b64_tr_b16 v[30:31], v89 offset:16640
    s_waitcnt vmcnt(12) lgkmcnt(10)
    v_mfma_f32_32x32x16_bf16 v[56:71], v[144:147], v[8:11], v[56:71]
    buffer_load_dwordx4 v[180:183], v93, s[52:55], s27 offen
    ds_read_b64_tr_b16 v[8:9], v90 offset:16384
    ds_read_b64_tr_b16 v[10:11], v90 offset:16640
    s_waitcnt vmcnt(12) lgkmcnt(10)
    v_mfma_f32_32x32x16_bf16 v[72:87], v[148:151], v[12:15], v[72:87]
    buffer_load_dwordx4 v[184:187], v94, s[52:55], s27 offen
    ds_read_b64_tr_b16 v[12:13], v91 offset:16384
    ds_read_b64_tr_b16 v[14:15], v91 offset:16640
    s_waitcnt vmcnt(12) lgkmcnt(10)
    v_mfma_f32_32x32x16_bf16 v[56:71], v[152:155], v[16:19], v[56:71]
    buffer_load_dwordx4 v[188:191], v95, s[52:55], s27 offen
    s_add_u32 s27, s27, 4096
    s_cmp_eq_u32 s27, s20
    s_cselect_b32 s27, s21, s27
    s_cmp_eq_u32 s22, 5
    s_cselect_b32 s23, 40960, 0
    v_subrev_u32 v88, s23, v88
    v_subrev_u32 v89, s23, v89
    v_subrev_u32 v90, s23, v90
    v_subrev_u32 v91, s23, v91
    ds_read_b64_tr_b16 v[16:17], v88 offset:20480
    ds_read_b64_tr_b16 v[18:19], v88 offset:20736
    s_waitcnt vmcnt(12) lgkmcnt(10)
    v_mfma_f32_32x32x16_bf16 v[72:87], v[156:159], v[20:23], v[72:87]
    buffer_load_dwordx4 v[192:195], v92, s[52:55], s27 offen
    ds_read_b64_tr_b16 v[20:21], v89 offset:20480
    ds_read_b64_tr_b16 v[22:23], v89 offset:20736
    s_waitcnt vmcnt(12) lgkmcnt(10)
    v_mfma_f32_32x32x16_bf16 v[56:71], v[160:163], v[24:27], v[56:71]
    buffer_load_dwordx4 v[196:199], v93, s[52:55], s27 offen
    ds_read_b64_tr_b16 v[24:25], v90 offset:20480
    ds_read_b64_tr_b16 v[26:27], v90 offset:20736
    s_waitcnt vmcnt(12) lgkmcnt(10)
    v_mfma_f32_32x32x16_bf16 v[72:87], v[164:167], v[28:31], v[72:87]
    buffer_load_dwordx4 v[200:203], v94, s[52:55], s27 offen
    ds_read_b64_tr_b16 v[28:29], v91 offset:20480
    ds_read_b64_tr_b16 v[30:31], v91 offset:20736
    s_waitcnt vmcnt(12) lgkmcnt(10)
    v_mfma_f32_32x32x16_bf16 v[56:71], v[168:171], v[8:11], v[56:71]
    buffer_load_dwordx4 v[204:207], v95, s[52:55], s27 offen
    s_add_u32 s27, s27, 4096
    s_cmp_eq_u32 s27, s20
    s_cselect_b32 s27, s21, s27
    s_cmp_eq_u32 s22, 6
    s_cselect_b32 s23, 40960, 0
    v_subrev_u32 v88, s23, v88
    v_subrev_u32 v89, s23, v89
    v_subrev_u32 v90, s23, v90
    v_subrev_u32 v91, s23, v91
    ds_read_b64_tr_b16 v[8:9], v88 offset:24576
    ds_read_b64_tr_b16 v[10:11], v88 offset:24832
    s_waitcnt vmcnt(12) lgkmcnt(10)
    v_mfma_f32_32x32x16_bf16 v[72:87], v[172:175], v[12:15], v[72:87]
    buffer_load_dwordx4 v[208:211], v92, s[52:55], s27 offen
    ds_read_b64_tr_b16 v[12:13], v89 offset:24576
    ds_read_b64_tr_b16 v[14:15], v89 offset:24832
    s_waitcnt vmcnt(8) lgkmcnt(10)
    v_mfma_f32_32x32x16_bf16 v[56:71], v[176:179], v[16:19], v[56:71]
    buffer_load_dwordx4 v[212:215], v93, s[52:55], s27 offen
    ds_read_b64_tr_b16 v[16:17], v90 offset:24576
    ds_read_b64_tr_b16 v[18:19], v90 offset:24832
    s_waitcnt vmcnt(8) lgkmcnt(10)
    v_mfma_f32_32x32x16_bf16 v[72:87], v[180:183], v[20:23], v[72:87]
    buffer_load_dwordx4 v[216:219], v94, s[52:55], s27 offen
    ds_read_b64_tr_b16 v[20:21], v91 offset:24576
    ds_read_b64_tr_b16 v[22:23], v91 offset:24832
    s_waitcnt vmcnt(8) lgkmcnt(10)
    v_mfma_f32_32x32x16_bf16 v[56:71], v[184:187], v[24:27], v[56:71]
    buffer_load_dwordx4 v[220:223], v95, s[52:55], s27 offen
    s_add_u32 s27, s27, 4096
    s_cmp_eq_u32 s27, s20
    s_cselect_b32 s27, s21, s27
    s_cmp_eq_u32 s22, 7
    s_cselect_b32 s23, 40960, 0
    v_subrev_u32 v88, s23, v88
    v_subrev_u32 v89, s23, v89
    v_subrev_u32 v90, s23, v90
    v_subrev_u32 v91, s23, v91
    ds_read_b64_tr_b16 v[24:25], v88 offset:28672
    ds_read_b64_tr_b16 v[26:27], v88 offset:28928
    s_waitcnt vmcnt(8) lgkmcnt(10)
    v_mfma_f32_32x32x16_bf16 v[72:87], v[188:191], v[28:31], v[72:87]
    buffer_load_dwordx4 v[224:227], v92, s[52:55], s27 offen
    ds_read_b64_tr_b16 v[28:29], v89 offset:28672
    ds_read_b64_tr_b16 v[30:31], v89 offset:28928
    s_waitcnt vmcnt(8) lgkmcnt(10)
    v_mfma_f32_32x32x16_bf16 v[56:71], v[192:195], v[8:11], v[56:71]
    buffer_load_dwordx4 v[228:231], v93, s[52:55], s27 offen
    ds_read_b64_tr_b16 v[8:9], v90 offset:28672
    ds_read_b64_tr_b16 v[10:11], v90 offset:28928
    s_waitcnt vmcnt(8) lgkmcnt(10)
    v_mfma_f32_32x32x16_bf16 v[72:87], v[196:199], v[12:15], v[72:87]
    buffer_load_dwordx4 v[232:235], v94, s[52:55], s27 offen
    ds_read_b64_tr_b16 v[12:13], v91 offset:28672
    ds_read_b64_tr_b16 v[14:15], v91 offset:28928
    s_waitcnt vmcnt(8) lgkmcnt(10)
    v_mfma_f32_32x32x16_bf16 v[56:71], v[200:203], v[16:19], v[56:71]
    buffer_load_dwordx4 v[236:239], v95, s[52:55], s27 offen
    s_add_u32 s27, s27, 4096
    s_cmp_eq_u32 s27, s20
    s_cselect_b32 s27, s21, s27
    s_cmp_eq_u32 s22, 8
    s_cselect_b32 s23, 40960, 0
    v_subrev_u32 v88, s23, v88
    v_subrev_u32 v89, s23, v89
    v_subrev_u32 v90, s23, v90
    v_subrev_u32 v91, s23, v91
    ds_read_b64_tr_b16 v[16:17], v88 offset:32768
    ds_read_b64_tr_b16 v[18:19], v88 offset:33024
    s_waitcnt vmcnt(8) lgkmcnt(10)
    v_mfma_f32_32x32x16_bf16 v[72:87], v[204:207], v[20:23], v[72:87]
    buffer_load_dwordx4 v[240:243], v92, s[52:55], s27 offen
    ds_read_b64_tr_b16 v[20:21], v89 offset:32768
    ds_read_b64_tr_b16 v[22:23], v89 offset:33024
    s_waitcnt vmcnt(8) lgkmcnt(10)
    v_mfma_f32_32x32x16_bf16 v[56:71], v[208:211], v[24:27], v[56:71]
    buffer_load_dwordx4 v[244:247], v93, s[52:55], s27 offen
    ds_read_b64_tr_b16 v[24:25], v90 offset:32768
    ds_read_b64_tr_b16 v[26:27], v90 offset:33024
    s_waitcnt vmcnt(8) lgkmcnt(10)
    v_mfma_f32_32x32x16_bf16 v[72:87], v[212:215], v[28:31], v[72:87]
    buffer_load_dwordx4 v[248:251], v94, s[52:55], s27 offen
    ds_read_b64_tr_b16 v[28:29], v91 offset:32768
    ds_read_b64_tr_b16 v[30:31], v91 offset:33024
    s_waitcnt vmcnt(8) lgkmcnt(10)
    v_mfma_f32_32x32x16_bf16 v[56:71], v[216:219], v[8:11], v[56:71]
    buffer_load_dwordx4 v[252:255], v95, s[52:55], s27 offen
    s_cmp_eq_u32 s22, 9
    s_cselect_b32 s23, 40960, 0
    v_subrev_u32 v88, s23, v88
    v_subrev_u32 v89, s23, v89
    v_subrev_u32 v90, s23, v90
    v_subrev_u32 v91, s23, v91
    ds_read_b64_tr_b16 v[8:9], v88 offset:36864
    ds_read_b64_tr_b16 v[10:11], v88 offset:37120
    s_waitcnt vmcnt(8) lgkmcnt(10)
    v_mfma_f32_32x32x16_bf16 v[72:87], v[220:223], v[12:15], v[72:87]
    ds_read_b64_tr_b16 v[12:13], v89 offset:36864
    ds_read_b64_tr_b16 v[14:15], v89 offset:37120
    s_waitcnt vmcnt(7) lgkmcnt(10)
    v_mfma_f32_32x32x16_bf16 v[56:71], v[224:227], v[16:19], v[56:71]
    ds_read_b64_tr_b16 v[16:17], v90 offset:36864
    ds_read_b64_tr_b16 v[18:19], v90 offset:37120
    s_waitcnt vmcnt(6) lgkmcnt(10)
    v_mfma_f32_32x32x16_bf16 v[72:87], v[228:231], v[20:23], v[72:87]
    ds_read_b64_tr_b16 v[20:21], v91 offset:36864
    ds_read_b64_tr_b16 v[22:23], v91 offset:37120
    s_waitcnt vmcnt(5) lgkmcnt(10)
    v_mfma_f32_32x32x16_bf16 v[56:71], v[232:235], v[24:27], v[56:71]
    s_waitcnt vmcnt(4) lgkmcnt(8)
    v_mfma_f32_32x32x16_bf16 v[72:87], v[236:239], v[28:31], v[72:87]
    s_waitcnt vmcnt(3) lgkmcnt(6)
    v_mfma_f32_32x32x16_bf16 v[56:71], v[240:243], v[8:11], v[56:71]
    s_waitcnt vmcnt(2) lgkmcnt(4)
    v_mfma_f32_32x32x16_bf16 v[72:87], v[244:247], v[12:15], v[72:87]
    s_waitcnt vmcnt(1) lgkmcnt(2)
    v_mfma_f32_32x32x16_bf16 v[56:71], v[248:251], v[16:19], v[56:71]
    s_waitcnt vmcnt(0) lgkmcnt(0)
    v_mfma_f32_32x32x16_bf16 v[72:87], v[252:255], v[20:23], v[72:87]
    s_nop 15
    s_nop 3
    v_add_f32 v56, v56, v72
    v_add_f32 v57, v57, v73
    v_add_f32 v58, v58, v74
    v_add_f32 v59, v59, v75
    v_add_f32 v60, v60, v76
    v_add_f32 v61, v61, v77
    v_add_f32 v62, v62, v78
    v_add_f32 v63, v63, v79
    v_add_f32 v64, v64, v80
    v_add_f32 v65, v65, v81
    v_add_f32 v66, v66, v82
    v_add_f32 v67, v67, v83
    v_add_f32 v68, v68, v84
    v_add_f32 v69, v69, v85
    v_add_f32 v70, v70, v86
    v_add_f32 v71, v71, v87
    s_waitcnt vmcnt(0)
    v_and_b32 v2, 31, v0
    v_mul_u32_u24 v4, 328, v2
    v_lshl_add_u32 v4, v3, 3, v4
    s_lshl_b32 s29, s40, 6
    s_add_u32 s29, s29, 84224
    v_add_u32 v4, s29, v4
    v_fma_f32 v56, -v48, v32, v56
    v_fma_f32 v57, -v48, v33, v57
    v_fma_f32 v58, -v48, v34, v58
    v_fma_f32 v59, -v48, v35, v59
    v_fma_f32 v60, -v48, v36, v60
    v_fma_f32 v61, -v48, v37, v61
    v_fma_f32 v62, -v48, v38, v62
    v_fma_f32 v63, -v48, v39, v63
    v_fma_f32 v64, -v48, v40, v64
    v_fma_f32 v65, -v48, v41, v65
    v_fma_f32 v66, -v48, v42, v66
    v_fma_f32 v67, -v48, v43, v67
    v_fma_f32 v68, -v48, v44, v68
    v_fma_f32 v69, -v48, v45, v69
    v_fma_f32 v70, -v48, v46, v70
    v_fma_f32 v71, -v48, v47, v71
    v_mul_f32 v56, v49, v56
    v_mul_f32 v57, v49, v57
    v_mul_f32 v58, v49, v58
    v_mul_f32 v59, v49, v59
    v_mul_f32 v60, v49, v60
    v_mul_f32 v61, v49, v61
    v_mul_f32 v62, v49, v62
    v_mul_f32 v63, v49, v63
    v_mul_f32 v64, v49, v64
    v_mul_f32 v65, v49, v65
    v_mul_f32 v66, v49, v66
    v_mul_f32 v67, v49, v67
    v_mul_f32 v68, v49, v68
    v_mul_f32 v69, v49, v69
    v_mul_f32 v70, v49, v70
    v_mul_f32 v71, v49, v71
    v_cvt_pk_bf16_f32 v8, v56, v57
    v_cvt_pk_bf16_f32 v9, v58, v59
    v_cvt_pk_bf16_f32 v10, v60, v61
    v_cvt_pk_bf16_f32 v11, v62, v63
    v_cvt_pk_bf16_f32 v12, v64, v65
    v_cvt_pk_bf16_f32 v13, v66, v67
    v_cvt_pk_bf16_f32 v14, v68, v69
    v_cvt_pk_bf16_f32 v15, v70, v71
    ds_write_b64 v4, v[8:9] offset:0
    ds_write_b64 v4, v[10:11] offset:16
    ds_write_b64 v4, v[12:13] offset:32
    ds_write_b64 v4, v[14:15] offset:48
    s_waitcnt lgkmcnt(0)
    s_branch fused1_kernel_barx10
fused1_kernel_red14:
    s_setprio 3
    s_cmp_eq_u32 s42, 0
    s_cbranch_scc1 fused1_kernel_barx10
    v_and_b32 v2, 31, v0
    ds_read_b64 v[56:57], v74 offset:0
    ds_read_b64 v[58:59], v74 offset:256
    ds_read_b64 v[60:61], v74 offset:512
    ds_read_b64 v[62:63], v74 offset:768
    ds_read_b64 v[64:65], v74 offset:1024
    ds_read_b64 v[66:67], v74 offset:1280
    ds_read_b64 v[68:69], v74 offset:1536
    ds_read_b64 v[70:71], v74 offset:1792
    s_waitcnt lgkmcnt(0)
    v_pk_add_f32 v[56:57], v[56:57], v[58:59]
    v_pk_add_f32 v[60:61], v[60:61], v[62:63]
    v_pk_add_f32 v[64:65], v[64:65], v[66:67]
    v_pk_add_f32 v[68:69], v[68:69], v[70:71]
    v_pk_add_f32 v[56:57], v[56:57], v[60:61]
    v_pk_add_f32 v[64:65], v[64:65], v[68:69]
    v_pk_add_f32 v[56:57], v[56:57], v[64:65]
    v_mul_f32 v48, 0x3acccccd, v56
    v_mul_f32 v49, 0x3acccccd, v57
    v_fma_f32 v49, -v48, v48, v49
    v_max_f32 v49, 0, v49
    v_cvt_pk_bf16_f32 v48, v48, v48
    v_lshlrev_b32 v48, 16, v48
    v_cvt_pk_bf16_f32 v49, v49, v49
    v_lshlrev_b32 v49, 16, v49
    v_add_f32 v49, 0x3727c5ac, v49
    v_cvt_pk_bf16_f32 v49, v49, v49
    v_lshlrev_b32 v49, 16, v49
    v_sqrt_f32 v49, v49
    s_nop 0
    v_cvt_pk_bf16_f32 v49, v49, v49
    v_lshlrev_b32 v49, 16, v49
    v_rcp_f32 v49, v49
    s_nop 0
    v_add_u32 v6, 2048, v74
    ds_write_b64 v6, v[48:49]
    v_add_u32 v6, 40960, v4
    ds_read_b128 v[96:99], v6 offset:0
    ds_read_b128 v[100:103], v6 offset:1024
    ds_read_b128 v[104:107], v6 offset:2048
    ds_read_b128 v[108:111], v6 offset:3072
    ds_read_b128 v[112:115], v6 offset:4096
    ds_read_b128 v[116:119], v6 offset:5120
    ds_read_b128 v[120:123], v6 offset:6144
    ds_read_b128 v[124:127], v6 offset:7168
    s_bfe_u32 s34, s3, 0x20003
    s_mul_i32 s34, s34, 40960
    s_lshr_b32 s35, s3, 5
    s_lshl_b32 s35, s35, 3
    s_and_b32 s31, s3, 7
    s_add_u32 s31, s31, s35
    ds_read_b128 v[128:131], v6 offset:8192
    ds_read_b128 v[132:135], v6 offset:9216
    ds_read_b128 v[136:139], v6 offset:10240
    ds_read_b128 v[140:143], v6 offset:11264
    s_waitcnt lgkmcnt(4)
    v_pk_add_f32 v[96:97], v[96:97], v[112:113]
    v_pk_add_f32 v[98:99], v[98:99], v[114:115]
    v_pk_add_f32 v[100:101], v[100:101], v[116:117]
    v_pk_add_f32 v[102:103], v[102:103], v[118:119]
    v_pk_add_f32 v[104:105], v[104:105], v[120:121]
    v_pk_add_f32 v[106:107], v[106:107], v[122:123]
    v_pk_add_f32 v[108:109], v[108:109], v[124:125]
    v_pk_add_f32 v[110:111], v[110:111], v[126:127]
    ds_read_b128 v[144:147], v6 offset:12288
    ds_read_b128 v[148:151], v6 offset:13312
    ds_read_b128 v[152:155], v6 offset:14336
    ds_read_b128 v[156:159], v6 offset:15360
    s_waitcnt lgkmcnt(4)
    v_pk_add_f32 v[96:97], v[96:97], v[128:129]
    v_pk_add_f32 v[98:99], v[98:99], v[130:131]
    v_pk_add_f32 v[100:101], v[100:101], v[132:133]
    v_pk_add_f32 v[102:103], v[102:103], v[134:135]
    v_pk_add_f32 v[104:105], v[104:105], v[136:137]
    v_pk_add_f32 v[106:107], v[106:107], v[138:139]
    v_pk_add_f32 v[108:109], v[108:109], v[140:141]
    v_pk_add_f32 v[110:111], v[110:111], v[142:143]
    ds_read_b128 v[160:163], v6 offset:16384
    ds_read_b128 v[164:167], v6 offset:17408
    ds_read_b128 v[168:171], v6 offset:18432
    ds_read_b128 v[172:175], v6 offset:19456
    s_waitcnt lgkmcnt(4)
    v_pk_add_f32 v[96:97], v[96:97], v[144:145]
    v_pk_add_f32 v[98:99], v[98:99], v[146:147]
    v_pk_add_f32 v[100:101], v[100:101], v[148:149]
    v_pk_add_f32 v[102:103], v[102:103], v[150:151]
    v_pk_add_f32 v[104:105], v[104:105], v[152:153]
    v_pk_add_f32 v[106:107], v[106:107], v[154:155]
    v_pk_add_f32 v[108:109], v[108:109], v[156:157]
    v_pk_add_f32 v[110:111], v[110:111], v[158:159]
    ds_read_b128 v[176:179], v6 offset:20480
    ds_read_b128 v[180:183], v6 offset:21504
    ds_read_b128 v[184:187], v6 offset:22528
    ds_read_b128 v[188:191], v6 offset:23552
    s_waitcnt lgkmcnt(4)
    v_pk_add_f32 v[96:97], v[96:97], v[160:161]
    v_pk_add_f32 v[98:99], v[98:99], v[162:163]
    v_pk_add_f32 v[100:101], v[100:101], v[164:165]
    v_pk_add_f32 v[102:103], v[102:103], v[166:167]
    v_pk_add_f32 v[104:105], v[104:105], v[168:169]
    v_pk_add_f32 v[106:107], v[106:107], v[170:171]
    v_pk_add_f32 v[108:109], v[108:109], v[172:173]
    v_pk_add_f32 v[110:111], v[110:111], v[174:175]
    ds_read_b128 v[192:195], v6 offset:24576
    ds_read_b128 v[196:199], v6 offset:25600
    ds_read_b128 v[200:203], v6 offset:26624
    ds_read_b128 v[204:207], v6 offset:27648
    s_waitcnt lgkmcnt(4)
    v_pk_add_f32 v[96:97], v[96:97], v[176:177]
    v_pk_add_f32 v[98:99], v[98:99], v[178:179]
    v_pk_add_f32 v[100:101], v[100:101], v[180:181]
    v_pk_add_f32 v[102:103], v[102:103], v[182:183]
    v_pk_add_f32 v[104:105], v[104:105], v[184:185]
    v_pk_add_f32 v[106:107], v[106:107], v[186:187]
    v_pk_add_f32 v[108:109], v[108:109], v[188:189]
    v_pk_add_f32 v[110:111], v[110:111], v[190:191]
    ds_read_b128 v[208:211], v6 offset:28672
    ds_read_b128 v[212:215], v6 offset:29696
    ds_read_b128 v[216:219], v6 offset:30720
    ds_read_b128 v[220:223], v6 offset:31744
    s_waitcnt lgkmcnt(4)
    v_pk_add_f32 v[96:97], v[96:97], v[192:193]
    v_pk_add_f32 v[98:99], v[98:99], v[194:195]
    v_pk_add_f32 v[100:101], v[100:101], v[196:197]
    v_pk_add_f32 v[102:103], v[102:103], v[198:199]
    v_pk_add_f32 v[104:105], v[104:105], v[200:201]
    v_pk_add_f32 v[106:107], v[106:107], v[202:203]
    v_pk_add_f32 v[108:109], v[108:109], v[204:205]
    v_pk_add_f32 v[110:111], v[110:111], v[206:207]
    s_waitcnt lgkmcnt(0)
    v_pk_add_f32 v[56:57], v[96:97], v[208:209]
    v_pk_add_f32 v[58:59], v[98:99], v[210:211]
    v_pk_add_f32 v[60:61], v[100:101], v[212:213]
    v_pk_add_f32 v[62:63], v[102:103], v[214:215]
    v_pk_add_f32 v[64:65], v[104:105], v[216:217]
    v_pk_add_f32 v[66:67], v[106:107], v[218:219]
    v_pk_add_f32 v[68:69], v[108:109], v[220:221]
    v_pk_add_f32 v[70:71], v[110:111], v[222:223]
    s_waitcnt vmcnt(0)
    s_cmp_eq_u32 s4, 1
    s_cbranch_scc1 fused1_kernel_v12
    v_fma_f32 v56, -v48, v224, v56
    v_fma_f32 v57, -v48, v225, v57
    v_fma_f32 v58, -v48, v226, v58
    v_fma_f32 v59, -v48, v227, v59
    v_fma_f32 v60, -v48, v228, v60
    v_fma_f32 v61, -v48, v229, v61
    v_fma_f32 v62, -v48, v230, v62
    v_fma_f32 v63, -v48, v231, v63
    v_fma_f32 v64, -v48, v232, v64
    v_fma_f32 v65, -v48, v233, v65
    v_fma_f32 v66, -v48, v234, v66
    v_fma_f32 v67, -v48, v235, v67
    v_mul_f32 v56, v49, v56
    v_mul_f32 v57, v49, v57
    v_mul_f32 v58, v49, v58
    v_mul_f32 v59, v49, v59
    v_mul_f32 v60, v49, v60
    v_mul_f32 v61, v49, v61
    v_mul_f32 v62, v49, v62
    v_mul_f32 v63, v49, v63
    v_mul_f32 v64, v49, v64
    v_mul_f32 v65, v49, v65
    v_mul_f32 v66, v49, v66
    v_mul_f32 v67, v49, v67
    v_cvt_pk_bf16_f32 v8, v56, v57
    v_cvt_pk_bf16_f32 v9, v58, v59
    v_cvt_pk_bf16_f32 v10, v60, v61
    v_cvt_pk_bf16_f32 v11, v62, v63
    v_cvt_pk_bf16_f32 v12, v64, v65
    v_cvt_pk_bf16_f32 v13, v66, v67
    v_lshlrev_b32 v4, 4, v2
    v_lshl_add_u32 v4, v3, 3, v4
    s_lshl_b32 s28, s31, 10
    s_add_u32 s28, s28, s34
    buffer_store_dwordx2 v[8:9], v4, s[56:59], s28 offen offset:0 sc1
    buffer_store_dwordx2 v[10:11], v4, s[56:59], s28 offen offset:512 sc1
    v_lshlrev_b32 v4, 3, v2
    s_lshl_b32 s28, s31, 8
    s_add_u32 s28, s28, 16384
    s_add_u32 s28, s28, s34
    s_mov_b32 exec_lo, -1
    s_mov_b32 exec_hi, 0
    buffer_store_dwordx2 v[12:13], v4, s[56:59], s28 offen sc1
    s_branch fused1_kernel_flag13
fused1_kernel_v12:
    v_lshlrev_b32 v6, 5, v3
    v_add_u32 v6, 83968, v6
    ds_read_b128 v[96:99], v6 offset:0
    ds_read_b128 v[100:103], v6 offset:16
    ds_read_b128 v[104:107], v6 offset:64
    ds_read_b128 v[108:111], v6 offset:80
    ds_read_b128 v[112:115], v6 offset:128
    ds_read_b128 v[116:119], v6 offset:144
    ds_read_b128 v[120:123], v6 offset:192
    ds_read_b128 v[124:127], v6 offset:208
    v_mul_u32_u24 v4, 320, v3
    v_lshl_add_u32 v4, v2, 4, v4
    s_mul_i32 s28, s31, 1280
    s_add_u32 s28, s28, 20480
    s_add_u32 s28, s28, s34
    s_mov_b32 s22, 0x000fffff
    s_mov_b32 s23, 0x000fffff
    s_waitcnt lgkmcnt(0)
    v_fma_f32 v56, -v96, v240, v56
    v_fma_f32 v57, -v98, v240, v57
    v_fma_f32 v58, -v100, v240, v58
    v_fma_f32 v59, -v102, v240, v59
    v_fma_f32 v60, -v104, v240, v60
    v_fma_f32 v61, -v106, v240, v61
    v_fma_f32 v62, -v108, v240, v62
    v_fma_f32 v63, -v110, v240, v63
    v_fma_f32 v64, -v112, v240, v64
    v_fma_f32 v65, -v114, v240, v65
    v_fma_f32 v66, -v116, v240, v66
    v_fma_f32 v67, -v118, v240, v67
    v_fma_f32 v68, -v120, v240, v68
    v_fma_f32 v69, -v122, v240, v69
    v_fma_f32 v70, -v124, v240, v70
    v_fma_f32 v71, -v126, v240, v71
    v_mul_f32 v56, v97, v56
    v_mul_f32 v57, v99, v57
    v_mul_f32 v58, v101, v58
    v_mul_f32 v59, v103, v59
    v_mul_f32 v60, v105, v60
    v_mul_f32 v61, v107, v61
    v_mul_f32 v62, v109, v62
    v_mul_f32 v63, v111, v63
    v_mul_f32 v64, v113, v64
    v_mul_f32 v65, v115, v65
    v_mul_f32 v66, v117, v66
    v_mul_f32 v67, v119, v67
    v_mul_f32 v68, v121, v68
    v_mul_f32 v69, v123, v69
    v_mul_f32 v70, v125, v70
    v_mul_f32 v71, v127, v71
    v_cvt_pk_bf16_f32 v8, v56, v57
    v_cvt_pk_bf16_f32 v9, v58, v59
    v_cvt_pk_bf16_f32 v10, v60, v61
    v_cvt_pk_bf16_f32 v11, v62, v63
    v_cvt_pk_bf16_f32 v12, v64, v65
    v_cvt_pk_bf16_f32 v13, v66, v67
    v_cvt_pk_bf16_f32 v14, v68, v69
    v_cvt_pk_bf16_f32 v15, v70, v71
    s_mov_b64 exec, s[22:23]
    buffer_store_dwordx4 v[8:11], v4, s[56:59], s28 offen sc1
    buffer_store_dwordx4 v[12:15], v4, s[56:59], s28 offen offset:640 sc1
fused1_kernel_flag13:
    s_mov_b64 exec, -1
    v_and_b32 v4, 63, v0
    v_lshlrev_b32 v4, 11, v4
    v_mov_b32 v5, 1
    s_lshl_b32 s28, s3, 1
    s_add_u32 s28, s28, s4
    s_lshr_b32 s29, s28, 3
    s_lshl_b32 s29, s29, 7
    s_and_b32 s28, s28, 7
    s_lshl_b32 s28, s28, 2
    s_add_u32 s28, s28, s29
    s_add_u32 s28, s28, 0
    s_mov_b32 exec_lo, 0xffff
    s_mov_b32 exec_hi, 0
    buffer_store_dword v5, v4, s[68:71], s28 offen sc1
    s_mov_b64 exec, -1
    s_barrier
    s_branch fused1_kernel_barx10
fused1_kernel_poll9:
    s_setprio 2
    s_cmp_eq_u32 s42, 0
    s_cbranch_scc1 fused1_kernel_nb16
    s_barrier
fused1_kernel_nb16:
    v_lshrrev_b32 v5, 2, v2
    v_lshlrev_b32 v5, 7, v5
    v_and_b32 v6, 3, v2
    v_lshl_add_u32 v5, v6, 3, v5
    s_and_b32 s28, s2, 15
    s_lshl_b32 s28, s28, 11
    s_add_u32 s28, s28, 0
    s_mov_b32 s29, 0
fused1_kernel_pl17:
    buffer_load_dwordx2 v[8:9], v5, s[68:71], s28 offen sc1
    s_waitcnt vmcnt(0)
    v_and_b32 v8, v8, v9
    v_cmp_ne_u32 vcc, 1, v8
    s_cbranch_vccz fused1_kernel_pd18
    s_sleep 1
    s_add_u32 s29, s29, 1
    s_cmp_lt_u32 s29, 0x8000
    s_cbranch_scc1 fused1_kernel_pl17
fused1_kernel_pd18:
    s_sub_u32 s20, s40, 6
    s_mul_i32 s20, s20, 20480
    v_add_u32 v5, s20, v4
    s_mov_b32 s21, s20
    buffer_load_dwordx4 v[96:99], v4, s[56:59], s21 offen offset:0
    buffer_load_dwordx4 v[100:103], v4, s[56:59], s21 offen offset:1024
    buffer_load_dwordx4 v[104:107], v4, s[56:59], s21 offen offset:2048
    buffer_load_dwordx4 v[108:111], v4, s[56:59], s21 offen offset:3072
    s_add_u32 s21, s21, 4096
    buffer_load_dwordx4 v[112:115], v4, s[56:59], s21 offen offset:0
    buffer_load_dwordx4 v[116:119], v4, s[56:59], s21 offen offset:1024
    buffer_load_dwordx4 v[120:123], v4, s[56:59], s21 offen offset:2048
    buffer_load_dwordx4 v[124:127], v4, s[56:59], s21 offen offset:3072
    s_add_u32 s21, s21, 4096
    buffer_load_dwordx4 v[128:131], v4, s[56:59], s21 offen offset:0
    buffer_load_dwordx4 v[132:135], v4, s[56:59], s21 offen offset:1024
    buffer_load_dwordx4 v[136:139], v4, s[56:59], s21 offen offset:2048
    buffer_load_dwordx4 v[140:143], v4, s[56:59], s21 offen offset:3072
    s_add_u32 s21, s21, 4096
    buffer_load_dwordx4 v[144:147], v4, s[56:59], s21 offen offset:0
    buffer_load_dwordx4 v[148:151], v4, s[56:59], s21 offen offset:1024
    buffer_load_dwordx4 v[152:155], v4, s[56:59], s21 offen offset:2048
    buffer_load_dwordx4 v[156:159], v4, s[56:59], s21 offen offset:3072
    s_add_u32 s21, s21, 4096
    buffer_load_dwordx4 v[160:163], v4, s[56:59], s21 offen offset:0
    buffer_load_dwordx4 v[164:167], v4, s[56:59], s21 offen offset:1024
    buffer_load_dwordx4 v[168:171], v4, s[56:59], s21 offen offset:2048
    buffer_load_dwordx4 v[172:175], v4, s[56:59], s21 offen offset:3072
    v_mov_b32 v28, 0
    v_mov_b32 v29, 0
    s_waitcnt vmcnt(19)
    ds_write_b128 v5, v[96:99] offset:0
    v_max3_u32 v28, v28, v96, v97
    v_max3_u32 v29, v29, v98, v99
    s_waitcnt vmcnt(18)
    ds_write_b128 v5, v[100:103] offset:1024
    v_max3_u32 v28, v28, v100, v101
    v_max3_u32 v29, v29, v102, v103
    s_waitcnt vmcnt(17)
    ds_write_b128 v5, v[104:107] offset:2048
    v_max3_u32 v28, v28, v104, v105
    v_max3_u32 v29, v29, v106, v107
    s_waitcnt vmcnt(16)
    ds_write_b128 v5, v[108:111] offset:3072
    v_max3_u32 v28, v28, v108, v109
    v_max3_u32 v29, v29, v110, v111
    s_waitcnt vmcnt(15)
    ds_write_b128 v5, v[112:115] offset:4096
    v_max3_u32 v28, v28, v112, v113
    v_max3_u32 v29, v29, v114, v115
    s_waitcnt vmcnt(14)
    ds_write_b128 v5, v[116:119] offset:5120
    v_max3_u32 v28, v28, v116, v117
    v_max3_u32 v29, v29, v118, v119
    s_waitcnt vmcnt(13)
    ds_write_b128 v5, v[120:123] offset:6144
    v_max3_u32 v28, v28, v120, v121
    v_max3_u32 v29, v29, v122, v123
    s_waitcnt vmcnt(12)
    ds_write_b128 v5, v[124:127] offset:7168
    v_max3_u32 v28, v28, v124, v125
    v_max3_u32 v29, v29, v126, v127
    s_waitcnt vmcnt(11)
    ds_write_b128 v5, v[128:131] offset:8192
    v_max3_u32 v28, v28, v128, v129
    v_max3_u32 v29, v29, v130, v131
    s_waitcnt vmcnt(10)
    ds_write_b128 v5, v[132:135] offset:9216
    v_max3_u32 v28, v28, v132, v133
    v_max3_u32 v29, v29, v134, v135
    s_waitcnt vmcnt(9)
    ds_write_b128 v5, v[136:139] offset:10240
    v_max3_u32 v28, v28, v136, v137
    v_max3_u32 v29, v29, v138, v139
    s_waitcnt vmcnt(8)
    ds_write_b128 v5, v[140:143] offset:11264
    v_max3_u32 v28, v28, v140, v141
    v_max3_u32 v29, v29, v142, v143
    s_waitcnt vmcnt(7)
    ds_write_b128 v5, v[144:147] offset:12288
    v_max3_u32 v28, v28, v144, v145
    v_max3_u32 v29, v29, v146, v147
    s_waitcnt vmcnt(6)
    ds_write_b128 v5, v[148:151] offset:13312
    v_max3_u32 v28, v28, v148, v149
    v_max3_u32 v29, v29, v150, v151
    s_waitcnt vmcnt(5)
    ds_write_b128 v5, v[152:155] offset:14336
    v_max3_u32 v28, v28, v152, v153
    v_max3_u32 v29, v29, v154, v155
    s_waitcnt vmcnt(4)
    ds_write_b128 v5, v[156:159] offset:15360
    v_max3_u32 v28, v28, v156, v157
    v_max3_u32 v29, v29, v158, v159
    s_waitcnt vmcnt(3)
    ds_write_b128 v5, v[160:163] offset:16384
    v_max3_u32 v28, v28, v160, v161
    v_max3_u32 v29, v29, v162, v163
    s_waitcnt vmcnt(2)
    ds_write_b128 v5, v[164:167] offset:17408
    v_max3_u32 v28, v28, v164, v165
    v_max3_u32 v29, v29, v166, v167
    s_waitcnt vmcnt(1)
    ds_write_b128 v5, v[168:171] offset:18432
    v_max3_u32 v28, v28, v168, v169
    v_max3_u32 v29, v29, v170, v171
    s_waitcnt vmcnt(0)
    ds_write_b128 v5, v[172:175] offset:19456
    v_max3_u32 v28, v28, v172, v173
    v_max3_u32 v29, v29, v174, v175
    v_max_u32 v28, v28, v29
    v_cmp_eq_u32 vcc, -1, v28
    s_cbranch_vccnz fused1_kernel_g0r19
fused1_kernel_g0d20:
    s_waitcnt lgkmcnt(0)
fused1_kernel_barx10:
    s_setprio 0
    s_barrier
    s_and_b32 s30, s40, 3
    s_lshr_b32 s31, s40, 2
    v_and_b32 v3, 31, v0
    v_bfe_u32 v4, v0, 5, 1
    v_mul_u32_u24 v5, 328, v3
    s_mul_i32 s5, s30, 80
    s_add_u32 s5, s5, 84224
    v_add_u32 v5, s5, v5
    v_lshl_add_u32 v6, v4, 4, v5
    ds_read2_b64 v[8:11], v6 offset0:0 offset1:1
    ds_read_b64 v[12:13], v5 offset:32
    ds_read2_b64 v[16:19], v6 offset0:5 offset1:6
    ds_read_b64 v[20:21], v5 offset:72
    v_and_b32 v1, 63, v0
    v_lshlrev_b32 v1, 4, v1
    s_mul_i32 s20, s40, 5120
    s_add_u32 m0, s20, 40960
    s_nop 0
    buffer_load_dwordx4 v1, s[56:59], m0 offen lds
    s_add_u32 m0, s20, 41984
    s_nop 0
    buffer_load_dwordx4 v1, s[56:59], m0 offen lds
    s_add_u32 m0, s20, 43008
    s_nop 0
    buffer_load_dwordx4 v1, s[56:59], m0 offen lds
    s_add_u32 m0, s20, 44032
    s_nop 0
    buffer_load_dwordx4 v1, s[56:59], m0 offen lds
    s_add_u32 m0, s20, 45056
    s_nop 0
    buffer_load_dwordx4 v1, s[56:59], m0 offen lds
    v_mov_b32 v30, 0
    v_mov_b32 v31, 0
    v_mov_b32 v38, 0
    v_mov_b32 v39, 0
    v_cmp_eq_u32 vcc, 20, v3
    v_mov_b32 v7, 0x3f803f80
    v_cndmask_b32 v40, 0, v7, vcc
    v_cndmask_b32 v41, 0, v7, vcc
    v_cndmask_b32 v42, 0, v7, vcc
    v_cndmask_b32 v43, 0, v7, vcc
    v_cndmask_b32 v44, 0, v7, vcc
    v_cndmask_b32 v45, 0, v7, vcc
    v_cndmask_b32 v46, 0, v7, vcc
    v_cndmask_b32 v47, 0, v7, vcc
    v_cndmask_b32 v48, 0, v7, vcc
    v_cndmask_b32 v49, 0, v7, vcc
    v_cndmask_b32 v50, 0, v7, vcc
    v_cndmask_b32 v51, 0, v7, vcc
    v_cndmask_b32 v52, 0, v7, vcc
    v_cndmask_b32 v53, 0, v7, vcc
    v_cndmask_b32 v54, 0, v7, vcc
    v_cndmask_b32 v55, 0, v7, vcc
    v_mov_b32 v144, 0
    v_mov_b32 v145, 0
    v_mov_b32 v146, 0
    v_mov_b32 v147, 0
    v_mov_b32 v148, 0
    v_mov_b32 v149, 0
    v_mov_b32 v150, 0
    v_mov_b32 v151, 0
    v_mov_b32 v152, 0
    v_mov_b32 v153, 0
    v_mov_b32 v154, 0
    v_mov_b32 v155, 0
    v_mov_b32 v156, 0
    v_mov_b32 v157, 0
    v_mov_b32 v158, 0
    v_mov_b32 v159, 0
    v_mov_b32 v160, 0
    v_mov_b32 v161, 0
    v_mov_b32 v162, 0
    v_mov_b32 v163, 0
    v_mov_b32 v164, 0
    v_mov_b32 v165, 0
    v_mov_b32 v166, 0
    v_mov_b32 v167, 0
    v_mov_b32 v168, 0
    v_mov_b32 v169, 0
    v_mov_b32 v170, 0
    v_mov_b32 v171, 0
    v_mov_b32 v172, 0
    v_mov_b32 v173, 0
    v_mov_b32 v174, 0
    v_mov_b32 v175, 0
    s_lshl_b32 s21, s31, 13
    v_add_u32 v56, s21, v1
    v_lshlrev_b32 v57, 3, v3
    s_lshl_b32 s21, s31, 11
    s_add_u32 s21, s21, 16384
    v_add_u32 v57, s21, v57
    v_mul_u32_u24 v58, 320, v4
    v_lshl_add_u32 v58, v3, 4, v58
    s_mul_i32 s21, s31, 10240
    s_add_u32 s21, s21, 20480
    v_add_u32 v58, s21, v58
    s_mov_b32 s22, 0x000fffff
    s_mov_b32 s23, 0x000fffff
    ds_read_b128 v[24:27], v56 offset:0
    ds_read_b64 v[28:29], v57 offset:0
    s_mov_b64 exec, s[22:23]
    ds_read_b128 v[40:43], v58 offset:0
    ds_read_b128 v[44:47], v58 offset:640
    s_mov_b64 exec, -1
    ds_read_b128 v[32:35], v56 offset:1024
    ds_read_b64 v[36:37], v57 offset:256
    s_waitcnt lgkmcnt(6)
    v_cmp_eq_u32 vcc, 0, v4
    v_mov_b32 v14, 0
    v_mov_b32 v15, 0
    v_cndmask_b32 v12, 0, v12, vcc
    v_cndmask_b32 v13, 0, v13, vcc
    v_mov_b32 v22, 0
    v_mov_b32 v23, 0
    v_cndmask_b32 v20, 0, v20, vcc
    v_cndmask_b32 v21, 0, v21, vcc
    s_waitcnt lgkmcnt(4)
    v_mfma_f32_32x32x16_bf16 v[64:79], v[24:27], v[8:11], 0
    v_mfma_f32_32x32x16_bf16 v[80:95], v[24:27], v[16:19], 0
    v_mfma_f32_32x32x8_bf16 v[64:79], v[28:29], v[12:13], v[64:79]
    v_mfma_f32_32x32x8_bf16 v[80:95], v[28:29], v[20:21], v[80:95]
    s_nop 15
    s_nop 3
    s_waitcnt lgkmcnt(0)
    v_mfma_f32_32x32x16_bf16 v[96:111], v[32:35], v[8:11], 0
    v_exp_f32 v64, v64
    v_exp_f32 v65, v65
    v_exp_f32 v66, v66
    v_exp_f32 v67, v67
    s_setprio 1
    v_exp_f32 v68, v68
    v_exp_f32 v69, v69
    v_exp_f32 v70, v70
    v_exp_f32 v71, v71
    v_mfma_f32_32x32x16_bf16 v[112:127], v[32:35], v[16:19], 0
    v_exp_f32 v72, v72
    v_exp_f32 v73, v73
    v_exp_f32 v74, v74
    v_exp_f32 v75, v75
    v_exp_f32 v76, v76
    v_exp_f32 v77, v77
    v_exp_f32 v78, v78
    v_exp_f32 v79, v79
    v_mfma_f32_32x32x8_bf16 v[96:111], v[36:37], v[12:13], v[96:111]
    ds_read_b128 v[24:27], v56 offset:2048
    ds_read_b64 v[28:29], v57 offset:512
    v_cvt_pk_bf16_f32 v128, v64, v65
    v_cvt_pk_bf16_f32 v129, v66, v67
    v_cvt_pk_bf16_f32 v130, v68, v69
    v_cvt_pk_bf16_f32 v131, v70, v71
    v_cvt_pk_bf16_f32 v132, v72, v73
    v_cvt_pk_bf16_f32 v133, v74, v75
    v_cvt_pk_bf16_f32 v134, v76, v77
    v_cvt_pk_bf16_f32 v135, v78, v79
    v_mfma_f32_32x32x8_bf16 v[112:127], v[36:37], v[20:21], v[112:127]
    v_exp_f32 v80, v80
    v_exp_f32 v81, v81
    v_exp_f32 v82, v82
    v_exp_f32 v83, v83
    s_waitcnt lgkmcnt(2)
    v_mfma_f32_32x32x16_bf16 v[144:159], v[40:43], v[128:131], v[144:159]
    v_exp_f32 v84, v84
    v_exp_f32 v85, v85
    v_exp_f32 v86, v86
    v_exp_f32 v87, v87
    v_exp_f32 v88, v88
    v_exp_f32 v89, v89
    v_exp_f32 v90, v90
    v_exp_f32 v91, v91
    v_mfma_f32_32x32x16_bf16 v[144:159], v[44:47], v[132:135], v[144:159]
    v_exp_f32 v92, v92
    v_exp_f32 v93, v93
    v_exp_f32 v94, v94
    v_exp_f32 v95, v95
    s_setprio 0
    s_mov_b64 exec, s[22:23]
    ds_read_b128 v[48:51], v58 offset:1280
    ds_read_b128 v[52:55], v58 offset:1920
    s_mov_b64 exec, -1
    v_cvt_pk_bf16_f32 v136, v80, v81
    v_cvt_pk_bf16_f32 v137, v82, v83
    v_cvt_pk_bf16_f32 v138, v84, v85
    v_cvt_pk_bf16_f32 v139, v86, v87
    v_cvt_pk_bf16_f32 v140, v88, v89
    v_cvt_pk_bf16_f32 v141, v90, v91
    v_cvt_pk_bf16_f32 v142, v92, v93
    v_cvt_pk_bf16_f32 v143, v94, v95
    s_waitcnt lgkmcnt(2)
    v_mfma_f32_32x32x16_bf16 v[64:79], v[24:27], v[8:11], 0
    v_exp_f32 v96, v96
    v_exp_f32 v97, v97
    v_exp_f32 v98, v98
    v_exp_f32 v99, v99
    s_setprio 1
    s_add_u32 m0, s20, 122880
    v_mfma_f32_32x32x16_bf16 v[160:175], v[40:43], v[136:139], v[160:175]
    v_exp_f32 v100, v100
    v_exp_f32 v101, v101
    v_exp_f32 v102, v102
    v_exp_f32 v103, v103
    buffer_load_dwordx4 v1, s[56:59], m0 offen lds
    v_mfma_f32_32x32x16_bf16 v[80:95], v[24:27], v[16:19], 0
    v_exp_f32 v104, v104
    v_exp_f32 v105, v105
    v_exp_f32 v106, v106
    v_exp_f32 v107, v107
    v_mfma_f32_32x32x16_bf16 v[160:175], v[44:47], v[140:143], v[160:175]
    v_exp_f32 v108, v108
    v_exp_f32 v109, v109
    v_exp_f32 v110, v110
    v_exp_f32 v111, v111
    v_mfma_f32_32x32x8_bf16 v[64:79], v[28:29], v[12:13], v[64:79]
    ds_read_b128 v[32:35], v56 offset:3072
    ds_read_b64 v[36:37], v57 offset:768
    v_cvt_pk_bf16_f32 v128, v96, v97
    v_cvt_pk_bf16_f32 v129, v98, v99
    v_cvt_pk_bf16_f32 v130, v100, v101
    v_cvt_pk_bf16_f32 v131, v102, v103
    v_cvt_pk_bf16_f32 v132, v104, v105
    v_cvt_pk_bf16_f32 v133, v106, v107
    v_cvt_pk_bf16_f32 v134, v108, v109
    v_cvt_pk_bf16_f32 v135, v110, v111
    v_mfma_f32_32x32x8_bf16 v[80:95], v[28:29], v[20:21], v[80:95]
    v_exp_f32 v112, v112
    v_exp_f32 v113, v113
    v_exp_f32 v114, v114
    v_exp_f32 v115, v115
    s_waitcnt lgkmcnt(2)
    v_mfma_f32_32x32x16_bf16 v[144:159], v[48:51], v[128:131], v[144:159]
    v_exp_f32 v116, v116
    v_exp_f32 v117, v117
    v_exp_f32 v118, v118
    v_exp_f32 v119, v119
    v_exp_f32 v120, v120
    v_exp_f32 v121, v121
    v_exp_f32 v122, v122
    v_exp_f32 v123, v123
    v_mfma_f32_32x32x16_bf16 v[144:159], v[52:55], v[132:135], v[144:159]
    v_exp_f32 v124, v124
    v_exp_f32 v125, v125
    v_exp_f32 v126, v126
    v_exp_f32 v127, v127
    s_setprio 0
    s_mov_b64 exec, s[22:23]
    ds_read_b128 v[40:43], v58 offset:2560
    ds_read_b128 v[44:47], v58 offset:3200
    s_mov_b64 exec, -1
    v_cvt_pk_bf16_f32 v136, v112, v113
    v_cvt_pk_bf16_f32 v137, v114, v115
    v_cvt_pk_bf16_f32 v138, v116, v117
    v_cvt_pk_bf16_f32 v139, v118, v119
    v_cvt_pk_bf16_f32 v140, v120, v121
    v_cvt_pk_bf16_f32 v141, v122, v123
    v_cvt_pk_bf16_f32 v142, v124, v125
    v_cvt_pk_bf16_f32 v143, v126, v127
    s_waitcnt lgkmcnt(2)
    v_mfma_f32_32x32x16_bf16 v[96:111], v[32:35], v[8:11], 0
    v_exp_f32 v64, v64
    v_exp_f32 v65, v65
    v_exp_f32 v66, v66
    v_exp_f32 v67, v67
    s_setprio 1
    s_add_u32 m0, s20, 123904
    v_mfma_f32_32x32x16_bf16 v[160:175], v[48:51], v[136:139], v[160:175]
    v_exp_f32 v68, v68
    v_exp_f32 v69, v69
    v_exp_f32 v70, v70
    v_exp_f32 v71, v71
    buffer_load_dwordx4 v1, s[56:59], m0 offen lds
    v_mfma_f32_32x32x16_bf16 v[112:127], v[32:35], v[16:19], 0
    v_exp_f32 v72, v72
    v_exp_f32 v73, v73
    v_exp_f32 v74, v74
    v_exp_f32 v75, v75
    v_mfma_f32_32x32x16_bf16 v[160:175], v[52:55], v[140:143], v[160:175]
    v_exp_f32 v76, v76
    v_exp_f32 v77, v77
    v_exp_f32 v78, v78
    v_exp_f32 v79, v79
    v_mfma_f32_32x32x8_bf16 v[96:111], v[36:37], v[12:13], v[96:111]
    ds_read_b128 v[24:27], v56 offset:4096
    ds_read_b64 v[28:29], v57 offset:1024
    v_cvt_pk_bf16_f32 v128, v64, v65
    v_cvt_pk_bf16_f32 v129, v66, v67
    v_cvt_pk_bf16_f32 v130, v68, v69
    v_cvt_pk_bf16_f32 v131, v70, v71
    v_cvt_pk_bf16_f32 v132, v72, v73
    v_cvt_pk_bf16_f32 v133, v74, v75
    v_cvt_pk_bf16_f32 v134, v76, v77
    v_cvt_pk_bf16_f32 v135, v78, v79
    v_mfma_f32_32x32x8_bf16 v[112:127], v[36:37], v[20:21], v[112:127]
    v_exp_f32 v80, v80
    v_exp_f32 v81, v81
    v_exp_f32 v82, v82
    v_exp_f32 v83, v83
    s_waitcnt lgkmcnt(2)
    v_mfma_f32_32x32x16_bf16 v[144:159], v[40:43], v[128:131], v[144:159]
    v_exp_f32 v84, v84
    v_exp_f32 v85, v85
    v_exp_f32 v86, v86
    v_exp_f32 v87, v87
    v_exp_f32 v88, v88
    v_exp_f32 v89, v89
    v_exp_f32 v90, v90
    v_exp_f32 v91, v91
    v_mfma_f32_32x32x16_bf16 v[144:159], v[44:47], v[132:135], v[144:159]
    v_exp_f32 v92, v92
    v_exp_f32 v93, v93
    v_exp_f32 v94, v94
    v_exp_f32 v95, v95
    s_setprio 0
    s_mov_b64 exec, s[22:23]
    ds_read_b128 v[48:51], v58 offset:3840
    ds_read_b128 v[52:55], v58 offset:4480
    s_mov_b64 exec, -1
    v_cvt_pk_bf16_f32 v136, v80, v81
    v_cvt_pk_bf16_f32 v137, v82, v83
    v_cvt_pk_bf16_f32 v138, v84, v85
    v_cvt_pk_bf16_f32 v139, v86, v87
    v_cvt_pk_bf16_f32 v140, v88, v89
    v_cvt_pk_bf16_f32 v141, v90, v91
    v_cvt_pk_bf16_f32 v142, v92, v93
    v_cvt_pk_bf16_f32 v143, v94, v95
    s_waitcnt lgkmcnt(2)
    v_mfma_f32_32x32x16_bf16 v[64:79], v[24:27], v[8:11], 0
    v_exp_f32 v96, v96
    v_exp_f32 v97, v97
    v_exp_f32 v98, v98
    v_exp_f32 v99, v99
    s_setprio 1
    s_add_u32 m0, s20, 124928
    v_mfma_f32_32x32x16_bf16 v[160:175], v[40:43], v[136:139], v[160:175]
    v_exp_f32 v100, v100
    v_exp_f32 v101, v101
    v_exp_f32 v102, v102
    v_exp_f32 v103, v103
    buffer_load_dwordx4 v1, s[56:59], m0 offen lds
    v_mfma_f32_32x32x16_bf16 v[80:95], v[24:27], v[16:19], 0
    v_exp_f32 v104, v104
    v_exp_f32 v105, v105
    v_exp_f32 v106, v106
    v_exp_f32 v107, v107
    v_mfma_f32_32x32x16_bf16 v[160:175], v[44:47], v[140:143], v[160:175]
    v_exp_f32 v108, v108
    v_exp_f32 v109, v109
    v_exp_f32 v110, v110
    v_exp_f32 v111, v111
    v_mfma_f32_32x32x8_bf16 v[64:79], v[28:29], v[12:13], v[64:79]
    ds_read_b128 v[32:35], v56 offset:5120
    ds_read_b64 v[36:37], v57 offset:1280
    v_cvt_pk_bf16_f32 v128, v96, v97
    v_cvt_pk_bf16_f32 v129, v98, v99
    v_cvt_pk_bf16_f32 v130, v100, v101
    v_cvt_pk_bf16_f32 v131, v102, v103
    v_cvt_pk_bf16_f32 v132, v104, v105
    v_cvt_pk_bf16_f32 v133, v106, v107
    v_cvt_pk_bf16_f32 v134, v108, v109
    v_cvt_pk_bf16_f32 v135, v110, v111
    v_mfma_f32_32x32x8_bf16 v[80:95], v[28:29], v[20:21], v[80:95]
    v_exp_f32 v112, v112
    v_exp_f32 v113, v113
    v_exp_f32 v114, v114
    v_exp_f32 v115, v115
    s_waitcnt lgkmcnt(2)
    v_mfma_f32_32x32x16_bf16 v[144:159], v[48:51], v[128:131], v[144:159]
    v_exp_f32 v116, v116
    v_exp_f32 v117, v117
    v_exp_f32 v118, v118
    v_exp_f32 v119, v119
    v_exp_f32 v120, v120
    v_exp_f32 v121, v121
    v_exp_f32 v122, v122
    v_exp_f32 v123, v123
    v_mfma_f32_32x32x16_bf16 v[144:159], v[52:55], v[132:135], v[144:159]
    v_exp_f32 v124, v124
    v_exp_f32 v125, v125
    v_exp_f32 v126, v126
    v_exp_f32 v127, v127
    s_setprio 0
    s_mov_b64 exec, s[22:23]
    ds_read_b128 v[40:43], v58 offset:5120
    ds_read_b128 v[44:47], v58 offset:5760
    s_mov_b64 exec, -1
    v_cvt_pk_bf16_f32 v136, v112, v113
    v_cvt_pk_bf16_f32 v137, v114, v115
    v_cvt_pk_bf16_f32 v138, v116, v117
    v_cvt_pk_bf16_f32 v139, v118, v119
    v_cvt_pk_bf16_f32 v140, v120, v121
    v_cvt_pk_bf16_f32 v141, v122, v123
    v_cvt_pk_bf16_f32 v142, v124, v125
    v_cvt_pk_bf16_f32 v143, v126, v127
    s_waitcnt lgkmcnt(2)
    v_mfma_f32_32x32x16_bf16 v[96:111], v[32:35], v[8:11], 0
    v_exp_f32 v64, v64
    v_exp_f32 v65, v65
    v_exp_f32 v66, v66
    v_exp_f32 v67, v67
    s_setprio 1
    s_add_u32 m0, s20, 125952
    v_mfma_f32_32x32x16_bf16 v[160:175], v[48:51], v[136:139], v[160:175]
    v_exp_f32 v68, v68
    v_exp_f32 v69, v69
    v_exp_f32 v70, v70
    v_exp_f32 v71, v71
    buffer_load_dwordx4 v1, s[56:59], m0 offen lds
    v_mfma_f32_32x32x16_bf16 v[112:127], v[32:35], v[16:19], 0
    v_exp_f32 v72, v72
    v_exp_f32 v73, v73
    v_exp_f32 v74, v74
    v_exp_f32 v75, v75
    v_mfma_f32_32x32x16_bf16 v[160:175], v[52:55], v[140:143], v[160:175]
    v_exp_f32 v76, v76
    v_exp_f32 v77, v77
    v_exp_f32 v78, v78
    v_exp_f32 v79, v79
    v_mfma_f32_32x32x8_bf16 v[96:111], v[36:37], v[12:13], v[96:111]
    ds_read_b128 v[24:27], v56 offset:6144
    ds_read_b64 v[28:29], v57 offset:1536
    v_cvt_pk_bf16_f32 v128, v64, v65
    v_cvt_pk_bf16_f32 v129, v66, v67
    v_cvt_pk_bf16_f32 v130, v68, v69
    v_cvt_pk_bf16_f32 v131, v70, v71
    v_cvt_pk_bf16_f32 v132, v72, v73
    v_cvt_pk_bf16_f32 v133, v74, v75
    v_cvt_pk_bf16_f32 v134, v76, v77
    v_cvt_pk_bf16_f32 v135, v78, v79
    v_mfma_f32_32x32x8_bf16 v[112:127], v[36:37], v[20:21], v[112:127]
    v_exp_f32 v80, v80
    v_exp_f32 v81, v81
    v_exp_f32 v82, v82
    v_exp_f32 v83, v83
    s_waitcnt lgkmcnt(2)
    v_mfma_f32_32x32x16_bf16 v[144:159], v[40:43], v[128:131], v[144:159]
    v_exp_f32 v84, v84
    v_exp_f32 v85, v85
    v_exp_f32 v86, v86
    v_exp_f32 v87, v87
    v_exp_f32 v88, v88
    v_exp_f32 v89, v89
    v_exp_f32 v90, v90
    v_exp_f32 v91, v91
    v_mfma_f32_32x32x16_bf16 v[144:159], v[44:47], v[132:135], v[144:159]
    v_exp_f32 v92, v92
    v_exp_f32 v93, v93
    v_exp_f32 v94, v94
    v_exp_f32 v95, v95
    s_setprio 0
    s_mov_b64 exec, s[22:23]
    ds_read_b128 v[48:51], v58 offset:6400
    ds_read_b128 v[52:55], v58 offset:7040
    s_mov_b64 exec, -1
    v_cvt_pk_bf16_f32 v136, v80, v81
    v_cvt_pk_bf16_f32 v137, v82, v83
    v_cvt_pk_bf16_f32 v138, v84, v85
    v_cvt_pk_bf16_f32 v139, v86, v87
    v_cvt_pk_bf16_f32 v140, v88, v89
    v_cvt_pk_bf16_f32 v141, v90, v91
    v_cvt_pk_bf16_f32 v142, v92, v93
    v_cvt_pk_bf16_f32 v143, v94, v95
    s_waitcnt lgkmcnt(2)
    v_mfma_f32_32x32x16_bf16 v[64:79], v[24:27], v[8:11], 0
    s_add_u32 s21, s20, 40960
    v_add_u32 v196, s21, v1
    s_waitcnt vmcnt(4)
    ds_read_b128 v[176:179], v196 offset:0
    ds_read_b128 v[180:183], v196 offset:1024
    ds_read_b128 v[184:187], v196 offset:2048
    ds_read_b128 v[188:191], v196 offset:3072
    ds_read_b128 v[192:195], v196 offset:4096
    v_exp_f32 v96, v96
    v_exp_f32 v97, v97
    v_exp_f32 v98, v98
    v_exp_f32 v99, v99
    s_setprio 1
    s_add_u32 m0, s20, 126976
    v_mfma_f32_32x32x16_bf16 v[160:175], v[40:43], v[136:139], v[160:175]
    v_exp_f32 v100, v100
    v_exp_f32 v101, v101
    v_exp_f32 v102, v102
    v_exp_f32 v103, v103
    buffer_load_dwordx4 v1, s[56:59], m0 offen lds
    v_mfma_f32_32x32x16_bf16 v[80:95], v[24:27], v[16:19], 0
    v_exp_f32 v104, v104
    v_exp_f32 v105, v105
    v_exp_f32 v106, v106
    v_exp_f32 v107, v107
    v_mfma_f32_32x32x16_bf16 v[160:175], v[44:47], v[140:143], v[160:175]
    v_exp_f32 v108, v108
    v_exp_f32 v109, v109
    v_exp_f32 v110, v110
    v_exp_f32 v111, v111
    v_mfma_f32_32x32x8_bf16 v[64:79], v[28:29], v[12:13], v[64:79]
    ds_read_b128 v[32:35], v56 offset:7168
    ds_read_b64 v[36:37], v57 offset:1792
    v_cvt_pk_bf16_f32 v128, v96, v97
    v_cvt_pk_bf16_f32 v129, v98, v99
    v_cvt_pk_bf16_f32 v130, v100, v101
    v_cvt_pk_bf16_f32 v131, v102, v103
    v_cvt_pk_bf16_f32 v132, v104, v105
    v_cvt_pk_bf16_f32 v133, v106, v107
    v_cvt_pk_bf16_f32 v134, v108, v109
    v_cvt_pk_bf16_f32 v135, v110, v111
    v_mfma_f32_32x32x8_bf16 v[80:95], v[28:29], v[20:21], v[80:95]
    v_exp_f32 v112, v112
    v_exp_f32 v113, v113
    v_exp_f32 v114, v114
    v_exp_f32 v115, v115
    s_waitcnt lgkmcnt(2)
    v_mfma_f32_32x32x16_bf16 v[144:159], v[48:51], v[128:131], v[144:159]
    v_exp_f32 v116, v116
    v_exp_f32 v117, v117
    v_exp_f32 v118, v118
    v_exp_f32 v119, v119
    v_exp_f32 v120, v120
    v_exp_f32 v121, v121
    v_exp_f32 v122, v122
    v_exp_f32 v123, v123
    v_mfma_f32_32x32x16_bf16 v[144:159], v[52:55], v[132:135], v[144:159]
    v_exp_f32 v124, v124
    v_exp_f32 v125, v125
    v_exp_f32 v126, v126
    v_exp_f32 v127, v127
    s_setprio 0
    s_mov_b64 exec, s[22:23]
    ds_read_b128 v[40:43], v58 offset:7680
    ds_read_b128 v[44:47], v58 offset:8320
    s_mov_b64 exec, -1
    v_cvt_pk_bf16_f32 v136, v112, v113
    v_cvt_pk_bf16_f32 v137, v114, v115
    v_cvt_pk_bf16_f32 v138, v116, v117
    v_cvt_pk_bf16_f32 v139, v118, v119
    v_cvt_pk_bf16_f32 v140, v120, v121
    v_cvt_pk_bf16_f32 v141, v122, v123
    v_cvt_pk_bf16_f32 v142, v124, v125
    v_cvt_pk_bf16_f32 v143, v126, v127
    v_max3_u32 v197, v176, v177, v178
    v_max3_u32 v198, v179, v180, v181
    v_max3_u32 v197, v197, v182, v183
    v_max3_u32 v198, v198, v184, v185
    v_max3_u32 v197, v197, v186, v187
    v_max3_u32 v198, v198, v188, v189
    v_max3_u32 v197, v197, v190, v191
    v_max3_u32 v198, v198, v192, v193
    v_max3_u32 v197, v197, v194, v195
    v_max_u32 v197, v197, v198
    v_cmp_eq_u32 vcc, -1, v197
    s_cbranch_vccnz fused1_kernel_vr21
fused1_kernel_vd24:
    s_barrier
    s_waitcnt lgkmcnt(2)
    v_mfma_f32_32x32x16_bf16 v[96:111], v[32:35], v[8:11], 0
    v_exp_f32 v64, v64
    v_exp_f32 v65, v65
    v_exp_f32 v66, v66
    v_exp_f32 v67, v67
    s_setprio 1
    s_add_u32 m0, s20, 81920
    v_mfma_f32_32x32x16_bf16 v[160:175], v[48:51], v[136:139], v[160:175]
    v_exp_f32 v68, v68
    v_exp_f32 v69, v69
    v_exp_f32 v70, v70
    v_exp_f32 v71, v71
    buffer_load_dwordx4 v1, s[56:59], m0 offen lds
    v_mfma_f32_32x32x16_bf16 v[112:127], v[32:35], v[16:19], 0
    v_exp_f32 v72, v72
    v_exp_f32 v73, v73
    v_exp_f32 v74, v74
    v_exp_f32 v75, v75
    v_mfma_f32_32x32x16_bf16 v[160:175], v[52:55], v[140:143], v[160:175]
    v_exp_f32 v76, v76
    v_exp_f32 v77, v77
    v_exp_f32 v78, v78
    v_exp_f32 v79, v79
    v_mfma_f32_32x32x8_bf16 v[96:111], v[36:37], v[12:13], v[96:111]
    ds_read_b128 v[24:27], v56 offset:40960
    ds_read_b64 v[28:29], v57 offset:40960
    v_cvt_pk_bf16_f32 v128, v64, v65
    v_cvt_pk_bf16_f32 v129, v66, v67
    v_cvt_pk_bf16_f32 v130, v68, v69
    v_cvt_pk_bf16_f32 v131, v70, v71
    v_cvt_pk_bf16_f32 v132, v72, v73
    v_cvt_pk_bf16_f32 v133, v74, v75
    v_cvt_pk_bf16_f32 v134, v76, v77
    v_cvt_pk_bf16_f32 v135, v78, v79
    v_mfma_f32_32x32x8_bf16 v[112:127], v[36:37], v[20:21], v[112:127]
    v_exp_f32 v80, v80
    v_exp_f32 v81, v81
    v_exp_f32 v82, v82
    v_exp_f32 v83, v83
    s_waitcnt lgkmcnt(2)
    v_mfma_f32_32x32x16_bf16 v[144:159], v[40:43], v[128:131], v[144:159]
    v_exp_f32 v84, v84
    v_exp_f32 v85, v85
    v_exp_f32 v86, v86
    v_exp_f32 v87, v87
    v_exp_f32 v88, v88
    v_exp_f32 v89, v89
    v_exp_f32 v90, v90
    v_exp_f32 v91, v91
    v_mfma_f32_32x32x16_bf16 v[144:159], v[44:47], v[132:135], v[144:159]
    v_exp_f32 v92, v92
    v_exp_f32 v93, v93
    v_exp_f32 v94, v94
    v_exp_f32 v95, v95
    s_setprio 0
    s_mov_b64 exec, s[22:23]
    ds_read_b128 v[48:51], v58 offset:8960
    ds_read_b128 v[52:55], v58 offset:9600
    s_mov_b64 exec, -1
    v_cvt_pk_bf16_f32 v136, v80, v81
    v_cvt_pk_bf16_f32 v137, v82, v83
    v_cvt_pk_bf16_f32 v138, v84, v85
    v_cvt_pk_bf16_f32 v139, v86, v87
    v_cvt_pk_bf16_f32 v140, v88, v89
    v_cvt_pk_bf16_f32 v141, v90, v91
    v_cvt_pk_bf16_f32 v142, v92, v93
    v_cvt_pk_bf16_f32 v143, v94, v95
    s_waitcnt lgkmcnt(2)
    v_mfma_f32_32x32x16_bf16 v[64:79], v[24:27], v[8:11], 0
    v_exp_f32 v96, v96
    v_exp_f32 v97, v97
    v_exp_f32 v98, v98
    v_exp_f32 v99, v99
    s_setprio 1
    s_add_u32 m0, s20, 82944
    v_mfma_f32_32x32x16_bf16 v[160:175], v[40:43], v[136:139], v[160:175]
    v_exp_f32 v100, v100
    v_exp_f32 v101, v101
    v_exp_f32 v102, v102
    v_exp_f32 v103, v103
    buffer_load_dwordx4 v1, s[56:59], m0 offen lds
    v_mfma_f32_32x32x16_bf16 v[80:95], v[24:27], v[16:19], 0
    v_exp_f32 v104, v104
    v_exp_f32 v105, v105
    v_exp_f32 v106, v106
    v_exp_f32 v107, v107
    v_mfma_f32_32x32x16_bf16 v[160:175], v[44:47], v[140:143], v[160:175]
    v_exp_f32 v108, v108
    v_exp_f32 v109, v109
    v_exp_f32 v110, v110
    v_exp_f32 v111, v111
    v_mfma_f32_32x32x8_bf16 v[64:79], v[28:29], v[12:13], v[64:79]
    ds_read_b128 v[32:35], v56 offset:41984
    ds_read_b64 v[36:37], v57 offset:41216
    v_cvt_pk_bf16_f32 v128, v96, v97
    v_cvt_pk_bf16_f32 v129, v98, v99
    v_cvt_pk_bf16_f32 v130, v100, v101
    v_cvt_pk_bf16_f32 v131, v102, v103
    v_cvt_pk_bf16_f32 v132, v104, v105
    v_cvt_pk_bf16_f32 v133, v106, v107
    v_cvt_pk_bf16_f32 v134, v108, v109
    v_cvt_pk_bf16_f32 v135, v110, v111
    v_mfma_f32_32x32x8_bf16 v[80:95], v[28:29], v[20:21], v[80:95]
    v_exp_f32 v112, v112
    v_exp_f32 v113, v113
    v_exp_f32 v114, v114
    v_exp_f32 v115, v115
    s_waitcnt lgkmcnt(2)
    v_mfma_f32_32x32x16_bf16 v[144:159], v[48:51], v[128:131], v[144:159]
    v_exp_f32 v116, v116
    v_exp_f32 v117, v117
    v_exp_f32 v118, v118
    v_exp_f32 v119, v119
    s_lshr_b32 s21, s2, 3
    s_mul_i32 s21, s21, 25600
    v_lshlrev_b32 v199, 6, v0
    v_cmp_gt_u32 vcc, 400, v0
    s_and_saveexec_b64 s[24:25], vcc
    buffer_load_dword v199, v199, s[64:67], s21 offen
    s_mov_b64 exec, s[24:25]
    v_exp_f32 v120, v120
    v_exp_f32 v121, v121
    v_exp_f32 v122, v122
    v_exp_f32 v123, v123
    v_mfma_f32_32x32x16_bf16 v[144:159], v[52:55], v[132:135], v[144:159]
    v_exp_f32 v124, v124
    v_exp_f32 v125, v125
    v_exp_f32 v126, v126
    v_exp_f32 v127, v127
    s_setprio 0
    s_mov_b64 exec, s[22:23]
    ds_read_b128 v[40:43], v58 offset:40960
    ds_read_b128 v[44:47], v58 offset:41600
    s_mov_b64 exec, -1
    v_cvt_pk_bf16_f32 v136, v112, v113
    v_cvt_pk_bf16_f32 v137, v114, v115
    v_cvt_pk_bf16_f32 v138, v116, v117
    v_cvt_pk_bf16_f32 v139, v118, v119
    v_cvt_pk_bf16_f32 v140, v120, v121
    v_cvt_pk_bf16_f32 v141, v122, v123
    v_cvt_pk_bf16_f32 v142, v124, v125
    v_cvt_pk_bf16_f32 v143, v126, v127
    v_add_u32 v56, 40960, v56
    v_add_u32 v57, 40960, v57
    v_add_u32 v58, 40960, v58
    s_waitcnt lgkmcnt(2)
    v_mfma_f32_32x32x16_bf16 v[96:111], v[32:35], v[8:11], 0
    v_exp_f32 v64, v64
    v_exp_f32 v65, v65
    v_exp_f32 v66, v66
    v_exp_f32 v67, v67
    s_setprio 1
    s_add_u32 m0, s20, 83968
    v_mfma_f32_32x32x16_bf16 v[160:175], v[48:51], v[136:139], v[160:175]
    v_exp_f32 v68, v68
    v_exp_f32 v69, v69
    v_exp_f32 v70, v70
    v_exp_f32 v71, v71
    buffer_load_dwordx4 v1, s[56:59], m0 offen lds
    v_mfma_f32_32x32x16_bf16 v[112:127], v[32:35], v[16:19], 0
    v_exp_f32 v72, v72
    v_exp_f32 v73, v73
    v_exp_f32 v74, v74
    v_exp_f32 v75, v75
    v_mfma_f32_32x32x16_bf16 v[160:175], v[52:55], v[140:143], v[160:175]
    v_exp_f32 v76, v76
    v_exp_f32 v77, v77
    v_exp_f32 v78, v78
    v_exp_f32 v79, v79
    v_mfma_f32_32x32x8_bf16 v[96:111], v[36:37], v[12:13], v[96:111]
    ds_read_b128 v[24:27], v56 offset:2048
    ds_read_b64 v[28:29], v57 offset:512
    v_cvt_pk_bf16_f32 v128, v64, v65
    v_cvt_pk_bf16_f32 v129, v66, v67
    v_cvt_pk_bf16_f32 v130, v68, v69
    v_cvt_pk_bf16_f32 v131, v70, v71
    v_cvt_pk_bf16_f32 v132, v72, v73
    v_cvt_pk_bf16_f32 v133, v74, v75
    v_cvt_pk_bf16_f32 v134, v76, v77
    v_cvt_pk_bf16_f32 v135, v78, v79
    v_mfma_f32_32x32x8_bf16 v[112:127], v[36:37], v[20:21], v[112:127]
    v_exp_f32 v80, v80
    v_exp_f32 v81, v81
    v_exp_f32 v82, v82
    v_exp_f32 v83, v83
    s_waitcnt lgkmcnt(2)
    v_mfma_f32_32x32x16_bf16 v[144:159], v[40:43], v[128:131], v[144:159]
    v_exp_f32 v84, v84
    v_exp_f32 v85, v85
    v_exp_f32 v86, v86
    v_exp_f32 v87, v87
    v_exp_f32 v88, v88
    v_exp_f32 v89, v89
    v_exp_f32 v90, v90
    v_exp_f32 v91, v91
    v_mfma_f32_32x32x16_bf16 v[144:159], v[44:47], v[132:135], v[144:159]
    v_exp_f32 v92, v92
    v_exp_f32 v93, v93
    v_exp_f32 v94, v94
    v_exp_f32 v95, v95
    s_setprio 0
    s_mov_b64 exec, s[22:23]
    ds_read_b128 v[48:51], v58 offset:1280
    ds_read_b128 v[52:55], v58 offset:1920
    s_mov_b64 exec, -1
    v_cvt_pk_bf16_f32 v136, v80, v81
    v_cvt_pk_bf16_f32 v137, v82, v83
    v_cvt_pk_bf16_f32 v138, v84, v85
    v_cvt_pk_bf16_f32 v139, v86, v87
    v_cvt_pk_bf16_f32 v140, v88, v89
    v_cvt_pk_bf16_f32 v141, v90, v91
    v_cvt_pk_bf16_f32 v142, v92, v93
    v_cvt_pk_bf16_f32 v143, v94, v95
    s_waitcnt lgkmcnt(2)
    v_mfma_f32_32x32x16_bf16 v[64:79], v[24:27], v[8:11], 0
    v_exp_f32 v96, v96
    v_exp_f32 v97, v97
    v_exp_f32 v98, v98
    v_exp_f32 v99, v99
    s_setprio 1
    s_add_u32 m0, s20, 84992
    v_mfma_f32_32x32x16_bf16 v[160:175], v[40:43], v[136:139], v[160:175]
    v_exp_f32 v100, v100
    v_exp_f32 v101, v101
    v_exp_f32 v102, v102
    v_exp_f32 v103, v103
    buffer_load_dwordx4 v1, s[56:59], m0 offen lds
    v_mfma_f32_32x32x16_bf16 v[80:95], v[24:27], v[16:19], 0
    v_exp_f32 v104, v104
    v_exp_f32 v105, v105
    v_exp_f32 v106, v106
    v_exp_f32 v107, v107
    v_mfma_f32_32x32x16_bf16 v[160:175], v[44:47], v[140:143], v[160:175]
    v_exp_f32 v108, v108
    v_exp_f32 v109, v109
    v_exp_f32 v110, v110
    v_exp_f32 v111, v111
    v_mfma_f32_32x32x8_bf16 v[64:79], v[28:29], v[12:13], v[64:79]
    ds_read_b128 v[32:35], v56 offset:3072
    ds_read_b64 v[36:37], v57 offset:768
    v_cvt_pk_bf16_f32 v128, v96, v97
    v_cvt_pk_bf16_f32 v129, v98, v99
    v_cvt_pk_bf16_f32 v130, v100, v101
    v_cvt_pk_bf16_f32 v131, v102, v103
    v_cvt_pk_bf16_f32 v132, v104, v105
    v_cvt_pk_bf16_f32 v133, v106, v107
    v_cvt_pk_bf16_f32 v134, v108, v109
    v_cvt_pk_bf16_f32 v135, v110, v111
    v_mfma_f32_32x32x8_bf16 v[80:95], v[28:29], v[20:21], v[80:95]
    v_exp_f32 v112, v112
    v_exp_f32 v113, v113
    v_exp_f32 v114, v114
    v_exp_f32 v115, v115
    s_waitcnt lgkmcnt(2)
    v_mfma_f32_32x32x16_bf16 v[144:159], v[48:51], v[128:131], v[144:159]
    v_exp_f32 v116, v116
    v_exp_f32 v117, v117
    v_exp_f32 v118, v118
    v_exp_f32 v119, v119
    v_exp_f32 v120, v120
    v_exp_f32 v121, v121
    v_exp_f32 v122, v122
    v_exp_f32 v123, v123
    v_mfma_f32_32x32x16_bf16 v[144:159], v[52:55], v[132:135], v[144:159]
    v_exp_f32 v124, v124
    v_exp_f32 v125, v125
    v_exp_f32 v126, v126
    v_exp_f32 v127, v127
    s_setprio 0
    s_mov_b64 exec, s[22:23]
    ds_read_b128 v[40:43], v58 offset:2560
    ds_read_b128 v[44:47], v58 offset:3200
    s_mov_b64 exec, -1
    v_cvt_pk_bf16_f32 v136, v112, v113
    v_cvt_pk_bf16_f32 v137, v114, v115
    v_cvt_pk_bf16_f32 v138, v116, v117
    v_cvt_pk_bf16_f32 v139, v118, v119
    v_cvt_pk_bf16_f32 v140, v120, v121
    v_cvt_pk_bf16_f32 v141, v122, v123
    v_cvt_pk_bf16_f32 v142, v124, v125
    v_cvt_pk_bf16_f32 v143, v126, v127
    s_waitcnt lgkmcnt(2)
    v_mfma_f32_32x32x16_bf16 v[96:111], v[32:35], v[8:11], 0
    v_exp_f32 v64, v64
    v_exp_f32 v65, v65
    v_exp_f32 v66, v66
    v_exp_f32 v67, v67
    s_setprio 1
    s_add_u32 m0, s20, 86016
    v_mfma_f32_32x32x16_bf16 v[160:175], v[48:51], v[136:139], v[160:175]
    v_exp_f32 v68, v68
    v_exp_f32 v69, v69
    v_exp_f32 v70, v70
    v_exp_f32 v71, v71
    buffer_load_dwordx4 v1, s[56:59], m0 offen lds
    v_mfma_f32_32x32x16_bf16 v[112:127], v[32:35], v[16:19], 0
    v_exp_f32 v72, v72
    v_exp_f32 v73, v73
    v_exp_f32 v74, v74
    v_exp_f32 v75, v75
    v_mfma_f32_32x32x16_bf16 v[160:175], v[52:55], v[140:143], v[160:175]
    v_exp_f32 v76, v76
    v_exp_f32 v77, v77
    v_exp_f32 v78, v78
    v_exp_f32 v79, v79
    v_mfma_f32_32x32x8_bf16 v[96:111], v[36:37], v[12:13], v[96:111]
    ds_read_b128 v[24:27], v56 offset:4096
    ds_read_b64 v[28:29], v57 offset:1024
    v_cvt_pk_bf16_f32 v128, v64, v65
    v_cvt_pk_bf16_f32 v129, v66, v67
    v_cvt_pk_bf16_f32 v130, v68, v69
    v_cvt_pk_bf16_f32 v131, v70, v71
    v_cvt_pk_bf16_f32 v132, v72, v73
    v_cvt_pk_bf16_f32 v133, v74, v75
    v_cvt_pk_bf16_f32 v134, v76, v77
    v_cvt_pk_bf16_f32 v135, v78, v79
    v_mfma_f32_32x32x8_bf16 v[112:127], v[36:37], v[20:21], v[112:127]
    v_exp_f32 v80, v80
    v_exp_f32 v81, v81
    v_exp_f32 v82, v82
    v_exp_f32 v83, v83
    s_waitcnt lgkmcnt(2)
    v_mfma_f32_32x32x16_bf16 v[144:159], v[40:43], v[128:131], v[144:159]
    v_exp_f32 v84, v84
    v_exp_f32 v85, v85
    v_exp_f32 v86, v86
    v_exp_f32 v87, v87
    v_exp_f32 v88, v88
    v_exp_f32 v89, v89
    v_exp_f32 v90, v90
    v_exp_f32 v91, v91
    v_mfma_f32_32x32x16_bf16 v[144:159], v[44:47], v[132:135], v[144:159]
    v_exp_f32 v92, v92
    v_exp_f32 v93, v93
    v_exp_f32 v94, v94
    v_exp_f32 v95, v95
    s_setprio 0
    s_mov_b64 exec, s[22:23]
    ds_read_b128 v[48:51], v58 offset:3840
    ds_read_b128 v[52:55], v58 offset:4480
    s_mov_b64 exec, -1
    v_cvt_pk_bf16_f32 v136, v80, v81
    v_cvt_pk_bf16_f32 v137, v82, v83
    v_cvt_pk_bf16_f32 v138, v84, v85
    v_cvt_pk_bf16_f32 v139, v86, v87
    v_cvt_pk_bf16_f32 v140, v88, v89
    v_cvt_pk_bf16_f32 v141, v90, v91
    v_cvt_pk_bf16_f32 v142, v92, v93
    v_cvt_pk_bf16_f32 v143, v94, v95
    s_waitcnt lgkmcnt(2)
    v_mfma_f32_32x32x16_bf16 v[64:79], v[24:27], v[8:11], 0
    s_add_u32 s21, s20, 122880
    v_add_u32 v196, s21, v1
    s_waitcnt vmcnt(5)
    ds_read_b128 v[176:179], v196 offset:0
    ds_read_b128 v[180:183], v196 offset:1024
    ds_read_b128 v[184:187], v196 offset:2048
    ds_read_b128 v[188:191], v196 offset:3072
    ds_read_b128 v[192:195], v196 offset:4096
    v_exp_f32 v96, v96
    v_exp_f32 v97, v97
    v_exp_f32 v98, v98
    v_exp_f32 v99, v99
    s_setprio 1
    v_mfma_f32_32x32x16_bf16 v[160:175], v[40:43], v[136:139], v[160:175]
    v_exp_f32 v100, v100
    v_exp_f32 v101, v101
    v_exp_f32 v102, v102
    v_exp_f32 v103, v103
    v_mfma_f32_32x32x16_bf16 v[80:95], v[24:27], v[16:19], 0
    v_exp_f32 v104, v104
    v_exp_f32 v105, v105
    v_exp_f32 v106, v106
    v_exp_f32 v107, v107
    v_mfma_f32_32x32x16_bf16 v[160:175], v[44:47], v[140:143], v[160:175]
    v_exp_f32 v108, v108
    v_exp_f32 v109, v109
    v_exp_f32 v110, v110
    v_exp_f32 v111, v111
    v_mfma_f32_32x32x8_bf16 v[64:79], v[28:29], v[12:13], v[64:79]
    ds_read_b128 v[32:35], v56 offset:5120
    ds_read_b64 v[36:37], v57 offset:1280
    v_cvt_pk_bf16_f32 v128, v96, v97
    v_cvt_pk_bf16_f32 v129, v98, v99
    v_cvt_pk_bf16_f32 v130, v100, v101
    v_cvt_pk_bf16_f32 v131, v102, v103
    v_cvt_pk_bf16_f32 v132, v104, v105
    v_cvt_pk_bf16_f32 v133, v106, v107
    v_cvt_pk_bf16_f32 v134, v108, v109
    v_cvt_pk_bf16_f32 v135, v110, v111
    v_mfma_f32_32x32x8_bf16 v[80:95], v[28:29], v[20:21], v[80:95]
    v_exp_f32 v112, v112
    v_exp_f32 v113, v113
    v_exp_f32 v114, v114
    v_exp_f32 v115, v115
    s_waitcnt lgkmcnt(2)
    v_mfma_f32_32x32x16_bf16 v[144:159], v[48:51], v[128:131], v[144:159]
    v_exp_f32 v116, v116
    v_exp_f32 v117, v117
    v_exp_f32 v118, v118
    v_exp_f32 v119, v119
    v_exp_f32 v120, v120
    v_exp_f32 v121, v121
    v_exp_f32 v122, v122
    v_exp_f32 v123, v123
    v_mfma_f32_32x32x16_bf16 v[144:159], v[52:55], v[132:135], v[144:159]
    v_exp_f32 v124, v124
    v_exp_f32 v125, v125
    v_exp_f32 v126, v126
    v_exp_f32 v127, v127
    s_setprio 0
    s_mov_b64 exec, s[22:23]
    ds_read_b128 v[40:43], v58 offset:5120
    ds_read_b128 v[44:47], v58 offset:5760
    s_mov_b64 exec, -1
    v_cvt_pk_bf16_f32 v136, v112, v113
    v_cvt_pk_bf16_f32 v137, v114, v115
    v_cvt_pk_bf16_f32 v138, v116, v117
    v_cvt_pk_bf16_f32 v139, v118, v119
    v_cvt_pk_bf16_f32 v140, v120, v121
    v_cvt_pk_bf16_f32 v141, v122, v123
    v_cvt_pk_bf16_f32 v142, v124, v125
    v_cvt_pk_bf16_f32 v143, v126, v127
    v_max3_u32 v197, v176, v177, v178
    v_max3_u32 v198, v179, v180, v181
    v_max3_u32 v197, v197, v182, v183
    v_max3_u32 v198, v198, v184, v185
    v_max3_u32 v197, v197, v186, v187
    v_max3_u32 v198, v198, v188, v189
    v_max3_u32 v197, v197, v190, v191
    v_max3_u32 v198, v198, v192, v193
    v_max3_u32 v197, v197, v194, v195
    v_max_u32 v197, v197, v198
    v_cmp_eq_u32 vcc, -1, v197
    s_cbranch_vccnz fused1_kernel_vr23
fused1_kernel_vd26:
    s_waitcnt lgkmcnt(2)
    v_mfma_f32_32x32x16_bf16 v[96:111], v[32:35], v[8:11], 0
    v_exp_f32 v64, v64
    v_exp_f32 v65, v65
    v_exp_f32 v66, v66
    v_exp_f32 v67, v67
    s_setprio 1
    v_mfma_f32_32x32x16_bf16 v[160:175], v[48:51], v[136:139], v[160:175]
    v_exp_f32 v68, v68
    v_exp_f32 v69, v69
    v_exp_f32 v70, v70
    v_exp_f32 v71, v71
    v_mfma_f32_32x32x16_bf16 v[112:127], v[32:35], v[16:19], 0
    v_exp_f32 v72, v72
    v_exp_f32 v73, v73
    v_exp_f32 v74, v74
    v_exp_f32 v75, v75
    v_mfma_f32_32x32x16_bf16 v[160:175], v[52:55], v[140:143], v[160:175]
    v_exp_f32 v76, v76
    v_exp_f32 v77, v77
    v_exp_f32 v78, v78
    v_exp_f32 v79, v79
    v_mfma_f32_32x32x8_bf16 v[96:111], v[36:37], v[12:13], v[96:111]
    ds_read_b128 v[24:27], v56 offset:6144
    ds_read_b64 v[28:29], v57 offset:1536
    v_cvt_pk_bf16_f32 v128, v64, v65
    v_cvt_pk_bf16_f32 v129, v66, v67
    v_cvt_pk_bf16_f32 v130, v68, v69
    v_cvt_pk_bf16_f32 v131, v70, v71
    v_cvt_pk_bf16_f32 v132, v72, v73
    v_cvt_pk_bf16_f32 v133, v74, v75
    v_cvt_pk_bf16_f32 v134, v76, v77
    v_cvt_pk_bf16_f32 v135, v78, v79
    v_mfma_f32_32x32x8_bf16 v[112:127], v[36:37], v[20:21], v[112:127]
    v_exp_f32 v80, v80
    v_exp_f32 v81, v81
    v_exp_f32 v82, v82
    v_exp_f32 v83, v83
    s_waitcnt lgkmcnt(2)
    v_mfma_f32_32x32x16_bf16 v[144:159], v[40:43], v[128:131], v[144:159]
    v_exp_f32 v84, v84
    v_exp_f32 v85, v85
    v_exp_f32 v86, v86
    v_exp_f32 v87, v87
    v_exp_f32 v88, v88
    v_exp_f32 v89, v89
    v_exp_f32 v90, v90
    v_exp_f32 v91, v91
    v_mfma_f32_32x32x16_bf16 v[144:159], v[44:47], v[132:135], v[144:159]
    v_exp_f32 v92, v92
    v_exp_f32 v93, v93
    v_exp_f32 v94, v94
    v_exp_f32 v95, v95
    s_setprio 0
    s_mov_b64 exec, s[22:23]
    ds_read_b128 v[48:51], v58 offset:6400
    ds_read_b128 v[52:55], v58 offset:7040
    s_mov_b64 exec, -1
    v_cvt_pk_bf16_f32 v136, v80, v81
    v_cvt_pk_bf16_f32 v137, v82, v83
    v_cvt_pk_bf16_f32 v138, v84, v85
    v_cvt_pk_bf16_f32 v139, v86, v87
    v_cvt_pk_bf16_f32 v140, v88, v89
    v_cvt_pk_bf16_f32 v141, v90, v91
    v_cvt_pk_bf16_f32 v142, v92, v93
    v_cvt_pk_bf16_f32 v143, v94, v95
    s_waitcnt lgkmcnt(2)
    v_mfma_f32_32x32x16_bf16 v[64:79], v[24:27], v[8:11], 0
    s_add_u32 s21, s20, 81920
    v_add_u32 v196, s21, v1
    s_waitcnt vmcnt(0)
    ds_read_b128 v[176:179], v196 offset:0
    ds_read_b128 v[180:183], v196 offset:1024
    ds_read_b128 v[184:187], v196 offset:2048
    ds_read_b128 v[188:191], v196 offset:3072
    ds_read_b128 v[192:195], v196 offset:4096
    v_exp_f32 v96, v96
    v_exp_f32 v97, v97
    v_exp_f32 v98, v98
    v_exp_f32 v99, v99
    s_setprio 1
    v_mfma_f32_32x32x16_bf16 v[160:175], v[40:43], v[136:139], v[160:175]
    v_exp_f32 v100, v100
    v_exp_f32 v101, v101
    v_exp_f32 v102, v102
    v_exp_f32 v103, v103
    v_mfma_f32_32x32x16_bf16 v[80:95], v[24:27], v[16:19], 0
    v_exp_f32 v104, v104
    v_exp_f32 v105, v105
    v_exp_f32 v106, v106
    v_exp_f32 v107, v107
    v_mfma_f32_32x32x16_bf16 v[160:175], v[44:47], v[140:143], v[160:175]
    v_exp_f32 v108, v108
    v_exp_f32 v109, v109
    v_exp_f32 v110, v110
    v_exp_f32 v111, v111
    v_mfma_f32_32x32x8_bf16 v[64:79], v[28:29], v[12:13], v[64:79]
    ds_read_b128 v[32:35], v56 offset:7168
    ds_read_b64 v[36:37], v57 offset:1792
    v_cvt_pk_bf16_f32 v128, v96, v97
    v_cvt_pk_bf16_f32 v129, v98, v99
    v_cvt_pk_bf16_f32 v130, v100, v101
    v_cvt_pk_bf16_f32 v131, v102, v103
    v_cvt_pk_bf16_f32 v132, v104, v105
    v_cvt_pk_bf16_f32 v133, v106, v107
    v_cvt_pk_bf16_f32 v134, v108, v109
    v_cvt_pk_bf16_f32 v135, v110, v111
    v_mfma_f32_32x32x8_bf16 v[80:95], v[28:29], v[20:21], v[80:95]
    v_exp_f32 v112, v112
    v_exp_f32 v113, v113
    v_exp_f32 v114, v114
    v_exp_f32 v115, v115
    s_waitcnt lgkmcnt(2)
    v_mfma_f32_32x32x16_bf16 v[144:159], v[48:51], v[128:131], v[144:159]
    v_exp_f32 v116, v116
    v_exp_f32 v117, v117
    v_exp_f32 v118, v118
    v_exp_f32 v119, v119
    v_exp_f32 v120, v120
    v_exp_f32 v121, v121
    v_exp_f32 v122, v122
    v_exp_f32 v123, v123
    v_mfma_f32_32x32x16_bf16 v[144:159], v[52:55], v[132:135], v[144:159]
    v_exp_f32 v124, v124
    v_exp_f32 v125, v125
    v_exp_f32 v126, v126
    v_exp_f32 v127, v127
    s_setprio 0
    s_mov_b64 exec, s[22:23]
    ds_read_b128 v[40:43], v58 offset:7680
    ds_read_b128 v[44:47], v58 offset:8320
    s_mov_b64 exec, -1
    v_cvt_pk_bf16_f32 v136, v112, v113
    v_cvt_pk_bf16_f32 v137, v114, v115
    v_cvt_pk_bf16_f32 v138, v116, v117
    v_cvt_pk_bf16_f32 v139, v118, v119
    v_cvt_pk_bf16_f32 v140, v120, v121
    v_cvt_pk_bf16_f32 v141, v122, v123
    v_cvt_pk_bf16_f32 v142, v124, v125
    v_cvt_pk_bf16_f32 v143, v126, v127
    v_max3_u32 v197, v176, v177, v178
    v_max3_u32 v198, v179, v180, v181
    v_max3_u32 v197, v197, v182, v183
    v_max3_u32 v198, v198, v184, v185
    v_max3_u32 v197, v197, v186, v187
    v_max3_u32 v198, v198, v188, v189
    v_max3_u32 v197, v197, v190, v191
    v_max3_u32 v198, v198, v192, v193
    v_max3_u32 v197, v197, v194, v195
    v_max_u32 v197, v197, v198
    v_cmp_eq_u32 vcc, -1, v197
    s_cbranch_vccnz fused1_kernel_vr22
fused1_kernel_vd25:
    s_barrier
    s_waitcnt lgkmcnt(2)
    v_mfma_f32_32x32x16_bf16 v[96:111], v[32:35], v[8:11], 0
    v_exp_f32 v64, v64
    v_exp_f32 v65, v65
    v_exp_f32 v66, v66
    v_exp_f32 v67, v67
    s_setprio 1
    v_mfma_f32_32x32x16_bf16 v[160:175], v[48:51], v[136:139], v[160:175]
    v_exp_f32 v68, v68
    v_exp_f32 v69, v69
    v_exp_f32 v70, v70
    v_exp_f32 v71, v71
    v_mfma_f32_32x32x16_bf16 v[112:127], v[32:35], v[16:19], 0
    v_exp_f32 v72, v72
    v_exp_f32 v73, v73
    v_exp_f32 v74, v74
    v_exp_f32 v75, v75
    v_mfma_f32_32x32x16_bf16 v[160:175], v[52:55], v[140:143], v[160:175]
    v_exp_f32 v76, v76
    v_exp_f32 v77, v77
    v_exp_f32 v78, v78
    v_exp_f32 v79, v79
    v_mfma_f32_32x32x8_bf16 v[96:111], v[36:37], v[12:13], v[96:111]
    ds_read_b128 v[24:27], v56 offset:40960
    ds_read_b64 v[28:29], v57 offset:40960
    v_cvt_pk_bf16_f32 v128, v64, v65
    v_cvt_pk_bf16_f32 v129, v66, v67
    v_cvt_pk_bf16_f32 v130, v68, v69
    v_cvt_pk_bf16_f32 v131, v70, v71
    v_cvt_pk_bf16_f32 v132, v72, v73
    v_cvt_pk_bf16_f32 v133, v74, v75
    v_cvt_pk_bf16_f32 v134, v76, v77
    v_cvt_pk_bf16_f32 v135, v78, v79
    v_mfma_f32_32x32x8_bf16 v[112:127], v[36:37], v[20:21], v[112:127]
    v_exp_f32 v80, v80
    v_exp_f32 v81, v81
    v_exp_f32 v82, v82
    v_exp_f32 v83, v83
    s_waitcnt lgkmcnt(2)
    v_mfma_f32_32x32x16_bf16 v[144:159], v[40:43], v[128:131], v[144:159]
    v_exp_f32 v84, v84
    v_exp_f32 v85, v85
    v_exp_f32 v86, v86
    v_exp_f32 v87, v87
    v_exp_f32 v88, v88
    v_exp_f32 v89, v89
    v_exp_f32 v90, v90
    v_exp_f32 v91, v91
    v_mfma_f32_32x32x16_bf16 v[144:159], v[44:47], v[132:135], v[144:159]
    v_exp_f32 v92, v92
    v_exp_f32 v93, v93
    v_exp_f32 v94, v94
    v_exp_f32 v95, v95
    s_setprio 0
    s_mov_b64 exec, s[22:23]
    ds_read_b128 v[48:51], v58 offset:8960
    ds_read_b128 v[52:55], v58 offset:9600
    s_mov_b64 exec, -1
    v_cvt_pk_bf16_f32 v136, v80, v81
    v_cvt_pk_bf16_f32 v137, v82, v83
    v_cvt_pk_bf16_f32 v138, v84, v85
    v_cvt_pk_bf16_f32 v139, v86, v87
    v_cvt_pk_bf16_f32 v140, v88, v89
    v_cvt_pk_bf16_f32 v141, v90, v91
    v_cvt_pk_bf16_f32 v142, v92, v93
    v_cvt_pk_bf16_f32 v143, v94, v95
    s_waitcnt lgkmcnt(2)
    v_mfma_f32_32x32x16_bf16 v[64:79], v[24:27], v[8:11], 0
    v_exp_f32 v96, v96
    v_exp_f32 v97, v97
    v_exp_f32 v98, v98
    v_exp_f32 v99, v99
    s_setprio 1
    s_mul_i32 s34, s4, 5
    s_cmp_eq_u32 s31, 0
    s_cselect_b32 s5, s30, 4
    s_cselect_b32 s27, s4, s30
    s_add_u32 s34, s34, s5
    s_mul_i32 s33, s34, 40960
    s_mul_i32 s27, s27, 10240
    s_add_u32 s27, s27, s33
    s_add_u32 s5, s4, 1
    s_and_b32 s5, s5, 3
    s_mul_i32 s5, s5, 10240
    s_add_u32 s33, s33, s5
    v_lshlrev_b32 v232, 8, v4
    v_lshl_add_u32 v232, v3, 1, v232
    s_mul_i32 s35, s3, 40960
    s_lshl_b32 s26, s34, 11
    s_add_u32 s35, s35, s26
    v_mfma_f32_32x32x16_bf16 v[160:175], v[40:43], v[136:139], v[160:175]
    v_exp_f32 v100, v100
    v_exp_f32 v101, v101
    v_exp_f32 v102, v102
    v_exp_f32 v103, v103
    buffer_load_dwordx4 v[176:179], v1, s[64:67], s27 offen offset:0
    v_mfma_f32_32x32x16_bf16 v[80:95], v[24:27], v[16:19], 0
    v_exp_f32 v104, v104
    v_exp_f32 v105, v105
    v_exp_f32 v106, v106
    v_exp_f32 v107, v107
    v_mfma_f32_32x32x16_bf16 v[160:175], v[44:47], v[140:143], v[160:175]
    v_exp_f32 v108, v108
    v_exp_f32 v109, v109
    v_exp_f32 v110, v110
    v_exp_f32 v111, v111
    v_mfma_f32_32x32x8_bf16 v[64:79], v[28:29], v[12:13], v[64:79]
    ds_read_b128 v[32:35], v56 offset:41984
    ds_read_b64 v[36:37], v57 offset:41216
    v_cvt_pk_bf16_f32 v128, v96, v97
    v_cvt_pk_bf16_f32 v129, v98, v99
    v_cvt_pk_bf16_f32 v130, v100, v101
    v_cvt_pk_bf16_f32 v131, v102, v103
    v_cvt_pk_bf16_f32 v132, v104, v105
    v_cvt_pk_bf16_f32 v133, v106, v107
    v_cvt_pk_bf16_f32 v134, v108, v109
    v_cvt_pk_bf16_f32 v135, v110, v111
    v_mfma_f32_32x32x8_bf16 v[80:95], v[28:29], v[20:21], v[80:95]
    v_exp_f32 v112, v112
    v_exp_f32 v113, v113
    v_exp_f32 v114, v114
    v_exp_f32 v115, v115
    s_waitcnt lgkmcnt(2)
    v_mfma_f32_32x32x16_bf16 v[144:159], v[48:51], v[128:131], v[144:159]
    v_exp_f32 v116, v116
    v_exp_f32 v117, v117
    v_exp_f32 v118, v118
    v_exp_f32 v119, v119
    v_exp_f32 v120, v120
    v_exp_f32 v121, v121
    v_exp_f32 v122, v122
    v_exp_f32 v123, v123
    v_mfma_f32_32x32x16_bf16 v[144:159], v[52:55], v[132:135], v[144:159]
    v_exp_f32 v124, v124
    v_exp_f32 v125, v125
    v_exp_f32 v126, v126
    v_exp_f32 v127, v127
    s_setprio 0
    s_mov_b64 exec, s[22:23]
    ds_read_b128 v[40:43], v58 offset:40960
    ds_read_b128 v[44:47], v58 offset:41600
    s_mov_b64 exec, -1
    v_cvt_pk_bf16_f32 v136, v112, v113
    v_cvt_pk_bf16_f32 v137, v114, v115
    v_cvt_pk_bf16_f32 v138, v116, v117
    v_cvt_pk_bf16_f32 v139, v118, v119
    v_cvt_pk_bf16_f32 v140, v120, v121
    v_cvt_pk_bf16_f32 v141, v122, v123
    v_cvt_pk_bf16_f32 v142, v124, v125
    v_cvt_pk_bf16_f32 v143, v126, v127
    v_add_u32 v56, 40960, v56
    v_add_u32 v57, 40960, v57
    v_add_u32 v58, 40960, v58
    s_waitcnt lgkmcnt(2)
    v_mfma_f32_32x32x16_bf16 v[96:111], v[32:35], v[8:11], 0
    v_exp_f32 v64, v64
    v_exp_f32 v65, v65
    v_exp_f32 v66, v66
    v_exp_f32 v67, v67
    s_setprio 1
    v_mfma_f32_32x32x16_bf16 v[160:175], v[48:51], v[136:139], v[160:175]
    v_exp_f32 v68, v68
    v_exp_f32 v69, v69
    v_exp_f32 v70, v70
    v_exp_f32 v71, v71
    buffer_load_dwordx4 v[180:183], v1, s[64:67], s27 offen offset:1024
    v_mfma_f32_32x32x16_bf16 v[112:127], v[32:35], v[16:19], 0
    v_exp_f32 v72, v72
    v_exp_f32 v73, v73
    v_exp_f32 v74, v74
    v_exp_f32 v75, v75
    v_mfma_f32_32x32x16_bf16 v[160:175], v[52:55], v[140:143], v[160:175]
    v_exp_f32 v76, v76
    v_exp_f32 v77, v77
    v_exp_f32 v78, v78
    v_exp_f32 v79, v79
    v_mfma_f32_32x32x8_bf16 v[96:111], v[36:37], v[12:13], v[96:111]
    ds_read_b128 v[24:27], v56 offset:2048
    ds_read_b64 v[28:29], v57 offset:512
    v_cvt_pk_bf16_f32 v128, v64, v65
    v_cvt_pk_bf16_f32 v129, v66, v67
    v_cvt_pk_bf16_f32 v130, v68, v69
    v_cvt_pk_bf16_f32 v131, v70, v71
    v_cvt_pk_bf16_f32 v132, v72, v73
    v_cvt_pk_bf16_f32 v133, v74, v75
    v_cvt_pk_bf16_f32 v134, v76, v77
    v_cvt_pk_bf16_f32 v135, v78, v79
    v_mfma_f32_32x32x8_bf16 v[112:127], v[36:37], v[20:21], v[112:127]
    v_exp_f32 v80, v80
    v_exp_f32 v81, v81
    v_exp_f32 v82, v82
    v_exp_f32 v83, v83
    s_waitcnt lgkmcnt(2)
    v_mfma_f32_32x32x16_bf16 v[144:159], v[40:43], v[128:131], v[144:159]
    v_exp_f32 v84, v84
    v_exp_f32 v85, v85
    v_exp_f32 v86, v86
    v_exp_f32 v87, v87
    s_cmp_lg_u32 s40, 4
    s_cbranch_scc1 fused1_kernel_w327
    buffer_load_ushort v216, v232, s[48:51], s35 offen offset:0
    buffer_load_ushort v217, v232, s[48:51], s35 offen offset:64
    buffer_load_ushort v218, v232, s[48:51], s35 offen offset:128
    buffer_load_ushort v219, v232, s[48:51], s35 offen offset:192
fused1_kernel_w327:
    v_exp_f32 v88, v88
    v_exp_f32 v89, v89
    v_exp_f32 v90, v90
    v_exp_f32 v91, v91
    v_mfma_f32_32x32x16_bf16 v[144:159], v[44:47], v[132:135], v[144:159]
    v_exp_f32 v92, v92
    v_exp_f32 v93, v93
    v_exp_f32 v94, v94
    v_exp_f32 v95, v95
    s_setprio 0
    s_mov_b64 exec, s[22:23]
    ds_read_b128 v[48:51], v58 offset:1280
    ds_read_b128 v[52:55], v58 offset:1920
    s_mov_b64 exec, -1
    v_cvt_pk_bf16_f32 v136, v80, v81
    v_cvt_pk_bf16_f32 v137, v82, v83
    v_cvt_pk_bf16_f32 v138, v84, v85
    v_cvt_pk_bf16_f32 v139, v86, v87
    v_cvt_pk_bf16_f32 v140, v88, v89
    v_cvt_pk_bf16_f32 v141, v90, v91
    v_cvt_pk_bf16_f32 v142, v92, v93
    v_cvt_pk_bf16_f32 v143, v94, v95
    s_waitcnt lgkmcnt(2)
    v_mfma_f32_32x32x16_bf16 v[64:79], v[24:27], v[8:11], 0
    v_exp_f32 v96, v96
    v_exp_f32 v97, v97
    v_exp_f32 v98, v98
    v_exp_f32 v99, v99
    s_setprio 1
    v_mfma_f32_32x32x16_bf16 v[160:175], v[40:43], v[136:139], v[160:175]
    v_exp_f32 v100, v100
    v_exp_f32 v101, v101
    v_exp_f32 v102, v102
    v_exp_f32 v103, v103
    buffer_load_dwordx4 v[184:187], v1, s[64:67], s27 offen offset:2048
    v_mfma_f32_32x32x16_bf16 v[80:95], v[24:27], v[16:19], 0
    v_exp_f32 v104, v104
    v_exp_f32 v105, v105
    v_exp_f32 v106, v106
    v_exp_f32 v107, v107
    v_mfma_f32_32x32x16_bf16 v[160:175], v[44:47], v[140:143], v[160:175]
    v_exp_f32 v108, v108
    v_exp_f32 v109, v109
    v_exp_f32 v110, v110
    v_exp_f32 v111, v111
    v_mfma_f32_32x32x8_bf16 v[64:79], v[28:29], v[12:13], v[64:79]
    ds_read_b128 v[32:35], v56 offset:3072
    ds_read_b64 v[36:37], v57 offset:768
    v_cvt_pk_bf16_f32 v128, v96, v97
    v_cvt_pk_bf16_f32 v129, v98, v99
    v_cvt_pk_bf16_f32 v130, v100, v101
    v_cvt_pk_bf16_f32 v131, v102, v103
    v_cvt_pk_bf16_f32 v132, v104, v105
    v_cvt_pk_bf16_f32 v133, v106, v107
    v_cvt_pk_bf16_f32 v134, v108, v109
    v_cvt_pk_bf16_f32 v135, v110, v111
    v_mfma_f32_32x32x8_bf16 v[80:95], v[28:29], v[20:21], v[80:95]
    v_exp_f32 v112, v112
    v_exp_f32 v113, v113
    v_exp_f32 v114, v114
    v_exp_f32 v115, v115
    s_waitcnt lgkmcnt(2)
    v_mfma_f32_32x32x16_bf16 v[144:159], v[48:51], v[128:131], v[144:159]
    v_exp_f32 v116, v116
    v_exp_f32 v117, v117
    v_exp_f32 v118, v118
    v_exp_f32 v119, v119
    s_cmp_lg_u32 s40, 4
    s_cbranch_scc1 fused1_kernel_w328
    buffer_load_ushort v220, v232, s[48:51], s35 offen offset:512
    buffer_load_ushort v221, v232, s[48:51], s35 offen offset:576
    buffer_load_ushort v222, v232, s[48:51], s35 offen offset:640
    buffer_load_ushort v223, v232, s[48:51], s35 offen offset:704
fused1_kernel_w328:
    v_exp_f32 v120, v120
    v_exp_f32 v121, v121
    v_exp_f32 v122, v122
    v_exp_f32 v123, v123
    v_mfma_f32_32x32x16_bf16 v[144:159], v[52:55], v[132:135], v[144:159]
    v_exp_f32 v124, v124
    v_exp_f32 v125, v125
    v_exp_f32 v126, v126
    v_exp_f32 v127, v127
    s_setprio 0
    s_mov_b64 exec, s[22:23]
    ds_read_b128 v[40:43], v58 offset:2560
    ds_read_b128 v[44:47], v58 offset:3200
    s_mov_b64 exec, -1
    v_cvt_pk_bf16_f32 v136, v112, v113
    v_cvt_pk_bf16_f32 v137, v114, v115
    v_cvt_pk_bf16_f32 v138, v116, v117
    v_cvt_pk_bf16_f32 v139, v118, v119
    v_cvt_pk_bf16_f32 v140, v120, v121
    v_cvt_pk_bf16_f32 v141, v122, v123
    v_cvt_pk_bf16_f32 v142, v124, v125
    v_cvt_pk_bf16_f32 v143, v126, v127
    s_waitcnt lgkmcnt(2)
    v_mfma_f32_32x32x16_bf16 v[96:111], v[32:35], v[8:11], 0
    v_exp_f32 v64, v64
    v_exp_f32 v65, v65
    v_exp_f32 v66, v66
    v_exp_f32 v67, v67
    s_setprio 1
    v_mfma_f32_32x32x16_bf16 v[160:175], v[48:51], v[136:139], v[160:175]
    v_exp_f32 v68, v68
    v_exp_f32 v69, v69
    v_exp_f32 v70, v70
    v_exp_f32 v71, v71
    buffer_load_dwordx4 v[188:191], v1, s[64:67], s27 offen offset:3072
    s_add_u32 s27, s27, 4096
    v_mfma_f32_32x32x16_bf16 v[112:127], v[32:35], v[16:19], 0
    v_exp_f32 v72, v72
    v_exp_f32 v73, v73
    v_exp_f32 v74, v74
    v_exp_f32 v75, v75
    v_mfma_f32_32x32x16_bf16 v[160:175], v[52:55], v[140:143], v[160:175]
    v_exp_f32 v76, v76
    v_exp_f32 v77, v77
    v_exp_f32 v78, v78
    v_exp_f32 v79, v79
    v_mfma_f32_32x32x8_bf16 v[96:111], v[36:37], v[12:13], v[96:111]
    ds_read_b128 v[24:27], v56 offset:4096
    ds_read_b64 v[28:29], v57 offset:1024
    v_cvt_pk_bf16_f32 v128, v64, v65
    v_cvt_pk_bf16_f32 v129, v66, v67
    v_cvt_pk_bf16_f32 v130, v68, v69
    v_cvt_pk_bf16_f32 v131, v70, v71
    v_cvt_pk_bf16_f32 v132, v72, v73
    v_cvt_pk_bf16_f32 v133, v74, v75
    v_cvt_pk_bf16_f32 v134, v76, v77
    v_cvt_pk_bf16_f32 v135, v78, v79
    v_mfma_f32_32x32x8_bf16 v[112:127], v[36:37], v[20:21], v[112:127]
    v_exp_f32 v80, v80
    v_exp_f32 v81, v81
    v_exp_f32 v82, v82
    v_exp_f32 v83, v83
    s_waitcnt lgkmcnt(2)
    v_mfma_f32_32x32x16_bf16 v[144:159], v[40:43], v[128:131], v[144:159]
    v_exp_f32 v84, v84
    v_exp_f32 v85, v85
    v_exp_f32 v86, v86
    v_exp_f32 v87, v87
    s_cmp_lg_u32 s40, 4
    s_cbranch_scc1 fused1_kernel_w329
    buffer_load_ushort v224, v232, s[48:51], s35 offen offset:1024
    buffer_load_ushort v225, v232, s[48:51], s35 offen offset:1088
    buffer_load_ushort v226, v232, s[48:51], s35 offen offset:1152
    buffer_load_ushort v227, v232, s[48:51], s35 offen offset:1216
fused1_kernel_w329:
    v_exp_f32 v88, v88
    v_exp_f32 v89, v89
    v_exp_f32 v90, v90
    v_exp_f32 v91, v91
    v_mfma_f32_32x32x16_bf16 v[144:159], v[44:47], v[132:135], v[144:159]
    v_exp_f32 v92, v92
    v_exp_f32 v93, v93
    v_exp_f32 v94, v94
    v_exp_f32 v95, v95
    s_setprio 0
    s_mov_b64 exec, s[22:23]
    ds_read_b128 v[48:51], v58 offset:3840
    ds_read_b128 v[52:55], v58 offset:4480
    s_mov_b64 exec, -1
    v_cvt_pk_bf16_f32 v136, v80, v81
    v_cvt_pk_bf16_f32 v137, v82, v83
    v_cvt_pk_bf16_f32 v138, v84, v85
    v_cvt_pk_bf16_f32 v139, v86, v87
    v_cvt_pk_bf16_f32 v140, v88, v89
    v_cvt_pk_bf16_f32 v141, v90, v91
    v_cvt_pk_bf16_f32 v142, v92, v93
    v_cvt_pk_bf16_f32 v143, v94, v95
    s_waitcnt lgkmcnt(2)
    v_mfma_f32_32x32x16_bf16 v[64:79], v[24:27], v[8:11], 0
    v_exp_f32 v96, v96
    v_exp_f32 v97, v97
    v_exp_f32 v98, v98
    v_exp_f32 v99, v99
    s_setprio 1
    v_mfma_f32_32x32x16_bf16 v[160:175], v[40:43], v[136:139], v[160:175]
    v_exp_f32 v100, v100
    v_exp_f32 v101, v101
    v_exp_f32 v102, v102
    v_exp_f32 v103, v103
    buffer_load_dwordx4 v[192:195], v1, s[64:67], s27 offen offset:0
    v_mfma_f32_32x32x16_bf16 v[80:95], v[24:27], v[16:19], 0
    v_exp_f32 v104, v104
    v_exp_f32 v105, v105
    v_exp_f32 v106, v106
    v_exp_f32 v107, v107
    v_mfma_f32_32x32x16_bf16 v[160:175], v[44:47], v[140:143], v[160:175]
    v_exp_f32 v108, v108
    v_exp_f32 v109, v109
    v_exp_f32 v110, v110
    v_exp_f32 v111, v111
    v_mfma_f32_32x32x8_bf16 v[64:79], v[28:29], v[12:13], v[64:79]
    ds_read_b128 v[32:35], v56 offset:5120
    ds_read_b64 v[36:37], v57 offset:1280
    v_cvt_pk_bf16_f32 v128, v96, v97
    v_cvt_pk_bf16_f32 v129, v98, v99
    v_cvt_pk_bf16_f32 v130, v100, v101
    v_cvt_pk_bf16_f32 v131, v102, v103
    v_cvt_pk_bf16_f32 v132, v104, v105
    v_cvt_pk_bf16_f32 v133, v106, v107
    v_cvt_pk_bf16_f32 v134, v108, v109
    v_cvt_pk_bf16_f32 v135, v110, v111
    v_mfma_f32_32x32x8_bf16 v[80:95], v[28:29], v[20:21], v[80:95]
    v_exp_f32 v112, v112
    v_exp_f32 v113, v113
    v_exp_f32 v114, v114
    v_exp_f32 v115, v115
    s_waitcnt lgkmcnt(2)
    v_mfma_f32_32x32x16_bf16 v[144:159], v[48:51], v[128:131], v[144:159]
    v_exp_f32 v116, v116
    v_exp_f32 v117, v117
    v_exp_f32 v118, v118
    v_exp_f32 v119, v119
    s_cmp_lg_u32 s40, 4
    s_cbranch_scc1 fused1_kernel_w330
    buffer_load_ushort v228, v232, s[48:51], s35 offen offset:1536
    buffer_load_ushort v229, v232, s[48:51], s35 offen offset:1600
    buffer_load_ushort v230, v232, s[48:51], s35 offen offset:1664
    buffer_load_ushort v231, v232, s[48:51], s35 offen offset:1728
fused1_kernel_w330:
    v_exp_f32 v120, v120
    v_exp_f32 v121, v121
    v_exp_f32 v122, v122
    v_exp_f32 v123, v123
    v_mfma_f32_32x32x16_bf16 v[144:159], v[52:55], v[132:135], v[144:159]
    v_exp_f32 v124, v124
    v_exp_f32 v125, v125
    v_exp_f32 v126, v126
    v_exp_f32 v127, v127
    s_setprio 0
    s_mov_b64 exec, s[22:23]
    ds_read_b128 v[40:43], v58 offset:5120
    ds_read_b128 v[44:47], v58 offset:5760
    s_mov_b64 exec, -1
    v_cvt_pk_bf16_f32 v136, v112, v113
    v_cvt_pk_bf16_f32 v137, v114, v115
    v_cvt_pk_bf16_f32 v138, v116, v117
    v_cvt_pk_bf16_f32 v139, v118, v119
    v_cvt_pk_bf16_f32 v140, v120, v121
    v_cvt_pk_bf16_f32 v141, v122, v123
    v_cvt_pk_bf16_f32 v142, v124, v125
    v_cvt_pk_bf16_f32 v143, v126, v127
    s_waitcnt lgkmcnt(2)
    v_mfma_f32_32x32x16_bf16 v[96:111], v[32:35], v[8:11], 0
    v_exp_f32 v64, v64
    v_exp_f32 v65, v65
    v_exp_f32 v66, v66
    v_exp_f32 v67, v67
    s_setprio 1
    v_mfma_f32_32x32x16_bf16 v[160:175], v[48:51], v[136:139], v[160:175]
    v_exp_f32 v68, v68
    v_exp_f32 v69, v69
    v_exp_f32 v70, v70
    v_exp_f32 v71, v71
    buffer_load_dwordx4 v[196:199], v1, s[64:67], s27 offen offset:1024
    v_mfma_f32_32x32x16_bf16 v[112:127], v[32:35], v[16:19], 0
    v_exp_f32 v72, v72
    v_exp_f32 v73, v73
    v_exp_f32 v74, v74
    v_exp_f32 v75, v75
    v_mfma_f32_32x32x16_bf16 v[160:175], v[52:55], v[140:143], v[160:175]
    v_exp_f32 v76, v76
    v_exp_f32 v77, v77
    v_exp_f32 v78, v78
    v_exp_f32 v79, v79
    v_mfma_f32_32x32x8_bf16 v[96:111], v[36:37], v[12:13], v[96:111]
    ds_read_b128 v[24:27], v56 offset:6144
    ds_read_b64 v[28:29], v57 offset:1536
    v_cvt_pk_bf16_f32 v128, v64, v65
    v_cvt_pk_bf16_f32 v129, v66, v67
    v_cvt_pk_bf16_f32 v130, v68, v69
    v_cvt_pk_bf16_f32 v131, v70, v71
    v_cvt_pk_bf16_f32 v132, v72, v73
    v_cvt_pk_bf16_f32 v133, v74, v75
    v_cvt_pk_bf16_f32 v134, v76, v77
    v_cvt_pk_bf16_f32 v135, v78, v79
    v_mfma_f32_32x32x8_bf16 v[112:127], v[36:37], v[20:21], v[112:127]
    v_exp_f32 v80, v80
    v_exp_f32 v81, v81
    v_exp_f32 v82, v82
    v_exp_f32 v83, v83
    s_waitcnt lgkmcnt(2)
    v_mfma_f32_32x32x16_bf16 v[144:159], v[40:43], v[128:131], v[144:159]
    v_exp_f32 v84, v84
    v_exp_f32 v85, v85
    v_exp_f32 v86, v86
    v_exp_f32 v87, v87
    v_exp_f32 v88, v88
    v_exp_f32 v89, v89
    v_exp_f32 v90, v90
    v_exp_f32 v91, v91
    v_mfma_f32_32x32x16_bf16 v[144:159], v[44:47], v[132:135], v[144:159]
    v_exp_f32 v92, v92
    v_exp_f32 v93, v93
    v_exp_f32 v94, v94
    v_exp_f32 v95, v95
    s_setprio 0
    s_mov_b64 exec, s[22:23]
    ds_read_b128 v[48:51], v58 offset:6400
    ds_read_b128 v[52:55], v58 offset:7040
    s_mov_b64 exec, -1
    v_cvt_pk_bf16_f32 v136, v80, v81
    v_cvt_pk_bf16_f32 v137, v82, v83
    v_cvt_pk_bf16_f32 v138, v84, v85
    v_cvt_pk_bf16_f32 v139, v86, v87
    v_cvt_pk_bf16_f32 v140, v88, v89
    v_cvt_pk_bf16_f32 v141, v90, v91
    v_cvt_pk_bf16_f32 v142, v92, v93
    v_cvt_pk_bf16_f32 v143, v94, v95
    s_waitcnt lgkmcnt(2)
    v_mfma_f32_32x32x16_bf16 v[64:79], v[24:27], v[8:11], 0
    v_exp_f32 v96, v96
    v_exp_f32 v97, v97
    v_exp_f32 v98, v98
    v_exp_f32 v99, v99
    s_setprio 1
    v_mfma_f32_32x32x16_bf16 v[160:175], v[40:43], v[136:139], v[160:175]
    v_exp_f32 v100, v100
    v_exp_f32 v101, v101
    v_exp_f32 v102, v102
    v_exp_f32 v103, v103
    buffer_load_dwordx4 v[200:203], v1, s[64:67], s27 offen offset:2048
    v_mfma_f32_32x32x16_bf16 v[80:95], v[24:27], v[16:19], 0
    v_exp_f32 v104, v104
    v_exp_f32 v105, v105
    v_exp_f32 v106, v106
    v_exp_f32 v107, v107
    v_mfma_f32_32x32x16_bf16 v[160:175], v[44:47], v[140:143], v[160:175]
    v_exp_f32 v108, v108
    v_exp_f32 v109, v109
    v_exp_f32 v110, v110
    v_exp_f32 v111, v111
    v_mfma_f32_32x32x8_bf16 v[64:79], v[28:29], v[12:13], v[64:79]
    ds_read_b128 v[32:35], v56 offset:7168
    ds_read_b64 v[36:37], v57 offset:1792
    v_cvt_pk_bf16_f32 v128, v96, v97
    v_cvt_pk_bf16_f32 v129, v98, v99
    v_cvt_pk_bf16_f32 v130, v100, v101
    v_cvt_pk_bf16_f32 v131, v102, v103
    v_cvt_pk_bf16_f32 v132, v104, v105
    v_cvt_pk_bf16_f32 v133, v106, v107
    v_cvt_pk_bf16_f32 v134, v108, v109
    v_cvt_pk_bf16_f32 v135, v110, v111
    v_mfma_f32_32x32x8_bf16 v[80:95], v[28:29], v[20:21], v[80:95]
    v_exp_f32 v112, v112
    v_exp_f32 v113, v113
    v_exp_f32 v114, v114
    v_exp_f32 v115, v115
    s_waitcnt lgkmcnt(2)
    v_mfma_f32_32x32x16_bf16 v[144:159], v[48:51], v[128:131], v[144:159]
    v_exp_f32 v116, v116
    v_exp_f32 v117, v117
    v_exp_f32 v118, v118
    v_exp_f32 v119, v119
    s_cmp_lg_u32 s31, 0
    s_cbranch_scc1 fused1_kernel_w231
    buffer_load_dwordx4 v[216:219], v1, s[64:67], s33 offen offset:0
    buffer_load_dwordx4 v[220:223], v1, s[64:67], s33 offen offset:1024
fused1_kernel_w231:
    v_exp_f32 v120, v120
    v_exp_f32 v121, v121
    v_exp_f32 v122, v122
    v_exp_f32 v123, v123
    v_mfma_f32_32x32x16_bf16 v[144:159], v[52:55], v[132:135], v[144:159]
    v_exp_f32 v124, v124
    v_exp_f32 v125, v125
    v_exp_f32 v126, v126
    v_exp_f32 v127, v127
    s_setprio 0
    s_mov_b64 exec, s[22:23]
    ds_read_b128 v[40:43], v58 offset:7680
    ds_read_b128 v[44:47], v58 offset:8320
    s_mov_b64 exec, -1
    v_cvt_pk_bf16_f32 v136, v112, v113
    v_cvt_pk_bf16_f32 v137, v114, v115
    v_cvt_pk_bf16_f32 v138, v116, v117
    v_cvt_pk_bf16_f32 v139, v118, v119
    v_cvt_pk_bf16_f32 v140, v120, v121
    v_cvt_pk_bf16_f32 v141, v122, v123
    v_cvt_pk_bf16_f32 v142, v124, v125
    v_cvt_pk_bf16_f32 v143, v126, v127
    s_waitcnt lgkmcnt(2)
    v_mfma_f32_32x32x16_bf16 v[96:111], v[32:35], v[8:11], 0
    v_exp_f32 v64, v64
    v_exp_f32 v65, v65
    v_exp_f32 v66, v66
    v_exp_f32 v67, v67
    s_setprio 1
    v_mfma_f32_32x32x16_bf16 v[160:175], v[48:51], v[136:139], v[160:175]
    v_exp_f32 v68, v68
    v_exp_f32 v69, v69
    v_exp_f32 v70, v70
    v_exp_f32 v71, v71
    buffer_load_dwordx4 v[204:207], v1, s[64:67], s27 offen offset:3072
    s_add_u32 s27, s27, 4096
    v_mfma_f32_32x32x16_bf16 v[112:127], v[32:35], v[16:19], 0
    v_exp_f32 v72, v72
    v_exp_f32 v73, v73
    v_exp_f32 v74, v74
    v_exp_f32 v75, v75
    v_mfma_f32_32x32x16_bf16 v[160:175], v[52:55], v[140:143], v[160:175]
    v_exp_f32 v76, v76
    v_exp_f32 v77, v77
    v_exp_f32 v78, v78
    v_exp_f32 v79, v79
    v_mfma_f32_32x32x8_bf16 v[96:111], v[36:37], v[12:13], v[96:111]
    ds_read_b128 v[24:27], v56 offset:40960
    ds_read_b64 v[28:29], v57 offset:40960
    v_cvt_pk_bf16_f32 v128, v64, v65
    v_cvt_pk_bf16_f32 v129, v66, v67
    v_cvt_pk_bf16_f32 v130, v68, v69
    v_cvt_pk_bf16_f32 v131, v70, v71
    v_cvt_pk_bf16_f32 v132, v72, v73
    v_cvt_pk_bf16_f32 v133, v74, v75
    v_cvt_pk_bf16_f32 v134, v76, v77
    v_cvt_pk_bf16_f32 v135, v78, v79
    v_mfma_f32_32x32x8_bf16 v[112:127], v[36:37], v[20:21], v[112:127]
    v_exp_f32 v80, v80
    v_exp_f32 v81, v81
    v_exp_f32 v82, v82
    v_exp_f32 v83, v83
    s_waitcnt lgkmcnt(2)
    v_mfma_f32_32x32x16_bf16 v[144:159], v[40:43], v[128:131], v[144:159]
    v_exp_f32 v84, v84
    v_exp_f32 v85, v85
    v_exp_f32 v86, v86
    v_exp_f32 v87, v87
    s_cmp_lg_u32 s31, 0
    s_cbranch_scc1 fused1_kernel_w232
    buffer_load_dwordx4 v[224:227], v1, s[64:67], s33 offen offset:2048
    buffer_load_dwordx4 v[228:231], v1, s[64:67], s33 offen offset:3072
    s_add_u32 s33, s33, 4096
fused1_kernel_w232:
    v_exp_f32 v88, v88
    v_exp_f32 v89, v89
    v_exp_f32 v90, v90
    v_exp_f32 v91, v91
    v_mfma_f32_32x32x16_bf16 v[144:159], v[44:47], v[132:135], v[144:159]
    v_exp_f32 v92, v92
    v_exp_f32 v93, v93
    v_exp_f32 v94, v94
    v_exp_f32 v95, v95
    s_setprio 0
    s_mov_b64 exec, s[22:23]
    ds_read_b128 v[48:51], v58 offset:8960
    ds_read_b128 v[52:55], v58 offset:9600
    s_mov_b64 exec, -1
    v_cvt_pk_bf16_f32 v136, v80, v81
    v_cvt_pk_bf16_f32 v137, v82, v83
    v_cvt_pk_bf16_f32 v138, v84, v85
    v_cvt_pk_bf16_f32 v139, v86, v87
    v_cvt_pk_bf16_f32 v140, v88, v89
    v_cvt_pk_bf16_f32 v141, v90, v91
    v_cvt_pk_bf16_f32 v142, v92, v93
    v_cvt_pk_bf16_f32 v143, v94, v95
    s_waitcnt lgkmcnt(2)
    v_mfma_f32_32x32x16_bf16 v[64:79], v[24:27], v[8:11], 0
    v_exp_f32 v96, v96
    v_exp_f32 v97, v97
    v_exp_f32 v98, v98
    v_exp_f32 v99, v99
    s_setprio 1
    v_mfma_f32_32x32x16_bf16 v[160:175], v[40:43], v[136:139], v[160:175]
    v_exp_f32 v100, v100
    v_exp_f32 v101, v101
    v_exp_f32 v102, v102
    v_exp_f32 v103, v103
    buffer_load_dwordx4 v[208:211], v1, s[64:67], s27 offen offset:0
    v_mfma_f32_32x32x16_bf16 v[80:95], v[24:27], v[16:19], 0
    v_exp_f32 v104, v104
    v_exp_f32 v105, v105
    v_exp_f32 v106, v106
    v_exp_f32 v107, v107
    v_mfma_f32_32x32x16_bf16 v[160:175], v[44:47], v[140:143], v[160:175]
    v_exp_f32 v108, v108
    v_exp_f32 v109, v109
    v_exp_f32 v110, v110
    v_exp_f32 v111, v111
    v_mfma_f32_32x32x8_bf16 v[64:79], v[28:29], v[12:13], v[64:79]
    ds_read_b128 v[32:35], v56 offset:41984
    ds_read_b64 v[36:37], v57 offset:41216
    v_cvt_pk_bf16_f32 v128, v96, v97
    v_cvt_pk_bf16_f32 v129, v98, v99
    v_cvt_pk_bf16_f32 v130, v100, v101
    v_cvt_pk_bf16_f32 v131, v102, v103
    v_cvt_pk_bf16_f32 v132, v104, v105
    v_cvt_pk_bf16_f32 v133, v106, v107
    v_cvt_pk_bf16_f32 v134, v108, v109
    v_cvt_pk_bf16_f32 v135, v110, v111
    v_mfma_f32_32x32x8_bf16 v[80:95], v[28:29], v[20:21], v[80:95]
    v_exp_f32 v112, v112
    v_exp_f32 v113, v113
    v_exp_f32 v114, v114
    v_exp_f32 v115, v115
    s_waitcnt lgkmcnt(2)
    v_mfma_f32_32x32x16_bf16 v[144:159], v[48:51], v[128:131], v[144:159]
    v_exp_f32 v116, v116
    v_exp_f32 v117, v117
    v_exp_f32 v118, v118
    v_exp_f32 v119, v119
    s_cmp_lg_u32 s31, 0
    s_cbranch_scc1 fused1_kernel_w233
    buffer_load_dwordx4 v[232:235], v1, s[64:67], s33 offen offset:0
    buffer_load_dwordx4 v[236:239], v1, s[64:67], s33 offen offset:1024
fused1_kernel_w233:
    v_exp_f32 v120, v120
    v_exp_f32 v121, v121
    v_exp_f32 v122, v122
    v_exp_f32 v123, v123
    v_mfma_f32_32x32x16_bf16 v[144:159], v[52:55], v[132:135], v[144:159]
    v_exp_f32 v124, v124
    v_exp_f32 v125, v125
    v_exp_f32 v126, v126
    v_exp_f32 v127, v127
    s_setprio 0
    s_mov_b64 exec, s[22:23]
    ds_read_b128 v[40:43], v58 offset:40960
    ds_read_b128 v[44:47], v58 offset:41600
    s_mov_b64 exec, -1
    v_cvt_pk_bf16_f32 v136, v112, v113
    v_cvt_pk_bf16_f32 v137, v114, v115
    v_cvt_pk_bf16_f32 v138, v116, v117
    v_cvt_pk_bf16_f32 v139, v118, v119
    v_cvt_pk_bf16_f32 v140, v120, v121
    v_cvt_pk_bf16_f32 v141, v122, v123
    v_cvt_pk_bf16_f32 v142, v124, v125
    v_cvt_pk_bf16_f32 v143, v126, v127
    v_add_u32 v56, 40960, v56
    v_add_u32 v57, 40960, v57
    v_add_u32 v58, 40960, v58
    s_waitcnt lgkmcnt(2)
    v_mfma_f32_32x32x16_bf16 v[96:111], v[32:35], v[8:11], 0
    v_exp_f32 v64, v64
    v_exp_f32 v65, v65
    v_exp_f32 v66, v66
    v_exp_f32 v67, v67
    s_setprio 1
    v_mfma_f32_32x32x16_bf16 v[160:175], v[48:51], v[136:139], v[160:175]
    v_exp_f32 v68, v68
    v_exp_f32 v69, v69
    v_exp_f32 v70, v70
    v_exp_f32 v71, v71
    buffer_load_dwordx4 v[212:215], v1, s[64:67], s27 offen offset:1024
    v_mfma_f32_32x32x16_bf16 v[112:127], v[32:35], v[16:19], 0
    v_exp_f32 v72, v72
    v_exp_f32 v73, v73
    v_exp_f32 v74, v74
    v_exp_f32 v75, v75
    v_mfma_f32_32x32x16_bf16 v[160:175], v[52:55], v[140:143], v[160:175]
    v_exp_f32 v76, v76
    v_exp_f32 v77, v77
    v_exp_f32 v78, v78
    v_exp_f32 v79, v79
    v_mfma_f32_32x32x8_bf16 v[96:111], v[36:37], v[12:13], v[96:111]
    ds_read_b128 v[24:27], v56 offset:2048
    ds_read_b64 v[28:29], v57 offset:512
    v_cvt_pk_bf16_f32 v128, v64, v65
    v_cvt_pk_bf16_f32 v129, v66, v67
    v_cvt_pk_bf16_f32 v130, v68, v69
    v_cvt_pk_bf16_f32 v131, v70, v71
    v_cvt_pk_bf16_f32 v132, v72, v73
    v_cvt_pk_bf16_f32 v133, v74, v75
    v_cvt_pk_bf16_f32 v134, v76, v77
    v_cvt_pk_bf16_f32 v135, v78, v79
    v_mfma_f32_32x32x8_bf16 v[112:127], v[36:37], v[20:21], v[112:127]
    v_exp_f32 v80, v80
    v_exp_f32 v81, v81
    v_exp_f32 v82, v82
    v_exp_f32 v83, v83
    s_waitcnt lgkmcnt(2)
    v_mfma_f32_32x32x16_bf16 v[144:159], v[40:43], v[128:131], v[144:159]
    v_exp_f32 v84, v84
    v_exp_f32 v85, v85
    v_exp_f32 v86, v86
    v_exp_f32 v87, v87
    s_cmp_lg_u32 s40, 4
    s_cbranch_scc1 fused1_kernel_kq35
    s_getpc_b64 s[96:97]
fused1_kernel_kpc36:
    s_add_u32 s96, s96, conv2_kernel-fused1_kernel_kpc36
    s_addc_u32 s97, s97, 0
    s_mov_b32 s98, fused2_kernel_end-conv2_kernel
    s_mov_b32 s99, 0x00020000
    s_bfe_u32 s94, s2, 0x30003
    s_lshl_b32 s94, s94, 13
    v_and_b32 v250, 63, v0
    v_lshlrev_b32 v250, 7, v250
    v_add_u32 v250, s94, v250
    buffer_load_dword v250, v250, s[96:99], 0 offen
fused1_kernel_kq35:
    s_cmp_lt_u32 s40, 5
    s_cbranch_scc1 fused1_kernel_kp34
    s_add_u32 s96, s6, 0xa00000
    s_addc_u32 s97, s7, 0
    s_mov_b32 s98, 0x294000
    s_mov_b32 s99, 0x00020000
    s_add_u32 s94, s2, 256
    s_lshr_b32 s95, s2, 1
    s_add_u32 s95, s95, 512
    s_cmp_eq_u32 s40, 6
    s_cselect_b32 s94, s94, s2
    s_cmp_eq_u32 s40, 7
    s_cselect_b32 s94, s95, s94
    s_mul_i32 s94, s94, 4224
    v_and_b32 v250, 63, v0
    v_mul_u32_u24 v250, 68, v250
    buffer_load_dword v250, v250, s[96:99], s94 offen
fused1_kernel_kp34:
    s_cmp_lg_u32 s31, 0
    s_cbranch_scc1 fused1_kernel_w237
    buffer_load_dwordx4 v[240:243], v1, s[64:67], s33 offen offset:2048
    buffer_load_dwordx4 v[244:247], v1, s[64:67], s33 offen offset:3072
    s_add_u32 s33, s33, 4096
fused1_kernel_w237:
    v_exp_f32 v88, v88
    v_exp_f32 v89, v89
    v_exp_f32 v90, v90
    v_exp_f32 v91, v91
    v_mfma_f32_32x32x16_bf16 v[144:159], v[44:47], v[132:135], v[144:159]
    v_exp_f32 v92, v92
    v_exp_f32 v93, v93
    v_exp_f32 v94, v94
    v_exp_f32 v95, v95
    s_setprio 0
    s_mov_b64 exec, s[22:23]
    ds_read_b128 v[48:51], v58 offset:1280
    ds_read_b128 v[52:55], v58 offset:1920
    s_mov_b64 exec, -1
    v_cvt_pk_bf16_f32 v136, v80, v81
    v_cvt_pk_bf16_f32 v137, v82, v83
    v_cvt_pk_bf16_f32 v138, v84, v85
    v_cvt_pk_bf16_f32 v139, v86, v87
    v_cvt_pk_bf16_f32 v140, v88, v89
    v_cvt_pk_bf16_f32 v141, v90, v91
    v_cvt_pk_bf16_f32 v142, v92, v93
    v_cvt_pk_bf16_f32 v143, v94, v95
    s_waitcnt lgkmcnt(2)
    v_mfma_f32_32x32x16_bf16 v[64:79], v[24:27], v[8:11], 0
    v_exp_f32 v96, v96
    v_exp_f32 v97, v97
    v_exp_f32 v98, v98
    v_exp_f32 v99, v99
    s_setprio 1
    v_mfma_f32_32x32x16_bf16 v[160:175], v[40:43], v[136:139], v[160:175]
    v_exp_f32 v100, v100
    v_exp_f32 v101, v101
    v_exp_f32 v102, v102
    v_exp_f32 v103, v103
    v_mfma_f32_32x32x16_bf16 v[80:95], v[24:27], v[16:19], 0
    v_exp_f32 v104, v104
    v_exp_f32 v105, v105
    v_exp_f32 v106, v106
    v_exp_f32 v107, v107
    v_mfma_f32_32x32x16_bf16 v[160:175], v[44:47], v[140:143], v[160:175]
    v_exp_f32 v108, v108
    v_exp_f32 v109, v109
    v_exp_f32 v110, v110
    v_exp_f32 v111, v111
    v_mfma_f32_32x32x8_bf16 v[64:79], v[28:29], v[12:13], v[64:79]
    ds_read_b128 v[32:35], v56 offset:3072
    ds_read_b64 v[36:37], v57 offset:768
    v_cvt_pk_bf16_f32 v128, v96, v97
    v_cvt_pk_bf16_f32 v129, v98, v99
    v_cvt_pk_bf16_f32 v130, v100, v101
    v_cvt_pk_bf16_f32 v131, v102, v103
    v_cvt_pk_bf16_f32 v132, v104, v105
    v_cvt_pk_bf16_f32 v133, v106, v107
    v_cvt_pk_bf16_f32 v134, v108, v109
    v_cvt_pk_bf16_f32 v135, v110, v111
    v_mfma_f32_32x32x8_bf16 v[80:95], v[28:29], v[20:21], v[80:95]
    v_exp_f32 v112, v112
    v_exp_f32 v113, v113
    v_exp_f32 v114, v114
    v_exp_f32 v115, v115
    s_waitcnt lgkmcnt(2)
    v_mfma_f32_32x32x16_bf16 v[144:159], v[48:51], v[128:131], v[144:159]
    v_exp_f32 v116, v116
    v_exp_f32 v117, v117
    v_exp_f32 v118, v118
    v_exp_f32 v119, v119
    s_cmp_lg_u32 s31, 0
    s_cbranch_scc1 fused1_kernel_w238
    buffer_load_dwordx4 v[248:251], v1, s[64:67], s33 offen offset:0
    buffer_load_dwordx4 v[252:255], v1, s[64:67], s33 offen offset:1024
fused1_kernel_w238:
    v_exp_f32 v120, v120
    v_exp_f32 v121, v121
    v_exp_f32 v122, v122
    v_exp_f32 v123, v123
    v_mfma_f32_32x32x16_bf16 v[144:159], v[52:55], v[132:135], v[144:159]
    v_exp_f32 v124, v124
    v_exp_f32 v125, v125
    v_exp_f32 v126, v126
    v_exp_f32 v127, v127
    s_setprio 0
    s_mov_b64 exec, s[22:23]
    ds_read_b128 v[40:43], v58 offset:2560
    ds_read_b128 v[44:47], v58 offset:3200
    s_mov_b64 exec, -1
    v_cvt_pk_bf16_f32 v136, v112, v113
    v_cvt_pk_bf16_f32 v137, v114, v115
    v_cvt_pk_bf16_f32 v138, v116, v117
    v_cvt_pk_bf16_f32 v139, v118, v119
    v_cvt_pk_bf16_f32 v140, v120, v121
    v_cvt_pk_bf16_f32 v141, v122, v123
    v_cvt_pk_bf16_f32 v142, v124, v125
    v_cvt_pk_bf16_f32 v143, v126, v127
    s_waitcnt lgkmcnt(2)
    v_mfma_f32_32x32x16_bf16 v[96:111], v[32:35], v[8:11], 0
    v_exp_f32 v64, v64
    v_exp_f32 v65, v65
    v_exp_f32 v66, v66
    v_exp_f32 v67, v67
    s_setprio 1
    v_mfma_f32_32x32x16_bf16 v[160:175], v[48:51], v[136:139], v[160:175]
    v_exp_f32 v68, v68
    v_exp_f32 v69, v69
    v_exp_f32 v70, v70
    v_exp_f32 v71, v71
    v_mfma_f32_32x32x16_bf16 v[112:127], v[32:35], v[16:19], 0
    v_exp_f32 v72, v72
    v_exp_f32 v73, v73
    v_exp_f32 v74, v74
    v_exp_f32 v75, v75
    v_mfma_f32_32x32x16_bf16 v[160:175], v[52:55], v[140:143], v[160:175]
    v_exp_f32 v76, v76
    v_exp_f32 v77, v77
    v_exp_f32 v78, v78
    v_exp_f32 v79, v79
    v_mfma_f32_32x32x8_bf16 v[96:111], v[36:37], v[12:13], v[96:111]
    ds_read_b128 v[24:27], v56 offset:4096
    ds_read_b64 v[28:29], v57 offset:1024
    v_cvt_pk_bf16_f32 v128, v64, v65
    v_cvt_pk_bf16_f32 v129, v66, v67
    v_cvt_pk_bf16_f32 v130, v68, v69
    v_cvt_pk_bf16_f32 v131, v70, v71
    v_cvt_pk_bf16_f32 v132, v72, v73
    v_cvt_pk_bf16_f32 v133, v74, v75
    v_cvt_pk_bf16_f32 v134, v76, v77
    v_cvt_pk_bf16_f32 v135, v78, v79
    v_mfma_f32_32x32x8_bf16 v[112:127], v[36:37], v[20:21], v[112:127]
    v_exp_f32 v80, v80
    v_exp_f32 v81, v81
    v_exp_f32 v82, v82
    v_exp_f32 v83, v83
    s_waitcnt lgkmcnt(2)
    v_mfma_f32_32x32x16_bf16 v[144:159], v[40:43], v[128:131], v[144:159]
    v_exp_f32 v84, v84
    v_exp_f32 v85, v85
    v_exp_f32 v86, v86
    v_exp_f32 v87, v87
    v_exp_f32 v88, v88
    v_exp_f32 v89, v89
    v_exp_f32 v90, v90
    v_exp_f32 v91, v91
    v_mfma_f32_32x32x16_bf16 v[144:159], v[44:47], v[132:135], v[144:159]
    v_exp_f32 v92, v92
    v_exp_f32 v93, v93
    v_exp_f32 v94, v94
    v_exp_f32 v95, v95
    s_setprio 0
    s_mov_b64 exec, s[22:23]
    ds_read_b128 v[48:51], v58 offset:3840
    ds_read_b128 v[52:55], v58 offset:4480
    s_mov_b64 exec, -1
    v_cvt_pk_bf16_f32 v136, v80, v81
    v_cvt_pk_bf16_f32 v137, v82, v83
    v_cvt_pk_bf16_f32 v138, v84, v85
    v_cvt_pk_bf16_f32 v139, v86, v87
    v_cvt_pk_bf16_f32 v140, v88, v89
    v_cvt_pk_bf16_f32 v141, v90, v91
    v_cvt_pk_bf16_f32 v142, v92, v93
    v_cvt_pk_bf16_f32 v143, v94, v95
    s_waitcnt lgkmcnt(2)
    v_mfma_f32_32x32x16_bf16 v[64:79], v[24:27], v[8:11], 0
    v_exp_f32 v96, v96
    v_exp_f32 v97, v97
    v_exp_f32 v98, v98
    v_exp_f32 v99, v99
    s_setprio 1
    v_mfma_f32_32x32x16_bf16 v[160:175], v[40:43], v[136:139], v[160:175]
    v_exp_f32 v100, v100
    v_exp_f32 v101, v101
    v_exp_f32 v102, v102
    v_exp_f32 v103, v103
    v_mfma_f32_32x32x16_bf16 v[80:95], v[24:27], v[16:19], 0
    v_exp_f32 v104, v104
    v_exp_f32 v105, v105
    v_exp_f32 v106, v106
    v_exp_f32 v107, v107
    v_mfma_f32_32x32x16_bf16 v[160:175], v[44:47], v[140:143], v[160:175]
    v_exp_f32 v108, v108
    v_exp_f32 v109, v109
    v_exp_f32 v110, v110
    v_exp_f32 v111, v111
    v_mfma_f32_32x32x8_bf16 v[64:79], v[28:29], v[12:13], v[64:79]
    ds_read_b128 v[32:35], v56 offset:5120
    ds_read_b64 v[36:37], v57 offset:1280
    v_cvt_pk_bf16_f32 v128, v96, v97
    v_cvt_pk_bf16_f32 v129, v98, v99
    v_cvt_pk_bf16_f32 v130, v100, v101
    v_cvt_pk_bf16_f32 v131, v102, v103
    v_cvt_pk_bf16_f32 v132, v104, v105
    v_cvt_pk_bf16_f32 v133, v106, v107
    v_cvt_pk_bf16_f32 v134, v108, v109
    v_cvt_pk_bf16_f32 v135, v110, v111
    v_mfma_f32_32x32x8_bf16 v[80:95], v[28:29], v[20:21], v[80:95]
    v_exp_f32 v112, v112
    v_exp_f32 v113, v113
    v_exp_f32 v114, v114
    v_exp_f32 v115, v115
    s_waitcnt lgkmcnt(2)
    v_mfma_f32_32x32x16_bf16 v[144:159], v[48:51], v[128:131], v[144:159]
    v_exp_f32 v116, v116
    v_exp_f32 v117, v117
    v_exp_f32 v118, v118
    v_exp_f32 v119, v119
    v_exp_f32 v120, v120
    v_exp_f32 v121, v121
    v_exp_f32 v122, v122
    v_exp_f32 v123, v123
    v_mfma_f32_32x32x16_bf16 v[144:159], v[52:55], v[132:135], v[144:159]
    v_exp_f32 v124, v124
    v_exp_f32 v125, v125
    v_exp_f32 v126, v126
    v_exp_f32 v127, v127
    s_setprio 0
    s_mov_b64 exec, s[22:23]
    ds_read_b128 v[40:43], v58 offset:5120
    ds_read_b128 v[44:47], v58 offset:5760
    s_mov_b64 exec, -1
    v_cvt_pk_bf16_f32 v136, v112, v113
    v_cvt_pk_bf16_f32 v137, v114, v115
    v_cvt_pk_bf16_f32 v138, v116, v117
    v_cvt_pk_bf16_f32 v139, v118, v119
    v_cvt_pk_bf16_f32 v140, v120, v121
    v_cvt_pk_bf16_f32 v141, v122, v123
    v_cvt_pk_bf16_f32 v142, v124, v125
    v_cvt_pk_bf16_f32 v143, v126, v127
    s_waitcnt lgkmcnt(2)
    v_mfma_f32_32x32x16_bf16 v[96:111], v[32:35], v[8:11], 0
    v_exp_f32 v64, v64
    v_exp_f32 v65, v65
    v_exp_f32 v66, v66
    v_exp_f32 v67, v67
    s_setprio 1
    v_mfma_f32_32x32x16_bf16 v[160:175], v[48:51], v[136:139], v[160:175]
    v_exp_f32 v68, v68
    v_exp_f32 v69, v69
    v_exp_f32 v70, v70
    v_exp_f32 v71, v71
    v_mfma_f32_32x32x16_bf16 v[112:127], v[32:35], v[16:19], 0
    v_exp_f32 v72, v72
    v_exp_f32 v73, v73
    v_exp_f32 v74, v74
    v_exp_f32 v75, v75
    v_mfma_f32_32x32x16_bf16 v[160:175], v[52:55], v[140:143], v[160:175]
    v_exp_f32 v76, v76
    v_exp_f32 v77, v77
    v_exp_f32 v78, v78
    v_exp_f32 v79, v79
    v_mfma_f32_32x32x8_bf16 v[96:111], v[36:37], v[12:13], v[96:111]
    ds_read_b128 v[24:27], v56 offset:6144
    ds_read_b64 v[28:29], v57 offset:1536
    v_cvt_pk_bf16_f32 v128, v64, v65
    v_cvt_pk_bf16_f32 v129, v66, v67
    v_cvt_pk_bf16_f32 v130, v68, v69
    v_cvt_pk_bf16_f32 v131, v70, v71
    v_cvt_pk_bf16_f32 v132, v72, v73
    v_cvt_pk_bf16_f32 v133, v74, v75
    v_cvt_pk_bf16_f32 v134, v76, v77
    v_cvt_pk_bf16_f32 v135, v78, v79
    v_mfma_f32_32x32x8_bf16 v[112:127], v[36:37], v[20:21], v[112:127]
    v_exp_f32 v80, v80
    v_exp_f32 v81, v81
    v_exp_f32 v82, v82
    v_exp_f32 v83, v83
    s_waitcnt lgkmcnt(2)
    v_mfma_f32_32x32x16_bf16 v[144:159], v[40:43], v[128:131], v[144:159]
    v_exp_f32 v84, v84
    v_exp_f32 v85, v85
    v_exp_f32 v86, v86
    v_exp_f32 v87, v87
    v_exp_f32 v88, v88
    v_exp_f32 v89, v89
    v_exp_f32 v90, v90
    v_exp_f32 v91, v91
    v_mfma_f32_32x32x16_bf16 v[144:159], v[44:47], v[132:135], v[144:159]
    v_exp_f32 v92, v92
    v_exp_f32 v93, v93
    v_exp_f32 v94, v94
    v_exp_f32 v95, v95
    s_setprio 0
    s_mov_b64 exec, s[22:23]
    ds_read_b128 v[48:51], v58 offset:6400
    ds_read_b128 v[52:55], v58 offset:7040
    s_mov_b64 exec, -1
    v_cvt_pk_bf16_f32 v136, v80, v81
    v_cvt_pk_bf16_f32 v137, v82, v83
    v_cvt_pk_bf16_f32 v138, v84, v85
    v_cvt_pk_bf16_f32 v139, v86, v87
    v_cvt_pk_bf16_f32 v140, v88, v89
    v_cvt_pk_bf16_f32 v141, v90, v91
    v_cvt_pk_bf16_f32 v142, v92, v93
    v_cvt_pk_bf16_f32 v143, v94, v95
    s_waitcnt lgkmcnt(2)
    v_mfma_f32_32x32x16_bf16 v[64:79], v[24:27], v[8:11], 0
    v_exp_f32 v96, v96
    v_exp_f32 v97, v97
    v_exp_f32 v98, v98
    v_exp_f32 v99, v99
    s_setprio 1
    v_mfma_f32_32x32x16_bf16 v[160:175], v[40:43], v[136:139], v[160:175]
    v_exp_f32 v100, v100
    v_exp_f32 v101, v101
    v_exp_f32 v102, v102
    v_exp_f32 v103, v103
    v_mfma_f32_32x32x16_bf16 v[80:95], v[24:27], v[16:19], 0
    v_exp_f32 v104, v104
    v_exp_f32 v105, v105
    v_exp_f32 v106, v106
    v_exp_f32 v107, v107
    v_mfma_f32_32x32x16_bf16 v[160:175], v[44:47], v[140:143], v[160:175]
    v_exp_f32 v108, v108
    v_exp_f32 v109, v109
    v_exp_f32 v110, v110
    v_exp_f32 v111, v111
    v_mfma_f32_32x32x8_bf16 v[64:79], v[28:29], v[12:13], v[64:79]
    ds_read_b128 v[32:35], v56 offset:7168
    ds_read_b64 v[36:37], v57 offset:1792
    v_cvt_pk_bf16_f32 v128, v96, v97
    v_cvt_pk_bf16_f32 v129, v98, v99
    v_cvt_pk_bf16_f32 v130, v100, v101
    v_cvt_pk_bf16_f32 v131, v102, v103
    v_cvt_pk_bf16_f32 v132, v104, v105
    v_cvt_pk_bf16_f32 v133, v106, v107
    v_cvt_pk_bf16_f32 v134, v108, v109
    v_cvt_pk_bf16_f32 v135, v110, v111
    v_mfma_f32_32x32x8_bf16 v[80:95], v[28:29], v[20:21], v[80:95]
    v_exp_f32 v112, v112
    v_exp_f32 v113, v113
    v_exp_f32 v114, v114
    v_exp_f32 v115, v115
    s_waitcnt lgkmcnt(2)
    v_mfma_f32_32x32x16_bf16 v[144:159], v[48:51], v[128:131], v[144:159]
    v_exp_f32 v116, v116
    v_exp_f32 v117, v117
    v_exp_f32 v118, v118
    v_exp_f32 v119, v119
    v_exp_f32 v120, v120
    v_exp_f32 v121, v121
    v_exp_f32 v122, v122
    v_exp_f32 v123, v123
    v_mfma_f32_32x32x16_bf16 v[144:159], v[52:55], v[132:135], v[144:159]
    v_exp_f32 v124, v124
    v_exp_f32 v125, v125
    v_exp_f32 v126, v126
    v_exp_f32 v127, v127
    s_setprio 0
    s_mov_b64 exec, s[22:23]
    ds_read_b128 v[40:43], v58 offset:7680
    ds_read_b128 v[44:47], v58 offset:8320
    s_mov_b64 exec, -1
    v_cvt_pk_bf16_f32 v136, v112, v113
    v_cvt_pk_bf16_f32 v137, v114, v115
    v_cvt_pk_bf16_f32 v138, v116, v117
    v_cvt_pk_bf16_f32 v139, v118, v119
    v_cvt_pk_bf16_f32 v140, v120, v121
    v_cvt_pk_bf16_f32 v141, v122, v123
    v_cvt_pk_bf16_f32 v142, v124, v125
    v_cvt_pk_bf16_f32 v143, v126, v127
    s_waitcnt lgkmcnt(2)
    v_mfma_f32_32x32x16_bf16 v[96:111], v[32:35], v[8:11], 0
    v_exp_f32 v64, v64
    v_exp_f32 v65, v65
    v_exp_f32 v66, v66
    v_exp_f32 v67, v67
    s_setprio 1
    v_mfma_f32_32x32x16_bf16 v[160:175], v[48:51], v[136:139], v[160:175]
    v_exp_f32 v68, v68
    v_exp_f32 v69, v69
    v_exp_f32 v70, v70
    v_exp_f32 v71, v71
    v_mfma_f32_32x32x16_bf16 v[112:127], v[32:35], v[16:19], 0
    v_exp_f32 v72, v72
    v_exp_f32 v73, v73
    v_exp_f32 v74, v74
    v_exp_f32 v75, v75
    v_mfma_f32_32x32x16_bf16 v[160:175], v[52:55], v[140:143], v[160:175]
    v_exp_f32 v76, v76
    v_exp_f32 v77, v77
    v_exp_f32 v78, v78
    v_exp_f32 v79, v79
    v_mfma_f32_32x32x8_bf16 v[96:111], v[36:37], v[12:13], v[96:111]
    v_cvt_pk_bf16_f32 v128, v64, v65
    v_cvt_pk_bf16_f32 v129, v66, v67
    v_cvt_pk_bf16_f32 v130, v68, v69
    v_cvt_pk_bf16_f32 v131, v70, v71
    v_cvt_pk_bf16_f32 v132, v72, v73
    v_cvt_pk_bf16_f32 v133, v74, v75
    v_cvt_pk_bf16_f32 v134, v76, v77
    v_cvt_pk_bf16_f32 v135, v78, v79
    v_mfma_f32_32x32x8_bf16 v[112:127], v[36:37], v[20:21], v[112:127]
    v_exp_f32 v80, v80
    v_exp_f32 v81, v81
    v_exp_f32 v82, v82
    v_exp_f32 v83, v83
    s_waitcnt lgkmcnt(0)
    v_mfma_f32_32x32x16_bf16 v[144:159], v[40:43], v[128:131], v[144:159]
    v_exp_f32 v84, v84
    v_exp_f32 v85, v85
    v_exp_f32 v86, v86
    v_exp_f32 v87, v87
    v_exp_f32 v88, v88
    v_exp_f32 v89, v89
    v_exp_f32 v90, v90
    v_exp_f32 v91, v91
    v_mfma_f32_32x32x16_bf16 v[144:159], v[44:47], v[132:135], v[144:159]
    v_exp_f32 v92, v92
    v_exp_f32 v93, v93
    v_exp_f32 v94, v94
    v_exp_f32 v95, v95
    s_setprio 0
    s_mov_b64 exec, s[22:23]
    ds_read_b128 v[48:51], v58 offset:8960
    ds_read_b128 v[52:55], v58 offset:9600
    s_mov_b64 exec, -1
    v_cvt_pk_bf16_f32 v136, v80, v81
    v_cvt_pk_bf16_f32 v137, v82, v83
    v_cvt_pk_bf16_f32 v138, v84, v85
    v_cvt_pk_bf16_f32 v139, v86, v87
    v_cvt_pk_bf16_f32 v140, v88, v89
    v_cvt_pk_bf16_f32 v141, v90, v91
    v_cvt_pk_bf16_f32 v142, v92, v93
    v_cvt_pk_bf16_f32 v143, v94, v95
    v_exp_f32 v96, v96
    v_exp_f32 v97, v97
    v_exp_f32 v98, v98
    v_exp_f32 v99, v99
    s_setprio 1
    v_mfma_f32_32x32x16_bf16 v[160:175], v[40:43], v[136:139], v[160:175]
    v_exp_f32 v100, v100
    v_exp_f32 v101, v101
    v_exp_f32 v102, v102
    v_exp_f32 v103, v103
    v_exp_f32 v104, v104
    v_exp_f32 v105, v105
    v_exp_f32 v106, v106
    v_exp_f32 v107, v107
    v_mfma_f32_32x32x16_bf16 v[160:175], v[44:47], v[140:143], v[160:175]
    v_exp_f32 v108, v108
    v_exp_f32 v109, v109
    v_exp_f32 v110, v110
    v_exp_f32 v111, v111
    v_cvt_pk_bf16_f32 v128, v96, v97
    v_cvt_pk_bf16_f32 v129, v98, v99
    v_cvt_pk_bf16_f32 v130, v100, v101
    v_cvt_pk_bf16_f32 v131, v102, v103
    v_cvt_pk_bf16_f32 v132, v104, v105
    v_cvt_pk_bf16_f32 v133, v106, v107
    v_cvt_pk_bf16_f32 v134, v108, v109
    v_cvt_pk_bf16_f32 v135, v110, v111
    v_exp_f32 v112, v112
    v_exp_f32 v113, v113
    v_exp_f32 v114, v114
    v_exp_f32 v115, v115
    s_waitcnt lgkmcnt(0)
    v_mfma_f32_32x32x16_bf16 v[144:159], v[48:51], v[128:131], v[144:159]
    v_exp_f32 v116, v116
    v_exp_f32 v117, v117
    v_exp_f32 v118, v118
    v_exp_f32 v119, v119
    v_exp_f32 v120, v120
    v_exp_f32 v121, v121
    v_exp_f32 v122, v122
    v_exp_f32 v123, v123
    v_mfma_f32_32x32x16_bf16 v[144:159], v[52:55], v[132:135], v[144:159]
    v_exp_f32 v124, v124
    v_exp_f32 v125, v125
    v_exp_f32 v126, v126
    v_exp_f32 v127, v127
    s_setprio 0
    v_cvt_pk_bf16_f32 v136, v112, v113
    v_cvt_pk_bf16_f32 v137, v114, v115
    v_cvt_pk_bf16_f32 v138, v116, v117
    v_cvt_pk_bf16_f32 v139, v118, v119
    v_cvt_pk_bf16_f32 v140, v120, v121
    v_cvt_pk_bf16_f32 v141, v122, v123
    v_cvt_pk_bf16_f32 v142, v124, v125
    v_cvt_pk_bf16_f32 v143, v126, v127
    s_setprio 0
    v_mfma_f32_32x32x16_bf16 v[160:175], v[48:51], v[136:139], v[160:175]
    v_mfma_f32_32x32x16_bf16 v[160:175], v[52:55], v[140:143], v[160:175]
    s_mul_i32 s21, s30, 6144
    v_add_u32 v2, s21, v1
    s_nop 15
    s_nop 1
    s_cmp_eq_u32 s31, 1
    s_cbranch_scc1 fused1_kernel_lo39
    ds_write_b128 v2, v[144:147] offset:0
    ds_write_b128 v2, v[160:163] offset:3072
    ds_write_b128 v2, v[148:151] offset:1024
    ds_write_b128 v2, v[164:167] offset:4096
    ds_write_b128 v2, v[152:155] offset:2048
    ds_write_b128 v2, v[168:171] offset:5120
    s_waitcnt lgkmcnt(0)
    s_add_u32 s5, s4, 2
    s_and_b32 s5, s5, 3
    s_mul_i32 s5, s5, 10240
    s_mul_i32 s27, s34, 40960
    s_add_u32 s27, s27, s5
    buffer_load_dwordx4 v[96:99], v1, s[64:67], s27 offen offset:0
    buffer_load_dwordx4 v[100:103], v1, s[64:67], s27 offen offset:1024
    buffer_load_dwordx4 v[104:107], v1, s[64:67], s27 offen offset:2048
    buffer_load_dwordx4 v[108:111], v1, s[64:67], s27 offen offset:3072
    s_add_u32 s27, s27, 4096
    buffer_load_dwordx4 v[112:115], v1, s[64:67], s27 offen offset:0
    buffer_load_dwordx4 v[116:119], v1, s[64:67], s27 offen offset:1024
    buffer_load_dwordx4 v[120:123], v1, s[64:67], s27 offen offset:2048
    buffer_load_dwordx4 v[124:127], v1, s[64:67], s27 offen offset:3072
    s_add_u32 s27, s27, 4096
    buffer_load_dwordx4 v[128:131], v1, s[64:67], s27 offen offset:0
    buffer_load_dwordx4 v[132:135], v1, s[64:67], s27 offen offset:1024
    s_add_u32 s5, s4, 3
    s_and_b32 s5, s5, 3
    s_mul_i32 s5, s5, 10240
    s_mul_i32 s27, s34, 40960
    s_add_u32 s27, s27, s5
    buffer_load_dwordx4 v[136:139], v1, s[64:67], s27 offen offset:0
    buffer_load_dwordx4 v[140:143], v1, s[64:67], s27 offen offset:1024
    buffer_load_dwordx4 v[144:147], v1, s[64:67], s27 offen offset:2048
    buffer_load_dwordx4 v[148:151], v1, s[64:67], s27 offen offset:3072
    s_add_u32 s27, s27, 4096
    buffer_load_dwordx4 v[152:155], v1, s[64:67], s27 offen offset:0
    buffer_load_dwordx4 v[156:159], v1, s[64:67], s27 offen offset:1024
    buffer_load_dwordx4 v[160:163], v1, s[64:67], s27 offen offset:2048
    buffer_load_dwordx4 v[164:167], v1, s[64:67], s27 offen offset:3072
    s_add_u32 s27, s27, 4096
    buffer_load_dwordx4 v[168:171], v1, s[64:67], s27 offen offset:0
    buffer_load_dwordx4 v[172:175], v1, s[64:67], s27 offen offset:1024
    v_lshlrev_b32 v6, 8, v4
    v_lshl_add_u32 v6, v3, 1, v6
    s_mul_i32 s35, s3, 40960
    s_lshl_b32 s26, s34, 11
    s_add_u32 s35, s35, s26
    buffer_load_ushort v64, v6, s[48:51], s35 offen offset:0
    buffer_load_ushort v65, v6, s[48:51], s35 offen offset:64
    buffer_load_ushort v66, v6, s[48:51], s35 offen offset:128
    buffer_load_ushort v67, v6, s[48:51], s35 offen offset:192
    buffer_load_ushort v68, v6, s[48:51], s35 offen offset:512
    buffer_load_ushort v69, v6, s[48:51], s35 offen offset:576
    buffer_load_ushort v70, v6, s[48:51], s35 offen offset:640
    buffer_load_ushort v71, v6, s[48:51], s35 offen offset:704
    buffer_load_ushort v72, v6, s[48:51], s35 offen offset:1024
    buffer_load_ushort v73, v6, s[48:51], s35 offen offset:1088
    buffer_load_ushort v74, v6, s[48:51], s35 offen offset:1152
    buffer_load_ushort v75, v6, s[48:51], s35 offen offset:1216
    buffer_load_ushort v76, v6, s[48:51], s35 offen offset:1536
    buffer_load_ushort v77, v6, s[48:51], s35 offen offset:1600
    buffer_load_ushort v78, v6, s[48:51], s35 offen offset:1664
    buffer_load_ushort v79, v6, s[48:51], s35 offen offset:1728
    s_add_u32 s5, s4, 0
    s_and_b32 s5, s5, 3
    s_mul_i32 s5, s5, 10240
    v_add_u32 v80, s5, v1
    s_add_u32 s5, s4, 1
    s_and_b32 s5, s5, 3
    s_mul_i32 s5, s5, 10240
    v_add_u32 v81, s5, v1
    s_add_u32 s5, s4, 2
    s_and_b32 s5, s5, 3
    s_mul_i32 s5, s5, 10240
    v_add_u32 v82, s5, v1
    s_add_u32 s5, s4, 3
    s_and_b32 s5, s5, 3
    s_mul_i32 s5, s5, 10240
    v_add_u32 v83, s5, v1
    v_mov_b32 v32, 0
    v_mov_b32 v33, 0
    v_mov_b32 v34, 0
    v_mov_b32 v35, 0
    v_mov_b32 v36, 0
    v_mov_b32 v37, 0
    v_mov_b32 v38, 0
    v_mov_b32 v39, 0
    v_mov_b32 v40, 0
    v_mov_b32 v41, 0
    v_mov_b32 v42, 0
    v_mov_b32 v43, 0
    v_mov_b32 v44, 0
    v_mov_b32 v45, 0
    v_mov_b32 v46, 0
    v_mov_b32 v47, 0
    v_mov_b32 v48, 0
    v_mov_b32 v49, 0
    v_mov_b32 v50, 0
    v_mov_b32 v51, 0
    v_mov_b32 v52, 0
    v_mov_b32 v53, 0
    v_mov_b32 v54, 0
    v_mov_b32 v55, 0
    v_mov_b32 v56, 0
    v_mov_b32 v57, 0
    v_mov_b32 v58, 0
    v_mov_b32 v59, 0
    v_mov_b32 v60, 0
    v_mov_b32 v61, 0
    v_mov_b32 v62, 0
    v_mov_b32 v63, 0
    s_barrier
    s_waitcnt vmcnt(36)
    s_barrier
    ds_read_b128 v[8:11], v80 offset:40960
    ds_read_b128 v[12:15], v80 offset:41984
    ds_read_b128 v[16:19], v80 offset:43008
    ds_read_b128 v[20:23], v80 offset:44032
    ds_read_b128 v[24:27], v80 offset:45056
    ds_read_b128 v[28:31], v80 offset:46080
    s_waitcnt lgkmcnt(5)
    v_mfma_f32_32x32x16_bf16 v[32:47], v[176:179], v[8:11], v[32:47]
    ds_read_b128 v[8:11], v80 offset:47104
    s_waitcnt lgkmcnt(5)
    v_mfma_f32_32x32x16_bf16 v[48:63], v[180:183], v[12:15], v[48:63]
    ds_read_b128 v[12:15], v80 offset:48128
    s_waitcnt lgkmcnt(5)
    v_mfma_f32_32x32x16_bf16 v[32:47], v[184:187], v[16:19], v[32:47]
    ds_read_b128 v[16:19], v80 offset:49152
    s_waitcnt lgkmcnt(5)
    v_mfma_f32_32x32x16_bf16 v[48:63], v[188:191], v[20:23], v[48:63]
    ds_read_b128 v[20:23], v80 offset:50176
    s_waitcnt lgkmcnt(5)
    v_mfma_f32_32x32x16_bf16 v[32:47], v[192:195], v[24:27], v[32:47]
    s_waitcnt lgkmcnt(4)
    v_mfma_f32_32x32x16_bf16 v[48:63], v[196:199], v[28:31], v[48:63]
    s_waitcnt lgkmcnt(3)
    v_mfma_f32_32x32x16_bf16 v[32:47], v[200:203], v[8:11], v[32:47]
    s_waitcnt lgkmcnt(2)
    v_mfma_f32_32x32x16_bf16 v[48:63], v[204:207], v[12:15], v[48:63]
    s_waitcnt lgkmcnt(1)
    v_mfma_f32_32x32x16_bf16 v[32:47], v[208:211], v[16:19], v[32:47]
    s_waitcnt lgkmcnt(0)
    v_mfma_f32_32x32x16_bf16 v[48:63], v[212:215], v[20:23], v[48:63]
    s_sleep 4
    s_branch fused1_kernel_owait40
fused1_kernel_lo39:
    s_barrier
    ds_read_b128 v[64:67], v2 offset:0
    ds_read_b128 v[68:71], v2 offset:1024
    ds_read_b128 v[72:75], v2 offset:2048
    ds_read_b128 v[76:79], v2 offset:3072
    ds_read_b128 v[80:83], v2 offset:4096
    ds_read_b128 v[84:87], v2 offset:5120
    s_waitcnt lgkmcnt(0)
    v_add_f32 v144, v144, v64
    v_add_f32 v160, v160, v76
    v_add_f32 v145, v145, v65
    v_add_f32 v161, v161, v77
    v_add_f32 v146, v146, v66
    v_add_f32 v162, v162, v78
    v_add_f32 v147, v147, v67
    v_add_f32 v163, v163, v79
    v_add_f32 v148, v148, v68
    v_add_f32 v164, v164, v80
    v_add_f32 v149, v149, v69
    v_add_f32 v165, v165, v81
    v_add_f32 v150, v150, v70
    v_add_f32 v166, v166, v82
    v_add_f32 v151, v151, v71
    v_add_f32 v167, v167, v83
    v_add_f32 v152, v152, v72
    v_add_f32 v168, v168, v84
    v_add_f32 v153, v153, v73
    v_add_f32 v169, v169, v85
    v_add_f32 v154, v154, v74
    v_add_f32 v170, v170, v86
    v_add_f32 v155, v155, v75
    v_add_f32 v171, v171, v87
    v_mov_b32 v60, v152
    v_mov_b32 v61, v152
    s_nop 1
    v_permlane32_swap_b32 v60, v61
    v_mov_b32 v62, v168
    v_mov_b32 v63, v168
    s_nop 1
    v_permlane32_swap_b32 v62, v63
    s_nop 1
    s_mov_b32 s24, 0x0d800000
    s_mov_b32 s25, 0x71800000
    v_cmp_nle_f32 vcc, s24, v61
    v_cmp_nge_f32 s[26:27], s25, v61
    s_or_b64 s[28:29], vcc, s[26:27]
    v_cmp_nle_f32 vcc, s24, v63
    v_cmp_nge_f32 s[26:27], s25, v63
    s_or_b64 s[28:29], s[28:29], vcc
    s_or_b64 s[28:29], s[28:29], s[26:27]
    s_cmp_lg_u64 s[28:29], 0
    s_cbranch_scc1 fused1_kernel_fb41
fused1_kernel_fin42:
    s_mul_i32 s26, s3, 40960
    s_mul_i32 s32, s4, 160
    s_mul_i32 s5, s30, 40
    s_add_u32 s32, s32, s5
    v_rcp_f32 v59, v61
    s_nop 0
    v_mul_f32 v144, v144, v59
    v_mul_f32 v145, v145, v59
    v_mul_f32 v146, v146, v59
    v_mul_f32 v147, v147, v59
    v_mul_f32 v148, v148, v59
    v_mul_f32 v149, v149, v59
    v_mul_f32 v150, v150, v59
    v_mul_f32 v151, v151, v59
    v_mul_f32 v152, v152, v59
    v_mul_f32 v153, v153, v59
    v_mul_f32 v154, v154, v59
    v_mul_f32 v155, v155, v59
    v_cvt_pk_bf16_f32 v64, v144, v145
    v_cvt_pk_bf16_f32 v65, v146, v147
    v_cvt_pk_bf16_f32 v66, v148, v149
    v_cvt_pk_bf16_f32 v67, v150, v151
    v_cvt_pk_bf16_f32 v68, v152, v153
    v_cvt_pk_bf16_f32 v69, v154, v155
    s_add_u32 s5, s32, 0
    v_lshlrev_b32 v6, 2, v4
    v_add_u32 v6, s5, v6
    v_lshrrev_b32 v7, 3, v6
    v_lshlrev_b32 v7, 9, v7
    v_and_b32 v5, 7, v6
    v_lshl_add_u32 v7, v5, 1, v7
    v_lshl_add_u32 v7, v3, 4, v7
    ds_write_b64 v7, v[64:65] offset:40960
    v_add_u32 v6, 8, v6
    v_lshrrev_b32 v7, 3, v6
    v_lshlrev_b32 v7, 9, v7
    v_and_b32 v5, 7, v6
    v_lshl_add_u32 v7, v5, 1, v7
    v_lshl_add_u32 v7, v3, 4, v7
    ds_write_b64 v7, v[66:67] offset:40960
    v_add_u32 v6, 8, v6
    v_lshrrev_b32 v7, 3, v6
    v_lshlrev_b32 v7, 9, v7
    v_and_b32 v5, 7, v6
    v_lshl_add_u32 v7, v5, 1, v7
    v_lshl_add_u32 v7, v3, 4, v7
    s_mov_b32 exec_lo, -1
    s_mov_b32 exec_hi, 0
    ds_write_b64 v7, v[68:69] offset:40960
    s_mov_b64 exec, -1
    v_rcp_f32 v59, v63
    s_nop 0
    v_mul_f32 v160, v160, v59
    v_mul_f32 v161, v161, v59
    v_mul_f32 v162, v162, v59
    v_mul_f32 v163, v163, v59
    v_mul_f32 v164, v164, v59
    v_mul_f32 v165, v165, v59
    v_mul_f32 v166, v166, v59
    v_mul_f32 v167, v167, v59
    v_mul_f32 v168, v168, v59
    v_mul_f32 v169, v169, v59
    v_mul_f32 v170, v170, v59
    v_mul_f32 v171, v171, v59
    v_cvt_pk_bf16_f32 v64, v160, v161
    v_cvt_pk_bf16_f32 v65, v162, v163
    v_cvt_pk_bf16_f32 v66, v164, v165
    v_cvt_pk_bf16_f32 v67, v166, v167
    v_cvt_pk_bf16_f32 v68, v168, v169
    v_cvt_pk_bf16_f32 v69, v170, v171
    s_add_u32 s5, s32, 20
    v_lshlrev_b32 v6, 2, v4
    v_add_u32 v6, s5, v6
    v_lshrrev_b32 v7, 3, v6
    v_lshlrev_b32 v7, 9, v7
    v_and_b32 v5, 7, v6
    v_lshl_add_u32 v7, v5, 1, v7
    v_lshl_add_u32 v7, v3, 4, v7
    ds_write_b64 v7, v[64:65] offset:40960
    v_add_u32 v6, 8, v6
    v_lshrrev_b32 v7, 3, v6
    v_lshlrev_b32 v7, 9, v7
    v_and_b32 v5, 7, v6
    v_lshl_add_u32 v7, v5, 1, v7
    v_lshl_add_u32 v7, v3, 4, v7
    ds_write_b64 v7, v[66:67] offset:40960
    v_add_u32 v6, 8, v6
    v_lshrrev_b32 v7, 3, v6
    v_lshlrev_b32 v7, 9, v7
    v_and_b32 v5, 7, v6
    v_lshl_add_u32 v7, v5, 1, v7
    v_lshl_add_u32 v7, v3, 4, v7
    s_mov_b32 exec_lo, -1
    s_mov_b32 exec_hi, 0
    ds_write_b64 v7, v[68:69] offset:40960
    s_mov_b64 exec, -1
    s_lshl_b32 s5, s32, 6
    v_add_u32 v7, s5, v1
    s_add_u32 s26, s26, s5
    s_waitcnt lgkmcnt(0)
    ds_read_b128 v[64:67], v7 offset:40960
    ds_read_b128 v[68:71], v7 offset:41984
    s_mov_b32 exec_lo, -1
    s_mov_b32 exec_hi, 0
    ds_read_b128 v[72:75], v7 offset:43008
    s_mov_b64 exec, -1
    s_waitcnt lgkmcnt(2)
    buffer_store_dwordx4 v[64:67], v1, s[60:63], s26 offen sc1
    s_waitcnt lgkmcnt(1)
    buffer_store_dwordx4 v[68:71], v1, s[60:63], s26 offen offset:1024 sc1
    s_waitcnt lgkmcnt(0)
    s_mov_b32 exec_lo, -1
    s_mov_b32 exec_hi, 0
    buffer_store_dwordx4 v[72:75], v1, s[60:63], s26 offen offset:2048 sc1
    s_mov_b64 exec, -1
    s_barrier
    v_mov_b32 v32, 0
    v_mov_b32 v33, 0
    v_mov_b32 v34, 0
    v_mov_b32 v35, 0
    v_mov_b32 v36, 0
    v_mov_b32 v37, 0
    v_mov_b32 v38, 0
    v_mov_b32 v39, 0
    v_mov_b32 v40, 0
    v_mov_b32 v41, 0
    v_mov_b32 v42, 0
    v_mov_b32 v43, 0
    v_mov_b32 v44, 0
    v_mov_b32 v45, 0
    v_mov_b32 v46, 0
    v_mov_b32 v47, 0
    v_mov_b32 v48, 0
    v_mov_b32 v49, 0
    v_mov_b32 v50, 0
    v_mov_b32 v51, 0
    v_mov_b32 v52, 0
    v_mov_b32 v53, 0
    v_mov_b32 v54, 0
    v_mov_b32 v55, 0
    v_mov_b32 v56, 0
    v_mov_b32 v57, 0
    v_mov_b32 v58, 0
    v_mov_b32 v59, 0
    v_mov_b32 v60, 0
    v_mov_b32 v61, 0
    v_mov_b32 v62, 0
    v_mov_b32 v63, 0
    s_sleep 10
fused1_kernel_owait40:
    s_cmp_eq_u32 s42, 1
    s_cbranch_scc1 fused1_kernel_dl43
    s_sleep 12
fused1_kernel_dl43:
    s_mul_i32 s25, s3, 40960
    s_mul_i32 s5, s4, 10
    s_lshl_b32 s24, s40, 2
    s_add_u32 s24, s24, 0
    s_min_u32 s24, s24, 29
    s_add_u32 s28, s24, 10
    s_cmp_ge_u32 s24, s5
    s_cselect_b32 s24, s28, s24
    s_lshl_b32 s12, s24, 10
    s_add_u32 s16, s12, s25
    s_lshl_b32 s24, s40, 2
    s_add_u32 s24, s24, 1
    s_min_u32 s24, s24, 29
    s_add_u32 s28, s24, 10
    s_cmp_ge_u32 s24, s5
    s_cselect_b32 s24, s28, s24
    s_lshl_b32 s13, s24, 10
    s_add_u32 s17, s13, s25
    s_lshl_b32 s24, s40, 2
    s_add_u32 s24, s24, 2
    s_min_u32 s24, s24, 29
    s_add_u32 s28, s24, 10
    s_cmp_ge_u32 s24, s5
    s_cselect_b32 s24, s28, s24
    s_lshl_b32 s14, s24, 10
    s_add_u32 s18, s14, s25
    s_lshl_b32 s24, s40, 2
    s_add_u32 s24, s24, 3
    s_min_u32 s24, s24, 29
    s_add_u32 s28, s24, 10
    s_cmp_ge_u32 s24, s5
    s_cselect_b32 s24, s28, s24
    s_lshl_b32 s15, s24, 10
    s_add_u32 s19, s15, s25
    s_mov_b32 s29, 0
    v_mov_b32 v30, 0
    v_writelane_b32 v30, s16, 0
    v_writelane_b32 v30, s17, 1
    v_writelane_b32 v30, s18, 2
    v_writelane_b32 v30, s19, 3
fused1_kernel_pl44:
    buffer_load_dwordx4 v[8:11], v1, s[60:63], s16 offen sc1
    buffer_load_dwordx4 v[12:15], v1, s[60:63], s17 offen sc1
    buffer_load_dwordx4 v[16:19], v1, s[60:63], s18 offen sc1
    buffer_load_dwordx4 v[20:23], v1, s[60:63], s19 offen sc1
    s_waitcnt vmcnt(0)
    v_max3_u32 v28, v8, v9, v10
    v_max3_u32 v29, v11, v12, v13
    v_max3_u32 v28, v28, v14, v15
    v_max3_u32 v29, v29, v16, v17
    v_max3_u32 v28, v28, v18, v19
    v_max3_u32 v29, v29, v20, v21
    v_max3_u32 v28, v28, v22, v23
    v_max_u32 v28, v28, v29
    v_cmp_eq_u32 vcc, -1, v28
    s_cbranch_vccz fused1_kernel_pd45
    s_mov_b64 exec, 0xf
fused1_kernel_pq46:
    buffer_load_dword v31, v30, s[60:63], 0 offen offset:1020 sc1
    s_add_u32 s29, s29, 1
    s_waitcnt vmcnt(0)
    v_cmp_eq_u32 vcc, -1, v31
    s_cbranch_vccz fused1_kernel_pqd47
    s_sleep 1
    s_cmp_lt_u32 s29, 0x8000
    s_cbranch_scc1 fused1_kernel_pq46
fused1_kernel_pqd47:
    s_mov_b64 exec, -1
    s_cmp_lt_u32 s29, 0x8000
    s_cbranch_scc1 fused1_kernel_pl44
fused1_kernel_pd45:
    v_add_u32 v24, s12, v1
    ds_write_b128 v24, v[8:11] offset:40960
    v_add_u32 v25, s13, v1
    ds_write_b128 v25, v[12:15] offset:40960
    v_add_u32 v26, s14, v1
    ds_write_b128 v26, v[16:19] offset:40960
    v_add_u32 v27, s15, v1
    ds_write_b128 v27, v[20:23] offset:40960
    s_waitcnt lgkmcnt(0)
    s_barrier
    s_cmp_eq_u32 s31, 1
    s_cbranch_scc1 fused1_kernel_glo48
    ds_read_b128 v[8:11], v81 offset:40960
    ds_read_b128 v[12:15], v81 offset:41984
    ds_read_b128 v[16:19], v81 offset:43008
    ds_read_b128 v[20:23], v81 offset:44032
    ds_read_b128 v[24:27], v81 offset:45056
    ds_read_b128 v[28:31], v81 offset:46080
    s_waitcnt lgkmcnt(5)
    v_mfma_f32_32x32x16_bf16 v[32:47], v[216:219], v[8:11], v[32:47]
    ds_read_b128 v[8:11], v81 offset:47104
    s_waitcnt lgkmcnt(5)
    v_mfma_f32_32x32x16_bf16 v[48:63], v[220:223], v[12:15], v[48:63]
    ds_read_b128 v[12:15], v81 offset:48128
    s_waitcnt lgkmcnt(5)
    v_mfma_f32_32x32x16_bf16 v[32:47], v[224:227], v[16:19], v[32:47]
    ds_read_b128 v[16:19], v81 offset:49152
    s_waitcnt lgkmcnt(5)
    v_mfma_f32_32x32x16_bf16 v[48:63], v[228:231], v[20:23], v[48:63]
    ds_read_b128 v[20:23], v81 offset:50176
    s_waitcnt lgkmcnt(5)
    v_mfma_f32_32x32x16_bf16 v[32:47], v[232:235], v[24:27], v[32:47]
    ds_read_b128 v[24:27], v82 offset:40960
    s_waitcnt lgkmcnt(5)
    v_mfma_f32_32x32x16_bf16 v[48:63], v[236:239], v[28:31], v[48:63]
    ds_read_b128 v[28:31], v82 offset:41984
    s_waitcnt lgkmcnt(5)
    v_mfma_f32_32x32x16_bf16 v[32:47], v[240:243], v[8:11], v[32:47]
    ds_read_b128 v[8:11], v82 offset:43008
    s_waitcnt lgkmcnt(5)
    v_mfma_f32_32x32x16_bf16 v[48:63], v[244:247], v[12:15], v[48:63]
    ds_read_b128 v[12:15], v82 offset:44032
    s_waitcnt lgkmcnt(5)
    v_mfma_f32_32x32x16_bf16 v[32:47], v[248:251], v[16:19], v[32:47]
    ds_read_b128 v[16:19], v82 offset:45056
    s_waitcnt lgkmcnt(5)
    v_mfma_f32_32x32x16_bf16 v[48:63], v[252:255], v[20:23], v[48:63]
    ds_read_b128 v[20:23], v82 offset:46080
    s_waitcnt lgkmcnt(5)
    v_mfma_f32_32x32x16_bf16 v[32:47], v[96:99], v[24:27], v[32:47]
    ds_read_b128 v[24:27], v82 offset:47104
    s_waitcnt lgkmcnt(5)
    v_mfma_f32_32x32x16_bf16 v[48:63], v[100:103], v[28:31], v[48:63]
    ds_read_b128 v[28:31], v82 offset:48128
    s_waitcnt lgkmcnt(5)
    v_mfma_f32_32x32x16_bf16 v[32:47], v[104:107], v[8:11], v[32:47]
    ds_read_b128 v[8:11], v82 offset:49152
    s_waitcnt lgkmcnt(5)
    v_mfma_f32_32x32x16_bf16 v[48:63], v[108:111], v[12:15], v[48:63]
    ds_read_b128 v[12:15], v82 offset:50176
    s_waitcnt lgkmcnt(5)
    v_mfma_f32_32x32x16_bf16 v[32:47], v[112:115], v[16:19], v[32:47]
    ds_read_b128 v[16:19], v83 offset:40960
    s_waitcnt lgkmcnt(5)
    v_mfma_f32_32x32x16_bf16 v[48:63], v[116:119], v[20:23], v[48:63]
    ds_read_b128 v[20:23], v83 offset:41984
    s_waitcnt lgkmcnt(5)
    v_mfma_f32_32x32x16_bf16 v[32:47], v[120:123], v[24:27], v[32:47]
    s_barrier
    ds_read_b128 v[24:27], v83 offset:43008
    s_waitcnt lgkmcnt(5)
    v_mfma_f32_32x32x16_bf16 v[48:63], v[124:127], v[28:31], v[48:63]
    ds_read_b128 v[28:31], v83 offset:44032
    s_waitcnt lgkmcnt(5)
    v_mfma_f32_32x32x16_bf16 v[32:47], v[128:131], v[8:11], v[32:47]
    ds_read_b128 v[8:11], v83 offset:45056
    s_waitcnt lgkmcnt(5)
    v_mfma_f32_32x32x16_bf16 v[48:63], v[132:135], v[12:15], v[48:63]
    ds_read_b128 v[12:15], v83 offset:46080
    s_waitcnt lgkmcnt(5)
    v_mfma_f32_32x32x16_bf16 v[32:47], v[136:139], v[16:19], v[32:47]
    ds_read_b128 v[16:19], v83 offset:47104
    s_waitcnt lgkmcnt(5)
    v_mfma_f32_32x32x16_bf16 v[48:63], v[140:143], v[20:23], v[48:63]
    ds_read_b128 v[20:23], v83 offset:48128
    s_waitcnt lgkmcnt(5)
    v_mfma_f32_32x32x16_bf16 v[32:47], v[144:147], v[24:27], v[32:47]
    ds_read_b128 v[24:27], v83 offset:49152
    s_waitcnt lgkmcnt(5)
    v_mfma_f32_32x32x16_bf16 v[48:63], v[148:151], v[28:31], v[48:63]
    ds_read_b128 v[28:31], v83 offset:50176
    s_waitcnt lgkmcnt(5)
    v_mfma_f32_32x32x16_bf16 v[32:47], v[152:155], v[8:11], v[32:47]
    s_waitcnt lgkmcnt(4)
    v_mfma_f32_32x32x16_bf16 v[48:63], v[156:159], v[12:15], v[48:63]
    s_waitcnt lgkmcnt(3)
    v_mfma_f32_32x32x16_bf16 v[32:47], v[160:163], v[16:19], v[32:47]
    s_waitcnt lgkmcnt(2)
    v_mfma_f32_32x32x16_bf16 v[48:63], v[164:167], v[20:23], v[48:63]
    s_waitcnt lgkmcnt(1)
    v_mfma_f32_32x32x16_bf16 v[32:47], v[168:171], v[24:27], v[32:47]
    s_waitcnt lgkmcnt(0)
    v_mfma_f32_32x32x16_bf16 v[48:63], v[172:175], v[28:31], v[48:63]
    s_nop 15
    s_nop 3
    v_add_f32 v32, v32, v48
    v_add_f32 v33, v33, v49
    v_add_f32 v34, v34, v50
    v_add_f32 v35, v35, v51
    v_add_f32 v36, v36, v52
    v_add_f32 v37, v37, v53
    v_add_f32 v38, v38, v54
    v_add_f32 v39, v39, v55
    v_add_f32 v40, v40, v56
    v_add_f32 v41, v41, v57
    v_add_f32 v42, v42, v58
    v_add_f32 v43, v43, v59
    v_add_f32 v44, v44, v60
    v_add_f32 v45, v45, v61
    v_add_f32 v46, v46, v62
    v_add_f32 v47, v47, v63
    s_branch fused1_kernel_epi49
fused1_kernel_glo48:
    s_mul_i32 s5, s30, 10240
    v_add_u32 v2, s5, v1
    ds_read_b128 v[8:11], v2 offset:40960
    ds_read_b128 v[12:15], v2 offset:41984
    ds_read_b128 v[16:19], v2 offset:43008
    ds_read_b128 v[20:23], v2 offset:44032
    ds_read_b128 v[24:27], v2 offset:45056
    ds_read_b128 v[28:31], v2 offset:46080
    s_waitcnt lgkmcnt(5)
    v_mfma_f32_32x32x16_bf16 v[32:47], v[176:179], v[8:11], v[32:47]
    ds_read_b128 v[8:11], v2 offset:47104
    s_waitcnt lgkmcnt(5)
    v_mfma_f32_32x32x16_bf16 v[48:63], v[180:183], v[12:15], v[48:63]
    ds_read_b128 v[12:15], v2 offset:48128
    s_waitcnt lgkmcnt(5)
    v_mfma_f32_32x32x16_bf16 v[32:47], v[184:187], v[16:19], v[32:47]
    ds_read_b128 v[16:19], v2 offset:49152
    s_waitcnt lgkmcnt(5)
    v_mfma_f32_32x32x16_bf16 v[48:63], v[188:191], v[20:23], v[48:63]
    ds_read_b128 v[20:23], v2 offset:50176
    s_waitcnt lgkmcnt(5)
    v_mfma_f32_32x32x16_bf16 v[32:47], v[192:195], v[24:27], v[32:47]
    s_waitcnt lgkmcnt(4)
    v_mfma_f32_32x32x16_bf16 v[48:63], v[196:199], v[28:31], v[48:63]
    s_waitcnt lgkmcnt(3)
    v_mfma_f32_32x32x16_bf16 v[32:47], v[200:203], v[8:11], v[32:47]
    s_waitcnt lgkmcnt(2)
    v_mfma_f32_32x32x16_bf16 v[48:63], v[204:207], v[12:15], v[48:63]
    s_waitcnt lgkmcnt(1)
    v_mfma_f32_32x32x16_bf16 v[32:47], v[208:211], v[16:19], v[32:47]
    s_waitcnt lgkmcnt(0)
    v_mfma_f32_32x32x16_bf16 v[48:63], v[212:215], v[20:23], v[48:63]
    s_nop 15
    s_nop 3
    v_add_f32 v32, v32, v48
    v_add_f32 v33, v33, v49
    v_add_f32 v34, v34, v50
    v_add_f32 v35, v35, v51
    v_add_f32 v36, v36, v52
    v_add_f32 v37, v37, v53
    v_add_f32 v38, v38, v54
    v_add_f32 v39, v39, v55
    v_add_f32 v40, v40, v56
    v_add_f32 v41, v41, v57
    v_add_f32 v42, v42, v58
    v_add_f32 v43, v43, v59
    v_add_f32 v44, v44, v60
    v_add_f32 v45, v45, v61
    v_add_f32 v46, v46, v62
    v_add_f32 v47, v47, v63
    s_lshl_b32 s5, s30, 12
    s_add_u32 s5, s5, 81920
    v_add_u32 v2, s5, v1
    s_cmp_eq_u32 s30, 0
    s_cbranch_scc1 fused1_kernel_w050
    ds_write_b128 v2, v[32:35] offset:0
    ds_write_b128 v2, v[36:39] offset:1024
    ds_write_b128 v2, v[40:43] offset:2048
    ds_write_b128 v2, v[44:47] offset:3072
    s_waitcnt lgkmcnt(0)
    s_barrier
    s_endpgm
fused1_kernel_w050:
    v_mov_b32 v64, v216
    v_mov_b32 v65, v217
    v_mov_b32 v66, v218
    v_mov_b32 v67, v219
    v_mov_b32 v68, v220
    v_mov_b32 v69, v221
    v_mov_b32 v70, v222
    v_mov_b32 v71, v223
    v_mov_b32 v72, v224
    v_mov_b32 v73, v225
    v_mov_b32 v74, v226
    v_mov_b32 v75, v227
    v_mov_b32 v76, v228
    v_mov_b32 v77, v229
    v_mov_b32 v78, v230
    v_mov_b32 v79, v231
    s_barrier
    ds_read_b128 v[96:99], v2 offset:4096
    ds_read_b128 v[100:103], v2 offset:5120
    ds_read_b128 v[104:107], v2 offset:6144
    ds_read_b128 v[108:111], v2 offset:7168
    ds_read_b128 v[112:115], v2 offset:8192
    ds_read_b128 v[116:119], v2 offset:9216
    ds_read_b128 v[120:123], v2 offset:10240
    ds_read_b128 v[124:127], v2 offset:11264
    ds_read_b128 v[128:131], v2 offset:12288
    ds_read_b128 v[132:135], v2 offset:13312
    ds_read_b128 v[136:139], v2 offset:14336
    ds_read_b128 v[140:143], v2 offset:15360
    s_waitcnt lgkmcnt(0)
    v_add_f32 v96, v96, v112
    v_add_f32 v32, v32, v128
    v_add_f32 v97, v97, v113
    v_add_f32 v33, v33, v129
    v_add_f32 v98, v98, v114
    v_add_f32 v34, v34, v130
    v_add_f32 v99, v99, v115
    v_add_f32 v35, v35, v131
    v_add_f32 v100, v100, v116
    v_add_f32 v36, v36, v132
    v_add_f32 v101, v101, v117
    v_add_f32 v37, v37, v133
    v_add_f32 v102, v102, v118
    v_add_f32 v38, v38, v134
    v_add_f32 v103, v103, v119
    v_add_f32 v39, v39, v135
    v_add_f32 v104, v104, v120
    v_add_f32 v40, v40, v136
    v_add_f32 v105, v105, v121
    v_add_f32 v41, v41, v137
    v_add_f32 v106, v106, v122
    v_add_f32 v42, v42, v138
    v_add_f32 v107, v107, v123
    v_add_f32 v43, v43, v139
    v_add_f32 v108, v108, v124
    v_add_f32 v44, v44, v140
    v_add_f32 v109, v109, v125
    v_add_f32 v45, v45, v141
    v_add_f32 v110, v110, v126
    v_add_f32 v46, v46, v142
    v_add_f32 v111, v111, v127
    v_add_f32 v47, v47, v143
    v_add_f32 v32, v32, v96
    v_add_f32 v33, v33, v97
    v_add_f32 v34, v34, v98
    v_add_f32 v35, v35, v99
    v_add_f32 v36, v36, v100
    v_add_f32 v37, v37, v101
    v_add_f32 v38, v38, v102
    v_add_f32 v39, v39, v103
    v_add_f32 v40, v40, v104
    v_add_f32 v41, v41, v105
    v_add_f32 v42, v42, v106
    v_add_f32 v43, v43, v107
    v_add_f32 v44, v44, v108
    v_add_f32 v45, v45, v109
    v_add_f32 v46, v46, v110
    v_add_f32 v47, v47, v111
fused1_kernel_epi49:
    v_cvt_pk_bf16_f32 v32, v32, v32
    v_lshlrev_b32 v32, 16, v32
    v_cvt_pk_bf16_f32 v33, v33, v33
    v_lshlrev_b32 v33, 16, v33
    v_cvt_pk_bf16_f32 v34, v34, v34
    v_lshlrev_b32 v34, 16, v34
    v_cvt_pk_bf16_f32 v35, v35, v35
    v_lshlrev_b32 v35, 16, v35
    v_cvt_pk_bf16_f32 v36, v36, v36
    v_lshlrev_b32 v36, 16, v36
    v_cvt_pk_bf16_f32 v37, v37, v37
    v_lshlrev_b32 v37, 16, v37
    v_cvt_pk_bf16_f32 v38, v38, v38
    v_lshlrev_b32 v38, 16, v38
    v_cvt_pk_bf16_f32 v39, v39, v39
    v_lshlrev_b32 v39, 16, v39
    v_cvt_pk_bf16_f32 v40, v40, v40
    v_lshlrev_b32 v40, 16, v40
    v_cvt_pk_bf16_f32 v41, v41, v41
    v_lshlrev_b32 v41, 16, v41
    v_cvt_pk_bf16_f32 v42, v42, v42
    v_lshlrev_b32 v42, 16, v42
    v_cvt_pk_bf16_f32 v43, v43, v43
    v_lshlrev_b32 v43, 16, v43
    v_cvt_pk_bf16_f32 v44, v44, v44
    v_lshlrev_b32 v44, 16, v44
    v_cvt_pk_bf16_f32 v45, v45, v45
    v_lshlrev_b32 v45, 16, v45
    v_cvt_pk_bf16_f32 v46, v46, v46
    v_lshlrev_b32 v46, 16, v46
    v_cvt_pk_bf16_f32 v47, v47, v47
    v_lshlrev_b32 v47, 16, v47
    v_lshlrev_b32 v64, 16, v64
    v_add_f32 v32, v32, v64
    v_lshlrev_b32 v65, 16, v65
    v_add_f32 v33, v33, v65
    v_lshlrev_b32 v66, 16, v66
    v_add_f32 v34, v34, v66
    v_lshlrev_b32 v67, 16, v67
    v_add_f32 v35, v35, v67
    v_lshlrev_b32 v68, 16, v68
    v_add_f32 v36, v36, v68
    v_lshlrev_b32 v69, 16, v69
    v_add_f32 v37, v37, v69
    v_lshlrev_b32 v70, 16, v70
    v_add_f32 v38, v38, v70
    v_lshlrev_b32 v71, 16, v71
    v_add_f32 v39, v39, v71
    v_lshlrev_b32 v72, 16, v72
    v_add_f32 v40, v40, v72
    v_lshlrev_b32 v73, 16, v73
    v_add_f32 v41, v41, v73
    v_lshlrev_b32 v74, 16, v74
    v_add_f32 v42, v42, v74
    v_lshlrev_b32 v75, 16, v75
    v_add_f32 v43, v43, v75
    v_lshlrev_b32 v76, 16, v76
    v_add_f32 v44, v44, v76
    v_lshlrev_b32 v77, 16, v77
    v_add_f32 v45, v45, v77
    v_lshlrev_b32 v78, 16, v78
    v_add_f32 v46, v46, v78
    v_lshlrev_b32 v79, 16, v79
    v_add_f32 v47, v47, v79
    v_lshlrev_b32 v5, 14, v4
    v_lshl_add_u32 v5, v3, 1, v5
    s_lshl_b32 s33, s34, 17
    s_lshl_b32 s35, s3, 6
    s_add_u32 s33, s33, s35
    v_cvt_pk_bf16_f32 v48, v32, v32
    s_add_u32 s35, s33, 0
    buffer_store_short v48, v5, s[72:75], s35 offen sc0 sc1
    v_cvt_pk_bf16_f32 v49, v33, v33
    s_add_u32 s35, s33, 4096
    buffer_store_short v49, v5, s[72:75], s35 offen sc0 sc1
    v_cvt_pk_bf16_f32 v50, v34, v34
    s_add_u32 s35, s33, 8192
    buffer_store_short v50, v5, s[72:75], s35 offen sc0 sc1
    v_cvt_pk_bf16_f32 v51, v35, v35
    s_add_u32 s35, s33, 12288
    buffer_store_short v51, v5, s[72:75], s35 offen sc0 sc1
    v_cvt_pk_bf16_f32 v52, v36, v36
    s_add_u32 s35, s33, 32768
    buffer_store_short v52, v5, s[72:75], s35 offen sc0 sc1
    v_cvt_pk_bf16_f32 v53, v37, v37
    s_add_u32 s35, s33, 36864
    buffer_store_short v53, v5, s[72:75], s35 offen sc0 sc1
    v_cvt_pk_bf16_f32 v54, v38, v38
    s_add_u32 s35, s33, 40960
    buffer_store_short v54, v5, s[72:75], s35 offen sc0 sc1
    v_cvt_pk_bf16_f32 v55, v39, v39
    s_add_u32 s35, s33, 45056
    buffer_store_short v55, v5, s[72:75], s35 offen sc0 sc1
    v_cvt_pk_bf16_f32 v56, v40, v40
    s_add_u32 s35, s33, 65536
    buffer_store_short v56, v5, s[72:75], s35 offen sc0 sc1
    v_cvt_pk_bf16_f32 v57, v41, v41
    s_add_u32 s35, s33, 69632
    buffer_store_short v57, v5, s[72:75], s35 offen sc0 sc1
    v_cvt_pk_bf16_f32 v58, v42, v42
    s_add_u32 s35, s33, 73728
    buffer_store_short v58, v5, s[72:75], s35 offen sc0 sc1
    v_cvt_pk_bf16_f32 v59, v43, v43
    s_add_u32 s35, s33, 77824
    buffer_store_short v59, v5, s[72:75], s35 offen sc0 sc1
    v_cvt_pk_bf16_f32 v60, v44, v44
    s_add_u32 s35, s33, 98304
    buffer_store_short v60, v5, s[72:75], s35 offen sc0 sc1
    v_cvt_pk_bf16_f32 v61, v45, v45
    s_add_u32 s35, s33, 102400
    buffer_store_short v61, v5, s[72:75], s35 offen sc0 sc1
    v_cvt_pk_bf16_f32 v62, v46, v46
    s_add_u32 s35, s33, 106496
    buffer_store_short v62, v5, s[72:75], s35 offen sc0 sc1
    v_cvt_pk_bf16_f32 v63, v47, v47
    s_add_u32 s35, s33, 110592
    buffer_store_short v63, v5, s[72:75], s35 offen sc0 sc1
    v_lshlrev_b32 v32, 16, v48
    v_lshlrev_b32 v33, 16, v49
    v_lshlrev_b32 v34, 16, v50
    v_lshlrev_b32 v35, 16, v51
    v_lshlrev_b32 v36, 16, v52
    v_lshlrev_b32 v37, 16, v53
    v_lshlrev_b32 v38, 16, v54
    v_lshlrev_b32 v39, 16, v55
    v_lshlrev_b32 v40, 16, v56
    v_lshlrev_b32 v41, 16, v57
    v_lshlrev_b32 v42, 16, v58
    v_lshlrev_b32 v43, 16, v59
    v_lshlrev_b32 v44, 16, v60
    v_lshlrev_b32 v45, 16, v61
    v_lshlrev_b32 v46, 16, v62
    v_lshlrev_b32 v47, 16, v63
    v_add_f32 v81, v32, v33
    v_add_f32 v82, v34, v35
    v_add_f32 v81, v81, v36
    v_add_f32 v82, v82, v37
    v_add_f32 v81, v81, v38
    v_add_f32 v82, v82, v39
    v_add_f32 v81, v81, v40
    v_add_f32 v82, v82, v41
    v_add_f32 v81, v81, v42
    v_add_f32 v82, v82, v43
    v_add_f32 v81, v81, v44
    v_add_f32 v82, v82, v45
    v_add_f32 v81, v81, v46
    v_add_f32 v82, v82, v47
    v_add_f32 v81, v81, v82
    v_mov_b32 v82, v81
    s_nop 1
    v_permlane32_swap_b32 v81, v82
    s_nop 1
    v_add_f32 v84, v81, v82
    v_mul_f32 v82, 0x3d000000, v84
    v_mov_b32 v83, 0
    v_mov_b32 v86, 0
    v_sub_f32 v80, v32, v82
    v_sub_f32 v87, v33, v82
    v_fmac_f32 v83, v80, v80
    v_fmac_f32 v86, v87, v87
    v_sub_f32 v80, v34, v82
    v_sub_f32 v87, v35, v82
    v_fmac_f32 v83, v80, v80
    v_fmac_f32 v86, v87, v87
    v_sub_f32 v80, v36, v82
    v_sub_f32 v87, v37, v82
    v_fmac_f32 v83, v80, v80
    v_fmac_f32 v86, v87, v87
    v_sub_f32 v80, v38, v82
    v_sub_f32 v87, v39, v82
    v_fmac_f32 v83, v80, v80
    v_fmac_f32 v86, v87, v87
    v_sub_f32 v80, v40, v82
    v_sub_f32 v87, v41, v82
    v_fmac_f32 v83, v80, v80
    v_fmac_f32 v86, v87, v87
    v_sub_f32 v80, v42, v82
    v_sub_f32 v87, v43, v82
    v_fmac_f32 v83, v80, v80
    v_fmac_f32 v86, v87, v87
    v_sub_f32 v80, v44, v82
    v_sub_f32 v87, v45, v82
    v_fmac_f32 v83, v80, v80
    v_fmac_f32 v86, v87, v87
    v_sub_f32 v80, v46, v82
    v_sub_f32 v87, v47, v82
    v_fmac_f32 v83, v80, v80
    v_fmac_f32 v86, v87, v87
    v_add_f32 v83, v83, v86
    v_mov_b32 v82, v83
    s_nop 1
    v_permlane32_swap_b32 v83, v82
    s_nop 1
    v_add_f32 v85, v83, v82
    v_lshlrev_b32 v6, 3, v3
    v_add_u32 v7, 122880, v6
    s_lshl_b32 s28, s40, 8
    v_add_u32 v5, s28, v7
    ds_write_b64 v5, v[84:85]
    s_waitcnt lgkmcnt(0)
    s_barrier
    s_cmp_lg_u32 s40, 0
    s_cbranch_scc1 fused1_kernel_end
    ds_read_b64 v[96:97], v7 offset:0
    ds_read_b64 v[98:99], v7 offset:256
    ds_read_b64 v[100:101], v7 offset:512
    ds_read_b64 v[102:103], v7 offset:768
    ds_read_b64 v[104:105], v7 offset:1024
    s_waitcnt lgkmcnt(0)
    v_add_f32 v84, v96, v98
    v_add_f32 v84, v84, v100
    v_add_f32 v84, v84, v102
    v_add_f32 v84, v84, v104
    v_add_f32 v85, v97, v99
    v_add_f32 v85, v85, v101
    v_add_f32 v85, v85, v103
    v_add_f32 v85, v85, v105
    v_mul_f32 v79, 0x3bcccccd, v84
    v_mov_b32 v82, 0
    s_mov_b32 s28, 0x3d000000
    v_fma_f32 v83, v96, s28, -v79
    v_fmac_f32 v82, v83, v83
    v_fma_f32 v83, v98, s28, -v79
    v_fmac_f32 v82, v83, v83
    v_fma_f32 v83, v100, s28, -v79
    v_fmac_f32 v82, v83, v83
    v_fma_f32 v83, v102, s28, -v79
    v_fmac_f32 v82, v83, v83
    v_fma_f32 v83, v104, s28, -v79
    v_fmac_f32 v82, v83, v83
    s_mov_b32 s28, 0x42000000
    v_fma_f32 v85, v82, s28, v85
    s_lshl_b32 s28, s4, 14
    s_lshl_b32 s29, s3, 8
    s_add_u32 s28, s28, s29
    s_mov_b32 exec_lo, -1
    s_mov_b32 exec_hi, 0
    s_cmp_eq_u32 s4, 0
    s_cbranch_scc1 fused1_kernel_sp51
    buffer_store_dwordx2 v[84:85], v6, s[76:79], s28 offen sc1
    s_endpgm
fused1_kernel_sp51:
    v_mov_b32 v96, v84
    v_mov_b32 v97, v85
    s_mov_b32 s30, 0
fused1_kernel_spl53:
    s_add_u32 s28, s29, 16384
    buffer_load_dwordx2 v[98:99], v6, s[76:79], s28 offen sc1
    s_add_u32 s28, s29, 32768
    buffer_load_dwordx2 v[100:101], v6, s[76:79], s28 offen sc1
    s_add_u32 s28, s29, 49152
    buffer_load_dwordx2 v[102:103], v6, s[76:79], s28 offen sc1
    s_waitcnt vmcnt(0)
    v_max3_u32 v80, v98, v99, v100
    v_max3_u32 v81, v101, v102, v103
    v_max_u32 v80, v80, v81
    v_cmp_eq_u32 vcc, -1, v80
    s_cbranch_vccz fused1_kernel_sd52
    s_add_u32 s30, s30, 1
    s_cmp_lt_u32 s30, 0x8000
    s_cbranch_scc1 fused1_kernel_spl53
fused1_kernel_sd52:
    v_add_f32 v84, v96, v98
    v_add_f32 v84, v84, v100
    v_add_f32 v84, v84, v102
    v_add_f32 v81, v97, v99
    v_add_f32 v81, v81, v101
    v_add_f32 v81, v81, v103
    v_mul_f32 v79, 0x3acccccd, v84
    v_mov_b32 v82, 0
    s_mov_b32 s28, 0x3bcccccd
    v_fma_f32 v83, v96, s28, -v79
    v_fmac_f32 v82, v83, v83
    v_fma_f32 v83, v98, s28, -v79
    v_fmac_f32 v82, v83, v83
    v_fma_f32 v83, v100, s28, -v79
    v_fmac_f32 v82, v83, v83
    v_fma_f32 v83, v102, s28, -v79
    v_fmac_f32 v82, v83, v83
    s_mov_b32 s28, 0x43200000
    v_fma_f32 v81, v82, s28, v81
    v_mov_b32 v80, v79
    v_mul_f32 v81, 0x3acccccd, v81
    v_cvt_pk_bf16_f32 v80, v80, v80
    v_lshlrev_b32 v80, 16, v80
    v_cvt_pk_bf16_f32 v81, v81, v81
    v_lshlrev_b32 v81, 16, v81
    v_add_f32 v81, 0x3727c5ac, v81
    v_cvt_pk_bf16_f32 v81, v81, v81
    v_lshlrev_b32 v81, 16, v81
    v_sqrt_f32 v81, v81
    s_nop 0
    v_cvt_pk_bf16_f32 v81, v81, v81
    v_lshlrev_b32 v81, 16, v81
    v_rcp_f32 v81, v81
    s_nop 0
    v_sub_f32 v80, 0, v80
    v_lshrrev_b32 v6, 1, v6
    s_lshr_b32 s29, s29, 1
    s_add_u32 s28, s29, 0x2000
    buffer_store_dword v80, v6, s[80:83], s29 offen sc0 sc1
    buffer_store_dword v81, v6, s[80:83], s28 offen sc0 sc1
    s_endpgm
fused1_kernel_g0r19:
    s_mov_b32 s29, 0
fused1_kernel_g0l54:
    s_sleep 2
    s_mov_b32 s21, s20
    buffer_load_dwordx4 v[96:99], v4, s[56:59], s21 offen offset:0 sc1
    buffer_load_dwordx4 v[100:103], v4, s[56:59], s21 offen offset:1024 sc1
    buffer_load_dwordx4 v[104:107], v4, s[56:59], s21 offen offset:2048 sc1
    buffer_load_dwordx4 v[108:111], v4, s[56:59], s21 offen offset:3072 sc1
    s_add_u32 s21, s21, 4096
    buffer_load_dwordx4 v[112:115], v4, s[56:59], s21 offen offset:0 sc1
    buffer_load_dwordx4 v[116:119], v4, s[56:59], s21 offen offset:1024 sc1
    buffer_load_dwordx4 v[120:123], v4, s[56:59], s21 offen offset:2048 sc1
    buffer_load_dwordx4 v[124:127], v4, s[56:59], s21 offen offset:3072 sc1
    s_add_u32 s21, s21, 4096
    buffer_load_dwordx4 v[128:131], v4, s[56:59], s21 offen offset:0 sc1
    buffer_load_dwordx4 v[132:135], v4, s[56:59], s21 offen offset:1024 sc1
    buffer_load_dwordx4 v[136:139], v4, s[56:59], s21 offen offset:2048 sc1
    buffer_load_dwordx4 v[140:143], v4, s[56:59], s21 offen offset:3072 sc1
    s_add_u32 s21, s21, 4096
    buffer_load_dwordx4 v[144:147], v4, s[56:59], s21 offen offset:0 sc1
    buffer_load_dwordx4 v[148:151], v4, s[56:59], s21 offen offset:1024 sc1
    buffer_load_dwordx4 v[152:155], v4, s[56:59], s21 offen offset:2048 sc1
    buffer_load_dwordx4 v[156:159], v4, s[56:59], s21 offen offset:3072 sc1
    s_add_u32 s21, s21, 4096
    buffer_load_dwordx4 v[160:163], v4, s[56:59], s21 offen offset:0 sc1
    buffer_load_dwordx4 v[164:167], v4, s[56:59], s21 offen offset:1024 sc1
    buffer_load_dwordx4 v[168:171], v4, s[56:59], s21 offen offset:2048 sc1
    buffer_load_dwordx4 v[172:175], v4, s[56:59], s21 offen offset:3072 sc1
    v_mov_b32 v28, 0
    v_mov_b32 v29, 0
    s_waitcnt vmcnt(19)
    ds_write_b128 v5, v[96:99] offset:0
    v_max3_u32 v28, v28, v96, v97
    v_max3_u32 v29, v29, v98, v99
    s_waitcnt vmcnt(18)
    ds_write_b128 v5, v[100:103] offset:1024
    v_max3_u32 v28, v28, v100, v101
    v_max3_u32 v29, v29, v102, v103
    s_waitcnt vmcnt(17)
    ds_write_b128 v5, v[104:107] offset:2048
    v_max3_u32 v28, v28, v104, v105
    v_max3_u32 v29, v29, v106, v107
    s_waitcnt vmcnt(16)
    ds_write_b128 v5, v[108:111] offset:3072
    v_max3_u32 v28, v28, v108, v109
    v_max3_u32 v29, v29, v110, v111
    s_waitcnt vmcnt(15)
    ds_write_b128 v5, v[112:115] offset:4096
    v_max3_u32 v28, v28, v112, v113
    v_max3_u32 v29, v29, v114, v115
    s_waitcnt vmcnt(14)
    ds_write_b128 v5, v[116:119] offset:5120
    v_max3_u32 v28, v28, v116, v117
    v_max3_u32 v29, v29, v118, v119
    s_waitcnt vmcnt(13)
    ds_write_b128 v5, v[120:123] offset:6144
    v_max3_u32 v28, v28, v120, v121
    v_max3_u32 v29, v29, v122, v123
    s_waitcnt vmcnt(12)
    ds_write_b128 v5, v[124:127] offset:7168
    v_max3_u32 v28, v28, v124, v125
    v_max3_u32 v29, v29, v126, v127
    s_waitcnt vmcnt(11)
    ds_write_b128 v5, v[128:131] offset:8192
    v_max3_u32 v28, v28, v128, v129
    v_max3_u32 v29, v29, v130, v131
    s_waitcnt vmcnt(10)
    ds_write_b128 v5, v[132:135] offset:9216
    v_max3_u32 v28, v28, v132, v133
    v_max3_u32 v29, v29, v134, v135
    s_waitcnt vmcnt(9)
    ds_write_b128 v5, v[136:139] offset:10240
    v_max3_u32 v28, v28, v136, v137
    v_max3_u32 v29, v29, v138, v139
    s_waitcnt vmcnt(8)
    ds_write_b128 v5, v[140:143] offset:11264
    v_max3_u32 v28, v28, v140, v141
    v_max3_u32 v29, v29, v142, v143
    s_waitcnt vmcnt(7)
    ds_write_b128 v5, v[144:147] offset:12288
    v_max3_u32 v28, v28, v144, v145
    v_max3_u32 v29, v29, v146, v147
    s_waitcnt vmcnt(6)
    ds_write_b128 v5, v[148:151] offset:13312
    v_max3_u32 v28, v28, v148, v149
    v_max3_u32 v29, v29, v150, v151
    s_waitcnt vmcnt(5)
    ds_write_b128 v5, v[152:155] offset:14336
    v_max3_u32 v28, v28, v152, v153
    v_max3_u32 v29, v29, v154, v155
    s_waitcnt vmcnt(4)
    ds_write_b128 v5, v[156:159] offset:15360
    v_max3_u32 v28, v28, v156, v157
    v_max3_u32 v29, v29, v158, v159
    s_waitcnt vmcnt(3)
    ds_write_b128 v5, v[160:163] offset:16384
    v_max3_u32 v28, v28, v160, v161
    v_max3_u32 v29, v29, v162, v163
    s_waitcnt vmcnt(2)
    ds_write_b128 v5, v[164:167] offset:17408
    v_max3_u32 v28, v28, v164, v165
    v_max3_u32 v29, v29, v166, v167
    s_waitcnt vmcnt(1)
    ds_write_b128 v5, v[168:171] offset:18432
    v_max3_u32 v28, v28, v168, v169
    v_max3_u32 v29, v29, v170, v171
    s_waitcnt vmcnt(0)
    ds_write_b128 v5, v[172:175] offset:19456
    v_max3_u32 v28, v28, v172, v173
    v_max3_u32 v29, v29, v174, v175
    v_max_u32 v28, v28, v29
    v_cmp_eq_u32 vcc, -1, v28
    s_cbranch_vccz fused1_kernel_g0d20
    s_add_u32 s29, s29, 1
    s_cmp_lt_u32 s29, 0x8000
    s_cbranch_scc1 fused1_kernel_g0l54
    s_branch fused1_kernel_g0d20
fused1_kernel_vr21:
    s_mov_b32 s29, 0
fused1_kernel_vl55:
    s_sleep 2
    s_add_u32 s21, s20, 40960
    buffer_load_dwordx4 v[176:179], v1, s[56:59], s21 offen sc1
    s_add_u32 s21, s21, 1024
    buffer_load_dwordx4 v[180:183], v1, s[56:59], s21 offen sc1
    s_add_u32 s21, s21, 1024
    buffer_load_dwordx4 v[184:187], v1, s[56:59], s21 offen sc1
    s_add_u32 s21, s21, 1024
    buffer_load_dwordx4 v[188:191], v1, s[56:59], s21 offen sc1
    s_add_u32 s21, s21, 1024
    buffer_load_dwordx4 v[192:195], v1, s[56:59], s21 offen sc1
    s_add_u32 s21, s21, 1024
    s_waitcnt vmcnt(0)
    ds_write_b128 v196, v[176:179] offset:0
    ds_write_b128 v196, v[180:183] offset:1024
    ds_write_b128 v196, v[184:187] offset:2048
    ds_write_b128 v196, v[188:191] offset:3072
    ds_write_b128 v196, v[192:195] offset:4096
    s_waitcnt lgkmcnt(0)
    v_max3_u32 v197, v176, v177, v178
    v_max3_u32 v198, v179, v180, v181
    v_max3_u32 v197, v197, v182, v183
    v_max3_u32 v198, v198, v184, v185
    v_max3_u32 v197, v197, v186, v187
    v_max3_u32 v198, v198, v188, v189
    v_max3_u32 v197, v197, v190, v191
    v_max3_u32 v198, v198, v192, v193
    v_max3_u32 v197, v197, v194, v195
    v_max_u32 v197, v197, v198
    v_cmp_eq_u32 vcc, -1, v197
    s_cbranch_vccz fused1_kernel_vd24
    s_add_u32 s29, s29, 1
    s_cmp_lt_u32 s29, 0x8000
    s_cbranch_scc1 fused1_kernel_vl55
    s_branch fused1_kernel_vd24
fused1_kernel_vr22:
    s_mov_b32 s29, 0
fused1_kernel_vl56:
    s_sleep 2
    s_add_u32 s21, s20, 81920
    buffer_load_dwordx4 v[176:179], v1, s[56:59], s21 offen sc1
    s_add_u32 s21, s21, 1024
    buffer_load_dwordx4 v[180:183], v1, s[56:59], s21 offen sc1
    s_add_u32 s21, s21, 1024
    buffer_load_dwordx4 v[184:187], v1, s[56:59], s21 offen sc1
    s_add_u32 s21, s21, 1024
    buffer_load_dwordx4 v[188:191], v1, s[56:59], s21 offen sc1
    s_add_u32 s21, s21, 1024
    buffer_load_dwordx4 v[192:195], v1, s[56:59], s21 offen sc1
    s_add_u32 s21, s21, 1024
    s_waitcnt vmcnt(0)
    ds_write_b128 v196, v[176:179] offset:0
    ds_write_b128 v196, v[180:183] offset:1024
    ds_write_b128 v196, v[184:187] offset:2048
    ds_write_b128 v196, v[188:191] offset:3072
    ds_write_b128 v196, v[192:195] offset:4096
    s_waitcnt lgkmcnt(0)
    v_max3_u32 v197, v176, v177, v178
    v_max3_u32 v198, v179, v180, v181
    v_max3_u32 v197, v197, v182, v183
    v_max3_u32 v198, v198, v184, v185
    v_max3_u32 v197, v197, v186, v187
    v_max3_u32 v198, v198, v188, v189
    v_max3_u32 v197, v197, v190, v191
    v_max3_u32 v198, v198, v192, v193
    v_max3_u32 v197, v197, v194, v195
    v_max_u32 v197, v197, v198
    v_cmp_eq_u32 vcc, -1, v197
    s_cbranch_vccz fused1_kernel_vd25
    s_add_u32 s29, s29, 1
    s_cmp_lt_u32 s29, 0x8000
    s_cbranch_scc1 fused1_kernel_vl56
    s_branch fused1_kernel_vd25
fused1_kernel_vr23:
    s_mov_b32 s29, 0
fused1_kernel_vl57:
    s_sleep 2
    s_add_u32 s21, s20, 122880
    buffer_load_dwordx4 v[176:179], v1, s[56:59], s21 offen sc1
    s_add_u32 s21, s21, 1024
    buffer_load_dwordx4 v[180:183], v1, s[56:59], s21 offen sc1
    s_add_u32 s21, s21, 1024
    buffer_load_dwordx4 v[184:187], v1, s[56:59], s21 offen sc1
    s_add_u32 s21, s21, 1024
    buffer_load_dwordx4 v[188:191], v1, s[56:59], s21 offen sc1
    s_add_u32 s21, s21, 1024
    buffer_load_dwordx4 v[192:195], v1, s[56:59], s21 offen sc1
    s_add_u32 s21, s21, 1024
    s_waitcnt vmcnt(0)
    ds_write_b128 v196, v[176:179] offset:0
    ds_write_b128 v196, v[180:183] offset:1024
    ds_write_b128 v196, v[184:187] offset:2048
    ds_write_b128 v196, v[188:191] offset:3072
    ds_write_b128 v196, v[192:195] offset:4096
    s_waitcnt lgkmcnt(0)
    v_max3_u32 v197, v176, v177, v178
    v_max3_u32 v198, v179, v180, v181
    v_max3_u32 v197, v197, v182, v183
    v_max3_u32 v198, v198, v184, v185
    v_max3_u32 v197, v197, v186, v187
    v_max3_u32 v198, v198, v188, v189
    v_max3_u32 v197, v197, v190, v191
    v_max3_u32 v198, v198, v192, v193
    v_max3_u32 v197, v197, v194, v195
    v_max_u32 v197, v197, v198
    v_cmp_eq_u32 vcc, -1, v197
    s_cbranch_vccz fused1_kernel_vd26
    s_add_u32 s29, s29, 1
    s_cmp_lt_u32 s29, 0x8000
    s_cbranch_scc1 fused1_kernel_vl57
    s_branch fused1_kernel_vd26
fused1_kernel_fb41:
    v_and_b32 v56, 63, v0
    v_lshlrev_b32 v56, 4, v56
    v_lshlrev_b32 v57, 3, v3
    v_mul_u32_u24 v58, 320, v4
    v_lshl_add_u32 v58, v3, 4, v58
    v_mov_b32 v144, 0
    v_mov_b32 v145, 0
    v_mov_b32 v146, 0
    v_mov_b32 v147, 0
    v_mov_b32 v148, 0
    v_mov_b32 v149, 0
    v_mov_b32 v150, 0
    v_mov_b32 v151, 0
    v_mov_b32 v152, 0
    v_mov_b32 v153, 0
    v_mov_b32 v154, 0
    v_mov_b32 v155, 0
    v_mov_b32 v156, 0
    v_mov_b32 v157, 0
    v_mov_b32 v158, 0
    v_mov_b32 v159, 0
    v_mov_b32 v60, 0xff7fffff
    s_mov_b32 s33, 0
fused1_kernel_fbl58:
    s_lshr_b32 s38, s33, 4
    s_mul_i32 s38, s38, 40960
    s_and_b32 s35, s33, 15
    s_lshl_b32 s36, s35, 10
    s_add_u32 s36, s36, s38
    buffer_load_dwordx4 v[24:27], v56, s[56:59], s36 offen sc1
    s_lshl_b32 s36, s35, 8
    s_add_u32 s36, s36, s38
    s_add_u32 s36, s36, 16384
    buffer_load_dwordx2 v[28:29], v57, s[56:59], s36 offen sc1
    s_mul_i32 s36, s35, 1280
    s_add_u32 s36, s36, s38
    s_add_u32 s36, s36, 20480
    s_mov_b64 exec, s[22:23]
    buffer_load_dwordx4 v[40:43], v58, s[56:59], s36 offen sc1
    buffer_load_dwordx4 v[44:47], v58, s[56:59], s36 offen offset:640 sc1
    s_mov_b64 exec, -1
    s_waitcnt vmcnt(0)
    v_mfma_f32_32x32x16_bf16 v[64:79], v[24:27], v[8:11], 0
    v_mfma_f32_32x32x8_bf16 v[64:79], v[28:29], v[12:13], v[64:79]
    s_nop 15
    s_nop 7
    v_max3_f32 v80, v64, v65, v66
    v_max3_f32 v80, v80, v67, v68
    v_max3_f32 v80, v80, v69, v70
    v_max3_f32 v80, v80, v71, v72
    v_max3_f32 v80, v80, v73, v74
    v_max3_f32 v80, v80, v75, v76
    v_max3_f32 v80, v80, v77, v78
    v_max3_f32 v80, v80, v79, v60
    v_mov_b32 v81, v80
    s_nop 1
    v_permlane32_swap_b32 v80, v81
    s_nop 1
    v_max_f32 v80, v80, v81
    v_sub_f32 v81, v60, v80
    v_exp_f32 v81, v81
    v_mov_b32 v60, v80
    v_sub_f32 v64, v64, v80
    v_mul_f32 v144, v144, v81
    v_sub_f32 v65, v65, v80
    v_mul_f32 v145, v145, v81
    v_sub_f32 v66, v66, v80
    v_mul_f32 v146, v146, v81
    v_sub_f32 v67, v67, v80
    v_mul_f32 v147, v147, v81
    v_sub_f32 v68, v68, v80
    v_mul_f32 v148, v148, v81
    v_sub_f32 v69, v69, v80
    v_mul_f32 v149, v149, v81
    v_sub_f32 v70, v70, v80
    v_mul_f32 v150, v150, v81
    v_sub_f32 v71, v71, v80
    v_mul_f32 v151, v151, v81
    v_sub_f32 v72, v72, v80
    v_mul_f32 v152, v152, v81
    v_sub_f32 v73, v73, v80
    v_mul_f32 v153, v153, v81
    v_sub_f32 v74, v74, v80
    v_mul_f32 v154, v154, v81
    v_sub_f32 v75, v75, v80
    v_mul_f32 v155, v155, v81
    v_sub_f32 v76, v76, v80
    v_mul_f32 v156, v156, v81
    v_sub_f32 v77, v77, v80
    v_mul_f32 v157, v157, v81
    v_sub_f32 v78, v78, v80
    v_mul_f32 v158, v158, v81
    v_sub_f32 v79, v79, v80
    v_mul_f32 v159, v159, v81
    v_exp_f32 v64, v64
    v_exp_f32 v65, v65
    v_exp_f32 v66, v66
    v_exp_f32 v67, v67
    v_exp_f32 v68, v68
    v_exp_f32 v69, v69
    v_exp_f32 v70, v70
    v_exp_f32 v71, v71
    v_exp_f32 v72, v72
    v_exp_f32 v73, v73
    v_exp_f32 v74, v74
    v_exp_f32 v75, v75
    v_exp_f32 v76, v76
    v_exp_f32 v77, v77
    v_exp_f32 v78, v78
    v_exp_f32 v79, v79
    s_nop 0
    v_cvt_pk_bf16_f32 v128, v64, v65
    v_cvt_pk_bf16_f32 v129, v66, v67
    v_cvt_pk_bf16_f32 v130, v68, v69
    v_cvt_pk_bf16_f32 v131, v70, v71
    v_cvt_pk_bf16_f32 v132, v72, v73
    v_cvt_pk_bf16_f32 v133, v74, v75
    v_cvt_pk_bf16_f32 v134, v76, v77
    v_cvt_pk_bf16_f32 v135, v78, v79
    s_nop 1
    v_mfma_f32_32x32x16_bf16 v[144:159], v[40:43], v[128:131], v[144:159]
    v_mfma_f32_32x32x16_bf16 v[144:159], v[44:47], v[132:135], v[144:159]
    s_nop 15
    s_nop 7
    s_add_u32 s33, s33, 1
    s_cmp_lt_u32 s33, 64
    s_cbranch_scc1 fused1_kernel_fbl58
    v_mov_b32 v60, v152
    v_mov_b32 v61, v152
    s_nop 1
    v_permlane32_swap_b32 v60, v61
    s_nop 1
    v_mov_b32 v160, 0
    v_mov_b32 v161, 0
    v_mov_b32 v162, 0
    v_mov_b32 v163, 0
    v_mov_b32 v164, 0
    v_mov_b32 v165, 0
    v_mov_b32 v166, 0
    v_mov_b32 v167, 0
    v_mov_b32 v168, 0
    v_mov_b32 v169, 0
    v_mov_b32 v170, 0
    v_mov_b32 v171, 0
    v_mov_b32 v172, 0
    v_mov_b32 v173, 0
    v_mov_b32 v174, 0
    v_mov_b32 v175, 0
    v_mov_b32 v60, 0xff7fffff
    s_mov_b32 s33, 0
fused1_kernel_fbl59:
    s_lshr_b32 s38, s33, 4
    s_mul_i32 s38, s38, 40960
    s_and_b32 s35, s33, 15
    s_lshl_b32 s36, s35, 10
    s_add_u32 s36, s36, s38
    buffer_load_dwordx4 v[24:27], v56, s[56:59], s36 offen sc1
    s_lshl_b32 s36, s35, 8
    s_add_u32 s36, s36, s38
    s_add_u32 s36, s36, 16384
    buffer_load_dwordx2 v[28:29], v57, s[56:59], s36 offen sc1
    s_mul_i32 s36, s35, 1280
    s_add_u32 s36, s36, s38
    s_add_u32 s36, s36, 20480
    s_mov_b64 exec, s[22:23]
    buffer_load_dwordx4 v[40:43], v58, s[56:59], s36 offen sc1
    buffer_load_dwordx4 v[44:47], v58, s[56:59], s36 offen offset:640 sc1
    s_mov_b64 exec, -1
    s_waitcnt vmcnt(0)
    v_mfma_f32_32x32x16_bf16 v[64:79], v[24:27], v[16:19], 0
    v_mfma_f32_32x32x8_bf16 v[64:79], v[28:29], v[20:21], v[64:79]
    s_nop 15
    s_nop 7
    v_max3_f32 v80, v64, v65, v66
    v_max3_f32 v80, v80, v67, v68
    v_max3_f32 v80, v80, v69, v70
    v_max3_f32 v80, v80, v71, v72
    v_max3_f32 v80, v80, v73, v74
    v_max3_f32 v80, v80, v75, v76
    v_max3_f32 v80, v80, v77, v78
    v_max3_f32 v80, v80, v79, v60
    v_mov_b32 v81, v80
    s_nop 1
    v_permlane32_swap_b32 v80, v81
    s_nop 1
    v_max_f32 v80, v80, v81
    v_sub_f32 v81, v60, v80
    v_exp_f32 v81, v81
    v_mov_b32 v60, v80
    v_sub_f32 v64, v64, v80
    v_mul_f32 v160, v160, v81
    v_sub_f32 v65, v65, v80
    v_mul_f32 v161, v161, v81
    v_sub_f32 v66, v66, v80
    v_mul_f32 v162, v162, v81
    v_sub_f32 v67, v67, v80
    v_mul_f32 v163, v163, v81
    v_sub_f32 v68, v68, v80
    v_mul_f32 v164, v164, v81
    v_sub_f32 v69, v69, v80
    v_mul_f32 v165, v165, v81
    v_sub_f32 v70, v70, v80
    v_mul_f32 v166, v166, v81
    v_sub_f32 v71, v71, v80
    v_mul_f32 v167, v167, v81
    v_sub_f32 v72, v72, v80
    v_mul_f32 v168, v168, v81
    v_sub_f32 v73, v73, v80
    v_mul_f32 v169, v169, v81
    v_sub_f32 v74, v74, v80
    v_mul_f32 v170, v170, v81
    v_sub_f32 v75, v75, v80
    v_mul_f32 v171, v171, v81
    v_sub_f32 v76, v76, v80
    v_mul_f32 v172, v172, v81
    v_sub_f32 v77, v77, v80
    v_mul_f32 v173, v173, v81
    v_sub_f32 v78, v78, v80
    v_mul_f32 v174, v174, v81
    v_sub_f32 v79, v79, v80
    v_mul_f32 v175, v175, v81
    v_exp_f32 v64, v64
    v_exp_f32 v65, v65
    v_exp_f32 v66, v66
    v_exp_f32 v67, v67
    v_exp_f32 v68, v68
    v_exp_f32 v69, v69
    v_exp_f32 v70, v70
    v_exp_f32 v71, v71
    v_exp_f32 v72, v72
    v_exp_f32 v73, v73
    v_exp_f32 v74, v74
    v_exp_f32 v75, v75
    v_exp_f32 v76, v76
    v_exp_f32 v77, v77
    v_exp_f32 v78, v78
    v_exp_f32 v79, v79
    s_nop 0
    v_cvt_pk_bf16_f32 v128, v64, v65
    v_cvt_pk_bf16_f32 v129, v66, v67
    v_cvt_pk_bf16_f32 v130, v68, v69
    v_cvt_pk_bf16_f32 v131, v70, v71
    v_cvt_pk_bf16_f32 v132, v72, v73
    v_cvt_pk_bf16_f32 v133, v74, v75
    v_cvt_pk_bf16_f32 v134, v76, v77
    v_cvt_pk_bf16_f32 v135, v78, v79
    s_nop 1
    v_mfma_f32_32x32x16_bf16 v[160:175], v[40:43], v[128:131], v[160:175]
    v_mfma_f32_32x32x16_bf16 v[160:175], v[44:47], v[132:135], v[160:175]
    s_nop 15
    s_nop 7
    s_add_u32 s33, s33, 1
    s_cmp_lt_u32 s33, 64
    s_cbranch_scc1 fused1_kernel_fbl59
    v_mov_b32 v62, v168
    v_mov_b32 v63, v168
    s_nop 1
    v_permlane32_swap_b32 v62, v63
    s_nop 1
    s_branch fused1_kernel_fin42
fused1_kernel_end:
    s_endpgm
.globl conv2_kernel
.p2align 8
.type conv2_kernel,@function
conv2_kernel:
    s_cmp_ge_u32 s2, 768
    s_cbranch_scc1 conv2_kernel_end
    s_load_dwordx2 s[6:7], s[0:1], 112
    s_load_dwordx2 s[4:5], s[0:1], 48
    s_sub_u32 s3, s2, 512
    s_lshr_b32 s3, s3, 1
    s_add_u32 s3, s3, 512
    s_cmp_lt_u32 s2, 512
    s_cselect_b32 s3, s2, s3
    v_lshrrev_b32 v30, 6, v0
    v_lshlrev_b32 v1, 4, v0
    v_readfirstlane_b32 s40, v30
    v_lshlrev_b32 v2, 6, v0
    s_lshl_b32 s28, s3, 12
    s_mul_i32 s29, s3, 4224
    s_waitcnt lgkmcnt(0)
    s_add_u32 s20, s6, 0xa00000
    s_addc_u32 s21, s7, 0
    s_mov_b32 s22, 0x294000
    s_mov_b32 s23, 0x00020000
    buffer_load_dwordx4 v[32:35], v1, s[20:23], s29 offen
    buffer_load_dwordx4 v[36:39], v1, s[20:23], s29 offen offset:16
    s_add_u32 s8, s6, 0x500000
    s_addc_u32 s9, s7, 0
    s_mov_b32 s10, 0x280000
    s_mov_b32 s11, 0x00020000
    buffer_load_dwordx4 v[4:7], v1, s[8:11], s28 offen
    s_add_u32 s16, s6, 0x1438000
    s_addc_u32 s17, s7, 0
    s_mov_b32 s18, 0x4000
    s_mov_b32 s19, 0x00020000
    v_lshlrev_b32 v12, 5, v0
    s_movk_i32 s30, 0x2000
    buffer_load_dwordx4 v[64:67], v12, s[16:19], 0 offen offset:0
    buffer_load_dwordx4 v[68:71], v12, s[16:19], 0 offen offset:16
    buffer_load_dwordx4 v[72:75], v12, s[16:19], s30 offen offset:0
    buffer_load_dwordx4 v[76:79], v12, s[16:19], s30 offen offset:16
    s_lshr_b32 s30, s3, 1
    s_lshl_b32 s30, s30, 2
    s_load_dword s44, s[4:5], s30
    s_movk_i32 s26, 0x3f80
    s_mov_b32 s27, 0x3f800000
    v_and_b32 v25, 15, v0
    v_bfe_u32 v26, v0, 4, 2
    s_add_u32 s12, s6, 0x780000
    s_addc_u32 s13, s7, 0
    s_mov_b32 s14, 0x280000
    s_mov_b32 s15, 0x00020000
    v_mov_b32 v16, 0
    v_mov_b32 v17, 0
    v_mov_b32 v18, 0
    v_mov_b32 v19, 0
    v_mul_u32_u24 v8, 4160, v0
    v_add_u32 v8, 4096, v8
    v_add_u32 v9, 33152, v1
    v_cmp_gt_u32 vcc, 8, v0
    v_cndmask_b32 v8, v9, v8, vcc
    v_cmp_gt_u32 vcc, 38, v0
    s_and_saveexec_b64 s[32:33], vcc
    ds_write_b128 v8, v[16:19]
    s_mov_b64 exec, s[32:33]
    v_lshrrev_b32 v28, 3, v25
    v_sub_u32 v28, v26, v28
    v_lshlrev_b32 v15, 4, v28
    v_sub_u32 v28, 7, v25
    v_and_b32 v28, 7, v28
    v_mul_u32_u24 v28, 4160, v28
    v_add_u32 v15, v15, v28
    s_lshl_b32 s31, s40, 6
    s_sub_u32 s35, 208, s31
    v_add_u32 v15, s35, v15
    v_lshlrev_b32 v28, 5, v25
    v_lshl_add_u32 v28, v26, 4, v28
    s_sub_u32 s35, 33472, s31
    v_add_u32 v28, s35, v28
    v_mul_u32_u24 v29, 80, v25
    v_lshl_add_u32 v29, v26, 4, v29
    s_mul_i32 s35, s40, 10240
    v_add_u32 v29, s35, v29
    s_waitcnt vmcnt(5)
    v_mov_b32 v40, v33
    v_mov_b32 v41, v34
    v_mov_b32 v42, v35
    v_mov_b32 v43, v36
    v_mov_b32 v44, v37
    v_mov_b32 v45, v38
    v_mov_b32 v46, v39
    v_alignbit_b32 v48, v33, v32, 16
    v_alignbit_b32 v49, v34, v33, 16
    v_alignbit_b32 v50, v35, v34, 16
    v_alignbit_b32 v51, v36, v35, 16
    v_alignbit_b32 v52, v37, v36, 16
    v_alignbit_b32 v53, v38, v37, 16
    v_alignbit_b32 v54, v39, v38, 16
    v_mov_b32 v56, v49
    v_mov_b32 v57, v50
    v_mov_b32 v58, v51
    v_mov_b32 v59, v52
    v_mov_b32 v60, v53
    v_mov_b32 v61, v54
    ds_write_b128 v1, v[32:35] offset:0
    ds_write_b128 v1, v[48:51] offset:4160
    ds_write_b128 v1, v[40:43] offset:8320
    ds_write_b128 v1, v[56:59] offset:12480
    ds_write_b128 v1, v[34:37] offset:16640
    ds_write_b128 v1, v[50:53] offset:20800
    ds_write_b128 v1, v[42:45] offset:24960
    ds_write_b128 v1, v[58:61] offset:29120
    s_waitcnt vmcnt(0)
    v_dot2_f32_bf16 v80, v4, s26, v64
    v_dot2_f32_bf16 v81, v4, s27, v65
    v_dot2_f32_bf16 v82, v5, s26, v66
    v_dot2_f32_bf16 v83, v5, s27, v67
    v_dot2_f32_bf16 v84, v6, s26, v68
    v_dot2_f32_bf16 v85, v6, s27, v69
    v_dot2_f32_bf16 v86, v7, s26, v70
    v_dot2_f32_bf16 v87, v7, s27, v71
    v_cvt_pk_bf16_f32 v8, v80, v81
    v_cvt_pk_bf16_f32 v9, v82, v83
    v_cvt_pk_bf16_f32 v10, v84, v85
    v_cvt_pk_bf16_f32 v11, v86, v87
    v_lshlrev_b32 v80, 16, v8
    v_and_b32 v81, 0xffff0000, v8
    v_lshlrev_b32 v82, 16, v9
    v_and_b32 v83, 0xffff0000, v9
    v_lshlrev_b32 v84, 16, v10
    v_and_b32 v85, 0xffff0000, v10
    v_lshlrev_b32 v86, 16, v11
    v_and_b32 v87, 0xffff0000, v11
    v_pk_mul_f32 v[80:81], v[80:81], v[72:73]
    v_pk_mul_f32 v[82:83], v[82:83], v[74:75]
    v_pk_mul_f32 v[84:85], v[84:85], v[76:77]
    v_pk_mul_f32 v[86:87], v[86:87], v[78:79]
    v_cvt_pk_bf16_f32 v8, v80, v81
    v_cvt_pk_bf16_f32 v9, v82, v83
    v_cvt_pk_bf16_f32 v10, v84, v85
    v_cvt_pk_bf16_f32 v11, v86, v87
    ds_write_b128 v1, v[8:11] offset:33760
    s_cmp_ge_u32 s2, 640
    s_cbranch_scc1 conv2_kernel_ar1
    s_lshl_b32 s34, s2, 12
    s_add_u32 s36, s6, 0x1180000
    s_addc_u32 s37, s7, 0
    s_mov_b32 s38, 0x280000
    s_mov_b32 s39, 0x00020000
    v_mov_b32 v20, -1
    v_mov_b32 v21, -1
    v_mov_b32 v22, -1
    v_mov_b32 v23, -1
    buffer_store_dwordx4 v[20:23], v1, s[36:39], s34 offen sc0 sc1
    s_cmp_ge_u32 s2, 40
    s_cbranch_scc1 conv2_kernel_ka2
    s_add_u32 s36, s6, 0x1400000
    s_addc_u32 s37, s7, 0
    s_mov_b32 s38, 0x28000
    s_mov_b32 s39, 0x00020000
    buffer_store_dwordx4 v[20:23], v1, s[36:39], s34 offen sc0 sc1
conv2_kernel_ka2:
    s_add_u32 s36, s6, 0xd00000
    s_addc_u32 s37, s7, 0
    s_mov_b32 s38, 0xdc000
    s_mov_b32 s39, 0x00020000
    s_lshr_b32 s31, s2, 3
    s_mul_i32 s31, s31, 11264
    v_cmp_gt_u32 vcc, 176, v0
    s_and_saveexec_b64 s[32:33], vcc
    buffer_load_dword v12, v2, s[36:39], s31 offen
    s_mov_b64 exec, s[32:33]
    s_branch conv2_kernel_ar23
conv2_kernel_ar1:
    s_cmp_ge_u32 s2, 656
    s_cbranch_scc1 conv2_kernel_ar23
conv2_kernel_ar23:
    s_lshl_b32 s28, s3, 6
    s_xor_b32 s31, s40, s2
    s_bitcmp1_b32 s31, 0
    s_cselect_b32 s42, 0, -1
    s_cselect_b32 s43, -1, 0
    s_cmp_lt_u32 s2, 512
    s_cselect_b32 s42, -1, s42
    s_cselect_b32 s43, -1, s43
    s_waitcnt expcnt(0) lgkmcnt(0)
    v_mov_b32 v1, v28
    v_mov_b32 v2, v29
    s_barrier
    s_cmp_ge_u32 s2, 512
    s_cbranch_scc1 conv2_kernel_half4
    ds_read_b128 v[16:19], v15 offset:0
    ds_read_b128 v[32:35], v1 offset:0
    ds_read_b128 v[20:23], v15 offset:256
    ds_read_b128 v[36:39], v1 offset:256
    ds_read_b128 v[24:27], v15 offset:512
    ds_read_b128 v[40:43], v1 offset:512
    ds_read_b128 v[44:47], v1 offset:768
    ds_read_b128 v[48:51], v1 offset:1024
    ds_read_b128 v[52:55], v1 offset:1280
    s_waitcnt lgkmcnt(7)
    v_mfma_f32_16x16x32_bf16 v[124:127], v[16:19], v[32:35], 0
    ds_read_b128 v[28:31], v15 offset:768
    ds_read_b128 v[56:59], v1 offset:1536
    s_waitcnt lgkmcnt(7)
    v_mfma_f32_16x16x32_bf16 v[124:127], v[20:23], v[36:39], v[124:127]
    ds_read_b128 v[16:19], v15 offset:1024
    ds_read_b128 v[60:63], v1 offset:1792
    s_waitcnt lgkmcnt(7)
    v_mfma_f32_16x16x32_bf16 v[120:123], v[24:27], v[32:35], 0
    ds_read_b128 v[20:23], v15 offset:1280
    ds_read_b128 v[64:67], v1 offset:2048
    v_mfma_f32_16x16x32_bf16 v[124:127], v[24:27], v[40:43], v[124:127]
    s_waitcnt lgkmcnt(5)
    v_mfma_f32_16x16x32_bf16 v[120:123], v[28:31], v[36:39], v[120:123]
    ds_read_b128 v[24:27], v15 offset:1536
    ds_read_b128 v[68:71], v1 offset:2304
    v_mfma_f32_16x16x32_bf16 v[124:127], v[28:31], v[44:47], v[124:127]
    s_waitcnt lgkmcnt(5)
    v_mfma_f32_16x16x32_bf16 v[116:119], v[16:19], v[32:35], 0
    ds_read_b128 v[28:31], v15 offset:1792
    ds_read_b128 v[72:75], v1 offset:2560
    v_mfma_f32_16x16x32_bf16 v[120:123], v[16:19], v[40:43], v[120:123]
    v_mfma_f32_16x16x32_bf16 v[124:127], v[16:19], v[48:51], v[124:127]
    s_waitcnt lgkmcnt(5)
    v_mfma_f32_16x16x32_bf16 v[116:119], v[20:23], v[36:39], v[116:119]
    ds_read_b128 v[16:19], v15 offset:2048
    ds_read_b128 v[76:79], v1 offset:2816
    v_mfma_f32_16x16x32_bf16 v[120:123], v[20:23], v[44:47], v[120:123]
    v_mfma_f32_16x16x32_bf16 v[124:127], v[20:23], v[52:55], v[124:127]
    s_waitcnt lgkmcnt(5)
    v_mfma_f32_16x16x32_bf16 v[112:115], v[24:27], v[32:35], 0
    ds_read_b128 v[20:23], v15 offset:2304
    ds_read_b128 v[80:83], v1 offset:3072
    v_mfma_f32_16x16x32_bf16 v[116:119], v[24:27], v[40:43], v[116:119]
    v_mfma_f32_16x16x32_bf16 v[120:123], v[24:27], v[48:51], v[120:123]
    v_mfma_f32_16x16x32_bf16 v[124:127], v[24:27], v[56:59], v[124:127]
    s_waitcnt lgkmcnt(5)
    v_mfma_f32_16x16x32_bf16 v[112:115], v[28:31], v[36:39], v[112:115]
    ds_read_b128 v[24:27], v15 offset:2560
    ds_read_b128 v[84:87], v1 offset:3328
    v_mfma_f32_16x16x32_bf16 v[116:119], v[28:31], v[44:47], v[116:119]
    v_mfma_f32_16x16x32_bf16 v[120:123], v[28:31], v[52:55], v[120:123]
    v_mfma_f32_16x16x32_bf16 v[124:127], v[28:31], v[60:63], v[124:127]
    s_waitcnt lgkmcnt(5)
    v_mfma_f32_16x16x32_bf16 v[108:111], v[16:19], v[32:35], 0
    ds_read_b128 v[28:31], v15 offset:2816
    ds_read_b128 v[88:91], v1 offset:3584
    v_mfma_f32_16x16x32_bf16 v[112:115], v[16:19], v[40:43], v[112:115]
    v_mfma_f32_16x16x32_bf16 v[116:119], v[16:19], v[48:51], v[116:119]
    v_mfma_f32_16x16x32_bf16 v[120:123], v[16:19], v[56:59], v[120:123]
    v_mfma_f32_16x16x32_bf16 v[124:127], v[16:19], v[64:67], v[124:127]
    s_waitcnt lgkmcnt(5)
    v_mfma_f32_16x16x32_bf16 v[108:111], v[20:23], v[36:39], v[108:111]
    ds_read_b128 v[16:19], v15 offset:3072
    ds_read_b128 v[92:95], v1 offset:3840
    v_mfma_f32_16x16x32_bf16 v[112:115], v[20:23], v[44:47], v[112:115]
    v_mfma_f32_16x16x32_bf16 v[116:119], v[20:23], v[52:55], v[116:119]
    v_mfma_f32_16x16x32_bf16 v[120:123], v[20:23], v[60:63], v[120:123]
    v_mfma_f32_16x16x32_bf16 v[124:127], v[20:23], v[68:71], v[124:127]
    s_waitcnt lgkmcnt(5)
    v_mfma_f32_16x16x32_bf16 v[104:107], v[24:27], v[32:35], 0
    ds_read_b128 v[20:23], v15 offset:3328
    v_mfma_f32_16x16x32_bf16 v[108:111], v[24:27], v[40:43], v[108:111]
    v_mfma_f32_16x16x32_bf16 v[112:115], v[24:27], v[48:51], v[112:115]
    v_mfma_f32_16x16x32_bf16 v[116:119], v[24:27], v[56:59], v[116:119]
    v_mfma_f32_16x16x32_bf16 v[120:123], v[24:27], v[64:67], v[120:123]
    v_mfma_f32_16x16x32_bf16 v[124:127], v[24:27], v[72:75], v[124:127]
    s_waitcnt lgkmcnt(4)
    v_mfma_f32_16x16x32_bf16 v[104:107], v[28:31], v[36:39], v[104:107]
    ds_read_b128 v[24:27], v15 offset:3584
    v_mfma_f32_16x16x32_bf16 v[108:111], v[28:31], v[44:47], v[108:111]
    v_mfma_f32_16x16x32_bf16 v[112:115], v[28:31], v[52:55], v[112:115]
    v_mfma_f32_16x16x32_bf16 v[116:119], v[28:31], v[60:63], v[116:119]
    v_mfma_f32_16x16x32_bf16 v[120:123], v[28:31], v[68:71], v[120:123]
    v_mfma_f32_16x16x32_bf16 v[124:127], v[28:31], v[76:79], v[124:127]
    s_waitcnt lgkmcnt(3)
    v_mfma_f32_16x16x32_bf16 v[100:103], v[16:19], v[32:35], 0
    ds_read_b128 v[28:31], v15 offset:3840
    v_mfma_f32_16x16x32_bf16 v[104:107], v[16:19], v[40:43], v[104:107]
    v_mfma_f32_16x16x32_bf16 v[108:111], v[16:19], v[48:51], v[108:111]
    v_mfma_f32_16x16x32_bf16 v[112:115], v[16:19], v[56:59], v[112:115]
    v_mfma_f32_16x16x32_bf16 v[116:119], v[16:19], v[64:67], v[116:119]
    v_mfma_f32_16x16x32_bf16 v[120:123], v[16:19], v[72:75], v[120:123]
    v_mfma_f32_16x16x32_bf16 v[124:127], v[16:19], v[80:83], v[124:127]
    s_waitcnt lgkmcnt(2)
    v_mfma_f32_16x16x32_bf16 v[100:103], v[20:23], v[36:39], v[100:103]
    v_mfma_f32_16x16x32_bf16 v[104:107], v[20:23], v[44:47], v[104:107]
    v_mfma_f32_16x16x32_bf16 v[108:111], v[20:23], v[52:55], v[108:111]
    v_mfma_f32_16x16x32_bf16 v[112:115], v[20:23], v[60:63], v[112:115]
    v_mfma_f32_16x16x32_bf16 v[116:119], v[20:23], v[68:71], v[116:119]
    v_mfma_f32_16x16x32_bf16 v[120:123], v[20:23], v[76:79], v[120:123]
    v_mfma_f32_16x16x32_bf16 v[124:127], v[20:23], v[84:87], v[124:127]
    s_waitcnt lgkmcnt(1)
    v_mfma_f32_16x16x32_bf16 v[96:99], v[24:27], v[32:35], 0
    v_mfma_f32_16x16x32_bf16 v[100:103], v[24:27], v[40:43], v[100:103]
    v_mfma_f32_16x16x32_bf16 v[104:107], v[24:27], v[48:51], v[104:107]
    v_mfma_f32_16x16x32_bf16 v[108:111], v[24:27], v[56:59], v[108:111]
    v_mfma_f32_16x16x32_bf16 v[112:115], v[24:27], v[64:67], v[112:115]
    v_mfma_f32_16x16x32_bf16 v[116:119], v[24:27], v[72:75], v[116:119]
    v_mfma_f32_16x16x32_bf16 v[120:123], v[24:27], v[80:83], v[120:123]
    v_mfma_f32_16x16x32_bf16 v[124:127], v[24:27], v[88:91], v[124:127]
    s_waitcnt lgkmcnt(0)
    v_mfma_f32_16x16x32_bf16 v[96:99], v[28:31], v[36:39], v[96:99]
    v_mfma_f32_16x16x32_bf16 v[100:103], v[28:31], v[44:47], v[100:103]
    v_mfma_f32_16x16x32_bf16 v[104:107], v[28:31], v[52:55], v[104:107]
    v_mfma_f32_16x16x32_bf16 v[108:111], v[28:31], v[60:63], v[108:111]
    v_mfma_f32_16x16x32_bf16 v[112:115], v[28:31], v[68:71], v[112:115]
    v_mfma_f32_16x16x32_bf16 v[116:119], v[28:31], v[76:79], v[116:119]
    v_mfma_f32_16x16x32_bf16 v[120:123], v[28:31], v[84:87], v[120:123]
    v_mfma_f32_16x16x32_bf16 v[124:127], v[28:31], v[92:95], v[124:127]
    s_barrier
    s_nop 7
    ds_write_b128 v2, v[96:99] offset:0
    ds_write_b128 v2, v[100:103] offset:1280
    ds_write_b128 v2, v[104:107] offset:2560
    ds_write_b128 v2, v[108:111] offset:3840
    ds_write_b128 v2, v[112:115] offset:5120
    ds_write_b128 v2, v[116:119] offset:6400
    ds_write_b128 v2, v[120:123] offset:7680
    ds_write_b128 v2, v[124:127] offset:8960
    s_branch conv2_kernel_halfr6
conv2_kernel_half4:
    s_bitcmp1_b32 s2, 0
    s_cbranch_scc1 conv2_kernel_half15
    ds_read_b128 v[16:19], v15 offset:0
    ds_read_b128 v[32:35], v1 offset:0
    ds_read_b128 v[20:23], v15 offset:256
    ds_read_b128 v[36:39], v1 offset:256
    ds_read_b128 v[24:27], v15 offset:512
    ds_read_b128 v[40:43], v1 offset:512
    ds_read_b128 v[44:47], v1 offset:768
    ds_read_b128 v[48:51], v1 offset:1024
    ds_read_b128 v[52:55], v1 offset:1280
    s_waitcnt lgkmcnt(7)
    v_mfma_f32_16x16x32_bf16 v[108:111], v[16:19], v[32:35], 0
    ds_read_b128 v[28:31], v15 offset:768
    ds_read_b128 v[56:59], v1 offset:1536
    s_waitcnt lgkmcnt(7)
    v_mfma_f32_16x16x32_bf16 v[108:111], v[20:23], v[36:39], v[108:111]
    ds_read_b128 v[16:19], v15 offset:1024
    ds_read_b128 v[60:63], v1 offset:1792
    s_waitcnt lgkmcnt(7)
    v_mfma_f32_16x16x32_bf16 v[108:111], v[24:27], v[40:43], v[108:111]
    ds_read_b128 v[20:23], v15 offset:1280
    ds_read_b128 v[64:67], v1 offset:2048
    s_waitcnt lgkmcnt(5)
    v_mfma_f32_16x16x32_bf16 v[108:111], v[28:31], v[44:47], v[108:111]
    ds_read_b128 v[24:27], v15 offset:1536
    ds_read_b128 v[68:71], v1 offset:2304
    s_waitcnt lgkmcnt(5)
    v_mfma_f32_16x16x32_bf16 v[108:111], v[16:19], v[48:51], v[108:111]
    ds_read_b128 v[28:31], v15 offset:1792
    ds_read_b128 v[72:75], v1 offset:2560
    s_waitcnt lgkmcnt(5)
    v_mfma_f32_16x16x32_bf16 v[108:111], v[20:23], v[52:55], v[108:111]
    ds_read_b128 v[16:19], v15 offset:2048
    ds_read_b128 v[76:79], v1 offset:2816
    s_waitcnt lgkmcnt(5)
    v_mfma_f32_16x16x32_bf16 v[104:107], v[24:27], v[32:35], 0
    ds_read_b128 v[20:23], v15 offset:2304
    ds_read_b128 v[80:83], v1 offset:3072
    v_mfma_f32_16x16x32_bf16 v[108:111], v[24:27], v[56:59], v[108:111]
    s_waitcnt lgkmcnt(5)
    v_mfma_f32_16x16x32_bf16 v[104:107], v[28:31], v[36:39], v[104:107]
    ds_read_b128 v[24:27], v15 offset:2560
    ds_read_b128 v[84:87], v1 offset:3328
    v_mfma_f32_16x16x32_bf16 v[108:111], v[28:31], v[60:63], v[108:111]
    s_waitcnt lgkmcnt(5)
    v_mfma_f32_16x16x32_bf16 v[100:103], v[16:19], v[32:35], 0
    ds_read_b128 v[28:31], v15 offset:2816
    ds_read_b128 v[88:91], v1 offset:3584
    v_mfma_f32_16x16x32_bf16 v[104:107], v[16:19], v[40:43], v[104:107]
    v_mfma_f32_16x16x32_bf16 v[108:111], v[16:19], v[64:67], v[108:111]
    s_waitcnt lgkmcnt(5)
    v_mfma_f32_16x16x32_bf16 v[100:103], v[20:23], v[36:39], v[100:103]
    ds_read_b128 v[16:19], v15 offset:3072
    ds_read_b128 v[92:95], v1 offset:3840
    v_mfma_f32_16x16x32_bf16 v[104:107], v[20:23], v[44:47], v[104:107]
    v_mfma_f32_16x16x32_bf16 v[108:111], v[20:23], v[68:71], v[108:111]
    s_waitcnt lgkmcnt(5)
    v_mfma_f32_16x16x32_bf16 v[100:103], v[24:27], v[40:43], v[100:103]
    ds_read_b128 v[20:23], v15 offset:3328
    v_mfma_f32_16x16x32_bf16 v[104:107], v[24:27], v[48:51], v[104:107]
    v_mfma_f32_16x16x32_bf16 v[108:111], v[24:27], v[72:75], v[108:111]
    s_waitcnt lgkmcnt(4)
    v_mfma_f32_16x16x32_bf16 v[100:103], v[28:31], v[44:47], v[100:103]
    ds_read_b128 v[24:27], v15 offset:3584
    v_mfma_f32_16x16x32_bf16 v[104:107], v[28:31], v[52:55], v[104:107]
    v_mfma_f32_16x16x32_bf16 v[108:111], v[28:31], v[76:79], v[108:111]
    s_waitcnt lgkmcnt(3)
    v_mfma_f32_16x16x32_bf16 v[100:103], v[16:19], v[48:51], v[100:103]
    ds_read_b128 v[28:31], v15 offset:3840
    v_mfma_f32_16x16x32_bf16 v[104:107], v[16:19], v[56:59], v[104:107]
    v_mfma_f32_16x16x32_bf16 v[108:111], v[16:19], v[80:83], v[108:111]
    s_waitcnt lgkmcnt(2)
    v_mfma_f32_16x16x32_bf16 v[100:103], v[20:23], v[52:55], v[100:103]
    v_mfma_f32_16x16x32_bf16 v[104:107], v[20:23], v[60:63], v[104:107]
    v_mfma_f32_16x16x32_bf16 v[108:111], v[20:23], v[84:87], v[108:111]
    s_waitcnt lgkmcnt(1)
    v_mfma_f32_16x16x32_bf16 v[96:99], v[24:27], v[32:35], 0
    v_mfma_f32_16x16x32_bf16 v[100:103], v[24:27], v[56:59], v[100:103]
    v_mfma_f32_16x16x32_bf16 v[104:107], v[24:27], v[64:67], v[104:107]
    v_mfma_f32_16x16x32_bf16 v[108:111], v[24:27], v[88:91], v[108:111]
    s_waitcnt lgkmcnt(0)
    v_mfma_f32_16x16x32_bf16 v[96:99], v[28:31], v[36:39], v[96:99]
    v_mfma_f32_16x16x32_bf16 v[100:103], v[28:31], v[60:63], v[100:103]
    v_mfma_f32_16x16x32_bf16 v[104:107], v[28:31], v[68:71], v[104:107]
    v_mfma_f32_16x16x32_bf16 v[108:111], v[28:31], v[92:95], v[108:111]
    s_barrier
    s_nop 7
    ds_write_b128 v2, v[96:99] offset:0
    ds_write_b128 v2, v[100:103] offset:3840
    ds_write_b128 v2, v[104:107] offset:5120
    ds_write_b128 v2, v[108:111] offset:8960
    s_branch conv2_kernel_halfr6
conv2_kernel_half15:
    ds_read_b128 v[16:19], v15 offset:512
    ds_read_b128 v[32:35], v1 offset:0
    ds_read_b128 v[20:23], v15 offset:768
    ds_read_b128 v[36:39], v1 offset:256
    ds_read_b128 v[24:27], v15 offset:1024
    ds_read_b128 v[40:43], v1 offset:512
    ds_read_b128 v[44:47], v1 offset:768
    ds_read_b128 v[48:51], v1 offset:1024
    ds_read_b128 v[52:55], v1 offset:1280
    s_waitcnt lgkmcnt(7)
    v_mfma_f32_16x16x32_bf16 v[108:111], v[16:19], v[32:35], 0
    ds_read_b128 v[28:31], v15 offset:1280
    ds_read_b128 v[56:59], v1 offset:1536
    s_waitcnt lgkmcnt(7)
    v_mfma_f32_16x16x32_bf16 v[108:111], v[20:23], v[36:39], v[108:111]
    ds_read_b128 v[16:19], v15 offset:1536
    ds_read_b128 v[60:63], v1 offset:1792
    s_waitcnt lgkmcnt(7)
    v_mfma_f32_16x16x32_bf16 v[104:107], v[24:27], v[32:35], 0
    ds_read_b128 v[20:23], v15 offset:1792
    ds_read_b128 v[64:67], v1 offset:2048
    v_mfma_f32_16x16x32_bf16 v[108:111], v[24:27], v[40:43], v[108:111]
    s_waitcnt lgkmcnt(5)
    v_mfma_f32_16x16x32_bf16 v[104:107], v[28:31], v[36:39], v[104:107]
    ds_read_b128 v[24:27], v15 offset:2048
    ds_read_b128 v[68:71], v1 offset:2304
    v_mfma_f32_16x16x32_bf16 v[108:111], v[28:31], v[44:47], v[108:111]
    s_waitcnt lgkmcnt(5)
    v_mfma_f32_16x16x32_bf16 v[104:107], v[16:19], v[40:43], v[104:107]
    ds_read_b128 v[28:31], v15 offset:2304
    ds_read_b128 v[72:75], v1 offset:2560
    v_mfma_f32_16x16x32_bf16 v[108:111], v[16:19], v[48:51], v[108:111]
    s_waitcnt lgkmcnt(5)
    v_mfma_f32_16x16x32_bf16 v[104:107], v[20:23], v[44:47], v[104:107]
    ds_read_b128 v[16:19], v15 offset:2560
    ds_read_b128 v[76:79], v1 offset:2816
    v_mfma_f32_16x16x32_bf16 v[108:111], v[20:23], v[52:55], v[108:111]
    s_waitcnt lgkmcnt(5)
    v_mfma_f32_16x16x32_bf16 v[104:107], v[24:27], v[48:51], v[104:107]
    ds_read_b128 v[20:23], v15 offset:2816
    ds_read_b128 v[80:83], v1 offset:3072
    v_mfma_f32_16x16x32_bf16 v[108:111], v[24:27], v[56:59], v[108:111]
    s_waitcnt lgkmcnt(5)
    v_mfma_f32_16x16x32_bf16 v[104:107], v[28:31], v[52:55], v[104:107]
    ds_read_b128 v[24:27], v15 offset:3072
    ds_read_b128 v[84:87], v1 offset:3328
    v_mfma_f32_16x16x32_bf16 v[108:111], v[28:31], v[60:63], v[108:111]
    s_waitcnt lgkmcnt(5)
    v_mfma_f32_16x16x32_bf16 v[100:103], v[16:19], v[32:35], 0
    ds_read_b128 v[28:31], v15 offset:3328
    v_mfma_f32_16x16x32_bf16 v[104:107], v[16:19], v[56:59], v[104:107]
    v_mfma_f32_16x16x32_bf16 v[108:111], v[16:19], v[64:67], v[108:111]
    s_waitcnt lgkmcnt(4)
    v_mfma_f32_16x16x32_bf16 v[100:103], v[20:23], v[36:39], v[100:103]
    ds_read_b128 v[16:19], v15 offset:3584
    v_mfma_f32_16x16x32_bf16 v[104:107], v[20:23], v[60:63], v[104:107]
    v_mfma_f32_16x16x32_bf16 v[108:111], v[20:23], v[68:71], v[108:111]
    s_waitcnt lgkmcnt(3)
    v_mfma_f32_16x16x32_bf16 v[96:99], v[24:27], v[32:35], 0
    ds_read_b128 v[20:23], v15 offset:3840
    v_mfma_f32_16x16x32_bf16 v[100:103], v[24:27], v[40:43], v[100:103]
    v_mfma_f32_16x16x32_bf16 v[104:107], v[24:27], v[64:67], v[104:107]
    v_mfma_f32_16x16x32_bf16 v[108:111], v[24:27], v[72:75], v[108:111]
    s_waitcnt lgkmcnt(2)
    v_mfma_f32_16x16x32_bf16 v[96:99], v[28:31], v[36:39], v[96:99]
    v_mfma_f32_16x16x32_bf16 v[100:103], v[28:31], v[44:47], v[100:103]
    v_mfma_f32_16x16x32_bf16 v[104:107], v[28:31], v[68:71], v[104:107]
    v_mfma_f32_16x16x32_bf16 v[108:111], v[28:31], v[76:79], v[108:111]
    s_waitcnt lgkmcnt(1)
    v_mfma_f32_16x16x32_bf16 v[96:99], v[16:19], v[40:43], v[96:99]
    v_mfma_f32_16x16x32_bf16 v[100:103], v[16:19], v[48:51], v[100:103]
    v_mfma_f32_16x16x32_bf16 v[104:107], v[16:19], v[72:75], v[104:107]
    v_mfma_f32_16x16x32_bf16 v[108:111], v[16:19], v[80:83], v[108:111]
    s_waitcnt lgkmcnt(0)
    v_mfma_f32_16x16x32_bf16 v[96:99], v[20:23], v[44:47], v[96:99]
    v_mfma_f32_16x16x32_bf16 v[100:103], v[20:23], v[52:55], v[100:103]
    v_mfma_f32_16x16x32_bf16 v[104:107], v[20:23], v[76:79], v[104:107]
    v_mfma_f32_16x16x32_bf16 v[108:111], v[20:23], v[84:87], v[108:111]
    s_barrier
    s_nop 7
    ds_write_b128 v2, v[96:99] offset:1280
    ds_write_b128 v2, v[100:103] offset:2560
    ds_write_b128 v2, v[104:107] offset:6400
    ds_write_b128 v2, v[108:111] offset:7680
conv2_kernel_halfr6:
    v_lshrrev_b32 v30, 1, v0
    v_mul_u32_u24 v30, 80, v30
    v_and_b32 v31, 1, v0
    v_lshl_add_u32 v30, v31, 5, v30
    v_lshrrev_b32 v28, 2, v0
    v_mul_u32_u24 v28, 40960, v28
    v_and_b32 v31, 3, v0
    v_lshl_add_u32 v28, v31, 4, v28
    s_lshr_b32 s45, s44, 16
    s_and_b32 s44, s44, 0xffff
    s_bitcmp1_b32 s3, 0
    s_cselect_b32 s44, s45, s44
    s_lshl_b32 s45, s44, 16
    v_dot2_f32_bf16 v72, v8, s44, 0
    v_dot2_f32_bf16 v73, v8, s45, 0
    v_dot2_f32_bf16 v74, v9, s44, 0
    v_dot2_f32_bf16 v75, v9, s45, 0
    v_dot2_f32_bf16 v76, v10, s44, 0
    v_dot2_f32_bf16 v77, v10, s45, 0
    v_dot2_f32_bf16 v78, v11, s44, 0
    v_dot2_f32_bf16 v79, v11, s45, 0
    v_lshlrev_b32 v64, 16, v4
    v_and_b32 v65, 0xffff0000, v4
    v_lshlrev_b32 v66, 16, v5
    v_and_b32 v67, 0xffff0000, v5
    v_lshlrev_b32 v68, 16, v6
    v_and_b32 v69, 0xffff0000, v6
    v_lshlrev_b32 v70, 16, v7
    v_and_b32 v71, 0xffff0000, v7
    v_cvt_pk_bf16_f32 v8, v72, v73
    v_cvt_pk_bf16_f32 v9, v74, v75
    v_cvt_pk_bf16_f32 v10, v76, v77
    v_cvt_pk_bf16_f32 v11, v78, v79
    v_lshlrev_b32 v72, 16, v8
    v_and_b32 v73, 0xffff0000, v8
    v_lshlrev_b32 v74, 16, v9
    v_and_b32 v75, 0xffff0000, v9
    v_lshlrev_b32 v76, 16, v10
    v_and_b32 v77, 0xffff0000, v10
    v_lshlrev_b32 v78, 16, v11
    v_and_b32 v79, 0xffff0000, v11
    s_waitcnt lgkmcnt(0)
    s_barrier
    s_mov_b64 exec, s[42:43]
    ds_read_b128 v[32:35], v30 offset:0
    ds_read_b128 v[36:39], v30 offset:16
    ds_read_b128 v[40:43], v30 offset:10240
    ds_read_b128 v[44:47], v30 offset:10256
    ds_read_b128 v[48:51], v30 offset:20480
    ds_read_b128 v[52:55], v30 offset:20496
    ds_read_b128 v[56:59], v30 offset:30720
    ds_read_b128 v[60:63], v30 offset:30736
    s_waitcnt lgkmcnt(4)
    v_pk_add_f32 v[32:33], v[32:33], v[40:41]
    v_pk_add_f32 v[34:35], v[34:35], v[42:43]
    v_pk_add_f32 v[36:37], v[36:37], v[44:45]
    v_pk_add_f32 v[38:39], v[38:39], v[46:47]
    s_waitcnt lgkmcnt(0)
    v_pk_add_f32 v[48:49], v[48:49], v[56:57]
    v_pk_add_f32 v[50:51], v[50:51], v[58:59]
    v_pk_add_f32 v[52:53], v[52:53], v[60:61]
    v_pk_add_f32 v[54:55], v[54:55], v[62:63]
    v_pk_add_f32 v[32:33], v[32:33], v[48:49]
    v_pk_add_f32 v[34:35], v[34:35], v[50:51]
    v_pk_add_f32 v[36:37], v[36:37], v[52:53]
    v_pk_add_f32 v[38:39], v[38:39], v[54:55]
    v_cvt_pk_bf16_f32 v40, v32, v33
    v_cvt_pk_bf16_f32 v41, v34, v35
    v_cvt_pk_bf16_f32 v42, v36, v37
    v_cvt_pk_bf16_f32 v43, v38, v39
    v_dot2_f32_bf16 v32, v40, s26, v72
    v_dot2_f32_bf16 v33, v40, s27, v73
    v_dot2_f32_bf16 v34, v41, s26, v74
    v_dot2_f32_bf16 v35, v41, s27, v75
    v_dot2_f32_bf16 v36, v42, s26, v76
    v_dot2_f32_bf16 v37, v42, s27, v77
    v_dot2_f32_bf16 v38, v43, s26, v78
    v_dot2_f32_bf16 v39, v43, s27, v79
    v_cvt_pk_bf16_f32 v40, v32, v33
    v_cvt_pk_bf16_f32 v41, v34, v35
    v_cvt_pk_bf16_f32 v42, v36, v37
    v_cvt_pk_bf16_f32 v43, v38, v39
    v_dot2_f32_bf16 v32, v40, s26, v64
    v_dot2_f32_bf16 v33, v40, s27, v65
    v_dot2_f32_bf16 v34, v41, s26, v66
    v_dot2_f32_bf16 v35, v41, s27, v67
    v_dot2_f32_bf16 v36, v42, s26, v68
    v_dot2_f32_bf16 v37, v42, s27, v69
    v_dot2_f32_bf16 v38, v43, s26, v70
    v_dot2_f32_bf16 v39, v43, s27, v71
    s_nop 2
    v_cvt_pk_bf16_f32 v24, v32, v33
    v_cvt_pk_bf16_f32 v25, v34, v35
    v_cvt_pk_bf16_f32 v26, v36, v37
    v_cvt_pk_bf16_f32 v27, v38, v39
    buffer_store_dwordx4 v[24:27], v28, s[12:15], s28 offen sc0 sc1
    s_endpgm
conv2_kernel_end:
    s_endpgm
.globl fused2_kernel
.p2align 8
.type fused2_kernel,@function
fused2_kernel:
    s_cmp_ge_u32 s2, 256
    s_cbranch_scc1 fused2_kernel_end
    s_load_dwordx2 s[6:7], s[0:1], 112
    s_load_dwordx2 s[36:37], s[0:1], 96
    v_lshrrev_b32 v1, 6, v0
    s_nop 0
    v_readfirstlane_b32 s40, v1
    s_and_b32 s5, s2, 7
    s_lshr_b32 s3, s2, 5
    s_lshl_b32 s3, s3, 3
    s_add_u32 s3, s3, s5
    s_bfe_u32 s4, s2, 0x20003
    s_mul_i32 s41, s4, 5
    s_add_u32 s41, s41, s40
    s_cmp_lt_u32 s4, 2
    s_cselect_b32 s42, 1, 0
    s_setprio 3
    s_waitcnt lgkmcnt(0)
    s_add_u32 s48, s6, 0x780000
    s_addc_u32 s49, s7, 0
    s_mov_b32 s50, 0x280000
    s_mov_b32 s51, 0x00020000
    v_and_b32 v5, 3, v0
    v_lshrrev_b32 v6, 2, v0
    v_lshlrev_b32 v7, 4, v0
    s_mul_i32 s26, s3, 40960
    s_add_u32 s27, s26, 0
    buffer_load_dwordx4 v[8:11], v7, s[48:51], s27 offen
    s_add_u32 s27, s26, 8192
    buffer_load_dwordx4 v[12:15], v7, s[48:51], s27 offen
    s_add_u32 s27, s26, 16384
    buffer_load_dwordx4 v[16:19], v7, s[48:51], s27 offen
    s_add_u32 s27, s26, 24576
    buffer_load_dwordx4 v[20:23], v7, s[48:51], s27 offen
    s_add_u32 s27, s26, 32768
    buffer_load_dwordx4 v[24:27], v7, s[48:51], s27 offen
    s_setprio 2
    s_add_u32 s52, s6, 0xd00000
    s_addc_u32 s53, s7, 0
    s_mov_b32 s54, 0xdc000
    s_mov_b32 s55, 0x00020000
    s_add_u32 s56, s6, 0x1400000
    s_addc_u32 s57, s7, 0
    s_mov_b32 s58, 0x28000
    s_mov_b32 s59, 0x00020000
    s_add_u32 s60, s6, 0x1180000
    s_addc_u32 s61, s7, 0
    s_mov_b32 s62, 0x280000
    s_mov_b32 s63, 0x00020000
    s_add_u32 s64, s6, 0xe00000
    s_addc_u32 s65, s7, 0
    s_mov_b32 s66, 0xc8000
    s_mov_b32 s67, 0x00020000
    s_add_u32 s68, s6, 0x1510000
    s_addc_u32 s69, s7, 0
    s_mov_b32 s70, 0x40000
    s_mov_b32 s71, 0x00020000
    s_add_u32 s8, s6, 0x1560000
    s_addc_u32 s9, s7, 0
    s_mov_b32 s10, 0xb00
    s_mov_b32 s11, 0x00020000
    s_mov_b32 s72, s36
    s_mov_b32 s73, s37
    s_mov_b32 s74, 0x280000
    s_mov_b32 s75, 0x00020000
    v_and_b32 v2, 63, v0
    v_lshlrev_b32 v4, 4, v2
    v_lshlrev_b32 v7, 6, v6
    v_lshl_add_u32 v7, v5, 4, v7
    v_add_u32 v7, 122880, v7
    s_add_u32 s43, s3, s40
    s_add_u32 s5, s43, 0
    s_and_b32 s5, s5, 3
    s_lshl_b32 s5, s5, 10
    v_add_u32 v92, s5, v4
    s_add_u32 s5, s43, 1
    s_and_b32 s5, s5, 3
    s_lshl_b32 s5, s5, 10
    v_add_u32 v93, s5, v4
    s_add_u32 s5, s43, 2
    s_and_b32 s5, s5, 3
    s_lshl_b32 s5, s5, 10
    v_add_u32 v94, s5, v4
    s_add_u32 s5, s43, 3
    s_and_b32 s5, s5, 3
    s_lshl_b32 s5, s5, 10
    v_add_u32 v95, s5, v4
    s_mul_i32 s21, s41, 40960
    s_add_u32 s20, s21, 40960
    s_mov_b32 s22, 0
    s_lshl_b32 s35, s22, 12
    s_add_u32 s27, s21, s35
    s_sub_u32 s22, 10, s22
    s_cmp_eq_u32 s42, 1
    s_cbranch_scc1 fused2_kernel_kv01
    s_cmp_ge_u32 s40, 5
    s_cbranch_scc1 fused2_kernel_nq3
    s_setprio 0
    buffer_load_dwordx4 v[96:99], v92, s[52:55], s27 offen
    buffer_load_dwordx4 v[100:103], v93, s[52:55], s27 offen
    buffer_load_dwordx4 v[104:107], v94, s[52:55], s27 offen
    buffer_load_dwordx4 v[108:111], v95, s[52:55], s27 offen
    s_add_u32 s27, s27, 4096
    s_cmp_eq_u32 s27, s20
    s_cselect_b32 s27, s21, s27
    s_setprio 3
    s_waitcnt vmcnt(8)
    ds_write_b128 v7, v[8:11] offset:0
    s_waitcnt vmcnt(7)
    ds_write_b128 v7, v[12:15] offset:8192
    s_waitcnt vmcnt(6)
    ds_write_b128 v7, v[16:19] offset:16384
    s_waitcnt vmcnt(5)
    ds_write_b128 v7, v[20:23] offset:24576
    s_waitcnt vmcnt(4)
    ds_write_b128 v7, v[24:27] offset:32768
    s_branch fused2_kernel_j02
fused2_kernel_nq3:
    s_setprio 3
    s_waitcnt vmcnt(4)
    ds_write_b128 v7, v[8:11] offset:0
    s_waitcnt vmcnt(3)
    ds_write_b128 v7, v[12:15] offset:8192
    s_waitcnt vmcnt(2)
    ds_write_b128 v7, v[16:19] offset:16384
    s_waitcnt vmcnt(1)
    ds_write_b128 v7, v[20:23] offset:24576
    s_waitcnt vmcnt(0)
    ds_write_b128 v7, v[24:27] offset:32768
    s_branch fused2_kernel_j02
fused2_kernel_kv01:
    s_add_u32 s5, s4, 20
    s_mul_i32 s5, s5, 40960
    s_lshl_b32 s28, s40, 10
    s_add_u32 s5, s5, s28
    buffer_load_dwordx4 v[32:35], v4, s[52:55], s5 offen
    s_add_u32 s5, s5, 8192
    buffer_load_dwordx4 v[36:39], v4, s[52:55], s5 offen
    s_add_u32 s5, s5, 8192
    buffer_load_dwordx4 v[40:43], v4, s[52:55], s5 offen
    s_add_u32 s5, s5, 8192
    buffer_load_dwordx4 v[44:47], v4, s[52:55], s5 offen
    s_add_u32 s5, s5, 8192
    buffer_load_dwordx4 v[48:51], v4, s[52:55], s5 offen
    s_cmp_ge_u32 s40, 5
    s_cbranch_scc1 fused2_kernel_nq4
    s_setprio 0
    buffer_load_dwordx4 v[96:99], v92, s[52:55], s27 offen
    buffer_load_dwordx4 v[100:103], v93, s[52:55], s27 offen
    buffer_load_dwordx4 v[104:107], v94, s[52:55], s27 offen
    buffer_load_dwordx4 v[108:111], v95, s[52:55], s27 offen
    s_add_u32 s27, s27, 4096
    s_cmp_eq_u32 s27, s20
    s_cselect_b32 s27, s21, s27
    s_setprio 3
    s_waitcnt vmcnt(13)
    ds_write_b128 v7, v[8:11] offset:0
    s_waitcnt vmcnt(12)
    ds_write_b128 v7, v[12:15] offset:8192
    s_waitcnt vmcnt(11)
    ds_write_b128 v7, v[16:19] offset:16384
    s_waitcnt vmcnt(10)
    ds_write_b128 v7, v[20:23] offset:24576
    s_waitcnt vmcnt(9)
    ds_write_b128 v7, v[24:27] offset:32768
    s_waitcnt vmcnt(4)
    s_branch fused2_kernel_j02
fused2_kernel_nq4:
    v_bfe_u32 v3, v2, 5, 1
    v_lshlrev_b32 v6, 4, v3
    s_mov_b32 s5, 2560
    buffer_load_dwordx4 v[224:227], v6, s[8:11], s5 offen offset:0
    buffer_load_dwordx4 v[228:231], v6, s[8:11], s5 offen offset:32
    buffer_load_dwordx4 v[232:235], v6, s[8:11], s5 offen offset:64
    buffer_load_dwordx4 v[236:239], v6, s[8:11], s5 offen offset:96
    v_and_b32 v6, 31, v0
    v_lshlrev_b32 v6, 2, v6
    buffer_load_dword v240, v6, s[8:11], 0 offen offset:2688
    s_setprio 3
    s_waitcnt vmcnt(14)
    ds_write_b128 v7, v[8:11] offset:0
    s_waitcnt vmcnt(13)
    ds_write_b128 v7, v[12:15] offset:8192
    s_waitcnt vmcnt(12)
    ds_write_b128 v7, v[16:19] offset:16384
    s_waitcnt vmcnt(11)
    ds_write_b128 v7, v[20:23] offset:24576
    s_waitcnt vmcnt(10)
    ds_write_b128 v7, v[24:27] offset:32768
    s_waitcnt vmcnt(5)
    s_branch fused2_kernel_j02
fused2_kernel_j02:
    v_bfe_u32 v3, v2, 5, 1
    v_bfe_u32 v5, v2, 2, 2
    v_lshl_add_u32 v5, v3, 3, v5
    v_lshlrev_b32 v5, 6, v5
    v_bfe_u32 v6, v2, 4, 1
    v_lshl_add_u32 v5, v6, 5, v5
    v_and_b32 v6, 3, v2
    v_lshl_add_u32 v5, v6, 3, v5
    v_add_u32 v5, 122880, v5
    v_sub_u32 v6, v5, v4
    v_add_u32 v6, s35, v6
    v_add_u32 v88, v6, v92
    v_add_u32 v89, v6, v93
    v_add_u32 v90, v6, v94
    v_add_u32 v91, v6, v95
    v_lshl_add_u32 v5, v1, 10, v5
    s_waitcnt lgkmcnt(0)
    ds_read_b64_tr_b16 v[8:9], v5 offset:0
    ds_read_b64_tr_b16 v[10:11], v5 offset:256
    ds_read_b64_tr_b16 v[12:13], v5 offset:8192
    ds_read_b64_tr_b16 v[14:15], v5 offset:8448
    ds_read_b64_tr_b16 v[16:17], v5 offset:16384
    ds_read_b64_tr_b16 v[18:19], v5 offset:16640
    ds_read_b64_tr_b16 v[20:21], v5 offset:24576
    ds_read_b64_tr_b16 v[22:23], v5 offset:24832
    ds_read_b64_tr_b16 v[24:25], v5 offset:32768
    ds_read_b64_tr_b16 v[26:27], v5 offset:33024
    s_mov_b32 s5, 0x3f803f80
    v_mov_b32 v72, 0
    v_mov_b32 v73, 0
    v_mov_b32 v74, 0
    v_mov_b32 v75, 0
    s_waitcnt lgkmcnt(0)
    s_cmp_eq_u32 s42, 0
    s_cbranch_scc1 fused2_kernel_nkv5
    s_cmp_eq_u32 s4, 1
    s_cbranch_scc1 fused2_kernel_vv6
    v_mfma_f32_32x32x16_bf16 v[56:71], v[32:35], v[8:11], 0
    v_mfma_f32_32x32x16_bf16 v[56:71], v[36:39], v[12:15], v[56:71]
    v_mfma_f32_32x32x16_bf16 v[56:71], v[40:43], v[16:19], v[56:71]
    v_mfma_f32_32x32x16_bf16 v[56:71], v[44:47], v[20:23], v[56:71]
    v_mfma_f32_32x32x16_bf16 v[56:71], v[48:51], v[24:27], v[56:71]
    s_branch fused2_kernel_nkv5
fused2_kernel_vv6:
    v_mfma_f32_32x32x16_bf16 v[56:71], v[8:11], v[32:35], 0
    v_mfma_f32_32x32x16_bf16 v[56:71], v[12:15], v[36:39], v[56:71]
    v_mfma_f32_32x32x16_bf16 v[56:71], v[16:19], v[40:43], v[56:71]
    v_mfma_f32_32x32x16_bf16 v[56:71], v[20:23], v[44:47], v[56:71]
    v_mfma_f32_32x32x16_bf16 v[56:71], v[24:27], v[48:51], v[56:71]
fused2_kernel_nkv5:
    s_cmp_ge_u32 s40, 5
    s_cbranch_scc1 fused2_kernel_nm8
    buffer_load_dwordx4 v[112:115], v92, s[52:55], s27 offen
    buffer_load_dwordx4 v[116:119], v93, s[52:55], s27 offen
    buffer_load_dwordx4 v[120:123], v94, s[52:55], s27 offen
    buffer_load_dwordx4 v[124:127], v95, s[52:55], s27 offen
    s_add_u32 s27, s27, 4096
    s_cmp_eq_u32 s27, s20
    s_cselect_b32 s27, s21, s27
    buffer_load_dwordx4 v[128:131], v92, s[52:55], s27 offen
    buffer_load_dwordx4 v[132:135], v93, s[52:55], s27 offen
    buffer_load_dwordx4 v[136:139], v94, s[52:55], s27 offen
    buffer_load_dwordx4 v[140:143], v95, s[52:55], s27 offen
    s_add_u32 s27, s27, 4096
    s_cmp_eq_u32 s27, s20
    s_cselect_b32 s27, s21, s27
fused2_kernel_nm8:
    v_dot2_f32_bf16 v72, v8, s5, v72
    v_dot2_f32_bf16 v73, v8, v8, v73
    v_dot2_f32_bf16 v74, v9, s5, v74
    v_dot2_f32_bf16 v75, v9, v9, v75
    v_dot2_f32_bf16 v72, v10, s5, v72
    v_dot2_f32_bf16 v73, v10, v10, v73
    v_dot2_f32_bf16 v74, v11, s5, v74
    v_dot2_f32_bf16 v75, v11, v11, v75
    v_dot2_f32_bf16 v72, v12, s5, v72
    v_dot2_f32_bf16 v73, v12, v12, v73
    v_dot2_f32_bf16 v74, v13, s5, v74
    v_dot2_f32_bf16 v75, v13, v13, v75
    v_dot2_f32_bf16 v72, v14, s5, v72
    v_dot2_f32_bf16 v73, v14, v14, v73
    v_dot2_f32_bf16 v74, v15, s5, v74
    v_dot2_f32_bf16 v75, v15, v15, v75
    v_dot2_f32_bf16 v72, v16, s5, v72
    v_dot2_f32_bf16 v73, v16, v16, v73
    v_dot2_f32_bf16 v74, v17, s5, v74
    v_dot2_f32_bf16 v75, v17, v17, v75
    v_dot2_f32_bf16 v72, v18, s5, v72
    v_dot2_f32_bf16 v73, v18, v18, v73
    v_dot2_f32_bf16 v74, v19, s5, v74
    v_dot2_f32_bf16 v75, v19, v19, v75
    v_dot2_f32_bf16 v72, v20, s5, v72
    v_dot2_f32_bf16 v73, v20, v20, v73
    v_dot2_f32_bf16 v74, v21, s5, v74
    v_dot2_f32_bf16 v75, v21, v21, v75
    v_dot2_f32_bf16 v72, v22, s5, v72
    v_dot2_f32_bf16 v73, v22, v22, v73
    v_dot2_f32_bf16 v74, v23, s5, v74
    v_dot2_f32_bf16 v75, v23, v23, v75
    v_dot2_f32_bf16 v72, v24, s5, v72
    v_dot2_f32_bf16 v73, v24, v24, v73
    v_dot2_f32_bf16 v74, v25, s5, v74
    v_dot2_f32_bf16 v75, v25, v25, v75
    v_dot2_f32_bf16 v72, v26, s5, v72
    v_dot2_f32_bf16 v73, v26, v26, v73
    v_dot2_f32_bf16 v74, v27, s5, v74
    v_dot2_f32_bf16 v75, v27, v27, v75
    s_nop 4
    v_add_f32 v72, v72, v74
    v_add_f32 v73, v73, v75
    v_mov_b32 v74, v72
    v_mov_b32 v75, v73
    s_nop 1
    v_permlane32_swap_b32 v72, v74
    v_permlane32_swap_b32 v73, v75
    s_nop 1
    v_add_f32 v72, v72, v74
    v_add_f32 v73, v73, v75
    v_and_b32 v74, 31, v0
    v_lshlrev_b32 v74, 3, v74
    v_add_u32 v74, 81920, v74
    v_lshl_add_u32 v75, v1, 8, v74
    ds_write_b64 v75, v[72:73]
    s_cmp_eq_u32 s42, 0
    s_cbranch_scc1 fused2_kernel_kvd7
    v_lshl_add_u32 v6, v1, 12, v4
    v_add_u32 v6, 40960, v6
    ds_write_b128 v6, v[56:59] offset:0
    ds_write_b128 v6, v[60:63] offset:1024
    ds_write_b128 v6, v[64:67] offset:2048
    ds_write_b128 v6, v[68:71] offset:3072
fused2_kernel_kvd7:
    s_waitcnt lgkmcnt(0)
    s_barrier
    s_cmp_ge_u32 s40, 6
    s_cbranch_scc1 fused2_kernel_poll9
    s_cmp_eq_u32 s40, 5
    s_cbranch_scc1 fused2_kernel_red14
    s_setprio 0
    buffer_load_dwordx4 v[144:147], v92, s[52:55], s27 offen
    buffer_load_dwordx4 v[148:151], v93, s[52:55], s27 offen
    buffer_load_dwordx4 v[152:155], v94, s[52:55], s27 offen
    buffer_load_dwordx4 v[156:159], v95, s[52:55], s27 offen
    s_add_u32 s27, s27, 4096
    s_cmp_eq_u32 s27, s20
    s_cselect_b32 s27, s21, s27
    buffer_load_dwordx4 v[160:163], v92, s[52:55], s27 offen
    buffer_load_dwordx4 v[164:167], v93, s[52:55], s27 offen
    buffer_load_dwordx4 v[168:171], v94, s[52:55], s27 offen
    buffer_load_dwordx4 v[172:175], v95, s[52:55], s27 offen
    s_add_u32 s27, s27, 4096
    s_cmp_eq_u32 s27, s20
    s_cselect_b32 s27, s21, s27
    v_lshlrev_b32 v6, 4, v3
    s_lshl_b32 s5, s41, 7
    buffer_load_dwordx4 v[32:35], v6, s[8:11], s5 offen offset:0
    buffer_load_dwordx4 v[36:39], v6, s[8:11], s5 offen offset:32
    buffer_load_dwordx4 v[40:43], v6, s[8:11], s5 offen offset:64
    buffer_load_dwordx4 v[44:47], v6, s[8:11], s5 offen offset:96
    ds_read_b64 v[56:57], v74 offset:0
    ds_read_b64 v[58:59], v74 offset:256
    ds_read_b64 v[60:61], v74 offset:512
    ds_read_b64 v[62:63], v74 offset:768
    ds_read_b64 v[64:65], v74 offset:1024
    ds_read_b64 v[66:67], v74 offset:1280
    ds_read_b64 v[68:69], v74 offset:1536
    ds_read_b64 v[70:71], v74 offset:1792
    s_waitcnt lgkmcnt(0)
    v_pk_add_f32 v[56:57], v[56:57], v[58:59]
    v_pk_add_f32 v[60:61], v[60:61], v[62:63]
    v_pk_add_f32 v[64:65], v[64:65], v[66:67]
    v_pk_add_f32 v[68:69], v[68:69], v[70:71]
    v_pk_add_f32 v[56:57], v[56:57], v[60:61]
    v_pk_add_f32 v[64:65], v[64:65], v[68:69]
    v_pk_add_f32 v[56:57], v[56:57], v[64:65]
    v_mul_f32 v48, 0x3acccccd, v56
    v_mul_f32 v49, 0x3acccccd, v57
    v_fma_f32 v49, -v48, v48, v49
    v_max_f32 v49, 0, v49
    v_cvt_pk_bf16_f32 v48, v48, v48
    v_lshlrev_b32 v48, 16, v48
    v_cvt_pk_bf16_f32 v49, v49, v49
    v_lshlrev_b32 v49, 16, v49
    v_add_f32 v49, 0x3727c5ac, v49
    v_cvt_pk_bf16_f32 v49, v49, v49
    v_lshlrev_b32 v49, 16, v49
    v_sqrt_f32 v49, v49
    s_nop 0
    v_cvt_pk_bf16_f32 v49, v49, v49
    v_lshlrev_b32 v49, 16, v49
    v_rcp_f32 v49, v49
    s_nop 0
    v_mul_f32 v49, 0x3ea52b5c, v49
    v_mov_b32 v56, 0
    v_mov_b32 v57, 0
    v_mov_b32 v58, 0
    v_mov_b32 v59, 0
    v_mov_b32 v60, 0
    v_mov_b32 v61, 0
    v_mov_b32 v62, 0
    v_mov_b32 v63, 0
    v_mov_b32 v64, 0
    v_mov_b32 v65, 0
    v_mov_b32 v66, 0
    v_mov_b32 v67, 0
    v_mov_b32 v68, 0
    v_mov_b32 v69, 0
    v_mov_b32 v70, 0
    v_mov_b32 v71, 0
    v_mov_b32 v72, 0
    v_mov_b32 v73, 0
    v_mov_b32 v74, 0
    v_mov_b32 v75, 0
    v_mov_b32 v76, 0
    v_mov_b32 v77, 0
    v_mov_b32 v78, 0
    v_mov_b32 v79, 0
    v_mov_b32 v80, 0
    v_mov_b32 v81, 0
    v_mov_b32 v82, 0
    v_mov_b32 v83, 0
    v_mov_b32 v84, 0
    v_mov_b32 v85, 0
    v_mov_b32 v86, 0
    v_mov_b32 v87, 0
    ds_read_b64_tr_b16 v[8:9], v88 offset:0
    ds_read_b64_tr_b16 v[10:11], v88 offset:256
    ds_read_b64_tr_b16 v[12:13], v89 offset:0
    ds_read_b64_tr_b16 v[14:15], v89 offset:256
    ds_read_b64_tr_b16 v[16:17], v90 offset:0
    ds_read_b64_tr_b16 v[18:19], v90 offset:256
    ds_read_b64_tr_b16 v[20:21], v91 offset:0
    ds_read_b64_tr_b16 v[22:23], v91 offset:256
    s_cmp_eq_u32 s22, 1
    s_cselect_b32 s23, 40960, 0
    v_subrev_u32 v88, s23, v88
    v_subrev_u32 v89, s23, v89
    v_subrev_u32 v90, s23, v90
    v_subrev_u32 v91, s23, v91
    ds_read_b64_tr_b16 v[24:25], v88 offset:4096
    ds_read_b64_tr_b16 v[26:27], v88 offset:4352
    ds_read_b64_tr_b16 v[28:29], v89 offset:4096
    ds_read_b64_tr_b16 v[30:31], v89 offset:4352
    s_waitcnt vmcnt(23) lgkmcnt(10)
    v_mfma_f32_32x32x16_bf16 v[56:71], v[96:99], v[8:11], v[56:71]
    ds_read_b64_tr_b16 v[8:9], v90 offset:4096
    ds_read_b64_tr_b16 v[10:11], v90 offset:4352
    s_waitcnt vmcnt(22) lgkmcnt(10)
    v_mfma_f32_32x32x16_bf16 v[72:87], v[100:103], v[12:15], v[72:87]
    ds_read_b64_tr_b16 v[12:13], v91 offset:4096
    ds_read_b64_tr_b16 v[14:15], v91 offset:4352
    s_waitcnt vmcnt(21) lgkmcnt(10)
    v_mfma_f32_32x32x16_bf16 v[56:71], v[104:107], v[16:19], v[56:71]
    s_cmp_eq_u32 s22, 2
    s_cselect_b32 s23, 40960, 0
    v_subrev_u32 v88, s23, v88
    v_subrev_u32 v89, s23, v89
    v_subrev_u32 v90, s23, v90
    v_subrev_u32 v91, s23, v91
    ds_read_b64_tr_b16 v[16:17], v88 offset:8192
    ds_read_b64_tr_b16 v[18:19], v88 offset:8448
    s_waitcnt vmcnt(20) lgkmcnt(10)
    v_mfma_f32_32x32x16_bf16 v[72:87], v[108:111], v[20:23], v[72:87]
    ds_read_b64_tr_b16 v[20:21], v89 offset:8192
    ds_read_b64_tr_b16 v[22:23], v89 offset:8448
    s_waitcnt vmcnt(19) lgkmcnt(10)
    v_mfma_f32_32x32x16_bf16 v[56:71], v[112:115], v[24:27], v[56:71]
    ds_read_b64_tr_b16 v[24:25], v90 offset:8192
    ds_read_b64_tr_b16 v[26:27], v90 offset:8448
    s_waitcnt vmcnt(18) lgkmcnt(10)
    v_mfma_f32_32x32x16_bf16 v[72:87], v[116:119], v[28:31], v[72:87]
    ds_read_b64_tr_b16 v[28:29], v91 offset:8192
    ds_read_b64_tr_b16 v[30:31], v91 offset:8448
    s_waitcnt vmcnt(17) lgkmcnt(10)
    v_mfma_f32_32x32x16_bf16 v[56:71], v[120:123], v[8:11], v[56:71]
    s_cmp_eq_u32 s22, 3
    s_cselect_b32 s23, 40960, 0
    v_subrev_u32 v88, s23, v88
    v_subrev_u32 v89, s23, v89
    v_subrev_u32 v90, s23, v90
    v_subrev_u32 v91, s23, v91
    ds_read_b64_tr_b16 v[8:9], v88 offset:12288
    ds_read_b64_tr_b16 v[10:11], v88 offset:12544
    s_waitcnt vmcnt(16) lgkmcnt(10)
    v_mfma_f32_32x32x16_bf16 v[72:87], v[124:127], v[12:15], v[72:87]
    ds_read_b64_tr_b16 v[12:13], v89 offset:12288
    ds_read_b64_tr_b16 v[14:15], v89 offset:12544
    s_waitcnt vmcnt(15) lgkmcnt(10)
    v_mfma_f32_32x32x16_bf16 v[56:71], v[128:131], v[16:19], v[56:71]
    ds_read_b64_tr_b16 v[16:17], v90 offset:12288
    ds_read_b64_tr_b16 v[18:19], v90 offset:12544
    s_waitcnt vmcnt(14) lgkmcnt(10)
    v_mfma_f32_32x32x16_bf16 v[72:87], v[132:135], v[20:23], v[72:87]
    ds_read_b64_tr_b16 v[20:21], v91 offset:12288
    ds_read_b64_tr_b16 v[22:23], v91 offset:12544
    s_waitcnt vmcnt(13) lgkmcnt(10)
    v_mfma_f32_32x32x16_bf16 v[56:71], v[136:139], v[24:27], v[56:71]
    s_cmp_eq_u32 s22, 4
    s_cselect_b32 s23, 40960, 0
    v_subrev_u32 v88, s23, v88
    v_subrev_u32 v89, s23, v89
    v_subrev_u32 v90, s23, v90
    v_subrev_u32 v91, s23, v91
    ds_read_b64_tr_b16 v[24:25], v88 offset:16384
    ds_read_b64_tr_b16 v[26:27], v88 offset:16640
    s_waitcnt vmcnt(12) lgkmcnt(10)
    v_mfma_f32_32x32x16_bf16 v[72:87], v[140:143], v[28:31], v[72:87]
    s_cmp_eq_u32 s42, 0
    s_cbranch_scc1 fused2_kernel_qb15
    s_barrier
fused2_kernel_qb15:
    buffer_load_dwordx4 v[176:179], v92, s[52:55], s27 offen
    ds_read_b64_tr_b16 v[28:29], v89 offset:16384
    ds_read_b64_tr_b16 v[30:31], v89 offset:16640
    s_waitcnt vmcnt(12) lgkmcnt(10)
    v_mfma_f32_32x32x16_bf16 v[56:71], v[144:147], v[8:11], v[56:71]
    buffer_load_dwordx4 v[180:183], v93, s[52:55], s27 offen
    ds_read_b64_tr_b16 v[8:9], v90 offset:16384
    ds_read_b64_tr_b16 v[10:11], v90 offset:16640
    s_waitcnt vmcnt(12) lgkmcnt(10)
    v_mfma_f32_32x32x16_bf16 v[72:87], v[148:151], v[12:15], v[72:87]
    buffer_load_dwordx4 v[184:187], v94, s[52:55], s27 offen
    ds_read_b64_tr_b16 v[12:13], v91 offset:16384
    ds_read_b64_tr_b16 v[14:15], v91 offset:16640
    s_waitcnt vmcnt(12) lgkmcnt(10)
    v_mfma_f32_32x32x16_bf16 v[56:71], v[152:155], v[16:19], v[56:71]
    buffer_load_dwordx4 v[188:191], v95, s[52:55], s27 offen
    s_add_u32 s27, s27, 4096
    s_cmp_eq_u32 s27, s20
    s_cselect_b32 s27, s21, s27
    s_cmp_eq_u32 s22, 5
    s_cselect_b32 s23, 40960, 0
    v_subrev_u32 v88, s23, v88
    v_subrev_u32 v89, s23, v89
    v_subrev_u32 v90, s23, v90
    v_subrev_u32 v91, s23, v91
    ds_read_b64_tr_b16 v[16:17], v88 offset:20480
    ds_read_b64_tr_b16 v[18:19], v88 offset:20736
    s_waitcnt vmcnt(12) lgkmcnt(10)
    v_mfma_f32_32x32x16_bf16 v[72:87], v[156:159], v[20:23], v[72:87]
    buffer_load_dwordx4 v[192:195], v92, s[52:55], s27 offen
    ds_read_b64_tr_b16 v[20:21], v89 offset:20480
    ds_read_b64_tr_b16 v[22:23], v89 offset:20736
    s_waitcnt vmcnt(12) lgkmcnt(10)
    v_mfma_f32_32x32x16_bf16 v[56:71], v[160:163], v[24:27], v[56:71]
    buffer_load_dwordx4 v[196:199], v93, s[52:55], s27 offen
    ds_read_b64_tr_b16 v[24:25], v90 offset:20480
    ds_read_b64_tr_b16 v[26:27], v90 offset:20736
    s_waitcnt vmcnt(12) lgkmcnt(10)
    v_mfma_f32_32x32x16_bf16 v[72:87], v[164:167], v[28:31], v[72:87]
    buffer_load_dwordx4 v[200:203], v94, s[52:55], s27 offen
    ds_read_b64_tr_b16 v[28:29], v91 offset:20480
    ds_read_b64_tr_b16 v[30:31], v91 offset:20736
    s_waitcnt vmcnt(12) lgkmcnt(10)
    v_mfma_f32_32x32x16_bf16 v[56:71], v[168:171], v[8:11], v[56:71]
    buffer_load_dwordx4 v[204:207], v95, s[52:55], s27 offen
    s_add_u32 s27, s27, 4096
    s_cmp_eq_u32 s27, s20
    s_cselect_b32 s27, s21, s27
    s_cmp_eq_u32 s22, 6
    s_cselect_b32 s23, 40960, 0
    v_subrev_u32 v88, s23, v88
    v_subrev_u32 v89, s23, v89
    v_subrev_u32 v90, s23, v90
    v_subrev_u32 v91, s23, v91
    ds_read_b64_tr_b16 v[8:9], v88 offset:24576
    ds_read_b64_tr_b16 v[10:11], v88 offset:24832
    s_waitcnt vmcnt(12) lgkmcnt(10)
    v_mfma_f32_32x32x16_bf16 v[72:87], v[172:175], v[12:15], v[72:87]
    buffer_load_dwordx4 v[208:211], v92, s[52:55], s27 offen
    ds_read_b64_tr_b16 v[12:13], v89 offset:24576
    ds_read_b64_tr_b16 v[14:15], v89 offset:24832
    s_waitcnt vmcnt(8) lgkmcnt(10)
    v_mfma_f32_32x32x16_bf16 v[56:71], v[176:179], v[16:19], v[56:71]
    buffer_load_dwordx4 v[212:215], v93, s[52:55], s27 offen
    ds_read_b64_tr_b16 v[16:17], v90 offset:24576
    ds_read_b64_tr_b16 v[18:19], v90 offset:24832
    s_waitcnt vmcnt(8) lgkmcnt(10)
    v_mfma_f32_32x32x16_bf16 v[72:87], v[180:183], v[20:23], v[72:87]
    buffer_load_dwordx4 v[216:219], v94, s[52:55], s27 offen
    ds_read_b64_tr_b16 v[20:21], v91 offset:24576
    ds_read_b64_tr_b16 v[22:23], v91 offset:24832
    s_waitcnt vmcnt(8) lgkmcnt(10)
    v_mfma_f32_32x32x16_bf16 v[56:71], v[184:187], v[24:27], v[56:71]
    buffer_load_dwordx4 v[220:223], v95, s[52:55], s27 offen
    s_add_u32 s27, s27, 4096
    s_cmp_eq_u32 s27, s20
    s_cselect_b32 s27, s21, s27
    s_cmp_eq_u32 s22, 7
    s_cselect_b32 s23, 40960, 0
    v_subrev_u32 v88, s23, v88
    v_subrev_u32 v89, s23, v89
    v_subrev_u32 v90, s23, v90
    v_subrev_u32 v91, s23, v91
    ds_read_b64_tr_b16 v[24:25], v88 offset:28672
    ds_read_b64_tr_b16 v[26:27], v88 offset:28928
    s_waitcnt vmcnt(8) lgkmcnt(10)
    v_mfma_f32_32x32x16_bf16 v[72:87], v[188:191], v[28:31], v[72:87]
    buffer_load_dwordx4 v[224:227], v92, s[52:55], s27 offen
    ds_read_b64_tr_b16 v[28:29], v89 offset:28672
    ds_read_b64_tr_b16 v[30:31], v89 offset:28928
    s_waitcnt vmcnt(8) lgkmcnt(10)
    v_mfma_f32_32x32x16_bf16 v[56:71], v[192:195], v[8:11], v[56:71]
    buffer_load_dwordx4 v[228:231], v93, s[52:55], s27 offen
    ds_read_b64_tr_b16 v[8:9], v90 offset:28672
    ds_read_b64_tr_b16 v[10:11], v90 offset:28928
    s_waitcnt vmcnt(8) lgkmcnt(10)
    v_mfma_f32_32x32x16_bf16 v[72:87], v[196:199], v[12:15], v[72:87]
    buffer_load_dwordx4 v[232:235], v94, s[52:55], s27 offen
    ds_read_b64_tr_b16 v[12:13], v91 offset:28672
    ds_read_b64_tr_b16 v[14:15], v91 offset:28928
    s_waitcnt vmcnt(8) lgkmcnt(10)
    v_mfma_f32_32x32x16_bf16 v[56:71], v[200:203], v[16:19], v[56:71]
    buffer_load_dwordx4 v[236:239], v95, s[52:55], s27 offen
    s_add_u32 s27, s27, 4096
    s_cmp_eq_u32 s27, s20
    s_cselect_b32 s27, s21, s27
    s_cmp_eq_u32 s22, 8
    s_cselect_b32 s23, 40960, 0
    v_subrev_u32 v88, s23, v88
    v_subrev_u32 v89, s23, v89
    v_subrev_u32 v90, s23, v90
    v_subrev_u32 v91, s23, v91
    ds_read_b64_tr_b16 v[16:17], v88 offset:32768
    ds_read_b64_tr_b16 v[18:19], v88 offset:33024
    s_waitcnt vmcnt(8) lgkmcnt(10)
    v_mfma_f32_32x32x16_bf16 v[72:87], v[204:207], v[20:23], v[72:87]
    buffer_load_dwordx4 v[240:243], v92, s[52:55], s27 offen
    ds_read_b64_tr_b16 v[20:21], v89 offset:32768
    ds_read_b64_tr_b16 v[22:23], v89 offset:33024
    s_waitcnt vmcnt(8) lgkmcnt(10)
    v_mfma_f32_32x32x16_bf16 v[56:71], v[208:211], v[24:27], v[56:71]
    buffer_load_dwordx4 v[244:247], v93, s[52:55], s27 offen
    ds_read_b64_tr_b16 v[24:25], v90 offset:32768
    ds_read_b64_tr_b16 v[26:27], v90 offset:33024
    s_waitcnt vmcnt(8) lgkmcnt(10)
    v_mfma_f32_32x32x16_bf16 v[72:87], v[212:215], v[28:31], v[72:87]
    buffer_load_dwordx4 v[248:251], v94, s[52:55], s27 offen
    ds_read_b64_tr_b16 v[28:29], v91 offset:32768
    ds_read_b64_tr_b16 v[30:31], v91 offset:33024
    s_waitcnt vmcnt(8) lgkmcnt(10)
    v_mfma_f32_32x32x16_bf16 v[56:71], v[216:219], v[8:11], v[56:71]
    buffer_load_dwordx4 v[252:255], v95, s[52:55], s27 offen
    s_cmp_eq_u32 s22, 9
    s_cselect_b32 s23, 40960, 0
    v_subrev_u32 v88, s23, v88
    v_subrev_u32 v89, s23, v89
    v_subrev_u32 v90, s23, v90
    v_subrev_u32 v91, s23, v91
    ds_read_b64_tr_b16 v[8:9], v88 offset:36864
    ds_read_b64_tr_b16 v[10:11], v88 offset:37120
    s_waitcnt vmcnt(8) lgkmcnt(10)
    v_mfma_f32_32x32x16_bf16 v[72:87], v[220:223], v[12:15], v[72:87]
    ds_read_b64_tr_b16 v[12:13], v89 offset:36864
    ds_read_b64_tr_b16 v[14:15], v89 offset:37120
    s_waitcnt vmcnt(7) lgkmcnt(10)
    v_mfma_f32_32x32x16_bf16 v[56:71], v[224:227], v[16:19], v[56:71]
    ds_read_b64_tr_b16 v[16:17], v90 offset:36864
    ds_read_b64_tr_b16 v[18:19], v90 offset:37120
    s_waitcnt vmcnt(6) lgkmcnt(10)
    v_mfma_f32_32x32x16_bf16 v[72:87], v[228:231], v[20:23], v[72:87]
    ds_read_b64_tr_b16 v[20:21], v91 offset:36864
    ds_read_b64_tr_b16 v[22:23], v91 offset:37120
    s_waitcnt vmcnt(5) lgkmcnt(10)
    v_mfma_f32_32x32x16_bf16 v[56:71], v[232:235], v[24:27], v[56:71]
    s_waitcnt vmcnt(4) lgkmcnt(8)
    v_mfma_f32_32x32x16_bf16 v[72:87], v[236:239], v[28:31], v[72:87]
    s_waitcnt vmcnt(3) lgkmcnt(6)
    v_mfma_f32_32x32x16_bf16 v[56:71], v[240:243], v[8:11], v[56:71]
    s_waitcnt vmcnt(2) lgkmcnt(4)
    v_mfma_f32_32x32x16_bf16 v[72:87], v[244:247], v[12:15], v[72:87]
    s_waitcnt vmcnt(1) lgkmcnt(2)
    v_mfma_f32_32x32x16_bf16 v[56:71], v[248:251], v[16:19], v[56:71]
    s_waitcnt vmcnt(0) lgkmcnt(0)
    v_mfma_f32_32x32x16_bf16 v[72:87], v[252:255], v[20:23], v[72:87]
    s_nop 15
    s_nop 3
    v_add_f32 v56, v56, v72
    v_add_f32 v57, v57, v73
    v_add_f32 v58, v58, v74
    v_add_f32 v59, v59, v75
    v_add_f32 v60, v60, v76
    v_add_f32 v61, v61, v77
    v_add_f32 v62, v62, v78
    v_add_f32 v63, v63, v79
    v_add_f32 v64, v64, v80
    v_add_f32 v65, v65, v81
    v_add_f32 v66, v66, v82
    v_add_f32 v67, v67, v83
    v_add_f32 v68, v68, v84
    v_add_f32 v69, v69, v85
    v_add_f32 v70, v70, v86
    v_add_f32 v71, v71, v87
    s_waitcnt vmcnt(0)
    v_and_b32 v2, 31, v0
    v_mul_u32_u24 v4, 328, v2
    v_lshl_add_u32 v4, v3, 3, v4
    s_lshl_b32 s29, s40, 6
    s_add_u32 s29, s29, 84224
    v_add_u32 v4, s29, v4
    v_fma_f32 v56, -v48, v32, v56
    v_fma_f32 v57, -v48, v33, v57
    v_fma_f32 v58, -v48, v34, v58
    v_fma_f32 v59, -v48, v35, v59
    v_fma_f32 v60, -v48, v36, v60
    v_fma_f32 v61, -v48, v37, v61
    v_fma_f32 v62, -v48, v38, v62
    v_fma_f32 v63, -v48, v39, v63
    v_fma_f32 v64, -v48, v40, v64
    v_fma_f32 v65, -v48, v41, v65
    v_fma_f32 v66, -v48, v42, v66
    v_fma_f32 v67, -v48, v43, v67
    v_fma_f32 v68, -v48, v44, v68
    v_fma_f32 v69, -v48, v45, v69
    v_fma_f32 v70, -v48, v46, v70
    v_fma_f32 v71, -v48, v47, v71
    v_mul_f32 v56, v49, v56
    v_mul_f32 v57, v49, v57
    v_mul_f32 v58, v49, v58
    v_mul_f32 v59, v49, v59
    v_mul_f32 v60, v49, v60
    v_mul_f32 v61, v49, v61
    v_mul_f32 v62, v49, v62
    v_mul_f32 v63, v49, v63
    v_mul_f32 v64, v49, v64
    v_mul_f32 v65, v49, v65
    v_mul_f32 v66, v49, v66
    v_mul_f32 v67, v49, v67
    v_mul_f32 v68, v49, v68
    v_mul_f32 v69, v49, v69
    v_mul_f32 v70, v49, v70
    v_mul_f32 v71, v49, v71
    v_cvt_pk_bf16_f32 v8, v56, v57
    v_cvt_pk_bf16_f32 v9, v58, v59
    v_cvt_pk_bf16_f32 v10, v60, v61
    v_cvt_pk_bf16_f32 v11, v62, v63
    v_cvt_pk_bf16_f32 v12, v64, v65
    v_cvt_pk_bf16_f32 v13, v66, v67
    v_cvt_pk_bf16_f32 v14, v68, v69
    v_cvt_pk_bf16_f32 v15, v70, v71
    ds_write_b64 v4, v[8:9] offset:0
    ds_write_b64 v4, v[10:11] offset:16
    ds_write_b64 v4, v[12:13] offset:32
    ds_write_b64 v4, v[14:15] offset:48
    s_waitcnt lgkmcnt(0)
    s_branch fused2_kernel_barx10
fused2_kernel_red14:
    s_setprio 3
    s_cmp_eq_u32 s42, 0
    s_cbranch_scc1 fused2_kernel_barx10
    v_and_b32 v2, 31, v0
    ds_read_b64 v[56:57], v74 offset:0
    ds_read_b64 v[58:59], v74 offset:256
    ds_read_b64 v[60:61], v74 offset:512
    ds_read_b64 v[62:63], v74 offset:768
    ds_read_b64 v[64:65], v74 offset:1024
    ds_read_b64 v[66:67], v74 offset:1280
    ds_read_b64 v[68:69], v74 offset:1536
    ds_read_b64 v[70:71], v74 offset:1792
    s_waitcnt lgkmcnt(0)
    v_pk_add_f32 v[56:57], v[56:57], v[58:59]
    v_pk_add_f32 v[60:61], v[60:61], v[62:63]
    v_pk_add_f32 v[64:65], v[64:65], v[66:67]
    v_pk_add_f32 v[68:69], v[68:69], v[70:71]
    v_pk_add_f32 v[56:57], v[56:57], v[60:61]
    v_pk_add_f32 v[64:65], v[64:65], v[68:69]
    v_pk_add_f32 v[56:57], v[56:57], v[64:65]
    v_mul_f32 v48, 0x3acccccd, v56
    v_mul_f32 v49, 0x3acccccd, v57
    v_fma_f32 v49, -v48, v48, v49
    v_max_f32 v49, 0, v49
    v_cvt_pk_bf16_f32 v48, v48, v48
    v_lshlrev_b32 v48, 16, v48
    v_cvt_pk_bf16_f32 v49, v49, v49
    v_lshlrev_b32 v49, 16, v49
    v_add_f32 v49, 0x3727c5ac, v49
    v_cvt_pk_bf16_f32 v49, v49, v49
    v_lshlrev_b32 v49, 16, v49
    v_sqrt_f32 v49, v49
    s_nop 0
    v_cvt_pk_bf16_f32 v49, v49, v49
    v_lshlrev_b32 v49, 16, v49
    v_rcp_f32 v49, v49
    s_nop 0
    v_add_u32 v6, 2048, v74
    ds_write_b64 v6, v[48:49]
    v_add_u32 v6, 40960, v4
    ds_read_b128 v[96:99], v6 offset:0
    ds_read_b128 v[100:103], v6 offset:1024
    ds_read_b128 v[104:107], v6 offset:2048
    ds_read_b128 v[108:111], v6 offset:3072
    ds_read_b128 v[112:115], v6 offset:4096
    ds_read_b128 v[116:119], v6 offset:5120
    ds_read_b128 v[120:123], v6 offset:6144
    ds_read_b128 v[124:127], v6 offset:7168
    s_bfe_u32 s34, s3, 0x20003
    s_mul_i32 s34, s34, 40960
    s_lshr_b32 s35, s3, 5
    s_lshl_b32 s35, s35, 3
    s_and_b32 s31, s3, 7
    s_add_u32 s31, s31, s35
    ds_read_b128 v[128:131], v6 offset:8192
    ds_read_b128 v[132:135], v6 offset:9216
    ds_read_b128 v[136:139], v6 offset:10240
    ds_read_b128 v[140:143], v6 offset:11264
    s_waitcnt lgkmcnt(4)
    v_pk_add_f32 v[96:97], v[96:97], v[112:113]
    v_pk_add_f32 v[98:99], v[98:99], v[114:115]
    v_pk_add_f32 v[100:101], v[100:101], v[116:117]
    v_pk_add_f32 v[102:103], v[102:103], v[118:119]
    v_pk_add_f32 v[104:105], v[104:105], v[120:121]
    v_pk_add_f32 v[106:107], v[106:107], v[122:123]
    v_pk_add_f32 v[108:109], v[108:109], v[124:125]
    v_pk_add_f32 v[110:111], v[110:111], v[126:127]
    ds_read_b128 v[144:147], v6 offset:12288
    ds_read_b128 v[148:151], v6 offset:13312
    ds_read_b128 v[152:155], v6 offset:14336
    ds_read_b128 v[156:159], v6 offset:15360
    s_waitcnt lgkmcnt(4)
    v_pk_add_f32 v[96:97], v[96:97], v[128:129]
    v_pk_add_f32 v[98:99], v[98:99], v[130:131]
    v_pk_add_f32 v[100:101], v[100:101], v[132:133]
    v_pk_add_f32 v[102:103], v[102:103], v[134:135]
    v_pk_add_f32 v[104:105], v[104:105], v[136:137]
    v_pk_add_f32 v[106:107], v[106:107], v[138:139]
    v_pk_add_f32 v[108:109], v[108:109], v[140:141]
    v_pk_add_f32 v[110:111], v[110:111], v[142:143]
    ds_read_b128 v[160:163], v6 offset:16384
    ds_read_b128 v[164:167], v6 offset:17408
    ds_read_b128 v[168:171], v6 offset:18432
    ds_read_b128 v[172:175], v6 offset:19456
    s_waitcnt lgkmcnt(4)
    v_pk_add_f32 v[96:97], v[96:97], v[144:145]
    v_pk_add_f32 v[98:99], v[98:99], v[146:147]
    v_pk_add_f32 v[100:101], v[100:101], v[148:149]
    v_pk_add_f32 v[102:103], v[102:103], v[150:151]
    v_pk_add_f32 v[104:105], v[104:105], v[152:153]
    v_pk_add_f32 v[106:107], v[106:107], v[154:155]
    v_pk_add_f32 v[108:109], v[108:109], v[156:157]
    v_pk_add_f32 v[110:111], v[110:111], v[158:159]
    ds_read_b128 v[176:179], v6 offset:20480
    ds_read_b128 v[180:183], v6 offset:21504
    ds_read_b128 v[184:187], v6 offset:22528
    ds_read_b128 v[188:191], v6 offset:23552
    s_waitcnt lgkmcnt(4)
    v_pk_add_f32 v[96:97], v[96:97], v[160:161]
    v_pk_add_f32 v[98:99], v[98:99], v[162:163]
    v_pk_add_f32 v[100:101], v[100:101], v[164:165]
    v_pk_add_f32 v[102:103], v[102:103], v[166:167]
    v_pk_add_f32 v[104:105], v[104:105], v[168:169]
    v_pk_add_f32 v[106:107], v[106:107], v[170:171]
    v_pk_add_f32 v[108:109], v[108:109], v[172:173]
    v_pk_add_f32 v[110:111], v[110:111], v[174:175]
    ds_read_b128 v[192:195], v6 offset:24576
    ds_read_b128 v[196:199], v6 offset:25600
    ds_read_b128 v[200:203], v6 offset:26624
    ds_read_b128 v[204:207], v6 offset:27648
    s_waitcnt lgkmcnt(4)
    v_pk_add_f32 v[96:97], v[96:97], v[176:177]
    v_pk_add_f32 v[98:99], v[98:99], v[178:179]
    v_pk_add_f32 v[100:101], v[100:101], v[180:181]
    v_pk_add_f32 v[102:103], v[102:103], v[182:183]
    v_pk_add_f32 v[104:105], v[104:105], v[184:185]
    v_pk_add_f32 v[106:107], v[106:107], v[186:187]
    v_pk_add_f32 v[108:109], v[108:109], v[188:189]
    v_pk_add_f32 v[110:111], v[110:111], v[190:191]
    ds_read_b128 v[208:211], v6 offset:28672
    ds_read_b128 v[212:215], v6 offset:29696
    ds_read_b128 v[216:219], v6 offset:30720
    ds_read_b128 v[220:223], v6 offset:31744
    s_waitcnt lgkmcnt(4)
    v_pk_add_f32 v[96:97], v[96:97], v[192:193]
    v_pk_add_f32 v[98:99], v[98:99], v[194:195]
    v_pk_add_f32 v[100:101], v[100:101], v[196:197]
    v_pk_add_f32 v[102:103], v[102:103], v[198:199]
    v_pk_add_f32 v[104:105], v[104:105], v[200:201]
    v_pk_add_f32 v[106:107], v[106:107], v[202:203]
    v_pk_add_f32 v[108:109], v[108:109], v[204:205]
    v_pk_add_f32 v[110:111], v[110:111], v[206:207]
    s_waitcnt lgkmcnt(0)
    v_pk_add_f32 v[56:57], v[96:97], v[208:209]
    v_pk_add_f32 v[58:59], v[98:99], v[210:211]
    v_pk_add_f32 v[60:61], v[100:101], v[212:213]
    v_pk_add_f32 v[62:63], v[102:103], v[214:215]
    v_pk_add_f32 v[64:65], v[104:105], v[216:217]
    v_pk_add_f32 v[66:67], v[106:107], v[218:219]
    v_pk_add_f32 v[68:69], v[108:109], v[220:221]
    v_pk_add_f32 v[70:71], v[110:111], v[222:223]
    s_waitcnt vmcnt(0)
    s_cmp_eq_u32 s4, 1
    s_cbranch_scc1 fused2_kernel_v12
    v_fma_f32 v56, -v48, v224, v56
    v_fma_f32 v57, -v48, v225, v57
    v_fma_f32 v58, -v48, v226, v58
    v_fma_f32 v59, -v48, v227, v59
    v_fma_f32 v60, -v48, v228, v60
    v_fma_f32 v61, -v48, v229, v61
    v_fma_f32 v62, -v48, v230, v62
    v_fma_f32 v63, -v48, v231, v63
    v_fma_f32 v64, -v48, v232, v64
    v_fma_f32 v65, -v48, v233, v65
    v_fma_f32 v66, -v48, v234, v66
    v_fma_f32 v67, -v48, v235, v67
    v_mul_f32 v56, v49, v56
    v_mul_f32 v57, v49, v57
    v_mul_f32 v58, v49, v58
    v_mul_f32 v59, v49, v59
    v_mul_f32 v60, v49, v60
    v_mul_f32 v61, v49, v61
    v_mul_f32 v62, v49, v62
    v_mul_f32 v63, v49, v63
    v_mul_f32 v64, v49, v64
    v_mul_f32 v65, v49, v65
    v_mul_f32 v66, v49, v66
    v_mul_f32 v67, v49, v67
    v_cvt_pk_bf16_f32 v8, v56, v57
    v_cvt_pk_bf16_f32 v9, v58, v59
    v_cvt_pk_bf16_f32 v10, v60, v61
    v_cvt_pk_bf16_f32 v11, v62, v63
    v_cvt_pk_bf16_f32 v12, v64, v65
    v_cvt_pk_bf16_f32 v13, v66, v67
    v_lshlrev_b32 v4, 4, v2
    v_lshl_add_u32 v4, v3, 3, v4
    s_lshl_b32 s28, s31, 10
    s_add_u32 s28, s28, s34
    buffer_store_dwordx2 v[8:9], v4, s[56:59], s28 offen offset:0 sc1
    buffer_store_dwordx2 v[10:11], v4, s[56:59], s28 offen offset:512 sc1
    v_lshlrev_b32 v4, 3, v2
    s_lshl_b32 s28, s31, 8
    s_add_u32 s28, s28, 16384
    s_add_u32 s28, s28, s34
    s_mov_b32 exec_lo, -1
    s_mov_b32 exec_hi, 0
    buffer_store_dwordx2 v[12:13], v4, s[56:59], s28 offen sc1
    s_branch fused2_kernel_flag13
fused2_kernel_v12:
    v_lshlrev_b32 v6, 5, v3
    v_add_u32 v6, 83968, v6
    ds_read_b128 v[96:99], v6 offset:0
    ds_read_b128 v[100:103], v6 offset:16
    ds_read_b128 v[104:107], v6 offset:64
    ds_read_b128 v[108:111], v6 offset:80
    ds_read_b128 v[112:115], v6 offset:128
    ds_read_b128 v[116:119], v6 offset:144
    ds_read_b128 v[120:123], v6 offset:192
    ds_read_b128 v[124:127], v6 offset:208
    v_mul_u32_u24 v4, 320, v3
    v_lshl_add_u32 v4, v2, 4, v4
    s_mul_i32 s28, s31, 1280
    s_add_u32 s28, s28, 20480
    s_add_u32 s28, s28, s34
    s_mov_b32 s22, 0x000fffff
    s_mov_b32 s23, 0x000fffff
    s_waitcnt lgkmcnt(0)
    v_fma_f32 v56, -v96, v240, v56
    v_fma_f32 v57, -v98, v240, v57
    v_fma_f32 v58, -v100, v240, v58
    v_fma_f32 v59, -v102, v240, v59
    v_fma_f32 v60, -v104, v240, v60
    v_fma_f32 v61, -v106, v240, v61
    v_fma_f32 v62, -v108, v240, v62
    v_fma_f32 v63, -v110, v240, v63
    v_fma_f32 v64, -v112, v240, v64
    v_fma_f32 v65, -v114, v240, v65
    v_fma_f32 v66, -v116, v240, v66
    v_fma_f32 v67, -v118, v240, v67
    v_fma_f32 v68, -v120, v240, v68
    v_fma_f32 v69, -v122, v240, v69
    v_fma_f32 v70, -v124, v240, v70
    v_fma_f32 v71, -v126, v240, v71
    v_mul_f32 v56, v97, v56
    v_mul_f32 v57, v99, v57
    v_mul_f32 v58, v101, v58
    v_mul_f32 v59, v103, v59
    v_mul_f32 v60, v105, v60
    v_mul_f32 v61, v107, v61
    v_mul_f32 v62, v109, v62
    v_mul_f32 v63, v111, v63
    v_mul_f32 v64, v113, v64
    v_mul_f32 v65, v115, v65
    v_mul_f32 v66, v117, v66
    v_mul_f32 v67, v119, v67
    v_mul_f32 v68, v121, v68
    v_mul_f32 v69, v123, v69
    v_mul_f32 v70, v125, v70
    v_mul_f32 v71, v127, v71
    v_cvt_pk_bf16_f32 v8, v56, v57
    v_cvt_pk_bf16_f32 v9, v58, v59
    v_cvt_pk_bf16_f32 v10, v60, v61
    v_cvt_pk_bf16_f32 v11, v62, v63
    v_cvt_pk_bf16_f32 v12, v64, v65
    v_cvt_pk_bf16_f32 v13, v66, v67
    v_cvt_pk_bf16_f32 v14, v68, v69
    v_cvt_pk_bf16_f32 v15, v70, v71
    s_mov_b64 exec, s[22:23]
    buffer_store_dwordx4 v[8:11], v4, s[56:59], s28 offen sc1
    buffer_store_dwordx4 v[12:15], v4, s[56:59], s28 offen offset:640 sc1
fused2_kernel_flag13:
    s_mov_b64 exec, -1
    v_and_b32 v4, 63, v0
    v_lshlrev_b32 v4, 11, v4
    v_mov_b32 v5, 1
    s_lshl_b32 s28, s3, 1
    s_add_u32 s28, s28, s4
    s_lshr_b32 s29, s28, 3
    s_lshl_b32 s29, s29, 7
    s_and_b32 s28, s28, 7
    s_lshl_b32 s28, s28, 2
    s_add_u32 s28, s28, s29
    s_add_u32 s28, s28, 131072
    s_mov_b32 exec_lo, 0xffff
    s_mov_b32 exec_hi, 0
    buffer_store_dword v5, v4, s[68:71], s28 offen sc1
    s_mov_b64 exec, -1
    s_barrier
    s_branch fused2_kernel_barx10
fused2_kernel_poll9:
    s_setprio 2
    s_cmp_eq_u32 s42, 0
    s_cbranch_scc1 fused2_kernel_nb16
    s_barrier
fused2_kernel_nb16:
    v_lshrrev_b32 v5, 2, v2
    v_lshlrev_b32 v5, 7, v5
    v_and_b32 v6, 3, v2
    v_lshl_add_u32 v5, v6, 3, v5
    s_and_b32 s28, s2, 15
    s_lshl_b32 s28, s28, 11
    s_add_u32 s28, s28, 131072
    s_mov_b32 s29, 0
fused2_kernel_pl17:
    buffer_load_dwordx2 v[8:9], v5, s[68:71], s28 offen sc1
    s_waitcnt vmcnt(0)
    v_and_b32 v8, v8, v9
    v_cmp_ne_u32 vcc, 1, v8
    s_cbranch_vccz fused2_kernel_pd18
    s_sleep 1
    s_add_u32 s29, s29, 1
    s_cmp_lt_u32 s29, 0x8000
    s_cbranch_scc1 fused2_kernel_pl17
fused2_kernel_pd18:
    s_sub_u32 s20, s40, 6
    s_mul_i32 s20, s20, 20480
    v_add_u32 v5, s20, v4
    s_mov_b32 s21, s20
    buffer_load_dwordx4 v[96:99], v4, s[56:59], s21 offen offset:0
    buffer_load_dwordx4 v[100:103], v4, s[56:59], s21 offen offset:1024
    buffer_load_dwordx4 v[104:107], v4, s[56:59], s21 offen offset:2048
    buffer_load_dwordx4 v[108:111], v4, s[56:59], s21 offen offset:3072
    s_add_u32 s21, s21, 4096
    buffer_load_dwordx4 v[112:115], v4, s[56:59], s21 offen offset:0
    buffer_load_dwordx4 v[116:119], v4, s[56:59], s21 offen offset:1024
    buffer_load_dwordx4 v[120:123], v4, s[56:59], s21 offen offset:2048
    buffer_load_dwordx4 v[124:127], v4, s[56:59], s21 offen offset:3072
    s_add_u32 s21, s21, 4096
    buffer_load_dwordx4 v[128:131], v4, s[56:59], s21 offen offset:0
    buffer_load_dwordx4 v[132:135], v4, s[56:59], s21 offen offset:1024
    buffer_load_dwordx4 v[136:139], v4, s[56:59], s21 offen offset:2048
    buffer_load_dwordx4 v[140:143], v4, s[56:59], s21 offen offset:3072
    s_add_u32 s21, s21, 4096
    buffer_load_dwordx4 v[144:147], v4, s[56:59], s21 offen offset:0
    buffer_load_dwordx4 v[148:151], v4, s[56:59], s21 offen offset:1024
    buffer_load_dwordx4 v[152:155], v4, s[56:59], s21 offen offset:2048
    buffer_load_dwordx4 v[156:159], v4, s[56:59], s21 offen offset:3072
    s_add_u32 s21, s21, 4096
    buffer_load_dwordx4 v[160:163], v4, s[56:59], s21 offen offset:0
    buffer_load_dwordx4 v[164:167], v4, s[56:59], s21 offen offset:1024
    buffer_load_dwordx4 v[168:171], v4, s[56:59], s21 offen offset:2048
    buffer_load_dwordx4 v[172:175], v4, s[56:59], s21 offen offset:3072
    v_mov_b32 v28, 0
    v_mov_b32 v29, 0
    s_waitcnt vmcnt(19)
    ds_write_b128 v5, v[96:99] offset:0
    v_max3_u32 v28, v28, v96, v97
    v_max3_u32 v29, v29, v98, v99
    s_waitcnt vmcnt(18)
    ds_write_b128 v5, v[100:103] offset:1024
    v_max3_u32 v28, v28, v100, v101
    v_max3_u32 v29, v29, v102, v103
    s_waitcnt vmcnt(17)
    ds_write_b128 v5, v[104:107] offset:2048
    v_max3_u32 v28, v28, v104, v105
    v_max3_u32 v29, v29, v106, v107
    s_waitcnt vmcnt(16)
    ds_write_b128 v5, v[108:111] offset:3072
    v_max3_u32 v28, v28, v108, v109
    v_max3_u32 v29, v29, v110, v111
    s_waitcnt vmcnt(15)
    ds_write_b128 v5, v[112:115] offset:4096
    v_max3_u32 v28, v28, v112, v113
    v_max3_u32 v29, v29, v114, v115
    s_waitcnt vmcnt(14)
    ds_write_b128 v5, v[116:119] offset:5120
    v_max3_u32 v28, v28, v116, v117
    v_max3_u32 v29, v29, v118, v119
    s_waitcnt vmcnt(13)
    ds_write_b128 v5, v[120:123] offset:6144
    v_max3_u32 v28, v28, v120, v121
    v_max3_u32 v29, v29, v122, v123
    s_waitcnt vmcnt(12)
    ds_write_b128 v5, v[124:127] offset:7168
    v_max3_u32 v28, v28, v124, v125
    v_max3_u32 v29, v29, v126, v127
    s_waitcnt vmcnt(11)
    ds_write_b128 v5, v[128:131] offset:8192
    v_max3_u32 v28, v28, v128, v129
    v_max3_u32 v29, v29, v130, v131
    s_waitcnt vmcnt(10)
    ds_write_b128 v5, v[132:135] offset:9216
    v_max3_u32 v28, v28, v132, v133
    v_max3_u32 v29, v29, v134, v135
    s_waitcnt vmcnt(9)
    ds_write_b128 v5, v[136:139] offset:10240
    v_max3_u32 v28, v28, v136, v137
    v_max3_u32 v29, v29, v138, v139
    s_waitcnt vmcnt(8)
    ds_write_b128 v5, v[140:143] offset:11264
    v_max3_u32 v28, v28, v140, v141
    v_max3_u32 v29, v29, v142, v143
    s_waitcnt vmcnt(7)
    ds_write_b128 v5, v[144:147] offset:12288
    v_max3_u32 v28, v28, v144, v145
    v_max3_u32 v29, v29, v146, v147
    s_waitcnt vmcnt(6)
    ds_write_b128 v5, v[148:151] offset:13312
    v_max3_u32 v28, v28, v148, v149
    v_max3_u32 v29, v29, v150, v151
    s_waitcnt vmcnt(5)
    ds_write_b128 v5, v[152:155] offset:14336
    v_max3_u32 v28, v28, v152, v153
    v_max3_u32 v29, v29, v154, v155
    s_waitcnt vmcnt(4)
    ds_write_b128 v5, v[156:159] offset:15360
    v_max3_u32 v28, v28, v156, v157
    v_max3_u32 v29, v29, v158, v159
    s_waitcnt vmcnt(3)
    ds_write_b128 v5, v[160:163] offset:16384
    v_max3_u32 v28, v28, v160, v161
    v_max3_u32 v29, v29, v162, v163
    s_waitcnt vmcnt(2)
    ds_write_b128 v5, v[164:167] offset:17408
    v_max3_u32 v28, v28, v164, v165
    v_max3_u32 v29, v29, v166, v167
    s_waitcnt vmcnt(1)
    ds_write_b128 v5, v[168:171] offset:18432
    v_max3_u32 v28, v28, v168, v169
    v_max3_u32 v29, v29, v170, v171
    s_waitcnt vmcnt(0)
    ds_write_b128 v5, v[172:175] offset:19456
    v_max3_u32 v28, v28, v172, v173
    v_max3_u32 v29, v29, v174, v175
    v_max_u32 v28, v28, v29
    v_cmp_eq_u32 vcc, -1, v28
    s_cbranch_vccnz fused2_kernel_g0r19
fused2_kernel_g0d20:
    s_waitcnt lgkmcnt(0)
fused2_kernel_barx10:
    s_setprio 0
    s_barrier
    s_and_b32 s30, s40, 3
    s_lshr_b32 s31, s40, 2
    v_and_b32 v3, 31, v0
    v_bfe_u32 v4, v0, 5, 1
    v_mul_u32_u24 v5, 328, v3
    s_mul_i32 s5, s30, 80
    s_add_u32 s5, s5, 84224
    v_add_u32 v5, s5, v5
    v_lshl_add_u32 v6, v4, 4, v5
    ds_read2_b64 v[8:11], v6 offset0:0 offset1:1
    ds_read_b64 v[12:13], v5 offset:32
    ds_read2_b64 v[16:19], v6 offset0:5 offset1:6
    ds_read_b64 v[20:21], v5 offset:72
    v_and_b32 v1, 63, v0
    v_lshlrev_b32 v1, 4, v1
    s_mul_i32 s20, s40, 5120
    s_add_u32 m0, s20, 40960
    s_nop 0
    buffer_load_dwordx4 v1, s[56:59], m0 offen lds
    s_add_u32 m0, s20, 41984
    s_nop 0
    buffer_load_dwordx4 v1, s[56:59], m0 offen lds
    s_add_u32 m0, s20, 43008
    s_nop 0
    buffer_load_dwordx4 v1, s[56:59], m0 offen lds
    s_add_u32 m0, s20, 44032
    s_nop 0
    buffer_load_dwordx4 v1, s[56:59], m0 offen lds
    s_add_u32 m0, s20, 45056
    s_nop 0
    buffer_load_dwordx4 v1, s[56:59], m0 offen lds
    v_mov_b32 v30, 0
    v_mov_b32 v31, 0
    v_mov_b32 v38, 0
    v_mov_b32 v39, 0
    v_cmp_eq_u32 vcc, 20, v3
    v_mov_b32 v7, 0x3f803f80
    v_cndmask_b32 v40, 0, v7, vcc
    v_cndmask_b32 v41, 0, v7, vcc
    v_cndmask_b32 v42, 0, v7, vcc
    v_cndmask_b32 v43, 0, v7, vcc
    v_cndmask_b32 v44, 0, v7, vcc
    v_cndmask_b32 v45, 0, v7, vcc
    v_cndmask_b32 v46, 0, v7, vcc
    v_cndmask_b32 v47, 0, v7, vcc
    v_cndmask_b32 v48, 0, v7, vcc
    v_cndmask_b32 v49, 0, v7, vcc
    v_cndmask_b32 v50, 0, v7, vcc
    v_cndmask_b32 v51, 0, v7, vcc
    v_cndmask_b32 v52, 0, v7, vcc
    v_cndmask_b32 v53, 0, v7, vcc
    v_cndmask_b32 v54, 0, v7, vcc
    v_cndmask_b32 v55, 0, v7, vcc
    v_mov_b32 v144, 0
    v_mov_b32 v145, 0
    v_mov_b32 v146, 0
    v_mov_b32 v147, 0
    v_mov_b32 v148, 0
    v_mov_b32 v149, 0
    v_mov_b32 v150, 0
    v_mov_b32 v151, 0
    v_mov_b32 v152, 0
    v_mov_b32 v153, 0
    v_mov_b32 v154, 0
    v_mov_b32 v155, 0
    v_mov_b32 v156, 0
    v_mov_b32 v157, 0
    v_mov_b32 v158, 0
    v_mov_b32 v159, 0
    v_mov_b32 v160, 0
    v_mov_b32 v161, 0
    v_mov_b32 v162, 0
    v_mov_b32 v163, 0
    v_mov_b32 v164, 0
    v_mov_b32 v165, 0
    v_mov_b32 v166, 0
    v_mov_b32 v167, 0
    v_mov_b32 v168, 0
    v_mov_b32 v169, 0
    v_mov_b32 v170, 0
    v_mov_b32 v171, 0
    v_mov_b32 v172, 0
    v_mov_b32 v173, 0
    v_mov_b32 v174, 0
    v_mov_b32 v175, 0
    s_lshl_b32 s21, s31, 13
    v_add_u32 v56, s21, v1
    v_lshlrev_b32 v57, 3, v3
    s_lshl_b32 s21, s31, 11
    s_add_u32 s21, s21, 16384
    v_add_u32 v57, s21, v57
    v_mul_u32_u24 v58, 320, v4
    v_lshl_add_u32 v58, v3, 4, v58
    s_mul_i32 s21, s31, 10240
    s_add_u32 s21, s21, 20480
    v_add_u32 v58, s21, v58
    s_mov_b32 s22, 0x000fffff
    s_mov_b32 s23, 0x000fffff
    ds_read_b128 v[24:27], v56 offset:0
    ds_read_b64 v[28:29], v57 offset:0
    s_mov_b64 exec, s[22:23]
    ds_read_b128 v[40:43], v58 offset:0
    ds_read_b128 v[44:47], v58 offset:640
    s_mov_b64 exec, -1
    ds_read_b128 v[32:35], v56 offset:1024
    ds_read_b64 v[36:37], v57 offset:256
    s_waitcnt lgkmcnt(6)
    v_cmp_eq_u32 vcc, 0, v4
    v_mov_b32 v14, 0
    v_mov_b32 v15, 0
    v_cndmask_b32 v12, 0, v12, vcc
    v_cndmask_b32 v13, 0, v13, vcc
    v_mov_b32 v22, 0
    v_mov_b32 v23, 0
    v_cndmask_b32 v20, 0, v20, vcc
    v_cndmask_b32 v21, 0, v21, vcc
    s_waitcnt lgkmcnt(4)
    v_mfma_f32_32x32x16_bf16 v[64:79], v[24:27], v[8:11], 0
    v_mfma_f32_32x32x16_bf16 v[80:95], v[24:27], v[16:19], 0
    v_mfma_f32_32x32x8_bf16 v[64:79], v[28:29], v[12:13], v[64:79]
    v_mfma_f32_32x32x8_bf16 v[80:95], v[28:29], v[20:21], v[80:95]
    s_nop 15
    s_nop 3
    s_waitcnt lgkmcnt(0)
    v_mfma_f32_32x32x16_bf16 v[96:111], v[32:35], v[8:11], 0
    v_exp_f32 v64, v64
    v_exp_f32 v65, v65
    v_exp_f32 v66, v66
    v_exp_f32 v67, v67
    s_setprio 1
    v_exp_f32 v68, v68
    v_exp_f32 v69, v69
    v_exp_f32 v70, v70
    v_exp_f32 v71, v71
    v_mfma_f32_32x32x16_bf16 v[112:127], v[32:35], v[16:19], 0
    v_exp_f32 v72, v72
    v_exp_f32 v73, v73
    v_exp_f32 v74, v74
    v_exp_f32 v75, v75
    v_exp_f32 v76, v76
    v_exp_f32 v77, v77
    v_exp_f32 v78, v78
    v_exp_f32 v79, v79
    v_mfma_f32_32x32x8_bf16 v[96:111], v[36:37], v[12:13], v[96:111]
    ds_read_b128 v[24:27], v56 offset:2048
    ds_read_b64 v[28:29], v57 offset:512
    v_cvt_pk_bf16_f32 v128, v64, v65
    v_cvt_pk_bf16_f32 v129, v66, v67
    v_cvt_pk_bf16_f32 v130, v68, v69
    v_cvt_pk_bf16_f32 v131, v70, v71
    v_cvt_pk_bf16_f32 v132, v72, v73
    v_cvt_pk_bf16_f32 v133, v74, v75
    v_cvt_pk_bf16_f32 v134, v76, v77
    v_cvt_pk_bf16_f32 v135, v78, v79
    v_mfma_f32_32x32x8_bf16 v[112:127], v[36:37], v[20:21], v[112:127]
    v_exp_f32 v80, v80
    v_exp_f32 v81, v81
    v_exp_f32 v82, v82
    v_exp_f32 v83, v83
    s_waitcnt lgkmcnt(2)
    v_mfma_f32_32x32x16_bf16 v[144:159], v[40:43], v[128:131], v[144:159]
    v_exp_f32 v84, v84
    v_exp_f32 v85, v85
    v_exp_f32 v86, v86
    v_exp_f32 v87, v87
    v_exp_f32 v88, v88
    v_exp_f32 v89, v89
    v_exp_f32 v90, v90
    v_exp_f32 v91, v91
    v_mfma_f32_32x32x16_bf16 v[144:159], v[44:47], v[132:135], v[144:159]
    v_exp_f32 v92, v92
    v_exp_f32 v93, v93
    v_exp_f32 v94, v94
    v_exp_f32 v95, v95
    s_setprio 0
    s_mov_b64 exec, s[22:23]
    ds_read_b128 v[48:51], v58 offset:1280
    ds_read_b128 v[52:55], v58 offset:1920
    s_mov_b64 exec, -1
    v_cvt_pk_bf16_f32 v136, v80, v81
    v_cvt_pk_bf16_f32 v137, v82, v83
    v_cvt_pk_bf16_f32 v138, v84, v85
    v_cvt_pk_bf16_f32 v139, v86, v87
    v_cvt_pk_bf16_f32 v140, v88, v89
    v_cvt_pk_bf16_f32 v141, v90, v91
    v_cvt_pk_bf16_f32 v142, v92, v93
    v_cvt_pk_bf16_f32 v143, v94, v95
    s_waitcnt lgkmcnt(2)
    v_mfma_f32_32x32x16_bf16 v[64:79], v[24:27], v[8:11], 0
    v_exp_f32 v96, v96
    v_exp_f32 v97, v97
    v_exp_f32 v98, v98
    v_exp_f32 v99, v99
    s_setprio 1
    s_add_u32 m0, s20, 122880
    v_mfma_f32_32x32x16_bf16 v[160:175], v[40:43], v[136:139], v[160:175]
    v_exp_f32 v100, v100
    v_exp_f32 v101, v101
    v_exp_f32 v102, v102
    v_exp_f32 v103, v103
    buffer_load_dwordx4 v1, s[56:59], m0 offen lds
    v_mfma_f32_32x32x16_bf16 v[80:95], v[24:27], v[16:19], 0
    v_exp_f32 v104, v104
    v_exp_f32 v105, v105
    v_exp_f32 v106, v106
    v_exp_f32 v107, v107
    v_mfma_f32_32x32x16_bf16 v[160:175], v[44:47], v[140:143], v[160:175]
    v_exp_f32 v108, v108
    v_exp_f32 v109, v109
    v_exp_f32 v110, v110
    v_exp_f32 v111, v111
    v_mfma_f32_32x32x8_bf16 v[64:79], v[28:29], v[12:13], v[64:79]
    ds_read_b128 v[32:35], v56 offset:3072
    ds_read_b64 v[36:37], v57 offset:768
    v_cvt_pk_bf16_f32 v128, v96, v97
    v_cvt_pk_bf16_f32 v129, v98, v99
    v_cvt_pk_bf16_f32 v130, v100, v101
    v_cvt_pk_bf16_f32 v131, v102, v103
    v_cvt_pk_bf16_f32 v132, v104, v105
    v_cvt_pk_bf16_f32 v133, v106, v107
    v_cvt_pk_bf16_f32 v134, v108, v109
    v_cvt_pk_bf16_f32 v135, v110, v111
    v_mfma_f32_32x32x8_bf16 v[80:95], v[28:29], v[20:21], v[80:95]
    v_exp_f32 v112, v112
    v_exp_f32 v113, v113
    v_exp_f32 v114, v114
    v_exp_f32 v115, v115
    s_waitcnt lgkmcnt(2)
    v_mfma_f32_32x32x16_bf16 v[144:159], v[48:51], v[128:131], v[144:159]
    v_exp_f32 v116, v116
    v_exp_f32 v117, v117
    v_exp_f32 v118, v118
    v_exp_f32 v119, v119
    v_exp_f32 v120, v120
    v_exp_f32 v121, v121
    v_exp_f32 v122, v122
    v_exp_f32 v123, v123
    v_mfma_f32_32x32x16_bf16 v[144:159], v[52:55], v[132:135], v[144:159]
    v_exp_f32 v124, v124
    v_exp_f32 v125, v125
    v_exp_f32 v126, v126
    v_exp_f32 v127, v127
    s_setprio 0
    s_mov_b64 exec, s[22:23]
    ds_read_b128 v[40:43], v58 offset:2560
    ds_read_b128 v[44:47], v58 offset:3200
    s_mov_b64 exec, -1
    v_cvt_pk_bf16_f32 v136, v112, v113
    v_cvt_pk_bf16_f32 v137, v114, v115
    v_cvt_pk_bf16_f32 v138, v116, v117
    v_cvt_pk_bf16_f32 v139, v118, v119
    v_cvt_pk_bf16_f32 v140, v120, v121
    v_cvt_pk_bf16_f32 v141, v122, v123
    v_cvt_pk_bf16_f32 v142, v124, v125
    v_cvt_pk_bf16_f32 v143, v126, v127
    s_waitcnt lgkmcnt(2)
    v_mfma_f32_32x32x16_bf16 v[96:111], v[32:35], v[8:11], 0
    v_exp_f32 v64, v64
    v_exp_f32 v65, v65
    v_exp_f32 v66, v66
    v_exp_f32 v67, v67
    s_setprio 1
    s_add_u32 m0, s20, 123904
    v_mfma_f32_32x32x16_bf16 v[160:175], v[48:51], v[136:139], v[160:175]
    v_exp_f32 v68, v68
    v_exp_f32 v69, v69
    v_exp_f32 v70, v70
    v_exp_f32 v71, v71
    buffer_load_dwordx4 v1, s[56:59], m0 offen lds
    v_mfma_f32_32x32x16_bf16 v[112:127], v[32:35], v[16:19], 0
    v_exp_f32 v72, v72
    v_exp_f32 v73, v73
    v_exp_f32 v74, v74
    v_exp_f32 v75, v75
    v_mfma_f32_32x32x16_bf16 v[160:175], v[52:55], v[140:143], v[160:175]
    v_exp_f32 v76, v76
    v_exp_f32 v77, v77
    v_exp_f32 v78, v78
    v_exp_f32 v79, v79
    v_mfma_f32_32x32x8_bf16 v[96:111], v[36:37], v[12:13], v[96:111]
    ds_read_b128 v[24:27], v56 offset:4096
    ds_read_b64 v[28:29], v57 offset:1024
    v_cvt_pk_bf16_f32 v128, v64, v65
    v_cvt_pk_bf16_f32 v129, v66, v67
    v_cvt_pk_bf16_f32 v130, v68, v69
    v_cvt_pk_bf16_f32 v131, v70, v71
    v_cvt_pk_bf16_f32 v132, v72, v73
    v_cvt_pk_bf16_f32 v133, v74, v75
    v_cvt_pk_bf16_f32 v134, v76, v77
    v_cvt_pk_bf16_f32 v135, v78, v79
    v_mfma_f32_32x32x8_bf16 v[112:127], v[36:37], v[20:21], v[112:127]
    v_exp_f32 v80, v80
    v_exp_f32 v81, v81
    v_exp_f32 v82, v82
    v_exp_f32 v83, v83
    s_waitcnt lgkmcnt(2)
    v_mfma_f32_32x32x16_bf16 v[144:159], v[40:43], v[128:131], v[144:159]
    v_exp_f32 v84, v84
    v_exp_f32 v85, v85
    v_exp_f32 v86, v86
    v_exp_f32 v87, v87
    v_exp_f32 v88, v88
    v_exp_f32 v89, v89
    v_exp_f32 v90, v90
    v_exp_f32 v91, v91
    v_mfma_f32_32x32x16_bf16 v[144:159], v[44:47], v[132:135], v[144:159]
    v_exp_f32 v92, v92
    v_exp_f32 v93, v93
    v_exp_f32 v94, v94
    v_exp_f32 v95, v95
    s_setprio 0
    s_mov_b64 exec, s[22:23]
    ds_read_b128 v[48:51], v58 offset:3840
    ds_read_b128 v[52:55], v58 offset:4480
    s_mov_b64 exec, -1
    v_cvt_pk_bf16_f32 v136, v80, v81
    v_cvt_pk_bf16_f32 v137, v82, v83
    v_cvt_pk_bf16_f32 v138, v84, v85
    v_cvt_pk_bf16_f32 v139, v86, v87
    v_cvt_pk_bf16_f32 v140, v88, v89
    v_cvt_pk_bf16_f32 v141, v90, v91
    v_cvt_pk_bf16_f32 v142, v92, v93
    v_cvt_pk_bf16_f32 v143, v94, v95
    s_waitcnt lgkmcnt(2)
    v_mfma_f32_32x32x16_bf16 v[64:79], v[24:27], v[8:11], 0
    v_exp_f32 v96, v96
    v_exp_f32 v97, v97
    v_exp_f32 v98, v98
    v_exp_f32 v99, v99
    s_setprio 1
    s_add_u32 m0, s20, 124928
    v_mfma_f32_32x32x16_bf16 v[160:175], v[40:43], v[136:139], v[160:175]
    v_exp_f32 v100, v100
    v_exp_f32 v101, v101
    v_exp_f32 v102, v102
    v_exp_f32 v103, v103
    buffer_load_dwordx4 v1, s[56:59], m0 offen lds
    v_mfma_f32_32x32x16_bf16 v[80:95], v[24:27], v[16:19], 0
    v_exp_f32 v104, v104
    v_exp_f32 v105, v105
    v_exp_f32 v106, v106
    v_exp_f32 v107, v107
    v_mfma_f32_32x32x16_bf16 v[160:175], v[44:47], v[140:143], v[160:175]
    v_exp_f32 v108, v108
    v_exp_f32 v109, v109
    v_exp_f32 v110, v110
    v_exp_f32 v111, v111
    v_mfma_f32_32x32x8_bf16 v[64:79], v[28:29], v[12:13], v[64:79]
    ds_read_b128 v[32:35], v56 offset:5120
    ds_read_b64 v[36:37], v57 offset:1280
    v_cvt_pk_bf16_f32 v128, v96, v97
    v_cvt_pk_bf16_f32 v129, v98, v99
    v_cvt_pk_bf16_f32 v130, v100, v101
    v_cvt_pk_bf16_f32 v131, v102, v103
    v_cvt_pk_bf16_f32 v132, v104, v105
    v_cvt_pk_bf16_f32 v133, v106, v107
    v_cvt_pk_bf16_f32 v134, v108, v109
    v_cvt_pk_bf16_f32 v135, v110, v111
    v_mfma_f32_32x32x8_bf16 v[80:95], v[28:29], v[20:21], v[80:95]
    v_exp_f32 v112, v112
    v_exp_f32 v113, v113
    v_exp_f32 v114, v114
    v_exp_f32 v115, v115
    s_waitcnt lgkmcnt(2)
    v_mfma_f32_32x32x16_bf16 v[144:159], v[48:51], v[128:131], v[144:159]
    v_exp_f32 v116, v116
    v_exp_f32 v117, v117
    v_exp_f32 v118, v118
    v_exp_f32 v119, v119
    v_exp_f32 v120, v120
    v_exp_f32 v121, v121
    v_exp_f32 v122, v122
    v_exp_f32 v123, v123
    v_mfma_f32_32x32x16_bf16 v[144:159], v[52:55], v[132:135], v[144:159]
    v_exp_f32 v124, v124
    v_exp_f32 v125, v125
    v_exp_f32 v126, v126
    v_exp_f32 v127, v127
    s_setprio 0
    s_mov_b64 exec, s[22:23]
    ds_read_b128 v[40:43], v58 offset:5120
    ds_read_b128 v[44:47], v58 offset:5760
    s_mov_b64 exec, -1
    v_cvt_pk_bf16_f32 v136, v112, v113
    v_cvt_pk_bf16_f32 v137, v114, v115
    v_cvt_pk_bf16_f32 v138, v116, v117
    v_cvt_pk_bf16_f32 v139, v118, v119
    v_cvt_pk_bf16_f32 v140, v120, v121
    v_cvt_pk_bf16_f32 v141, v122, v123
    v_cvt_pk_bf16_f32 v142, v124, v125
    v_cvt_pk_bf16_f32 v143, v126, v127
    s_waitcnt lgkmcnt(2)
    v_mfma_f32_32x32x16_bf16 v[96:111], v[32:35], v[8:11], 0
    v_exp_f32 v64, v64
    v_exp_f32 v65, v65
    v_exp_f32 v66, v66
    v_exp_f32 v67, v67
    s_setprio 1
    s_add_u32 m0, s20, 125952
    v_mfma_f32_32x32x16_bf16 v[160:175], v[48:51], v[136:139], v[160:175]
    v_exp_f32 v68, v68
    v_exp_f32 v69, v69
    v_exp_f32 v70, v70
    v_exp_f32 v71, v71
    buffer_load_dwordx4 v1, s[56:59], m0 offen lds
    v_mfma_f32_32x32x16_bf16 v[112:127], v[32:35], v[16:19], 0
    v_exp_f32 v72, v72
    v_exp_f32 v73, v73
    v_exp_f32 v74, v74
    v_exp_f32 v75, v75
    v_mfma_f32_32x32x16_bf16 v[160:175], v[52:55], v[140:143], v[160:175]
    v_exp_f32 v76, v76
    v_exp_f32 v77, v77
    v_exp_f32 v78, v78
    v_exp_f32 v79, v79
    v_mfma_f32_32x32x8_bf16 v[96:111], v[36:37], v[12:13], v[96:111]
    ds_read_b128 v[24:27], v56 offset:6144
    ds_read_b64 v[28:29], v57 offset:1536
    v_cvt_pk_bf16_f32 v128, v64, v65
    v_cvt_pk_bf16_f32 v129, v66, v67
    v_cvt_pk_bf16_f32 v130, v68, v69
    v_cvt_pk_bf16_f32 v131, v70, v71
    v_cvt_pk_bf16_f32 v132, v72, v73
    v_cvt_pk_bf16_f32 v133, v74, v75
    v_cvt_pk_bf16_f32 v134, v76, v77
    v_cvt_pk_bf16_f32 v135, v78, v79
    v_mfma_f32_32x32x8_bf16 v[112:127], v[36:37], v[20:21], v[112:127]
    v_exp_f32 v80, v80
    v_exp_f32 v81, v81
    v_exp_f32 v82, v82
    v_exp_f32 v83, v83
    s_waitcnt lgkmcnt(2)
    v_mfma_f32_32x32x16_bf16 v[144:159], v[40:43], v[128:131], v[144:159]
    v_exp_f32 v84, v84
    v_exp_f32 v85, v85
    v_exp_f32 v86, v86
    v_exp_f32 v87, v87
    v_exp_f32 v88, v88
    v_exp_f32 v89, v89
    v_exp_f32 v90, v90
    v_exp_f32 v91, v91
    v_mfma_f32_32x32x16_bf16 v[144:159], v[44:47], v[132:135], v[144:159]
    v_exp_f32 v92, v92
    v_exp_f32 v93, v93
    v_exp_f32 v94, v94
    v_exp_f32 v95, v95
    s_setprio 0
    s_mov_b64 exec, s[22:23]
    ds_read_b128 v[48:51], v58 offset:6400
    ds_read_b128 v[52:55], v58 offset:7040
    s_mov_b64 exec, -1
    v_cvt_pk_bf16_f32 v136, v80, v81
    v_cvt_pk_bf16_f32 v137, v82, v83
    v_cvt_pk_bf16_f32 v138, v84, v85
    v_cvt_pk_bf16_f32 v139, v86, v87
    v_cvt_pk_bf16_f32 v140, v88, v89
    v_cvt_pk_bf16_f32 v141, v90, v91
    v_cvt_pk_bf16_f32 v142, v92, v93
    v_cvt_pk_bf16_f32 v143, v94, v95
    s_waitcnt lgkmcnt(2)
    v_mfma_f32_32x32x16_bf16 v[64:79], v[24:27], v[8:11], 0
    s_add_u32 s21, s20, 40960
    v_add_u32 v196, s21, v1
    s_waitcnt vmcnt(4)
    ds_read_b128 v[176:179], v196 offset:0
    ds_read_b128 v[180:183], v196 offset:1024
    ds_read_b128 v[184:187], v196 offset:2048
    ds_read_b128 v[188:191], v196 offset:3072
    ds_read_b128 v[192:195], v196 offset:4096
    v_exp_f32 v96, v96
    v_exp_f32 v97, v97
    v_exp_f32 v98, v98
    v_exp_f32 v99, v99
    s_setprio 1
    s_add_u32 m0, s20, 126976
    v_mfma_f32_32x32x16_bf16 v[160:175], v[40:43], v[136:139], v[160:175]
    v_exp_f32 v100, v100
    v_exp_f32 v101, v101
    v_exp_f32 v102, v102
    v_exp_f32 v103, v103
    buffer_load_dwordx4 v1, s[56:59], m0 offen lds
    v_mfma_f32_32x32x16_bf16 v[80:95], v[24:27], v[16:19], 0
    v_exp_f32 v104, v104
    v_exp_f32 v105, v105
    v_exp_f32 v106, v106
    v_exp_f32 v107, v107
    v_mfma_f32_32x32x16_bf16 v[160:175], v[44:47], v[140:143], v[160:175]
    v_exp_f32 v108, v108
    v_exp_f32 v109, v109
    v_exp_f32 v110, v110
    v_exp_f32 v111, v111
    v_mfma_f32_32x32x8_bf16 v[64:79], v[28:29], v[12:13], v[64:79]
    ds_read_b128 v[32:35], v56 offset:7168
    ds_read_b64 v[36:37], v57 offset:1792
    v_cvt_pk_bf16_f32 v128, v96, v97
    v_cvt_pk_bf16_f32 v129, v98, v99
    v_cvt_pk_bf16_f32 v130, v100, v101
    v_cvt_pk_bf16_f32 v131, v102, v103
    v_cvt_pk_bf16_f32 v132, v104, v105
    v_cvt_pk_bf16_f32 v133, v106, v107
    v_cvt_pk_bf16_f32 v134, v108, v109
    v_cvt_pk_bf16_f32 v135, v110, v111
    v_mfma_f32_32x32x8_bf16 v[80:95], v[28:29], v[20:21], v[80:95]
    v_exp_f32 v112, v112
    v_exp_f32 v113, v113
    v_exp_f32 v114, v114
    v_exp_f32 v115, v115
    s_waitcnt lgkmcnt(2)
    v_mfma_f32_32x32x16_bf16 v[144:159], v[48:51], v[128:131], v[144:159]
    v_exp_f32 v116, v116
    v_exp_f32 v117, v117
    v_exp_f32 v118, v118
    v_exp_f32 v119, v119
    v_exp_f32 v120, v120
    v_exp_f32 v121, v121
    v_exp_f32 v122, v122
    v_exp_f32 v123, v123
    v_mfma_f32_32x32x16_bf16 v[144:159], v[52:55], v[132:135], v[144:159]
    v_exp_f32 v124, v124
    v_exp_f32 v125, v125
    v_exp_f32 v126, v126
    v_exp_f32 v127, v127
    s_setprio 0
    s_mov_b64 exec, s[22:23]
    ds_read_b128 v[40:43], v58 offset:7680
    ds_read_b128 v[44:47], v58 offset:8320
    s_mov_b64 exec, -1
    v_cvt_pk_bf16_f32 v136, v112, v113
    v_cvt_pk_bf16_f32 v137, v114, v115
    v_cvt_pk_bf16_f32 v138, v116, v117
    v_cvt_pk_bf16_f32 v139, v118, v119
    v_cvt_pk_bf16_f32 v140, v120, v121
    v_cvt_pk_bf16_f32 v141, v122, v123
    v_cvt_pk_bf16_f32 v142, v124, v125
    v_cvt_pk_bf16_f32 v143, v126, v127
    v_max3_u32 v197, v176, v177, v178
    v_max3_u32 v198, v179, v180, v181
    v_max3_u32 v197, v197, v182, v183
    v_max3_u32 v198, v198, v184, v185
    v_max3_u32 v197, v197, v186, v187
    v_max3_u32 v198, v198, v188, v189
    v_max3_u32 v197, v197, v190, v191
    v_max3_u32 v198, v198, v192, v193
    v_max3_u32 v197, v197, v194, v195
    v_max_u32 v197, v197, v198
    v_cmp_eq_u32 vcc, -1, v197
    s_cbranch_vccnz fused2_kernel_vr21
fused2_kernel_vd24:
    s_barrier
    s_waitcnt lgkmcnt(2)
    v_mfma_f32_32x32x16_bf16 v[96:111], v[32:35], v[8:11], 0
    v_exp_f32 v64, v64
    v_exp_f32 v65, v65
    v_exp_f32 v66, v66
    v_exp_f32 v67, v67
    s_setprio 1
    s_add_u32 m0, s20, 81920
    v_mfma_f32_32x32x16_bf16 v[160:175], v[48:51], v[136:139], v[160:175]
    v_exp_f32 v68, v68
    v_exp_f32 v69, v69
    v_exp_f32 v70, v70
    v_exp_f32 v71, v71
    buffer_load_dwordx4 v1, s[56:59], m0 offen lds
    v_mfma_f32_32x32x16_bf16 v[112:127], v[32:35], v[16:19], 0
    v_exp_f32 v72, v72
    v_exp_f32 v73, v73
    v_exp_f32 v74, v74
    v_exp_f32 v75, v75
    v_mfma_f32_32x32x16_bf16 v[160:175], v[52:55], v[140:143], v[160:175]
    v_exp_f32 v76, v76
    v_exp_f32 v77, v77
    v_exp_f32 v78, v78
    v_exp_f32 v79, v79
    v_mfma_f32_32x32x8_bf16 v[96:111], v[36:37], v[12:13], v[96:111]
    ds_read_b128 v[24:27], v56 offset:40960
    ds_read_b64 v[28:29], v57 offset:40960
    v_cvt_pk_bf16_f32 v128, v64, v65
    v_cvt_pk_bf16_f32 v129, v66, v67
    v_cvt_pk_bf16_f32 v130, v68, v69
    v_cvt_pk_bf16_f32 v131, v70, v71
    v_cvt_pk_bf16_f32 v132, v72, v73
    v_cvt_pk_bf16_f32 v133, v74, v75
    v_cvt_pk_bf16_f32 v134, v76, v77
    v_cvt_pk_bf16_f32 v135, v78, v79
    v_mfma_f32_32x32x8_bf16 v[112:127], v[36:37], v[20:21], v[112:127]
    v_exp_f32 v80, v80
    v_exp_f32 v81, v81
    v_exp_f32 v82, v82
    v_exp_f32 v83, v83
    s_waitcnt lgkmcnt(2)
    v_mfma_f32_32x32x16_bf16 v[144:159], v[40:43], v[128:131], v[144:159]
    v_exp_f32 v84, v84
    v_exp_f32 v85, v85
    v_exp_f32 v86, v86
    v_exp_f32 v87, v87
    v_exp_f32 v88, v88
    v_exp_f32 v89, v89
    v_exp_f32 v90, v90
    v_exp_f32 v91, v91
    v_mfma_f32_32x32x16_bf16 v[144:159], v[44:47], v[132:135], v[144:159]
    v_exp_f32 v92, v92
    v_exp_f32 v93, v93
    v_exp_f32 v94, v94
    v_exp_f32 v95, v95
    s_setprio 0
    s_mov_b64 exec, s[22:23]
    ds_read_b128 v[48:51], v58 offset:8960
    ds_read_b128 v[52:55], v58 offset:9600
    s_mov_b64 exec, -1
    v_cvt_pk_bf16_f32 v136, v80, v81
    v_cvt_pk_bf16_f32 v137, v82, v83
    v_cvt_pk_bf16_f32 v138, v84, v85
    v_cvt_pk_bf16_f32 v139, v86, v87
    v_cvt_pk_bf16_f32 v140, v88, v89
    v_cvt_pk_bf16_f32 v141, v90, v91
    v_cvt_pk_bf16_f32 v142, v92, v93
    v_cvt_pk_bf16_f32 v143, v94, v95
    s_waitcnt lgkmcnt(2)
    v_mfma_f32_32x32x16_bf16 v[64:79], v[24:27], v[8:11], 0
    v_exp_f32 v96, v96
    v_exp_f32 v97, v97
    v_exp_f32 v98, v98
    v_exp_f32 v99, v99
    s_setprio 1
    s_add_u32 m0, s20, 82944
    v_mfma_f32_32x32x16_bf16 v[160:175], v[40:43], v[136:139], v[160:175]
    v_exp_f32 v100, v100
    v_exp_f32 v101, v101
    v_exp_f32 v102, v102
    v_exp_f32 v103, v103
    buffer_load_dwordx4 v1, s[56:59], m0 offen lds
    v_mfma_f32_32x32x16_bf16 v[80:95], v[24:27], v[16:19], 0
    v_exp_f32 v104, v104
    v_exp_f32 v105, v105
    v_exp_f32 v106, v106
    v_exp_f32 v107, v107
    v_mfma_f32_32x32x16_bf16 v[160:175], v[44:47], v[140:143], v[160:175]
    v_exp_f32 v108, v108
    v_exp_f32 v109, v109
    v_exp_f32 v110, v110
    v_exp_f32 v111, v111
    v_mfma_f32_32x32x8_bf16 v[64:79], v[28:29], v[12:13], v[64:79]
    ds_read_b128 v[32:35], v56 offset:41984
    ds_read_b64 v[36:37], v57 offset:41216
    v_cvt_pk_bf16_f32 v128, v96, v97
    v_cvt_pk_bf16_f32 v129, v98, v99
    v_cvt_pk_bf16_f32 v130, v100, v101
    v_cvt_pk_bf16_f32 v131, v102, v103
    v_cvt_pk_bf16_f32 v132, v104, v105
    v_cvt_pk_bf16_f32 v133, v106, v107
    v_cvt_pk_bf16_f32 v134, v108, v109
    v_cvt_pk_bf16_f32 v135, v110, v111
    v_mfma_f32_32x32x8_bf16 v[80:95], v[28:29], v[20:21], v[80:95]
    v_exp_f32 v112, v112
    v_exp_f32 v113, v113
    v_exp_f32 v114, v114
    v_exp_f32 v115, v115
    s_waitcnt lgkmcnt(2)
    v_mfma_f32_32x32x16_bf16 v[144:159], v[48:51], v[128:131], v[144:159]
    v_exp_f32 v116, v116
    v_exp_f32 v117, v117
    v_exp_f32 v118, v118
    v_exp_f32 v119, v119
    s_lshr_b32 s21, s2, 3
    s_mul_i32 s21, s21, 25600
    v_lshlrev_b32 v199, 6, v0
    v_cmp_gt_u32 vcc, 400, v0
    s_and_saveexec_b64 s[24:25], vcc
    buffer_load_dword v199, v199, s[64:67], s21 offen
    s_mov_b64 exec, s[24:25]
    v_exp_f32 v120, v120
    v_exp_f32 v121, v121
    v_exp_f32 v122, v122
    v_exp_f32 v123, v123
    v_mfma_f32_32x32x16_bf16 v[144:159], v[52:55], v[132:135], v[144:159]
    v_exp_f32 v124, v124
    v_exp_f32 v125, v125
    v_exp_f32 v126, v126
    v_exp_f32 v127, v127
    s_setprio 0
    s_mov_b64 exec, s[22:23]
    ds_read_b128 v[40:43], v58 offset:40960
    ds_read_b128 v[44:47], v58 offset:41600
    s_mov_b64 exec, -1
    v_cvt_pk_bf16_f32 v136, v112, v113
    v_cvt_pk_bf16_f32 v137, v114, v115
    v_cvt_pk_bf16_f32 v138, v116, v117
    v_cvt_pk_bf16_f32 v139, v118, v119
    v_cvt_pk_bf16_f32 v140, v120, v121
    v_cvt_pk_bf16_f32 v141, v122, v123
    v_cvt_pk_bf16_f32 v142, v124, v125
    v_cvt_pk_bf16_f32 v143, v126, v127
    v_add_u32 v56, 40960, v56
    v_add_u32 v57, 40960, v57
    v_add_u32 v58, 40960, v58
    s_waitcnt lgkmcnt(2)
    v_mfma_f32_32x32x16_bf16 v[96:111], v[32:35], v[8:11], 0
    v_exp_f32 v64, v64
    v_exp_f32 v65, v65
    v_exp_f32 v66, v66
    v_exp_f32 v67, v67
    s_setprio 1
    s_add_u32 m0, s20, 83968
    v_mfma_f32_32x32x16_bf16 v[160:175], v[48:51], v[136:139], v[160:175]
    v_exp_f32 v68, v68
    v_exp_f32 v69, v69
    v_exp_f32 v70, v70
    v_exp_f32 v71, v71
    buffer_load_dwordx4 v1, s[56:59], m0 offen lds
    v_mfma_f32_32x32x16_bf16 v[112:127], v[32:35], v[16:19], 0
    v_exp_f32 v72, v72
    v_exp_f32 v73, v73
    v_exp_f32 v74, v74
    v_exp_f32 v75, v75
    v_mfma_f32_32x32x16_bf16 v[160:175], v[52:55], v[140:143], v[160:175]
    v_exp_f32 v76, v76
    v_exp_f32 v77, v77
    v_exp_f32 v78, v78
    v_exp_f32 v79, v79
    v_mfma_f32_32x32x8_bf16 v[96:111], v[36:37], v[12:13], v[96:111]
    ds_read_b128 v[24:27], v56 offset:2048
    ds_read_b64 v[28:29], v57 offset:512
    v_cvt_pk_bf16_f32 v128, v64, v65
    v_cvt_pk_bf16_f32 v129, v66, v67
    v_cvt_pk_bf16_f32 v130, v68, v69
    v_cvt_pk_bf16_f32 v131, v70, v71
    v_cvt_pk_bf16_f32 v132, v72, v73
    v_cvt_pk_bf16_f32 v133, v74, v75
    v_cvt_pk_bf16_f32 v134, v76, v77
    v_cvt_pk_bf16_f32 v135, v78, v79
    v_mfma_f32_32x32x8_bf16 v[112:127], v[36:37], v[20:21], v[112:127]
    v_exp_f32 v80, v80
    v_exp_f32 v81, v81
    v_exp_f32 v82, v82
    v_exp_f32 v83, v83
    s_waitcnt lgkmcnt(2)
    v_mfma_f32_32x32x16_bf16 v[144:159], v[40:43], v[128:131], v[144:159]
    v_exp_f32 v84, v84
    v_exp_f32 v85, v85
    v_exp_f32 v86, v86
    v_exp_f32 v87, v87
    v_exp_f32 v88, v88
    v_exp_f32 v89, v89
    v_exp_f32 v90, v90
    v_exp_f32 v91, v91
    v_mfma_f32_32x32x16_bf16 v[144:159], v[44:47], v[132:135], v[144:159]
    v_exp_f32 v92, v92
    v_exp_f32 v93, v93
    v_exp_f32 v94, v94
    v_exp_f32 v95, v95
    s_setprio 0
    s_mov_b64 exec, s[22:23]
    ds_read_b128 v[48:51], v58 offset:1280
    ds_read_b128 v[52:55], v58 offset:1920
    s_mov_b64 exec, -1
    v_cvt_pk_bf16_f32 v136, v80, v81
    v_cvt_pk_bf16_f32 v137, v82, v83
    v_cvt_pk_bf16_f32 v138, v84, v85
    v_cvt_pk_bf16_f32 v139, v86, v87
    v_cvt_pk_bf16_f32 v140, v88, v89
    v_cvt_pk_bf16_f32 v141, v90, v91
    v_cvt_pk_bf16_f32 v142, v92, v93
    v_cvt_pk_bf16_f32 v143, v94, v95
    s_waitcnt lgkmcnt(2)
    v_mfma_f32_32x32x16_bf16 v[64:79], v[24:27], v[8:11], 0
    v_exp_f32 v96, v96
    v_exp_f32 v97, v97
    v_exp_f32 v98, v98
    v_exp_f32 v99, v99
    s_setprio 1
    s_add_u32 m0, s20, 84992
    v_mfma_f32_32x32x16_bf16 v[160:175], v[40:43], v[136:139], v[160:175]
    v_exp_f32 v100, v100
    v_exp_f32 v101, v101
    v_exp_f32 v102, v102
    v_exp_f32 v103, v103
    buffer_load_dwordx4 v1, s[56:59], m0 offen lds
    v_mfma_f32_32x32x16_bf16 v[80:95], v[24:27], v[16:19], 0
    v_exp_f32 v104, v104
    v_exp_f32 v105, v105
    v_exp_f32 v106, v106
    v_exp_f32 v107, v107
    v_mfma_f32_32x32x16_bf16 v[160:175], v[44:47], v[140:143], v[160:175]
    v_exp_f32 v108, v108
    v_exp_f32 v109, v109
    v_exp_f32 v110, v110
    v_exp_f32 v111, v111
    v_mfma_f32_32x32x8_bf16 v[64:79], v[28:29], v[12:13], v[64:79]
    ds_read_b128 v[32:35], v56 offset:3072
    ds_read_b64 v[36:37], v57 offset:768
    v_cvt_pk_bf16_f32 v128, v96, v97
    v_cvt_pk_bf16_f32 v129, v98, v99
    v_cvt_pk_bf16_f32 v130, v100, v101
    v_cvt_pk_bf16_f32 v131, v102, v103
    v_cvt_pk_bf16_f32 v132, v104, v105
    v_cvt_pk_bf16_f32 v133, v106, v107
    v_cvt_pk_bf16_f32 v134, v108, v109
    v_cvt_pk_bf16_f32 v135, v110, v111
    v_mfma_f32_32x32x8_bf16 v[80:95], v[28:29], v[20:21], v[80:95]
    v_exp_f32 v112, v112
    v_exp_f32 v113, v113
    v_exp_f32 v114, v114
    v_exp_f32 v115, v115
    s_waitcnt lgkmcnt(2)
    v_mfma_f32_32x32x16_bf16 v[144:159], v[48:51], v[128:131], v[144:159]
    v_exp_f32 v116, v116
    v_exp_f32 v117, v117
    v_exp_f32 v118, v118
    v_exp_f32 v119, v119
    v_exp_f32 v120, v120
    v_exp_f32 v121, v121
    v_exp_f32 v122, v122
    v_exp_f32 v123, v123
    v_mfma_f32_32x32x16_bf16 v[144:159], v[52:55], v[132:135], v[144:159]
    v_exp_f32 v124, v124
    v_exp_f32 v125, v125
    v_exp_f32 v126, v126
    v_exp_f32 v127, v127
    s_setprio 0
    s_mov_b64 exec, s[22:23]
    ds_read_b128 v[40:43], v58 offset:2560
    ds_read_b128 v[44:47], v58 offset:3200
    s_mov_b64 exec, -1
    v_cvt_pk_bf16_f32 v136, v112, v113
    v_cvt_pk_bf16_f32 v137, v114, v115
    v_cvt_pk_bf16_f32 v138, v116, v117
    v_cvt_pk_bf16_f32 v139, v118, v119
    v_cvt_pk_bf16_f32 v140, v120, v121
    v_cvt_pk_bf16_f32 v141, v122, v123
    v_cvt_pk_bf16_f32 v142, v124, v125
    v_cvt_pk_bf16_f32 v143, v126, v127
    s_waitcnt lgkmcnt(2)
    v_mfma_f32_32x32x16_bf16 v[96:111], v[32:35], v[8:11], 0
    v_exp_f32 v64, v64
    v_exp_f32 v65, v65
    v_exp_f32 v66, v66
    v_exp_f32 v67, v67
    s_setprio 1
    s_add_u32 m0, s20, 86016
    v_mfma_f32_32x32x16_bf16 v[160:175], v[48:51], v[136:139], v[160:175]
    v_exp_f32 v68, v68
    v_exp_f32 v69, v69
    v_exp_f32 v70, v70
    v_exp_f32 v71, v71
    buffer_load_dwordx4 v1, s[56:59], m0 offen lds
    v_mfma_f32_32x32x16_bf16 v[112:127], v[32:35], v[16:19], 0
    v_exp_f32 v72, v72
    v_exp_f32 v73, v73
    v_exp_f32 v74, v74
    v_exp_f32 v75, v75
    v_mfma_f32_32x32x16_bf16 v[160:175], v[52:55], v[140:143], v[160:175]
    v_exp_f32 v76, v76
    v_exp_f32 v77, v77
    v_exp_f32 v78, v78
    v_exp_f32 v79, v79
    v_mfma_f32_32x32x8_bf16 v[96:111], v[36:37], v[12:13], v[96:111]
    ds_read_b128 v[24:27], v56 offset:4096
    ds_read_b64 v[28:29], v57 offset:1024
    v_cvt_pk_bf16_f32 v128, v64, v65
    v_cvt_pk_bf16_f32 v129, v66, v67
    v_cvt_pk_bf16_f32 v130, v68, v69
    v_cvt_pk_bf16_f32 v131, v70, v71
    v_cvt_pk_bf16_f32 v132, v72, v73
    v_cvt_pk_bf16_f32 v133, v74, v75
    v_cvt_pk_bf16_f32 v134, v76, v77
    v_cvt_pk_bf16_f32 v135, v78, v79
    v_mfma_f32_32x32x8_bf16 v[112:127], v[36:37], v[20:21], v[112:127]
    v_exp_f32 v80, v80
    v_exp_f32 v81, v81
    v_exp_f32 v82, v82
    v_exp_f32 v83, v83
    s_waitcnt lgkmcnt(2)
    v_mfma_f32_32x32x16_bf16 v[144:159], v[40:43], v[128:131], v[144:159]
    v_exp_f32 v84, v84
    v_exp_f32 v85, v85
    v_exp_f32 v86, v86
    v_exp_f32 v87, v87
    v_exp_f32 v88, v88
    v_exp_f32 v89, v89
    v_exp_f32 v90, v90
    v_exp_f32 v91, v91
    v_mfma_f32_32x32x16_bf16 v[144:159], v[44:47], v[132:135], v[144:159]
    v_exp_f32 v92, v92
    v_exp_f32 v93, v93
    v_exp_f32 v94, v94
    v_exp_f32 v95, v95
    s_setprio 0
    s_mov_b64 exec, s[22:23]
    ds_read_b128 v[48:51], v58 offset:3840
    ds_read_b128 v[52:55], v58 offset:4480
    s_mov_b64 exec, -1
    v_cvt_pk_bf16_f32 v136, v80, v81
    v_cvt_pk_bf16_f32 v137, v82, v83
    v_cvt_pk_bf16_f32 v138, v84, v85
    v_cvt_pk_bf16_f32 v139, v86, v87
    v_cvt_pk_bf16_f32 v140, v88, v89
    v_cvt_pk_bf16_f32 v141, v90, v91
    v_cvt_pk_bf16_f32 v142, v92, v93
    v_cvt_pk_bf16_f32 v143, v94, v95
    s_waitcnt lgkmcnt(2)
    v_mfma_f32_32x32x16_bf16 v[64:79], v[24:27], v[8:11], 0
    s_add_u32 s21, s20, 122880
    v_add_u32 v196, s21, v1
    s_waitcnt vmcnt(5)
    ds_read_b128 v[176:179], v196 offset:0
    ds_read_b128 v[180:183], v196 offset:1024
    ds_read_b128 v[184:187], v196 offset:2048
    ds_read_b128 v[188:191], v196 offset:3072
    ds_read_b128 v[192:195], v196 offset:4096
    v_exp_f32 v96, v96
    v_exp_f32 v97, v97
    v_exp_f32 v98, v98
    v_exp_f32 v99, v99
    s_setprio 1
    v_mfma_f32_32x32x16_bf16 v[160:175], v[40:43], v[136:139], v[160:175]
    v_exp_f32 v100, v100
    v_exp_f32 v101, v101
    v_exp_f32 v102, v102
    v_exp_f32 v103, v103
    v_mfma_f32_32x32x16_bf16 v[80:95], v[24:27], v[16:19], 0
    v_exp_f32 v104, v104
    v_exp_f32 v105, v105
    v_exp_f32 v106, v106
    v_exp_f32 v107, v107
    v_mfma_f32_32x32x16_bf16 v[160:175], v[44:47], v[140:143], v[160:175]
    v_exp_f32 v108, v108
    v_exp_f32 v109, v109
    v_exp_f32 v110, v110
    v_exp_f32 v111, v111
    v_mfma_f32_32x32x8_bf16 v[64:79], v[28:29], v[12:13], v[64:79]
    ds_read_b128 v[32:35], v56 offset:5120
    ds_read_b64 v[36:37], v57 offset:1280
    v_cvt_pk_bf16_f32 v128, v96, v97
    v_cvt_pk_bf16_f32 v129, v98, v99
    v_cvt_pk_bf16_f32 v130, v100, v101
    v_cvt_pk_bf16_f32 v131, v102, v103
    v_cvt_pk_bf16_f32 v132, v104, v105
    v_cvt_pk_bf16_f32 v133, v106, v107
    v_cvt_pk_bf16_f32 v134, v108, v109
    v_cvt_pk_bf16_f32 v135, v110, v111
    v_mfma_f32_32x32x8_bf16 v[80:95], v[28:29], v[20:21], v[80:95]
    v_exp_f32 v112, v112
    v_exp_f32 v113, v113
    v_exp_f32 v114, v114
    v_exp_f32 v115, v115
    s_waitcnt lgkmcnt(2)
    v_mfma_f32_32x32x16_bf16 v[144:159], v[48:51], v[128:131], v[144:159]
    v_exp_f32 v116, v116
    v_exp_f32 v117, v117
    v_exp_f32 v118, v118
    v_exp_f32 v119, v119
    v_exp_f32 v120, v120
    v_exp_f32 v121, v121
    v_exp_f32 v122, v122
    v_exp_f32 v123, v123
    v_mfma_f32_32x32x16_bf16 v[144:159], v[52:55], v[132:135], v[144:159]
    v_exp_f32 v124, v124
    v_exp_f32 v125, v125
    v_exp_f32 v126, v126
    v_exp_f32 v127, v127
    s_setprio 0
    s_mov_b64 exec, s[22:23]
    ds_read_b128 v[40:43], v58 offset:5120
    ds_read_b128 v[44:47], v58 offset:5760
    s_mov_b64 exec, -1
    v_cvt_pk_bf16_f32 v136, v112, v113
    v_cvt_pk_bf16_f32 v137, v114, v115
    v_cvt_pk_bf16_f32 v138, v116, v117
    v_cvt_pk_bf16_f32 v139, v118, v119
    v_cvt_pk_bf16_f32 v140, v120, v121
    v_cvt_pk_bf16_f32 v141, v122, v123
    v_cvt_pk_bf16_f32 v142, v124, v125
    v_cvt_pk_bf16_f32 v143, v126, v127
    v_max3_u32 v197, v176, v177, v178
    v_max3_u32 v198, v179, v180, v181
    v_max3_u32 v197, v197, v182, v183
    v_max3_u32 v198, v198, v184, v185
    v_max3_u32 v197, v197, v186, v187
    v_max3_u32 v198, v198, v188, v189
    v_max3_u32 v197, v197, v190, v191
    v_max3_u32 v198, v198, v192, v193
    v_max3_u32 v197, v197, v194, v195
    v_max_u32 v197, v197, v198
    v_cmp_eq_u32 vcc, -1, v197
    s_cbranch_vccnz fused2_kernel_vr23
fused2_kernel_vd26:
    s_waitcnt lgkmcnt(2)
    v_mfma_f32_32x32x16_bf16 v[96:111], v[32:35], v[8:11], 0
    v_exp_f32 v64, v64
    v_exp_f32 v65, v65
    v_exp_f32 v66, v66
    v_exp_f32 v67, v67
    s_setprio 1
    v_mfma_f32_32x32x16_bf16 v[160:175], v[48:51], v[136:139], v[160:175]
    v_exp_f32 v68, v68
    v_exp_f32 v69, v69
    v_exp_f32 v70, v70
    v_exp_f32 v71, v71
    v_mfma_f32_32x32x16_bf16 v[112:127], v[32:35], v[16:19], 0
    v_exp_f32 v72, v72
    v_exp_f32 v73, v73
    v_exp_f32 v74, v74
    v_exp_f32 v75, v75
    v_mfma_f32_32x32x16_bf16 v[160:175], v[52:55], v[140:143], v[160:175]
    v_exp_f32 v76, v76
    v_exp_f32 v77, v77
    v_exp_f32 v78, v78
    v_exp_f32 v79, v79
    v_mfma_f32_32x32x8_bf16 v[96:111], v[36:37], v[12:13], v[96:111]
    ds_read_b128 v[24:27], v56 offset:6144
    ds_read_b64 v[28:29], v57 offset:1536
    v_cvt_pk_bf16_f32 v128, v64, v65
    v_cvt_pk_bf16_f32 v129, v66, v67
    v_cvt_pk_bf16_f32 v130, v68, v69
    v_cvt_pk_bf16_f32 v131, v70, v71
    v_cvt_pk_bf16_f32 v132, v72, v73
    v_cvt_pk_bf16_f32 v133, v74, v75
    v_cvt_pk_bf16_f32 v134, v76, v77
    v_cvt_pk_bf16_f32 v135, v78, v79
    v_mfma_f32_32x32x8_bf16 v[112:127], v[36:37], v[20:21], v[112:127]
    v_exp_f32 v80, v80
    v_exp_f32 v81, v81
    v_exp_f32 v82, v82
    v_exp_f32 v83, v83
    s_waitcnt lgkmcnt(2)
    v_mfma_f32_32x32x16_bf16 v[144:159], v[40:43], v[128:131], v[144:159]
    v_exp_f32 v84, v84
    v_exp_f32 v85, v85
    v_exp_f32 v86, v86
    v_exp_f32 v87, v87
    v_exp_f32 v88, v88
    v_exp_f32 v89, v89
    v_exp_f32 v90, v90
    v_exp_f32 v91, v91
    v_mfma_f32_32x32x16_bf16 v[144:159], v[44:47], v[132:135], v[144:159]
    v_exp_f32 v92, v92
    v_exp_f32 v93, v93
    v_exp_f32 v94, v94
    v_exp_f32 v95, v95
    s_setprio 0
    s_mov_b64 exec, s[22:23]
    ds_read_b128 v[48:51], v58 offset:6400
    ds_read_b128 v[52:55], v58 offset:7040
    s_mov_b64 exec, -1
    v_cvt_pk_bf16_f32 v136, v80, v81
    v_cvt_pk_bf16_f32 v137, v82, v83
    v_cvt_pk_bf16_f32 v138, v84, v85
    v_cvt_pk_bf16_f32 v139, v86, v87
    v_cvt_pk_bf16_f32 v140, v88, v89
    v_cvt_pk_bf16_f32 v141, v90, v91
    v_cvt_pk_bf16_f32 v142, v92, v93
    v_cvt_pk_bf16_f32 v143, v94, v95
    s_waitcnt lgkmcnt(2)
    v_mfma_f32_32x32x16_bf16 v[64:79], v[24:27], v[8:11], 0
    s_add_u32 s21, s20, 81920
    v_add_u32 v196, s21, v1
    s_waitcnt vmcnt(0)
    ds_read_b128 v[176:179], v196 offset:0
    ds_read_b128 v[180:183], v196 offset:1024
    ds_read_b128 v[184:187], v196 offset:2048
    ds_read_b128 v[188:191], v196 offset:3072
    ds_read_b128 v[192:195], v196 offset:4096
    v_exp_f32 v96, v96
    v_exp_f32 v97, v97
    v_exp_f32 v98, v98
    v_exp_f32 v99, v99
    s_setprio 1
    v_mfma_f32_32x32x16_bf16 v[160:175], v[40:43], v[136:139], v[160:175]
    v_exp_f32 v100, v100
    v_exp_f32 v101, v101
    v_exp_f32 v102, v102
    v_exp_f32 v103, v103
    v_mfma_f32_32x32x16_bf16 v[80:95], v[24:27], v[16:19], 0
    v_exp_f32 v104, v104
    v_exp_f32 v105, v105
    v_exp_f32 v106, v106
    v_exp_f32 v107, v107
    v_mfma_f32_32x32x16_bf16 v[160:175], v[44:47], v[140:143], v[160:175]
    v_exp_f32 v108, v108
    v_exp_f32 v109, v109
    v_exp_f32 v110, v110
    v_exp_f32 v111, v111
    v_mfma_f32_32x32x8_bf16 v[64:79], v[28:29], v[12:13], v[64:79]
    ds_read_b128 v[32:35], v56 offset:7168
    ds_read_b64 v[36:37], v57 offset:1792
    v_cvt_pk_bf16_f32 v128, v96, v97
    v_cvt_pk_bf16_f32 v129, v98, v99
    v_cvt_pk_bf16_f32 v130, v100, v101
    v_cvt_pk_bf16_f32 v131, v102, v103
    v_cvt_pk_bf16_f32 v132, v104, v105
    v_cvt_pk_bf16_f32 v133, v106, v107
    v_cvt_pk_bf16_f32 v134, v108, v109
    v_cvt_pk_bf16_f32 v135, v110, v111
    v_mfma_f32_32x32x8_bf16 v[80:95], v[28:29], v[20:21], v[80:95]
    v_exp_f32 v112, v112
    v_exp_f32 v113, v113
    v_exp_f32 v114, v114
    v_exp_f32 v115, v115
    s_waitcnt lgkmcnt(2)
    v_mfma_f32_32x32x16_bf16 v[144:159], v[48:51], v[128:131], v[144:159]
    v_exp_f32 v116, v116
    v_exp_f32 v117, v117
    v_exp_f32 v118, v118
    v_exp_f32 v119, v119
    v_exp_f32 v120, v120
    v_exp_f32 v121, v121
    v_exp_f32 v122, v122
    v_exp_f32 v123, v123
    v_mfma_f32_32x32x16_bf16 v[144:159], v[52:55], v[132:135], v[144:159]
    v_exp_f32 v124, v124
    v_exp_f32 v125, v125
    v_exp_f32 v126, v126
    v_exp_f32 v127, v127
    s_setprio 0
    s_mov_b64 exec, s[22:23]
    ds_read_b128 v[40:43], v58 offset:7680
    ds_read_b128 v[44:47], v58 offset:8320
    s_mov_b64 exec, -1
    v_cvt_pk_bf16_f32 v136, v112, v113
    v_cvt_pk_bf16_f32 v137, v114, v115
    v_cvt_pk_bf16_f32 v138, v116, v117
    v_cvt_pk_bf16_f32 v139, v118, v119
    v_cvt_pk_bf16_f32 v140, v120, v121
    v_cvt_pk_bf16_f32 v141, v122, v123
    v_cvt_pk_bf16_f32 v142, v124, v125
    v_cvt_pk_bf16_f32 v143, v126, v127
    v_max3_u32 v197, v176, v177, v178
    v_max3_u32 v198, v179, v180, v181
    v_max3_u32 v197, v197, v182, v183
    v_max3_u32 v198, v198, v184, v185
    v_max3_u32 v197, v197, v186, v187
    v_max3_u32 v198, v198, v188, v189
    v_max3_u32 v197, v197, v190, v191
    v_max3_u32 v198, v198, v192, v193
    v_max3_u32 v197, v197, v194, v195
    v_max_u32 v197, v197, v198
    v_cmp_eq_u32 vcc, -1, v197
    s_cbranch_vccnz fused2_kernel_vr22
fused2_kernel_vd25:
    s_barrier
    s_waitcnt lgkmcnt(2)
    v_mfma_f32_32x32x16_bf16 v[96:111], v[32:35], v[8:11], 0
    v_exp_f32 v64, v64
    v_exp_f32 v65, v65
    v_exp_f32 v66, v66
    v_exp_f32 v67, v67
    s_setprio 1
    v_mfma_f32_32x32x16_bf16 v[160:175], v[48:51], v[136:139], v[160:175]
    v_exp_f32 v68, v68
    v_exp_f32 v69, v69
    v_exp_f32 v70, v70
    v_exp_f32 v71, v71
    v_mfma_f32_32x32x16_bf16 v[112:127], v[32:35], v[16:19], 0
    v_exp_f32 v72, v72
    v_exp_f32 v73, v73
    v_exp_f32 v74, v74
    v_exp_f32 v75, v75
    v_mfma_f32_32x32x16_bf16 v[160:175], v[52:55], v[140:143], v[160:175]
    v_exp_f32 v76, v76
    v_exp_f32 v77, v77
    v_exp_f32 v78, v78
    v_exp_f32 v79, v79
    v_mfma_f32_32x32x8_bf16 v[96:111], v[36:37], v[12:13], v[96:111]
    ds_read_b128 v[24:27], v56 offset:40960
    ds_read_b64 v[28:29], v57 offset:40960
    v_cvt_pk_bf16_f32 v128, v64, v65
    v_cvt_pk_bf16_f32 v129, v66, v67
    v_cvt_pk_bf16_f32 v130, v68, v69
    v_cvt_pk_bf16_f32 v131, v70, v71
    v_cvt_pk_bf16_f32 v132, v72, v73
    v_cvt_pk_bf16_f32 v133, v74, v75
    v_cvt_pk_bf16_f32 v134, v76, v77
    v_cvt_pk_bf16_f32 v135, v78, v79
    v_mfma_f32_32x32x8_bf16 v[112:127], v[36:37], v[20:21], v[112:127]
    v_exp_f32 v80, v80
    v_exp_f32 v81, v81
    v_exp_f32 v82, v82
    v_exp_f32 v83, v83
    s_waitcnt lgkmcnt(2)
    v_mfma_f32_32x32x16_bf16 v[144:159], v[40:43], v[128:131], v[144:159]
    v_exp_f32 v84, v84
    v_exp_f32 v85, v85
    v_exp_f32 v86, v86
    v_exp_f32 v87, v87
    v_exp_f32 v88, v88
    v_exp_f32 v89, v89
    v_exp_f32 v90, v90
    v_exp_f32 v91, v91
    v_mfma_f32_32x32x16_bf16 v[144:159], v[44:47], v[132:135], v[144:159]
    v_exp_f32 v92, v92
    v_exp_f32 v93, v93
    v_exp_f32 v94, v94
    v_exp_f32 v95, v95
    s_setprio 0
    s_mov_b64 exec, s[22:23]
    ds_read_b128 v[48:51], v58 offset:8960
    ds_read_b128 v[52:55], v58 offset:9600
    s_mov_b64 exec, -1
    v_cvt_pk_bf16_f32 v136, v80, v81
    v_cvt_pk_bf16_f32 v137, v82, v83
    v_cvt_pk_bf16_f32 v138, v84, v85
    v_cvt_pk_bf16_f32 v139, v86, v87
    v_cvt_pk_bf16_f32 v140, v88, v89
    v_cvt_pk_bf16_f32 v141, v90, v91
    v_cvt_pk_bf16_f32 v142, v92, v93
    v_cvt_pk_bf16_f32 v143, v94, v95
    s_waitcnt lgkmcnt(2)
    v_mfma_f32_32x32x16_bf16 v[64:79], v[24:27], v[8:11], 0
    v_exp_f32 v96, v96
    v_exp_f32 v97, v97
    v_exp_f32 v98, v98
    v_exp_f32 v99, v99
    s_setprio 1
    s_mul_i32 s34, s4, 5
    s_cmp_eq_u32 s31, 0
    s_cselect_b32 s5, s30, 4
    s_cselect_b32 s27, s4, s30
    s_add_u32 s34, s34, s5
    s_mul_i32 s33, s34, 40960
    s_mul_i32 s27, s27, 10240
    s_add_u32 s27, s27, s33
    s_add_u32 s5, s4, 1
    s_and_b32 s5, s5, 3
    s_mul_i32 s5, s5, 10240
    s_add_u32 s33, s33, s5
    v_lshlrev_b32 v232, 8, v4
    v_lshl_add_u32 v232, v3, 1, v232
    s_mul_i32 s35, s3, 40960
    s_lshl_b32 s26, s34, 11
    s_add_u32 s35, s35, s26
    v_mfma_f32_32x32x16_bf16 v[160:175], v[40:43], v[136:139], v[160:175]
    v_exp_f32 v100, v100
    v_exp_f32 v101, v101
    v_exp_f32 v102, v102
    v_exp_f32 v103, v103
    buffer_load_dwordx4 v[176:179], v1, s[64:67], s27 offen offset:0
    v_mfma_f32_32x32x16_bf16 v[80:95], v[24:27], v[16:19], 0
    v_exp_f32 v104, v104
    v_exp_f32 v105, v105
    v_exp_f32 v106, v106
    v_exp_f32 v107, v107
    v_mfma_f32_32x32x16_bf16 v[160:175], v[44:47], v[140:143], v[160:175]
    v_exp_f32 v108, v108
    v_exp_f32 v109, v109
    v_exp_f32 v110, v110
    v_exp_f32 v111, v111
    v_mfma_f32_32x32x8_bf16 v[64:79], v[28:29], v[12:13], v[64:79]
    ds_read_b128 v[32:35], v56 offset:41984
    ds_read_b64 v[36:37], v57 offset:41216
    v_cvt_pk_bf16_f32 v128, v96, v97
    v_cvt_pk_bf16_f32 v129, v98, v99
    v_cvt_pk_bf16_f32 v130, v100, v101
    v_cvt_pk_bf16_f32 v131, v102, v103
    v_cvt_pk_bf16_f32 v132, v104, v105
    v_cvt_pk_bf16_f32 v133, v106, v107
    v_cvt_pk_bf16_f32 v134, v108, v109
    v_cvt_pk_bf16_f32 v135, v110, v111
    v_mfma_f32_32x32x8_bf16 v[80:95], v[28:29], v[20:21], v[80:95]
    v_exp_f32 v112, v112
    v_exp_f32 v113, v113
    v_exp_f32 v114, v114
    v_exp_f32 v115, v115
    s_waitcnt lgkmcnt(2)
    v_mfma_f32_32x32x16_bf16 v[144:159], v[48:51], v[128:131], v[144:159]
    v_exp_f32 v116, v116
    v_exp_f32 v117, v117
    v_exp_f32 v118, v118
    v_exp_f32 v119, v119
    v_exp_f32 v120, v120
    v_exp_f32 v121, v121
    v_exp_f32 v122, v122
    v_exp_f32 v123, v123
    v_mfma_f32_32x32x16_bf16 v[144:159], v[52:55], v[132:135], v[144:159]
    v_exp_f32 v124, v124
    v_exp_f32 v125, v125
    v_exp_f32 v126, v126
    v_exp_f32 v127, v127
    s_setprio 0
    s_mov_b64 exec, s[22:23]
    ds_read_b128 v[40:43], v58 offset:40960
    ds_read_b128 v[44:47], v58 offset:41600
    s_mov_b64 exec, -1
    v_cvt_pk_bf16_f32 v136, v112, v113
    v_cvt_pk_bf16_f32 v137, v114, v115
    v_cvt_pk_bf16_f32 v138, v116, v117
    v_cvt_pk_bf16_f32 v139, v118, v119
    v_cvt_pk_bf16_f32 v140, v120, v121
    v_cvt_pk_bf16_f32 v141, v122, v123
    v_cvt_pk_bf16_f32 v142, v124, v125
    v_cvt_pk_bf16_f32 v143, v126, v127
    v_add_u32 v56, 40960, v56
    v_add_u32 v57, 40960, v57
    v_add_u32 v58, 40960, v58
    s_waitcnt lgkmcnt(2)
    v_mfma_f32_32x32x16_bf16 v[96:111], v[32:35], v[8:11], 0
    v_exp_f32 v64, v64
    v_exp_f32 v65, v65
    v_exp_f32 v66, v66
    v_exp_f32 v67, v67
    s_setprio 1
    v_mfma_f32_32x32x16_bf16 v[160:175], v[48:51], v[136:139], v[160:175]
    v_exp_f32 v68, v68
    v_exp_f32 v69, v69
    v_exp_f32 v70, v70
    v_exp_f32 v71, v71
    buffer_load_dwordx4 v[180:183], v1, s[64:67], s27 offen offset:1024
    v_mfma_f32_32x32x16_bf16 v[112:127], v[32:35], v[16:19], 0
    v_exp_f32 v72, v72
    v_exp_f32 v73, v73
    v_exp_f32 v74, v74
    v_exp_f32 v75, v75
    v_mfma_f32_32x32x16_bf16 v[160:175], v[52:55], v[140:143], v[160:175]
    v_exp_f32 v76, v76
    v_exp_f32 v77, v77
    v_exp_f32 v78, v78
    v_exp_f32 v79, v79
    v_mfma_f32_32x32x8_bf16 v[96:111], v[36:37], v[12:13], v[96:111]
    ds_read_b128 v[24:27], v56 offset:2048
    ds_read_b64 v[28:29], v57 offset:512
    v_cvt_pk_bf16_f32 v128, v64, v65
    v_cvt_pk_bf16_f32 v129, v66, v67
    v_cvt_pk_bf16_f32 v130, v68, v69
    v_cvt_pk_bf16_f32 v131, v70, v71
    v_cvt_pk_bf16_f32 v132, v72, v73
    v_cvt_pk_bf16_f32 v133, v74, v75
    v_cvt_pk_bf16_f32 v134, v76, v77
    v_cvt_pk_bf16_f32 v135, v78, v79
    v_mfma_f32_32x32x8_bf16 v[112:127], v[36:37], v[20:21], v[112:127]
    v_exp_f32 v80, v80
    v_exp_f32 v81, v81
    v_exp_f32 v82, v82
    v_exp_f32 v83, v83
    s_waitcnt lgkmcnt(2)
    v_mfma_f32_32x32x16_bf16 v[144:159], v[40:43], v[128:131], v[144:159]
    v_exp_f32 v84, v84
    v_exp_f32 v85, v85
    v_exp_f32 v86, v86
    v_exp_f32 v87, v87
    s_cmp_lg_u32 s40, 4
    s_cbranch_scc1 fused2_kernel_w327
    buffer_load_ushort v216, v232, s[48:51], s35 offen offset:0
    buffer_load_ushort v217, v232, s[48:51], s35 offen offset:64
    buffer_load_ushort v218, v232, s[48:51], s35 offen offset:128
    buffer_load_ushort v219, v232, s[48:51], s35 offen offset:192
fused2_kernel_w327:
    v_exp_f32 v88, v88
    v_exp_f32 v89, v89
    v_exp_f32 v90, v90
    v_exp_f32 v91, v91
    v_mfma_f32_32x32x16_bf16 v[144:159], v[44:47], v[132:135], v[144:159]
    v_exp_f32 v92, v92
    v_exp_f32 v93, v93
    v_exp_f32 v94, v94
    v_exp_f32 v95, v95
    s_setprio 0
    s_mov_b64 exec, s[22:23]
    ds_read_b128 v[48:51], v58 offset:1280
    ds_read_b128 v[52:55], v58 offset:1920
    s_mov_b64 exec, -1
    v_cvt_pk_bf16_f32 v136, v80, v81
    v_cvt_pk_bf16_f32 v137, v82, v83
    v_cvt_pk_bf16_f32 v138, v84, v85
    v_cvt_pk_bf16_f32 v139, v86, v87
    v_cvt_pk_bf16_f32 v140, v88, v89
    v_cvt_pk_bf16_f32 v141, v90, v91
    v_cvt_pk_bf16_f32 v142, v92, v93
    v_cvt_pk_bf16_f32 v143, v94, v95
    s_waitcnt lgkmcnt(2)
    v_mfma_f32_32x32x16_bf16 v[64:79], v[24:27], v[8:11], 0
    v_exp_f32 v96, v96
    v_exp_f32 v97, v97
    v_exp_f32 v98, v98
    v_exp_f32 v99, v99
    s_setprio 1
    v_mfma_f32_32x32x16_bf16 v[160:175], v[40:43], v[136:139], v[160:175]
    v_exp_f32 v100, v100
    v_exp_f32 v101, v101
    v_exp_f32 v102, v102
    v_exp_f32 v103, v103
    buffer_load_dwordx4 v[184:187], v1, s[64:67], s27 offen offset:2048
    v_mfma_f32_32x32x16_bf16 v[80:95], v[24:27], v[16:19], 0
    v_exp_f32 v104, v104
    v_exp_f32 v105, v105
    v_exp_f32 v106, v106
    v_exp_f32 v107, v107
    v_mfma_f32_32x32x16_bf16 v[160:175], v[44:47], v[140:143], v[160:175]
    v_exp_f32 v108, v108
    v_exp_f32 v109, v109
    v_exp_f32 v110, v110
    v_exp_f32 v111, v111
    v_mfma_f32_32x32x8_bf16 v[64:79], v[28:29], v[12:13], v[64:79]
    ds_read_b128 v[32:35], v56 offset:3072
    ds_read_b64 v[36:37], v57 offset:768
    v_cvt_pk_bf16_f32 v128, v96, v97
    v_cvt_pk_bf16_f32 v129, v98, v99
    v_cvt_pk_bf16_f32 v130, v100, v101
    v_cvt_pk_bf16_f32 v131, v102, v103
    v_cvt_pk_bf16_f32 v132, v104, v105
    v_cvt_pk_bf16_f32 v133, v106, v107
    v_cvt_pk_bf16_f32 v134, v108, v109
    v_cvt_pk_bf16_f32 v135, v110, v111
    v_mfma_f32_32x32x8_bf16 v[80:95], v[28:29], v[20:21], v[80:95]
    v_exp_f32 v112, v112
    v_exp_f32 v113, v113
    v_exp_f32 v114, v114
    v_exp_f32 v115, v115
    s_waitcnt lgkmcnt(2)
    v_mfma_f32_32x32x16_bf16 v[144:159], v[48:51], v[128:131], v[144:159]
    v_exp_f32 v116, v116
    v_exp_f32 v117, v117
    v_exp_f32 v118, v118
    v_exp_f32 v119, v119
    s_cmp_lg_u32 s40, 4
    s_cbranch_scc1 fused2_kernel_w328
    buffer_load_ushort v220, v232, s[48:51], s35 offen offset:512
    buffer_load_ushort v221, v232, s[48:51], s35 offen offset:576
    buffer_load_ushort v222, v232, s[48:51], s35 offen offset:640
    buffer_load_ushort v223, v232, s[48:51], s35 offen offset:704
fused2_kernel_w328:
    v_exp_f32 v120, v120
    v_exp_f32 v121, v121
    v_exp_f32 v122, v122
    v_exp_f32 v123, v123
    v_mfma_f32_32x32x16_bf16 v[144:159], v[52:55], v[132:135], v[144:159]
    v_exp_f32 v124, v124
    v_exp_f32 v125, v125
    v_exp_f32 v126, v126
    v_exp_f32 v127, v127
    s_setprio 0
    s_mov_b64 exec, s[22:23]
    ds_read_b128 v[40:43], v58 offset:2560
    ds_read_b128 v[44:47], v58 offset:3200
    s_mov_b64 exec, -1
    v_cvt_pk_bf16_f32 v136, v112, v113
    v_cvt_pk_bf16_f32 v137, v114, v115
    v_cvt_pk_bf16_f32 v138, v116, v117
    v_cvt_pk_bf16_f32 v139, v118, v119
    v_cvt_pk_bf16_f32 v140, v120, v121
    v_cvt_pk_bf16_f32 v141, v122, v123
    v_cvt_pk_bf16_f32 v142, v124, v125
    v_cvt_pk_bf16_f32 v143, v126, v127
    s_waitcnt lgkmcnt(2)
    v_mfma_f32_32x32x16_bf16 v[96:111], v[32:35], v[8:11], 0
    v_exp_f32 v64, v64
    v_exp_f32 v65, v65
    v_exp_f32 v66, v66
    v_exp_f32 v67, v67
    s_setprio 1
    v_mfma_f32_32x32x16_bf16 v[160:175], v[48:51], v[136:139], v[160:175]
    v_exp_f32 v68, v68
    v_exp_f32 v69, v69
    v_exp_f32 v70, v70
    v_exp_f32 v71, v71
    buffer_load_dwordx4 v[188:191], v1, s[64:67], s27 offen offset:3072
    s_add_u32 s27, s27, 4096
    v_mfma_f32_32x32x16_bf16 v[112:127], v[32:35], v[16:19], 0
    v_exp_f32 v72, v72
    v_exp_f32 v73, v73
    v_exp_f32 v74, v74
    v_exp_f32 v75, v75
    v_mfma_f32_32x32x16_bf16 v[160:175], v[52:55], v[140:143], v[160:175]
    v_exp_f32 v76, v76
    v_exp_f32 v77, v77
    v_exp_f32 v78, v78
    v_exp_f32 v79, v79
    v_mfma_f32_32x32x8_bf16 v[96:111], v[36:37], v[12:13], v[96:111]
    ds_read_b128 v[24:27], v56 offset:4096
    ds_read_b64 v[28:29], v57 offset:1024
    v_cvt_pk_bf16_f32 v128, v64, v65
    v_cvt_pk_bf16_f32 v129, v66, v67
    v_cvt_pk_bf16_f32 v130, v68, v69
    v_cvt_pk_bf16_f32 v131, v70, v71
    v_cvt_pk_bf16_f32 v132, v72, v73
    v_cvt_pk_bf16_f32 v133, v74, v75
    v_cvt_pk_bf16_f32 v134, v76, v77
    v_cvt_pk_bf16_f32 v135, v78, v79
    v_mfma_f32_32x32x8_bf16 v[112:127], v[36:37], v[20:21], v[112:127]
    v_exp_f32 v80, v80
    v_exp_f32 v81, v81
    v_exp_f32 v82, v82
    v_exp_f32 v83, v83
    s_waitcnt lgkmcnt(2)
    v_mfma_f32_32x32x16_bf16 v[144:159], v[40:43], v[128:131], v[144:159]
    v_exp_f32 v84, v84
    v_exp_f32 v85, v85
    v_exp_f32 v86, v86
    v_exp_f32 v87, v87
    s_cmp_lg_u32 s40, 4
    s_cbranch_scc1 fused2_kernel_w329
    buffer_load_ushort v224, v232, s[48:51], s35 offen offset:1024
    buffer_load_ushort v225, v232, s[48:51], s35 offen offset:1088
    buffer_load_ushort v226, v232, s[48:51], s35 offen offset:1152
    buffer_load_ushort v227, v232, s[48:51], s35 offen offset:1216
fused2_kernel_w329:
    v_exp_f32 v88, v88
    v_exp_f32 v89, v89
    v_exp_f32 v90, v90
    v_exp_f32 v91, v91
    v_mfma_f32_32x32x16_bf16 v[144:159], v[44:47], v[132:135], v[144:159]
    v_exp_f32 v92, v92
    v_exp_f32 v93, v93
    v_exp_f32 v94, v94
    v_exp_f32 v95, v95
    s_setprio 0
    s_mov_b64 exec, s[22:23]
    ds_read_b128 v[48:51], v58 offset:3840
    ds_read_b128 v[52:55], v58 offset:4480
    s_mov_b64 exec, -1
    v_cvt_pk_bf16_f32 v136, v80, v81
    v_cvt_pk_bf16_f32 v137, v82, v83
    v_cvt_pk_bf16_f32 v138, v84, v85
    v_cvt_pk_bf16_f32 v139, v86, v87
    v_cvt_pk_bf16_f32 v140, v88, v89
    v_cvt_pk_bf16_f32 v141, v90, v91
    v_cvt_pk_bf16_f32 v142, v92, v93
    v_cvt_pk_bf16_f32 v143, v94, v95
    s_waitcnt lgkmcnt(2)
    v_mfma_f32_32x32x16_bf16 v[64:79], v[24:27], v[8:11], 0
    v_exp_f32 v96, v96
    v_exp_f32 v97, v97
    v_exp_f32 v98, v98
    v_exp_f32 v99, v99
    s_setprio 1
    v_mfma_f32_32x32x16_bf16 v[160:175], v[40:43], v[136:139], v[160:175]
    v_exp_f32 v100, v100
    v_exp_f32 v101, v101
    v_exp_f32 v102, v102
    v_exp_f32 v103, v103
    buffer_load_dwordx4 v[192:195], v1, s[64:67], s27 offen offset:0
    v_mfma_f32_32x32x16_bf16 v[80:95], v[24:27], v[16:19], 0
    v_exp_f32 v104, v104
    v_exp_f32 v105, v105
    v_exp_f32 v106, v106
    v_exp_f32 v107, v107
    v_mfma_f32_32x32x16_bf16 v[160:175], v[44:47], v[140:143], v[160:175]
    v_exp_f32 v108, v108
    v_exp_f32 v109, v109
    v_exp_f32 v110, v110
    v_exp_f32 v111, v111
    v_mfma_f32_32x32x8_bf16 v[64:79], v[28:29], v[12:13], v[64:79]
    ds_read_b128 v[32:35], v56 offset:5120
    ds_read_b64 v[36:37], v57 offset:1280
    v_cvt_pk_bf16_f32 v128, v96, v97
    v_cvt_pk_bf16_f32 v129, v98, v99
    v_cvt_pk_bf16_f32 v130, v100, v101
    v_cvt_pk_bf16_f32 v131, v102, v103
    v_cvt_pk_bf16_f32 v132, v104, v105
    v_cvt_pk_bf16_f32 v133, v106, v107
    v_cvt_pk_bf16_f32 v134, v108, v109
    v_cvt_pk_bf16_f32 v135, v110, v111
    v_mfma_f32_32x32x8_bf16 v[80:95], v[28:29], v[20:21], v[80:95]
    v_exp_f32 v112, v112
    v_exp_f32 v113, v113
    v_exp_f32 v114, v114
    v_exp_f32 v115, v115
    s_waitcnt lgkmcnt(2)
    v_mfma_f32_32x32x16_bf16 v[144:159], v[48:51], v[128:131], v[144:159]
    v_exp_f32 v116, v116
    v_exp_f32 v117, v117
    v_exp_f32 v118, v118
    v_exp_f32 v119, v119
    s_cmp_lg_u32 s40, 4
    s_cbranch_scc1 fused2_kernel_w330
    buffer_load_ushort v228, v232, s[48:51], s35 offen offset:1536
    buffer_load_ushort v229, v232, s[48:51], s35 offen offset:1600
    buffer_load_ushort v230, v232, s[48:51], s35 offen offset:1664
    buffer_load_ushort v231, v232, s[48:51], s35 offen offset:1728
fused2_kernel_w330:
    v_exp_f32 v120, v120
    v_exp_f32 v121, v121
    v_exp_f32 v122, v122
    v_exp_f32 v123, v123
    v_mfma_f32_32x32x16_bf16 v[144:159], v[52:55], v[132:135], v[144:159]
    v_exp_f32 v124, v124
    v_exp_f32 v125, v125
    v_exp_f32 v126, v126
    v_exp_f32 v127, v127
    s_setprio 0
    s_mov_b64 exec, s[22:23]
    ds_read_b128 v[40:43], v58 offset:5120
    ds_read_b128 v[44:47], v58 offset:5760
    s_mov_b64 exec, -1
    v_cvt_pk_bf16_f32 v136, v112, v113
    v_cvt_pk_bf16_f32 v137, v114, v115
    v_cvt_pk_bf16_f32 v138, v116, v117
    v_cvt_pk_bf16_f32 v139, v118, v119
    v_cvt_pk_bf16_f32 v140, v120, v121
    v_cvt_pk_bf16_f32 v141, v122, v123
    v_cvt_pk_bf16_f32 v142, v124, v125
    v_cvt_pk_bf16_f32 v143, v126, v127
    s_waitcnt lgkmcnt(2)
    v_mfma_f32_32x32x16_bf16 v[96:111], v[32:35], v[8:11], 0
    v_exp_f32 v64, v64
    v_exp_f32 v65, v65
    v_exp_f32 v66, v66
    v_exp_f32 v67, v67
    s_setprio 1
    v_mfma_f32_32x32x16_bf16 v[160:175], v[48:51], v[136:139], v[160:175]
    v_exp_f32 v68, v68
    v_exp_f32 v69, v69
    v_exp_f32 v70, v70
    v_exp_f32 v71, v71
    buffer_load_dwordx4 v[196:199], v1, s[64:67], s27 offen offset:1024
    v_mfma_f32_32x32x16_bf16 v[112:127], v[32:35], v[16:19], 0
    v_exp_f32 v72, v72
    v_exp_f32 v73, v73
    v_exp_f32 v74, v74
    v_exp_f32 v75, v75
    v_mfma_f32_32x32x16_bf16 v[160:175], v[52:55], v[140:143], v[160:175]
    v_exp_f32 v76, v76
    v_exp_f32 v77, v77
    v_exp_f32 v78, v78
    v_exp_f32 v79, v79
    v_mfma_f32_32x32x8_bf16 v[96:111], v[36:37], v[12:13], v[96:111]
    ds_read_b128 v[24:27], v56 offset:6144
    ds_read_b64 v[28:29], v57 offset:1536
    v_cvt_pk_bf16_f32 v128, v64, v65
    v_cvt_pk_bf16_f32 v129, v66, v67
    v_cvt_pk_bf16_f32 v130, v68, v69
    v_cvt_pk_bf16_f32 v131, v70, v71
    v_cvt_pk_bf16_f32 v132, v72, v73
    v_cvt_pk_bf16_f32 v133, v74, v75
    v_cvt_pk_bf16_f32 v134, v76, v77
    v_cvt_pk_bf16_f32 v135, v78, v79
    v_mfma_f32_32x32x8_bf16 v[112:127], v[36:37], v[20:21], v[112:127]
    v_exp_f32 v80, v80
    v_exp_f32 v81, v81
    v_exp_f32 v82, v82
    v_exp_f32 v83, v83
    s_waitcnt lgkmcnt(2)
    v_mfma_f32_32x32x16_bf16 v[144:159], v[40:43], v[128:131], v[144:159]
    v_exp_f32 v84, v84
    v_exp_f32 v85, v85
    v_exp_f32 v86, v86
    v_exp_f32 v87, v87
    v_exp_f32 v88, v88
    v_exp_f32 v89, v89
    v_exp_f32 v90, v90
    v_exp_f32 v91, v91
    v_mfma_f32_32x32x16_bf16 v[144:159], v[44:47], v[132:135], v[144:159]
    v_exp_f32 v92, v92
    v_exp_f32 v93, v93
    v_exp_f32 v94, v94
    v_exp_f32 v95, v95
    s_setprio 0
    s_mov_b64 exec, s[22:23]
    ds_read_b128 v[48:51], v58 offset:6400
    ds_read_b128 v[52:55], v58 offset:7040
    s_mov_b64 exec, -1
    v_cvt_pk_bf16_f32 v136, v80, v81
    v_cvt_pk_bf16_f32 v137, v82, v83
    v_cvt_pk_bf16_f32 v138, v84, v85
    v_cvt_pk_bf16_f32 v139, v86, v87
    v_cvt_pk_bf16_f32 v140, v88, v89
    v_cvt_pk_bf16_f32 v141, v90, v91
    v_cvt_pk_bf16_f32 v142, v92, v93
    v_cvt_pk_bf16_f32 v143, v94, v95
    s_waitcnt lgkmcnt(2)
    v_mfma_f32_32x32x16_bf16 v[64:79], v[24:27], v[8:11], 0
    v_exp_f32 v96, v96
    v_exp_f32 v97, v97
    v_exp_f32 v98, v98
    v_exp_f32 v99, v99
    s_setprio 1
    v_mfma_f32_32x32x16_bf16 v[160:175], v[40:43], v[136:139], v[160:175]
    v_exp_f32 v100, v100
    v_exp_f32 v101, v101
    v_exp_f32 v102, v102
    v_exp_f32 v103, v103
    buffer_load_dwordx4 v[200:203], v1, s[64:67], s27 offen offset:2048
    v_mfma_f32_32x32x16_bf16 v[80:95], v[24:27], v[16:19], 0
    v_exp_f32 v104, v104
    v_exp_f32 v105, v105
    v_exp_f32 v106, v106
    v_exp_f32 v107, v107
    v_mfma_f32_32x32x16_bf16 v[160:175], v[44:47], v[140:143], v[160:175]
    v_exp_f32 v108, v108
    v_exp_f32 v109, v109
    v_exp_f32 v110, v110
    v_exp_f32 v111, v111
    v_mfma_f32_32x32x8_bf16 v[64:79], v[28:29], v[12:13], v[64:79]
    ds_read_b128 v[32:35], v56 offset:7168
    ds_read_b64 v[36:37], v57 offset:1792
    v_cvt_pk_bf16_f32 v128, v96, v97
    v_cvt_pk_bf16_f32 v129, v98, v99
    v_cvt_pk_bf16_f32 v130, v100, v101
    v_cvt_pk_bf16_f32 v131, v102, v103
    v_cvt_pk_bf16_f32 v132, v104, v105
    v_cvt_pk_bf16_f32 v133, v106, v107
    v_cvt_pk_bf16_f32 v134, v108, v109
    v_cvt_pk_bf16_f32 v135, v110, v111
    v_mfma_f32_32x32x8_bf16 v[80:95], v[28:29], v[20:21], v[80:95]
    v_exp_f32 v112, v112
    v_exp_f32 v113, v113
    v_exp_f32 v114, v114
    v_exp_f32 v115, v115
    s_waitcnt lgkmcnt(2)
    v_mfma_f32_32x32x16_bf16 v[144:159], v[48:51], v[128:131], v[144:159]
    v_exp_f32 v116, v116
    v_exp_f32 v117, v117
    v_exp_f32 v118, v118
    v_exp_f32 v119, v119
    s_cmp_lg_u32 s31, 0
    s_cbranch_scc1 fused2_kernel_w231
    buffer_load_dwordx4 v[216:219], v1, s[64:67], s33 offen offset:0
    buffer_load_dwordx4 v[220:223], v1, s[64:67], s33 offen offset:1024
fused2_kernel_w231:
    v_exp_f32 v120, v120
    v_exp_f32 v121, v121
    v_exp_f32 v122, v122
    v_exp_f32 v123, v123
    v_mfma_f32_32x32x16_bf16 v[144:159], v[52:55], v[132:135], v[144:159]
    v_exp_f32 v124, v124
    v_exp_f32 v125, v125
    v_exp_f32 v126, v126
    v_exp_f32 v127, v127
    s_setprio 0
    s_mov_b64 exec, s[22:23]
    ds_read_b128 v[40:43], v58 offset:7680
    ds_read_b128 v[44:47], v58 offset:8320
    s_mov_b64 exec, -1
    v_cvt_pk_bf16_f32 v136, v112, v113
    v_cvt_pk_bf16_f32 v137, v114, v115
    v_cvt_pk_bf16_f32 v138, v116, v117
    v_cvt_pk_bf16_f32 v139, v118, v119
    v_cvt_pk_bf16_f32 v140, v120, v121
    v_cvt_pk_bf16_f32 v141, v122, v123
    v_cvt_pk_bf16_f32 v142, v124, v125
    v_cvt_pk_bf16_f32 v143, v126, v127
    s_waitcnt lgkmcnt(2)
    v_mfma_f32_32x32x16_bf16 v[96:111], v[32:35], v[8:11], 0
    v_exp_f32 v64, v64
    v_exp_f32 v65, v65
    v_exp_f32 v66, v66
    v_exp_f32 v67, v67
    s_setprio 1
    v_mfma_f32_32x32x16_bf16 v[160:175], v[48:51], v[136:139], v[160:175]
    v_exp_f32 v68, v68
    v_exp_f32 v69, v69
    v_exp_f32 v70, v70
    v_exp_f32 v71, v71
    buffer_load_dwordx4 v[204:207], v1, s[64:67], s27 offen offset:3072
    s_add_u32 s27, s27, 4096
    v_mfma_f32_32x32x16_bf16 v[112:127], v[32:35], v[16:19], 0
    v_exp_f32 v72, v72
    v_exp_f32 v73, v73
    v_exp_f32 v74, v74
    v_exp_f32 v75, v75
    v_mfma_f32_32x32x16_bf16 v[160:175], v[52:55], v[140:143], v[160:175]
    v_exp_f32 v76, v76
    v_exp_f32 v77, v77
    v_exp_f32 v78, v78
    v_exp_f32 v79, v79
    v_mfma_f32_32x32x8_bf16 v[96:111], v[36:37], v[12:13], v[96:111]
    ds_read_b128 v[24:27], v56 offset:40960
    ds_read_b64 v[28:29], v57 offset:40960
    v_cvt_pk_bf16_f32 v128, v64, v65
    v_cvt_pk_bf16_f32 v129, v66, v67
    v_cvt_pk_bf16_f32 v130, v68, v69
    v_cvt_pk_bf16_f32 v131, v70, v71
    v_cvt_pk_bf16_f32 v132, v72, v73
    v_cvt_pk_bf16_f32 v133, v74, v75
    v_cvt_pk_bf16_f32 v134, v76, v77
    v_cvt_pk_bf16_f32 v135, v78, v79
    v_mfma_f32_32x32x8_bf16 v[112:127], v[36:37], v[20:21], v[112:127]
    v_exp_f32 v80, v80
    v_exp_f32 v81, v81
    v_exp_f32 v82, v82
    v_exp_f32 v83, v83
    s_waitcnt lgkmcnt(2)
    v_mfma_f32_32x32x16_bf16 v[144:159], v[40:43], v[128:131], v[144:159]
    v_exp_f32 v84, v84
    v_exp_f32 v85, v85
    v_exp_f32 v86, v86
    v_exp_f32 v87, v87
    s_cmp_lg_u32 s31, 0
    s_cbranch_scc1 fused2_kernel_w232
    buffer_load_dwordx4 v[224:227], v1, s[64:67], s33 offen offset:2048
    buffer_load_dwordx4 v[228:231], v1, s[64:67], s33 offen offset:3072
    s_add_u32 s33, s33, 4096
fused2_kernel_w232:
    v_exp_f32 v88, v88
    v_exp_f32 v89, v89
    v_exp_f32 v90, v90
    v_exp_f32 v91, v91
    v_mfma_f32_32x32x16_bf16 v[144:159], v[44:47], v[132:135], v[144:159]
    v_exp_f32 v92, v92
    v_exp_f32 v93, v93
    v_exp_f32 v94, v94
    v_exp_f32 v95, v95
    s_setprio 0
    s_mov_b64 exec, s[22:23]
    ds_read_b128 v[48:51], v58 offset:8960
    ds_read_b128 v[52:55], v58 offset:9600
    s_mov_b64 exec, -1
    v_cvt_pk_bf16_f32 v136, v80, v81
    v_cvt_pk_bf16_f32 v137, v82, v83
    v_cvt_pk_bf16_f32 v138, v84, v85
    v_cvt_pk_bf16_f32 v139, v86, v87
    v_cvt_pk_bf16_f32 v140, v88, v89
    v_cvt_pk_bf16_f32 v141, v90, v91
    v_cvt_pk_bf16_f32 v142, v92, v93
    v_cvt_pk_bf16_f32 v143, v94, v95
    s_waitcnt lgkmcnt(2)
    v_mfma_f32_32x32x16_bf16 v[64:79], v[24:27], v[8:11], 0
    v_exp_f32 v96, v96
    v_exp_f32 v97, v97
    v_exp_f32 v98, v98
    v_exp_f32 v99, v99
    s_setprio 1
    v_mfma_f32_32x32x16_bf16 v[160:175], v[40:43], v[136:139], v[160:175]
    v_exp_f32 v100, v100
    v_exp_f32 v101, v101
    v_exp_f32 v102, v102
    v_exp_f32 v103, v103
    buffer_load_dwordx4 v[208:211], v1, s[64:67], s27 offen offset:0
    v_mfma_f32_32x32x16_bf16 v[80:95], v[24:27], v[16:19], 0
    v_exp_f32 v104, v104
    v_exp_f32 v105, v105
    v_exp_f32 v106, v106
    v_exp_f32 v107, v107
    v_mfma_f32_32x32x16_bf16 v[160:175], v[44:47], v[140:143], v[160:175]
    v_exp_f32 v108, v108
    v_exp_f32 v109, v109
    v_exp_f32 v110, v110
    v_exp_f32 v111, v111
    v_mfma_f32_32x32x8_bf16 v[64:79], v[28:29], v[12:13], v[64:79]
    ds_read_b128 v[32:35], v56 offset:41984
    ds_read_b64 v[36:37], v57 offset:41216
    v_cvt_pk_bf16_f32 v128, v96, v97
    v_cvt_pk_bf16_f32 v129, v98, v99
    v_cvt_pk_bf16_f32 v130, v100, v101
    v_cvt_pk_bf16_f32 v131, v102, v103
    v_cvt_pk_bf16_f32 v132, v104, v105
    v_cvt_pk_bf16_f32 v133, v106, v107
    v_cvt_pk_bf16_f32 v134, v108, v109
    v_cvt_pk_bf16_f32 v135, v110, v111
    v_mfma_f32_32x32x8_bf16 v[80:95], v[28:29], v[20:21], v[80:95]
    v_exp_f32 v112, v112
    v_exp_f32 v113, v113
    v_exp_f32 v114, v114
    v_exp_f32 v115, v115
    s_waitcnt lgkmcnt(2)
    v_mfma_f32_32x32x16_bf16 v[144:159], v[48:51], v[128:131], v[144:159]
    v_exp_f32 v116, v116
    v_exp_f32 v117, v117
    v_exp_f32 v118, v118
    v_exp_f32 v119, v119
    s_cmp_lg_u32 s31, 0
    s_cbranch_scc1 fused2_kernel_w233
    buffer_load_dwordx4 v[232:235], v1, s[64:67], s33 offen offset:0
    buffer_load_dwordx4 v[236:239], v1, s[64:67], s33 offen offset:1024
fused2_kernel_w233:
    v_exp_f32 v120, v120
    v_exp_f32 v121, v121
    v_exp_f32 v122, v122
    v_exp_f32 v123, v123
    v_mfma_f32_32x32x16_bf16 v[144:159], v[52:55], v[132:135], v[144:159]
    v_exp_f32 v124, v124
    v_exp_f32 v125, v125
    v_exp_f32 v126, v126
    v_exp_f32 v127, v127
    s_setprio 0
    s_mov_b64 exec, s[22:23]
    ds_read_b128 v[40:43], v58 offset:40960
    ds_read_b128 v[44:47], v58 offset:41600
    s_mov_b64 exec, -1
    v_cvt_pk_bf16_f32 v136, v112, v113
    v_cvt_pk_bf16_f32 v137, v114, v115
    v_cvt_pk_bf16_f32 v138, v116, v117
    v_cvt_pk_bf16_f32 v139, v118, v119
    v_cvt_pk_bf16_f32 v140, v120, v121
    v_cvt_pk_bf16_f32 v141, v122, v123
    v_cvt_pk_bf16_f32 v142, v124, v125
    v_cvt_pk_bf16_f32 v143, v126, v127
    v_add_u32 v56, 40960, v56
    v_add_u32 v57, 40960, v57
    v_add_u32 v58, 40960, v58
    s_waitcnt lgkmcnt(2)
    v_mfma_f32_32x32x16_bf16 v[96:111], v[32:35], v[8:11], 0
    v_exp_f32 v64, v64
    v_exp_f32 v65, v65
    v_exp_f32 v66, v66
    v_exp_f32 v67, v67
    s_setprio 1
    v_mfma_f32_32x32x16_bf16 v[160:175], v[48:51], v[136:139], v[160:175]
    v_exp_f32 v68, v68
    v_exp_f32 v69, v69
    v_exp_f32 v70, v70
    v_exp_f32 v71, v71
    buffer_load_dwordx4 v[212:215], v1, s[64:67], s27 offen offset:1024
    v_mfma_f32_32x32x16_bf16 v[112:127], v[32:35], v[16:19], 0
    v_exp_f32 v72, v72
    v_exp_f32 v73, v73
    v_exp_f32 v74, v74
    v_exp_f32 v75, v75
    v_mfma_f32_32x32x16_bf16 v[160:175], v[52:55], v[140:143], v[160:175]
    v_exp_f32 v76, v76
    v_exp_f32 v77, v77
    v_exp_f32 v78, v78
    v_exp_f32 v79, v79
    v_mfma_f32_32x32x8_bf16 v[96:111], v[36:37], v[12:13], v[96:111]
    ds_read_b128 v[24:27], v56 offset:2048
    ds_read_b64 v[28:29], v57 offset:512
    v_cvt_pk_bf16_f32 v128, v64, v65
    v_cvt_pk_bf16_f32 v129, v66, v67
    v_cvt_pk_bf16_f32 v130, v68, v69
    v_cvt_pk_bf16_f32 v131, v70, v71
    v_cvt_pk_bf16_f32 v132, v72, v73
    v_cvt_pk_bf16_f32 v133, v74, v75
    v_cvt_pk_bf16_f32 v134, v76, v77
    v_cvt_pk_bf16_f32 v135, v78, v79
    v_mfma_f32_32x32x8_bf16 v[112:127], v[36:37], v[20:21], v[112:127]
    v_exp_f32 v80, v80
    v_exp_f32 v81, v81
    v_exp_f32 v82, v82
    v_exp_f32 v83, v83
    s_waitcnt lgkmcnt(2)
    v_mfma_f32_32x32x16_bf16 v[144:159], v[40:43], v[128:131], v[144:159]
    v_exp_f32 v84, v84
    v_exp_f32 v85, v85
    v_exp_f32 v86, v86
    v_exp_f32 v87, v87
    s_cmp_lg_u32 s31, 0
    s_cbranch_scc1 fused2_kernel_w234
    buffer_load_dwordx4 v[240:243], v1, s[64:67], s33 offen offset:2048
    buffer_load_dwordx4 v[244:247], v1, s[64:67], s33 offen offset:3072
    s_add_u32 s33, s33, 4096
fused2_kernel_w234:
    v_exp_f32 v88, v88
    v_exp_f32 v89, v89
    v_exp_f32 v90, v90
    v_exp_f32 v91, v91
    v_mfma_f32_32x32x16_bf16 v[144:159], v[44:47], v[132:135], v[144:159]
    v_exp_f32 v92, v92
    v_exp_f32 v93, v93
    v_exp_f32 v94, v94
    v_exp_f32 v95, v95
    s_setprio 0
    s_mov_b64 exec, s[22:23]
    ds_read_b128 v[48:51], v58 offset:1280
    ds_read_b128 v[52:55], v58 offset:1920
    s_mov_b64 exec, -1
    v_cvt_pk_bf16_f32 v136, v80, v81
    v_cvt_pk_bf16_f32 v137, v82, v83
    v_cvt_pk_bf16_f32 v138, v84, v85
    v_cvt_pk_bf16_f32 v139, v86, v87
    v_cvt_pk_bf16_f32 v140, v88, v89
    v_cvt_pk_bf16_f32 v141, v90, v91
    v_cvt_pk_bf16_f32 v142, v92, v93
    v_cvt_pk_bf16_f32 v143, v94, v95
    s_waitcnt lgkmcnt(2)
    v_mfma_f32_32x32x16_bf16 v[64:79], v[24:27], v[8:11], 0
    v_exp_f32 v96, v96
    v_exp_f32 v97, v97
    v_exp_f32 v98, v98
    v_exp_f32 v99, v99
    s_setprio 1
    v_mfma_f32_32x32x16_bf16 v[160:175], v[40:43], v[136:139], v[160:175]
    v_exp_f32 v100, v100
    v_exp_f32 v101, v101
    v_exp_f32 v102, v102
    v_exp_f32 v103, v103
    v_mfma_f32_32x32x16_bf16 v[80:95], v[24:27], v[16:19], 0
    v_exp_f32 v104, v104
    v_exp_f32 v105, v105
    v_exp_f32 v106, v106
    v_exp_f32 v107, v107
    v_mfma_f32_32x32x16_bf16 v[160:175], v[44:47], v[140:143], v[160:175]
    v_exp_f32 v108, v108
    v_exp_f32 v109, v109
    v_exp_f32 v110, v110
    v_exp_f32 v111, v111
    v_mfma_f32_32x32x8_bf16 v[64:79], v[28:29], v[12:13], v[64:79]
    ds_read_b128 v[32:35], v56 offset:3072
    ds_read_b64 v[36:37], v57 offset:768
    v_cvt_pk_bf16_f32 v128, v96, v97
    v_cvt_pk_bf16_f32 v129, v98, v99
    v_cvt_pk_bf16_f32 v130, v100, v101
    v_cvt_pk_bf16_f32 v131, v102, v103
    v_cvt_pk_bf16_f32 v132, v104, v105
    v_cvt_pk_bf16_f32 v133, v106, v107
    v_cvt_pk_bf16_f32 v134, v108, v109
    v_cvt_pk_bf16_f32 v135, v110, v111
    v_mfma_f32_32x32x8_bf16 v[80:95], v[28:29], v[20:21], v[80:95]
    v_exp_f32 v112, v112
    v_exp_f32 v113, v113
    v_exp_f32 v114, v114
    v_exp_f32 v115, v115
    s_waitcnt lgkmcnt(2)
    v_mfma_f32_32x32x16_bf16 v[144:159], v[48:51], v[128:131], v[144:159]
    v_exp_f32 v116, v116
    v_exp_f32 v117, v117
    v_exp_f32 v118, v118
    v_exp_f32 v119, v119
    s_cmp_lg_u32 s31, 0
    s_cbranch_scc1 fused2_kernel_w235
    buffer_load_dwordx4 v[248:251], v1, s[64:67], s33 offen offset:0
    buffer_load_dwordx4 v[252:255], v1, s[64:67], s33 offen offset:1024
fused2_kernel_w235:
    v_exp_f32 v120, v120
    v_exp_f32 v121, v121
    v_exp_f32 v122, v122
    v_exp_f32 v123, v123
    v_mfma_f32_32x32x16_bf16 v[144:159], v[52:55], v[132:135], v[144:159]
    v_exp_f32 v124, v124
    v_exp_f32 v125, v125
    v_exp_f32 v126, v126
    v_exp_f32 v127, v127
    s_setprio 0
    s_mov_b64 exec, s[22:23]
    ds_read_b128 v[40:43], v58 offset:2560
    ds_read_b128 v[44:47], v58 offset:3200
    s_mov_b64 exec, -1
    v_cvt_pk_bf16_f32 v136, v112, v113
    v_cvt_pk_bf16_f32 v137, v114, v115
    v_cvt_pk_bf16_f32 v138, v116, v117
    v_cvt_pk_bf16_f32 v139, v118, v119
    v_cvt_pk_bf16_f32 v140, v120, v121
    v_cvt_pk_bf16_f32 v141, v122, v123
    v_cvt_pk_bf16_f32 v142, v124, v125
    v_cvt_pk_bf16_f32 v143, v126, v127
    s_waitcnt lgkmcnt(2)
    v_mfma_f32_32x32x16_bf16 v[96:111], v[32:35], v[8:11], 0
    v_exp_f32 v64, v64
    v_exp_f32 v65, v65
    v_exp_f32 v66, v66
    v_exp_f32 v67, v67
    s_setprio 1
    v_mfma_f32_32x32x16_bf16 v[160:175], v[48:51], v[136:139], v[160:175]
    v_exp_f32 v68, v68
    v_exp_f32 v69, v69
    v_exp_f32 v70, v70
    v_exp_f32 v71, v71
    v_mfma_f32_32x32x16_bf16 v[112:127], v[32:35], v[16:19], 0
    v_exp_f32 v72, v72
    v_exp_f32 v73, v73
    v_exp_f32 v74, v74
    v_exp_f32 v75, v75
    v_mfma_f32_32x32x16_bf16 v[160:175], v[52:55], v[140:143], v[160:175]
    v_exp_f32 v76, v76
    v_exp_f32 v77, v77
    v_exp_f32 v78, v78
    v_exp_f32 v79, v79
    v_mfma_f32_32x32x8_bf16 v[96:111], v[36:37], v[12:13], v[96:111]
    ds_read_b128 v[24:27], v56 offset:4096
    ds_read_b64 v[28:29], v57 offset:1024
    v_cvt_pk_bf16_f32 v128, v64, v65
    v_cvt_pk_bf16_f32 v129, v66, v67
    v_cvt_pk_bf16_f32 v130, v68, v69
    v_cvt_pk_bf16_f32 v131, v70, v71
    v_cvt_pk_bf16_f32 v132, v72, v73
    v_cvt_pk_bf16_f32 v133, v74, v75
    v_cvt_pk_bf16_f32 v134, v76, v77
    v_cvt_pk_bf16_f32 v135, v78, v79
    v_mfma_f32_32x32x8_bf16 v[112:127], v[36:37], v[20:21], v[112:127]
    v_exp_f32 v80, v80
    v_exp_f32 v81, v81
    v_exp_f32 v82, v82
    v_exp_f32 v83, v83
    s_waitcnt lgkmcnt(2)
    v_mfma_f32_32x32x16_bf16 v[144:159], v[40:43], v[128:131], v[144:159]
    v_exp_f32 v84, v84
    v_exp_f32 v85, v85
    v_exp_f32 v86, v86
    v_exp_f32 v87, v87
    v_exp_f32 v88, v88
    v_exp_f32 v89, v89
    v_exp_f32 v90, v90
    v_exp_f32 v91, v91
    v_mfma_f32_32x32x16_bf16 v[144:159], v[44:47], v[132:135], v[144:159]
    v_exp_f32 v92, v92
    v_exp_f32 v93, v93
    v_exp_f32 v94, v94
    v_exp_f32 v95, v95
    s_setprio 0
    s_mov_b64 exec, s[22:23]
    ds_read_b128 v[48:51], v58 offset:3840
    ds_read_b128 v[52:55], v58 offset:4480
    s_mov_b64 exec, -1
    v_cvt_pk_bf16_f32 v136, v80, v81
    v_cvt_pk_bf16_f32 v137, v82, v83
    v_cvt_pk_bf16_f32 v138, v84, v85
    v_cvt_pk_bf16_f32 v139, v86, v87
    v_cvt_pk_bf16_f32 v140, v88, v89
    v_cvt_pk_bf16_f32 v141, v90, v91
    v_cvt_pk_bf16_f32 v142, v92, v93
    v_cvt_pk_bf16_f32 v143, v94, v95
    s_waitcnt lgkmcnt(2)
    v_mfma_f32_32x32x16_bf16 v[64:79], v[24:27], v[8:11], 0
    v_exp_f32 v96, v96
    v_exp_f32 v97, v97
    v_exp_f32 v98, v98
    v_exp_f32 v99, v99
    s_setprio 1
    v_mfma_f32_32x32x16_bf16 v[160:175], v[40:43], v[136:139], v[160:175]
    v_exp_f32 v100, v100
    v_exp_f32 v101, v101
    v_exp_f32 v102, v102
    v_exp_f32 v103, v103
    v_mfma_f32_32x32x16_bf16 v[80:95], v[24:27], v[16:19], 0
    v_exp_f32 v104, v104
    v_exp_f32 v105, v105
    v_exp_f32 v106, v106
    v_exp_f32 v107, v107
    v_mfma_f32_32x32x16_bf16 v[160:175], v[44:47], v[140:143], v[160:175]
    v_exp_f32 v108, v108
    v_exp_f32 v109, v109
    v_exp_f32 v110, v110
    v_exp_f32 v111, v111
    v_mfma_f32_32x32x8_bf16 v[64:79], v[28:29], v[12:13], v[64:79]
    ds_read_b128 v[32:35], v56 offset:5120
    ds_read_b64 v[36:37], v57 offset:1280
    v_cvt_pk_bf16_f32 v128, v96, v97
    v_cvt_pk_bf16_f32 v129, v98, v99
    v_cvt_pk_bf16_f32 v130, v100, v101
    v_cvt_pk_bf16_f32 v131, v102, v103
    v_cvt_pk_bf16_f32 v132, v104, v105
    v_cvt_pk_bf16_f32 v133, v106, v107
    v_cvt_pk_bf16_f32 v134, v108, v109
    v_cvt_pk_bf16_f32 v135, v110, v111
    v_mfma_f32_32x32x8_bf16 v[80:95], v[28:29], v[20:21], v[80:95]
    v_exp_f32 v112, v112
    v_exp_f32 v113, v113
    v_exp_f32 v114, v114
    v_exp_f32 v115, v115
    s_waitcnt lgkmcnt(2)
    v_mfma_f32_32x32x16_bf16 v[144:159], v[48:51], v[128:131], v[144:159]
    v_exp_f32 v116, v116
    v_exp_f32 v117, v117
    v_exp_f32 v118, v118
    v_exp_f32 v119, v119
    v_exp_f32 v120, v120
    v_exp_f32 v121, v121
    v_exp_f32 v122, v122
    v_exp_f32 v123, v123
    v_mfma_f32_32x32x16_bf16 v[144:159], v[52:55], v[132:135], v[144:159]
    v_exp_f32 v124, v124
    v_exp_f32 v125, v125
    v_exp_f32 v126, v126
    v_exp_f32 v127, v127
    s_setprio 0
    s_mov_b64 exec, s[22:23]
    ds_read_b128 v[40:43], v58 offset:5120
    ds_read_b128 v[44:47], v58 offset:5760
    s_mov_b64 exec, -1
    v_cvt_pk_bf16_f32 v136, v112, v113
    v_cvt_pk_bf16_f32 v137, v114, v115
    v_cvt_pk_bf16_f32 v138, v116, v117
    v_cvt_pk_bf16_f32 v139, v118, v119
    v_cvt_pk_bf16_f32 v140, v120, v121
    v_cvt_pk_bf16_f32 v141, v122, v123
    v_cvt_pk_bf16_f32 v142, v124, v125
    v_cvt_pk_bf16_f32 v143, v126, v127
    s_waitcnt lgkmcnt(2)
    v_mfma_f32_32x32x16_bf16 v[96:111], v[32:35], v[8:11], 0
    v_exp_f32 v64, v64
    v_exp_f32 v65, v65
    v_exp_f32 v66, v66
    v_exp_f32 v67, v67
    s_setprio 1
    v_mfma_f32_32x32x16_bf16 v[160:175], v[48:51], v[136:139], v[160:175]
    v_exp_f32 v68, v68
    v_exp_f32 v69, v69
    v_exp_f32 v70, v70
    v_exp_f32 v71, v71
    v_mfma_f32_32x32x16_bf16 v[112:127], v[32:35], v[16:19], 0
    v_exp_f32 v72, v72
    v_exp_f32 v73, v73
    v_exp_f32 v74, v74
    v_exp_f32 v75, v75
    v_mfma_f32_32x32x16_bf16 v[160:175], v[52:55], v[140:143], v[160:175]
    v_exp_f32 v76, v76
    v_exp_f32 v77, v77
    v_exp_f32 v78, v78
    v_exp_f32 v79, v79
    v_mfma_f32_32x32x8_bf16 v[96:111], v[36:37], v[12:13], v[96:111]
    ds_read_b128 v[24:27], v56 offset:6144
    ds_read_b64 v[28:29], v57 offset:1536
    v_cvt_pk_bf16_f32 v128, v64, v65
    v_cvt_pk_bf16_f32 v129, v66, v67
    v_cvt_pk_bf16_f32 v130, v68, v69
    v_cvt_pk_bf16_f32 v131, v70, v71
    v_cvt_pk_bf16_f32 v132, v72, v73
    v_cvt_pk_bf16_f32 v133, v74, v75
    v_cvt_pk_bf16_f32 v134, v76, v77
    v_cvt_pk_bf16_f32 v135, v78, v79
    v_mfma_f32_32x32x8_bf16 v[112:127], v[36:37], v[20:21], v[112:127]
    v_exp_f32 v80, v80
    v_exp_f32 v81, v81
    v_exp_f32 v82, v82
    v_exp_f32 v83, v83
    s_waitcnt lgkmcnt(2)
    v_mfma_f32_32x32x16_bf16 v[144:159], v[40:43], v[128:131], v[144:159]
    v_exp_f32 v84, v84
    v_exp_f32 v85, v85
    v_exp_f32 v86, v86
    v_exp_f32 v87, v87
    v_exp_f32 v88, v88
    v_exp_f32 v89, v89
    v_exp_f32 v90, v90
    v_exp_f32 v91, v91
    v_mfma_f32_32x32x16_bf16 v[144:159], v[44:47], v[132:135], v[144:159]
    v_exp_f32 v92, v92
    v_exp_f32 v93, v93
    v_exp_f32 v94, v94
    v_exp_f32 v95, v95
    s_setprio 0
    s_mov_b64 exec, s[22:23]
    ds_read_b128 v[48:51], v58 offset:6400
    ds_read_b128 v[52:55], v58 offset:7040
    s_mov_b64 exec, -1
    v_cvt_pk_bf16_f32 v136, v80, v81
    v_cvt_pk_bf16_f32 v137, v82, v83
    v_cvt_pk_bf16_f32 v138, v84, v85
    v_cvt_pk_bf16_f32 v139, v86, v87
    v_cvt_pk_bf16_f32 v140, v88, v89
    v_cvt_pk_bf16_f32 v141, v90, v91
    v_cvt_pk_bf16_f32 v142, v92, v93
    v_cvt_pk_bf16_f32 v143, v94, v95
    s_waitcnt lgkmcnt(2)
    v_mfma_f32_32x32x16_bf16 v[64:79], v[24:27], v[8:11], 0
    v_exp_f32 v96, v96
    v_exp_f32 v97, v97
    v_exp_f32 v98, v98
    v_exp_f32 v99, v99
    s_setprio 1
    v_mfma_f32_32x32x16_bf16 v[160:175], v[40:43], v[136:139], v[160:175]
    v_exp_f32 v100, v100
    v_exp_f32 v101, v101
    v_exp_f32 v102, v102
    v_exp_f32 v103, v103
    v_mfma_f32_32x32x16_bf16 v[80:95], v[24:27], v[16:19], 0
    v_exp_f32 v104, v104
    v_exp_f32 v105, v105
    v_exp_f32 v106, v106
    v_exp_f32 v107, v107
    v_mfma_f32_32x32x16_bf16 v[160:175], v[44:47], v[140:143], v[160:175]
    v_exp_f32 v108, v108
    v_exp_f32 v109, v109
    v_exp_f32 v110, v110
    v_exp_f32 v111, v111
    v_mfma_f32_32x32x8_bf16 v[64:79], v[28:29], v[12:13], v[64:79]
    ds_read_b128 v[32:35], v56 offset:7168
    ds_read_b64 v[36:37], v57 offset:1792
    v_cvt_pk_bf16_f32 v128, v96, v97
    v_cvt_pk_bf16_f32 v129, v98, v99
    v_cvt_pk_bf16_f32 v130, v100, v101
    v_cvt_pk_bf16_f32 v131, v102, v103
    v_cvt_pk_bf16_f32 v132, v104, v105
    v_cvt_pk_bf16_f32 v133, v106, v107
    v_cvt_pk_bf16_f32 v134, v108, v109
    v_cvt_pk_bf16_f32 v135, v110, v111
    v_mfma_f32_32x32x8_bf16 v[80:95], v[28:29], v[20:21], v[80:95]
    v_exp_f32 v112, v112
    v_exp_f32 v113, v113
    v_exp_f32 v114, v114
    v_exp_f32 v115, v115
    s_waitcnt lgkmcnt(2)
    v_mfma_f32_32x32x16_bf16 v[144:159], v[48:51], v[128:131], v[144:159]
    v_exp_f32 v116, v116
    v_exp_f32 v117, v117
    v_exp_f32 v118, v118
    v_exp_f32 v119, v119
    v_exp_f32 v120, v120
    v_exp_f32 v121, v121
    v_exp_f32 v122, v122
    v_exp_f32 v123, v123
    v_mfma_f32_32x32x16_bf16 v[144:159], v[52:55], v[132:135], v[144:159]
    v_exp_f32 v124, v124
    v_exp_f32 v125, v125
    v_exp_f32 v126, v126
    v_exp_f32 v127, v127
    s_setprio 0
    s_mov_b64 exec, s[22:23]
    ds_read_b128 v[40:43], v58 offset:7680
    ds_read_b128 v[44:47], v58 offset:8320
    s_mov_b64 exec, -1
    v_cvt_pk_bf16_f32 v136, v112, v113
    v_cvt_pk_bf16_f32 v137, v114, v115
    v_cvt_pk_bf16_f32 v138, v116, v117
    v_cvt_pk_bf16_f32 v139, v118, v119
    v_cvt_pk_bf16_f32 v140, v120, v121
    v_cvt_pk_bf16_f32 v141, v122, v123
    v_cvt_pk_bf16_f32 v142, v124, v125
    v_cvt_pk_bf16_f32 v143, v126, v127
    s_waitcnt lgkmcnt(2)
    v_mfma_f32_32x32x16_bf16 v[96:111], v[32:35], v[8:11], 0
    v_exp_f32 v64, v64
    v_exp_f32 v65, v65
    v_exp_f32 v66, v66
    v_exp_f32 v67, v67
    s_setprio 1
    v_mfma_f32_32x32x16_bf16 v[160:175], v[48:51], v[136:139], v[160:175]
    v_exp_f32 v68, v68
    v_exp_f32 v69, v69
    v_exp_f32 v70, v70
    v_exp_f32 v71, v71
    v_mfma_f32_32x32x16_bf16 v[112:127], v[32:35], v[16:19], 0
    v_exp_f32 v72, v72
    v_exp_f32 v73, v73
    v_exp_f32 v74, v74
    v_exp_f32 v75, v75
    v_mfma_f32_32x32x16_bf16 v[160:175], v[52:55], v[140:143], v[160:175]
    v_exp_f32 v76, v76
    v_exp_f32 v77, v77
    v_exp_f32 v78, v78
    v_exp_f32 v79, v79
    v_mfma_f32_32x32x8_bf16 v[96:111], v[36:37], v[12:13], v[96:111]
    v_cvt_pk_bf16_f32 v128, v64, v65
    v_cvt_pk_bf16_f32 v129, v66, v67
    v_cvt_pk_bf16_f32 v130, v68, v69
    v_cvt_pk_bf16_f32 v131, v70, v71
    v_cvt_pk_bf16_f32 v132, v72, v73
    v_cvt_pk_bf16_f32 v133, v74, v75
    v_cvt_pk_bf16_f32 v134, v76, v77
    v_cvt_pk_bf16_f32 v135, v78, v79
    v_mfma_f32_32x32x8_bf16 v[112:127], v[36:37], v[20:21], v[112:127]
    v_exp_f32 v80, v80
    v_exp_f32 v81, v81
    v_exp_f32 v82, v82
    v_exp_f32 v83, v83
    s_waitcnt lgkmcnt(0)
    v_mfma_f32_32x32x16_bf16 v[144:159], v[40:43], v[128:131], v[144:159]
    v_exp_f32 v84, v84
    v_exp_f32 v85, v85
    v_exp_f32 v86, v86
    v_exp_f32 v87, v87
    v_exp_f32 v88, v88
    v_exp_f32 v89, v89
    v_exp_f32 v90, v90
    v_exp_f32 v91, v91
    v_mfma_f32_32x32x16_bf16 v[144:159], v[44:47], v[132:135], v[144:159]
    v_exp_f32 v92, v92
    v_exp_f32 v93, v93
    v_exp_f32 v94, v94
    v_exp_f32 v95, v95
    s_setprio 0
    s_mov_b64 exec, s[22:23]
    ds_read_b128 v[48:51], v58 offset:8960
    ds_read_b128 v[52:55], v58 offset:9600
    s_mov_b64 exec, -1
    v_cvt_pk_bf16_f32 v136, v80, v81
    v_cvt_pk_bf16_f32 v137, v82, v83
    v_cvt_pk_bf16_f32 v138, v84, v85
    v_cvt_pk_bf16_f32 v139, v86, v87
    v_cvt_pk_bf16_f32 v140, v88, v89
    v_cvt_pk_bf16_f32 v141, v90, v91
    v_cvt_pk_bf16_f32 v142, v92, v93
    v_cvt_pk_bf16_f32 v143, v94, v95
    v_exp_f32 v96, v96
    v_exp_f32 v97, v97
    v_exp_f32 v98, v98
    v_exp_f32 v99, v99
    s_setprio 1
    v_mfma_f32_32x32x16_bf16 v[160:175], v[40:43], v[136:139], v[160:175]
    v_exp_f32 v100, v100
    v_exp_f32 v101, v101
    v_exp_f32 v102, v102
    v_exp_f32 v103, v103
    v_exp_f32 v104, v104
    v_exp_f32 v105, v105
    v_exp_f32 v106, v106
    v_exp_f32 v107, v107
    v_mfma_f32_32x32x16_bf16 v[160:175], v[44:47], v[140:143], v[160:175]
    v_exp_f32 v108, v108
    v_exp_f32 v109, v109
    v_exp_f32 v110, v110
    v_exp_f32 v111, v111
    v_cvt_pk_bf16_f32 v128, v96, v97
    v_cvt_pk_bf16_f32 v129, v98, v99
    v_cvt_pk_bf16_f32 v130, v100, v101
    v_cvt_pk_bf16_f32 v131, v102, v103
    v_cvt_pk_bf16_f32 v132, v104, v105
    v_cvt_pk_bf16_f32 v133, v106, v107
    v_cvt_pk_bf16_f32 v134, v108, v109
    v_cvt_pk_bf16_f32 v135, v110, v111
    v_exp_f32 v112, v112
    v_exp_f32 v113, v113
    v_exp_f32 v114, v114
    v_exp_f32 v115, v115
    s_waitcnt lgkmcnt(0)
    v_mfma_f32_32x32x16_bf16 v[144:159], v[48:51], v[128:131], v[144:159]
    v_exp_f32 v116, v116
    v_exp_f32 v117, v117
    v_exp_f32 v118, v118
    v_exp_f32 v119, v119
    v_exp_f32 v120, v120
    v_exp_f32 v121, v121
    v_exp_f32 v122, v122
    v_exp_f32 v123, v123
    v_mfma_f32_32x32x16_bf16 v[144:159], v[52:55], v[132:135], v[144:159]
    v_exp_f32 v124, v124
    v_exp_f32 v125, v125
    v_exp_f32 v126, v126
    v_exp_f32 v127, v127
    s_setprio 0
    v_cvt_pk_bf16_f32 v136, v112, v113
    v_cvt_pk_bf16_f32 v137, v114, v115
    v_cvt_pk_bf16_f32 v138, v116, v117
    v_cvt_pk_bf16_f32 v139, v118, v119
    v_cvt_pk_bf16_f32 v140, v120, v121
    v_cvt_pk_bf16_f32 v141, v122, v123
    v_cvt_pk_bf16_f32 v142, v124, v125
    v_cvt_pk_bf16_f32 v143, v126, v127
    s_setprio 0
    v_mfma_f32_32x32x16_bf16 v[160:175], v[48:51], v[136:139], v[160:175]
    v_mfma_f32_32x32x16_bf16 v[160:175], v[52:55], v[140:143], v[160:175]
    s_mul_i32 s21, s30, 6144
    v_add_u32 v2, s21, v1
    s_nop 15
    s_nop 1
    s_cmp_eq_u32 s31, 1
    s_cbranch_scc1 fused2_kernel_lo36
    ds_write_b128 v2, v[144:147] offset:0
    ds_write_b128 v2, v[160:163] offset:3072
    ds_write_b128 v2, v[148:151] offset:1024
    ds_write_b128 v2, v[164:167] offset:4096
    ds_write_b128 v2, v[152:155] offset:2048
    ds_write_b128 v2, v[168:171] offset:5120
    s_waitcnt lgkmcnt(0)
    s_add_u32 s5, s4, 2
    s_and_b32 s5, s5, 3
    s_mul_i32 s5, s5, 10240
    s_mul_i32 s27, s34, 40960
    s_add_u32 s27, s27, s5
    buffer_load_dwordx4 v[96:99], v1, s[64:67], s27 offen offset:0
    buffer_load_dwordx4 v[100:103], v1, s[64:67], s27 offen offset:1024
    buffer_load_dwordx4 v[104:107], v1, s[64:67], s27 offen offset:2048
    buffer_load_dwordx4 v[108:111], v1, s[64:67], s27 offen offset:3072
    s_add_u32 s27, s27, 4096
    buffer_load_dwordx4 v[112:115], v1, s[64:67], s27 offen offset:0
    buffer_load_dwordx4 v[116:119], v1, s[64:67], s27 offen offset:1024
    buffer_load_dwordx4 v[120:123], v1, s[64:67], s27 offen offset:2048
    buffer_load_dwordx4 v[124:127], v1, s[64:67], s27 offen offset:3072
    s_add_u32 s27, s27, 4096
    buffer_load_dwordx4 v[128:131], v1, s[64:67], s27 offen offset:0
    buffer_load_dwordx4 v[132:135], v1, s[64:67], s27 offen offset:1024
    s_add_u32 s5, s4, 3
    s_and_b32 s5, s5, 3
    s_mul_i32 s5, s5, 10240
    s_mul_i32 s27, s34, 40960
    s_add_u32 s27, s27, s5
    buffer_load_dwordx4 v[136:139], v1, s[64:67], s27 offen offset:0
    buffer_load_dwordx4 v[140:143], v1, s[64:67], s27 offen offset:1024
    buffer_load_dwordx4 v[144:147], v1, s[64:67], s27 offen offset:2048
    buffer_load_dwordx4 v[148:151], v1, s[64:67], s27 offen offset:3072
    s_add_u32 s27, s27, 4096
    buffer_load_dwordx4 v[152:155], v1, s[64:67], s27 offen offset:0
    buffer_load_dwordx4 v[156:159], v1, s[64:67], s27 offen offset:1024
    buffer_load_dwordx4 v[160:163], v1, s[64:67], s27 offen offset:2048
    buffer_load_dwordx4 v[164:167], v1, s[64:67], s27 offen offset:3072
    s_add_u32 s27, s27, 4096
    buffer_load_dwordx4 v[168:171], v1, s[64:67], s27 offen offset:0
    buffer_load_dwordx4 v[172:175], v1, s[64:67], s27 offen offset:1024
    v_lshlrev_b32 v6, 8, v4
    v_lshl_add_u32 v6, v3, 1, v6
    s_mul_i32 s35, s3, 40960
    s_lshl_b32 s26, s34, 11
    s_add_u32 s35, s35, s26
    buffer_load_ushort v64, v6, s[48:51], s35 offen offset:0
    buffer_load_ushort v65, v6, s[48:51], s35 offen offset:64
    buffer_load_ushort v66, v6, s[48:51], s35 offen offset:128
    buffer_load_ushort v67, v6, s[48:51], s35 offen offset:192
    buffer_load_ushort v68, v6, s[48:51], s35 offen offset:512
    buffer_load_ushort v69, v6, s[48:51], s35 offen offset:576
    buffer_load_ushort v70, v6, s[48:51], s35 offen offset:640
    buffer_load_ushort v71, v6, s[48:51], s35 offen offset:704
    buffer_load_ushort v72, v6, s[48:51], s35 offen offset:1024
    buffer_load_ushort v73, v6, s[48:51], s35 offen offset:1088
    buffer_load_ushort v74, v6, s[48:51], s35 offen offset:1152
    buffer_load_ushort v75, v6, s[48:51], s35 offen offset:1216
    buffer_load_ushort v76, v6, s[48:51], s35 offen offset:1536
    buffer_load_ushort v77, v6, s[48:51], s35 offen offset:1600
    buffer_load_ushort v78, v6, s[48:51], s35 offen offset:1664
    buffer_load_ushort v79, v6, s[48:51], s35 offen offset:1728
    s_add_u32 s5, s4, 0
    s_and_b32 s5, s5, 3
    s_mul_i32 s5, s5, 10240
    v_add_u32 v80, s5, v1
    s_add_u32 s5, s4, 1
    s_and_b32 s5, s5, 3
    s_mul_i32 s5, s5, 10240
    v_add_u32 v81, s5, v1
    s_add_u32 s5, s4, 2
    s_and_b32 s5, s5, 3
    s_mul_i32 s5, s5, 10240
    v_add_u32 v82, s5, v1
    s_add_u32 s5, s4, 3
    s_and_b32 s5, s5, 3
    s_mul_i32 s5, s5, 10240
    v_add_u32 v83, s5, v1
    v_mov_b32 v32, 0
    v_mov_b32 v33, 0
    v_mov_b32 v34, 0
    v_mov_b32 v35, 0
    v_mov_b32 v36, 0
    v_mov_b32 v37, 0
    v_mov_b32 v38, 0
    v_mov_b32 v39, 0
    v_mov_b32 v40, 0
    v_mov_b32 v41, 0
    v_mov_b32 v42, 0
    v_mov_b32 v43, 0
    v_mov_b32 v44, 0
    v_mov_b32 v45, 0
    v_mov_b32 v46, 0
    v_mov_b32 v47, 0
    v_mov_b32 v48, 0
    v_mov_b32 v49, 0
    v_mov_b32 v50, 0
    v_mov_b32 v51, 0
    v_mov_b32 v52, 0
    v_mov_b32 v53, 0
    v_mov_b32 v54, 0
    v_mov_b32 v55, 0
    v_mov_b32 v56, 0
    v_mov_b32 v57, 0
    v_mov_b32 v58, 0
    v_mov_b32 v59, 0
    v_mov_b32 v60, 0
    v_mov_b32 v61, 0
    v_mov_b32 v62, 0
    v_mov_b32 v63, 0
    s_barrier
    s_waitcnt vmcnt(36)
    s_barrier
    ds_read_b128 v[8:11], v80 offset:40960
    ds_read_b128 v[12:15], v80 offset:41984
    ds_read_b128 v[16:19], v80 offset:43008
    ds_read_b128 v[20:23], v80 offset:44032
    ds_read_b128 v[24:27], v80 offset:45056
    ds_read_b128 v[28:31], v80 offset:46080
    s_waitcnt lgkmcnt(5)
    v_mfma_f32_32x32x16_bf16 v[32:47], v[176:179], v[8:11], v[32:47]
    ds_read_b128 v[8:11], v80 offset:47104
    s_waitcnt lgkmcnt(5)
    v_mfma_f32_32x32x16_bf16 v[48:63], v[180:183], v[12:15], v[48:63]
    ds_read_b128 v[12:15], v80 offset:48128
    s_waitcnt lgkmcnt(5)
    v_mfma_f32_32x32x16_bf16 v[32:47], v[184:187], v[16:19], v[32:47]
    ds_read_b128 v[16:19], v80 offset:49152
    s_waitcnt lgkmcnt(5)
    v_mfma_f32_32x32x16_bf16 v[48:63], v[188:191], v[20:23], v[48:63]
    ds_read_b128 v[20:23], v80 offset:50176
    s_waitcnt lgkmcnt(5)
    v_mfma_f32_32x32x16_bf16 v[32:47], v[192:195], v[24:27], v[32:47]
    s_waitcnt lgkmcnt(4)
    v_mfma_f32_32x32x16_bf16 v[48:63], v[196:199], v[28:31], v[48:63]
    s_waitcnt lgkmcnt(3)
    v_mfma_f32_32x32x16_bf16 v[32:47], v[200:203], v[8:11], v[32:47]
    s_waitcnt lgkmcnt(2)
    v_mfma_f32_32x32x16_bf16 v[48:63], v[204:207], v[12:15], v[48:63]
    s_waitcnt lgkmcnt(1)
    v_mfma_f32_32x32x16_bf16 v[32:47], v[208:211], v[16:19], v[32:47]
    s_waitcnt lgkmcnt(0)
    v_mfma_f32_32x32x16_bf16 v[48:63], v[212:215], v[20:23], v[48:63]
    s_sleep 4
    s_branch fused2_kernel_owait37
fused2_kernel_lo36:
    s_barrier
    ds_read_b128 v[64:67], v2 offset:0
    ds_read_b128 v[68:71], v2 offset:1024
    ds_read_b128 v[72:75], v2 offset:2048
    ds_read_b128 v[76:79], v2 offset:3072
    ds_read_b128 v[80:83], v2 offset:4096
    ds_read_b128 v[84:87], v2 offset:5120
    s_waitcnt lgkmcnt(0)
    v_add_f32 v144, v144, v64
    v_add_f32 v160, v160, v76
    v_add_f32 v145, v145, v65
    v_add_f32 v161, v161, v77
    v_add_f32 v146, v146, v66
    v_add_f32 v162, v162, v78
    v_add_f32 v147, v147, v67
    v_add_f32 v163, v163, v79
    v_add_f32 v148, v148, v68
    v_add_f32 v164, v164, v80
    v_add_f32 v149, v149, v69
    v_add_f32 v165, v165, v81
    v_add_f32 v150, v150, v70
    v_add_f32 v166, v166, v82
    v_add_f32 v151, v151, v71
    v_add_f32 v167, v167, v83
    v_add_f32 v152, v152, v72
    v_add_f32 v168, v168, v84
    v_add_f32 v153, v153, v73
    v_add_f32 v169, v169, v85
    v_add_f32 v154, v154, v74
    v_add_f32 v170, v170, v86
    v_add_f32 v155, v155, v75
    v_add_f32 v171, v171, v87
    v_mov_b32 v60, v152
    v_mov_b32 v61, v152
    s_nop 1
    v_permlane32_swap_b32 v60, v61
    v_mov_b32 v62, v168
    v_mov_b32 v63, v168
    s_nop 1
    v_permlane32_swap_b32 v62, v63
    s_nop 1
    s_mov_b32 s24, 0x0d800000
    s_mov_b32 s25, 0x71800000
    v_cmp_nle_f32 vcc, s24, v61
    v_cmp_nge_f32 s[26:27], s25, v61
    s_or_b64 s[28:29], vcc, s[26:27]
    v_cmp_nle_f32 vcc, s24, v63
    v_cmp_nge_f32 s[26:27], s25, v63
    s_or_b64 s[28:29], s[28:29], vcc
    s_or_b64 s[28:29], s[28:29], s[26:27]
    s_cmp_lg_u64 s[28:29], 0
    s_cbranch_scc1 fused2_kernel_fb38
fused2_kernel_fin39:
    s_mul_i32 s26, s3, 40960
    s_mul_i32 s32, s4, 160
    s_mul_i32 s5, s30, 40
    s_add_u32 s32, s32, s5
    v_rcp_f32 v59, v61
    s_nop 0
    v_mul_f32 v144, v144, v59
    v_mul_f32 v145, v145, v59
    v_mul_f32 v146, v146, v59
    v_mul_f32 v147, v147, v59
    v_mul_f32 v148, v148, v59
    v_mul_f32 v149, v149, v59
    v_mul_f32 v150, v150, v59
    v_mul_f32 v151, v151, v59
    v_mul_f32 v152, v152, v59
    v_mul_f32 v153, v153, v59
    v_mul_f32 v154, v154, v59
    v_mul_f32 v155, v155, v59
    v_cvt_pk_bf16_f32 v64, v144, v145
    v_cvt_pk_bf16_f32 v65, v146, v147
    v_cvt_pk_bf16_f32 v66, v148, v149
    v_cvt_pk_bf16_f32 v67, v150, v151
    v_cvt_pk_bf16_f32 v68, v152, v153
    v_cvt_pk_bf16_f32 v69, v154, v155
    s_add_u32 s5, s32, 0
    v_lshlrev_b32 v6, 2, v4
    v_add_u32 v6, s5, v6
    v_lshrrev_b32 v7, 3, v6
    v_lshlrev_b32 v7, 9, v7
    v_and_b32 v5, 7, v6
    v_lshl_add_u32 v7, v5, 1, v7
    v_lshl_add_u32 v7, v3, 4, v7
    ds_write_b64 v7, v[64:65] offset:40960
    v_add_u32 v6, 8, v6
    v_lshrrev_b32 v7, 3, v6
    v_lshlrev_b32 v7, 9, v7
    v_and_b32 v5, 7, v6
    v_lshl_add_u32 v7, v5, 1, v7
    v_lshl_add_u32 v7, v3, 4, v7
    ds_write_b64 v7, v[66:67] offset:40960
    v_add_u32 v6, 8, v6
    v_lshrrev_b32 v7, 3, v6
    v_lshlrev_b32 v7, 9, v7
    v_and_b32 v5, 7, v6
    v_lshl_add_u32 v7, v5, 1, v7
    v_lshl_add_u32 v7, v3, 4, v7
    s_mov_b32 exec_lo, -1
    s_mov_b32 exec_hi, 0
    ds_write_b64 v7, v[68:69] offset:40960
    s_mov_b64 exec, -1
    v_rcp_f32 v59, v63
    s_nop 0
    v_mul_f32 v160, v160, v59
    v_mul_f32 v161, v161, v59
    v_mul_f32 v162, v162, v59
    v_mul_f32 v163, v163, v59
    v_mul_f32 v164, v164, v59
    v_mul_f32 v165, v165, v59
    v_mul_f32 v166, v166, v59
    v_mul_f32 v167, v167, v59
    v_mul_f32 v168, v168, v59
    v_mul_f32 v169, v169, v59
    v_mul_f32 v170, v170, v59
    v_mul_f32 v171, v171, v59
    v_cvt_pk_bf16_f32 v64, v160, v161
    v_cvt_pk_bf16_f32 v65, v162, v163
    v_cvt_pk_bf16_f32 v66, v164, v165
    v_cvt_pk_bf16_f32 v67, v166, v167
    v_cvt_pk_bf16_f32 v68, v168, v169
    v_cvt_pk_bf16_f32 v69, v170, v171
    s_add_u32 s5, s32, 20
    v_lshlrev_b32 v6, 2, v4
    v_add_u32 v6, s5, v6
    v_lshrrev_b32 v7, 3, v6
    v_lshlrev_b32 v7, 9, v7
    v_and_b32 v5, 7, v6
    v_lshl_add_u32 v7, v5, 1, v7
    v_lshl_add_u32 v7, v3, 4, v7
    ds_write_b64 v7, v[64:65] offset:40960
    v_add_u32 v6, 8, v6
    v_lshrrev_b32 v7, 3, v6
    v_lshlrev_b32 v7, 9, v7
    v_and_b32 v5, 7, v6
    v_lshl_add_u32 v7, v5, 1, v7
    v_lshl_add_u32 v7, v3, 4, v7
    ds_write_b64 v7, v[66:67] offset:40960
    v_add_u32 v6, 8, v6
    v_lshrrev_b32 v7, 3, v6
    v_lshlrev_b32 v7, 9, v7
    v_and_b32 v5, 7, v6
    v_lshl_add_u32 v7, v5, 1, v7
    v_lshl_add_u32 v7, v3, 4, v7
    s_mov_b32 exec_lo, -1
    s_mov_b32 exec_hi, 0
    ds_write_b64 v7, v[68:69] offset:40960
    s_mov_b64 exec, -1
    s_lshl_b32 s5, s32, 6
    v_add_u32 v7, s5, v1
    s_add_u32 s26, s26, s5
    s_waitcnt lgkmcnt(0)
    ds_read_b128 v[64:67], v7 offset:40960
    ds_read_b128 v[68:71], v7 offset:41984
    s_mov_b32 exec_lo, -1
    s_mov_b32 exec_hi, 0
    ds_read_b128 v[72:75], v7 offset:43008
    s_mov_b64 exec, -1
    s_waitcnt lgkmcnt(2)
    buffer_store_dwordx4 v[64:67], v1, s[60:63], s26 offen sc1
    s_waitcnt lgkmcnt(1)
    buffer_store_dwordx4 v[68:71], v1, s[60:63], s26 offen offset:1024 sc1
    s_waitcnt lgkmcnt(0)
    s_mov_b32 exec_lo, -1
    s_mov_b32 exec_hi, 0
    buffer_store_dwordx4 v[72:75], v1, s[60:63], s26 offen offset:2048 sc1
    s_mov_b64 exec, -1
    s_barrier
    v_mov_b32 v32, 0
    v_mov_b32 v33, 0
    v_mov_b32 v34, 0
    v_mov_b32 v35, 0
    v_mov_b32 v36, 0
    v_mov_b32 v37, 0
    v_mov_b32 v38, 0
    v_mov_b32 v39, 0
    v_mov_b32 v40, 0
    v_mov_b32 v41, 0
    v_mov_b32 v42, 0
    v_mov_b32 v43, 0
    v_mov_b32 v44, 0
    v_mov_b32 v45, 0
    v_mov_b32 v46, 0
    v_mov_b32 v47, 0
    v_mov_b32 v48, 0
    v_mov_b32 v49, 0
    v_mov_b32 v50, 0
    v_mov_b32 v51, 0
    v_mov_b32 v52, 0
    v_mov_b32 v53, 0
    v_mov_b32 v54, 0
    v_mov_b32 v55, 0
    v_mov_b32 v56, 0
    v_mov_b32 v57, 0
    v_mov_b32 v58, 0
    v_mov_b32 v59, 0
    v_mov_b32 v60, 0
    v_mov_b32 v61, 0
    v_mov_b32 v62, 0
    v_mov_b32 v63, 0
    s_sleep 10
fused2_kernel_owait37:
    s_cmp_eq_u32 s42, 1
    s_cbranch_scc1 fused2_kernel_dl40
    s_sleep 12
fused2_kernel_dl40:
    s_mul_i32 s25, s3, 40960
    s_mul_i32 s5, s4, 10
    s_lshl_b32 s24, s40, 2
    s_add_u32 s24, s24, 0
    s_min_u32 s24, s24, 29
    s_add_u32 s28, s24, 10
    s_cmp_ge_u32 s24, s5
    s_cselect_b32 s24, s28, s24
    s_lshl_b32 s12, s24, 10
    s_add_u32 s16, s12, s25
    s_lshl_b32 s24, s40, 2
    s_add_u32 s24, s24, 1
    s_min_u32 s24, s24, 29
    s_add_u32 s28, s24, 10
    s_cmp_ge_u32 s24, s5
    s_cselect_b32 s24, s28, s24
    s_lshl_b32 s13, s24, 10
    s_add_u32 s17, s13, s25
    s_lshl_b32 s24, s40, 2
    s_add_u32 s24, s24, 2
    s_min_u32 s24, s24, 29
    s_add_u32 s28, s24, 10
    s_cmp_ge_u32 s24, s5
    s_cselect_b32 s24, s28, s24
    s_lshl_b32 s14, s24, 10
    s_add_u32 s18, s14, s25
    s_lshl_b32 s24, s40, 2
    s_add_u32 s24, s24, 3
    s_min_u32 s24, s24, 29
    s_add_u32 s28, s24, 10
    s_cmp_ge_u32 s24, s5
    s_cselect_b32 s24, s28, s24
    s_lshl_b32 s15, s24, 10
    s_add_u32 s19, s15, s25
    s_mov_b32 s29, 0
    v_mov_b32 v30, 0
    v_writelane_b32 v30, s16, 0
    v_writelane_b32 v30, s17, 1
    v_writelane_b32 v30, s18, 2
    v_writelane_b32 v30, s19, 3
fused2_kernel_pl41:
    buffer_load_dwordx4 v[8:11], v1, s[60:63], s16 offen sc1
    buffer_load_dwordx4 v[12:15], v1, s[60:63], s17 offen sc1
    buffer_load_dwordx4 v[16:19], v1, s[60:63], s18 offen sc1
    buffer_load_dwordx4 v[20:23], v1, s[60:63], s19 offen sc1
    s_waitcnt vmcnt(0)
    v_max3_u32 v28, v8, v9, v10
    v_max3_u32 v29, v11, v12, v13
    v_max3_u32 v28, v28, v14, v15
    v_max3_u32 v29, v29, v16, v17
    v_max3_u32 v28, v28, v18, v19
    v_max3_u32 v29, v29, v20, v21
    v_max3_u32 v28, v28, v22, v23
    v_max_u32 v28, v28, v29
    v_cmp_eq_u32 vcc, -1, v28
    s_cbranch_vccz fused2_kernel_pd42
    s_mov_b64 exec, 0xf
fused2_kernel_pq43:
    buffer_load_dword v31, v30, s[60:63], 0 offen offset:1020 sc1
    s_add_u32 s29, s29, 1
    s_waitcnt vmcnt(0)
    v_cmp_eq_u32 vcc, -1, v31
    s_cbranch_vccz fused2_kernel_pqd44
    s_sleep 1
    s_cmp_lt_u32 s29, 0x8000
    s_cbranch_scc1 fused2_kernel_pq43
fused2_kernel_pqd44:
    s_mov_b64 exec, -1
    s_cmp_lt_u32 s29, 0x8000
    s_cbranch_scc1 fused2_kernel_pl41
fused2_kernel_pd42:
    v_add_u32 v24, s12, v1
    ds_write_b128 v24, v[8:11] offset:40960
    v_add_u32 v25, s13, v1
    ds_write_b128 v25, v[12:15] offset:40960
    v_add_u32 v26, s14, v1
    ds_write_b128 v26, v[16:19] offset:40960
    v_add_u32 v27, s15, v1
    ds_write_b128 v27, v[20:23] offset:40960
    s_waitcnt lgkmcnt(0)
    s_barrier
    s_cmp_eq_u32 s31, 1
    s_cbranch_scc1 fused2_kernel_glo45
    ds_read_b128 v[8:11], v81 offset:40960
    ds_read_b128 v[12:15], v81 offset:41984
    ds_read_b128 v[16:19], v81 offset:43008
    ds_read_b128 v[20:23], v81 offset:44032
    ds_read_b128 v[24:27], v81 offset:45056
    ds_read_b128 v[28:31], v81 offset:46080
    s_waitcnt lgkmcnt(5)
    v_mfma_f32_32x32x16_bf16 v[32:47], v[216:219], v[8:11], v[32:47]
    ds_read_b128 v[8:11], v81 offset:47104
    s_waitcnt lgkmcnt(5)
    v_mfma_f32_32x32x16_bf16 v[48:63], v[220:223], v[12:15], v[48:63]
    ds_read_b128 v[12:15], v81 offset:48128
    s_waitcnt lgkmcnt(5)
    v_mfma_f32_32x32x16_bf16 v[32:47], v[224:227], v[16:19], v[32:47]
    ds_read_b128 v[16:19], v81 offset:49152
    s_waitcnt lgkmcnt(5)
    v_mfma_f32_32x32x16_bf16 v[48:63], v[228:231], v[20:23], v[48:63]
    ds_read_b128 v[20:23], v81 offset:50176
    s_waitcnt lgkmcnt(5)
    v_mfma_f32_32x32x16_bf16 v[32:47], v[232:235], v[24:27], v[32:47]
    ds_read_b128 v[24:27], v82 offset:40960
    s_waitcnt lgkmcnt(5)
    v_mfma_f32_32x32x16_bf16 v[48:63], v[236:239], v[28:31], v[48:63]
    ds_read_b128 v[28:31], v82 offset:41984
    s_waitcnt lgkmcnt(5)
    v_mfma_f32_32x32x16_bf16 v[32:47], v[240:243], v[8:11], v[32:47]
    ds_read_b128 v[8:11], v82 offset:43008
    s_waitcnt lgkmcnt(5)
    v_mfma_f32_32x32x16_bf16 v[48:63], v[244:247], v[12:15], v[48:63]
    ds_read_b128 v[12:15], v82 offset:44032
    s_waitcnt lgkmcnt(5)
    v_mfma_f32_32x32x16_bf16 v[32:47], v[248:251], v[16:19], v[32:47]
    ds_read_b128 v[16:19], v82 offset:45056
    s_waitcnt lgkmcnt(5)
    v_mfma_f32_32x32x16_bf16 v[48:63], v[252:255], v[20:23], v[48:63]
    ds_read_b128 v[20:23], v82 offset:46080
    s_waitcnt lgkmcnt(5)
    v_mfma_f32_32x32x16_bf16 v[32:47], v[96:99], v[24:27], v[32:47]
    ds_read_b128 v[24:27], v82 offset:47104
    s_waitcnt lgkmcnt(5)
    v_mfma_f32_32x32x16_bf16 v[48:63], v[100:103], v[28:31], v[48:63]
    ds_read_b128 v[28:31], v82 offset:48128
    s_waitcnt lgkmcnt(5)
    v_mfma_f32_32x32x16_bf16 v[32:47], v[104:107], v[8:11], v[32:47]
    ds_read_b128 v[8:11], v82 offset:49152
    s_waitcnt lgkmcnt(5)
    v_mfma_f32_32x32x16_bf16 v[48:63], v[108:111], v[12:15], v[48:63]
    ds_read_b128 v[12:15], v82 offset:50176
    s_waitcnt lgkmcnt(5)
    v_mfma_f32_32x32x16_bf16 v[32:47], v[112:115], v[16:19], v[32:47]
    ds_read_b128 v[16:19], v83 offset:40960
    s_waitcnt lgkmcnt(5)
    v_mfma_f32_32x32x16_bf16 v[48:63], v[116:119], v[20:23], v[48:63]
    ds_read_b128 v[20:23], v83 offset:41984
    s_waitcnt lgkmcnt(5)
    v_mfma_f32_32x32x16_bf16 v[32:47], v[120:123], v[24:27], v[32:47]
    s_barrier
    ds_read_b128 v[24:27], v83 offset:43008
    s_waitcnt lgkmcnt(5)
    v_mfma_f32_32x32x16_bf16 v[48:63], v[124:127], v[28:31], v[48:63]
    ds_read_b128 v[28:31], v83 offset:44032
    s_waitcnt lgkmcnt(5)
    v_mfma_f32_32x32x16_bf16 v[32:47], v[128:131], v[8:11], v[32:47]
    ds_read_b128 v[8:11], v83 offset:45056
    s_waitcnt lgkmcnt(5)
    v_mfma_f32_32x32x16_bf16 v[48:63], v[132:135], v[12:15], v[48:63]
    ds_read_b128 v[12:15], v83 offset:46080
    s_waitcnt lgkmcnt(5)
    v_mfma_f32_32x32x16_bf16 v[32:47], v[136:139], v[16:19], v[32:47]
    ds_read_b128 v[16:19], v83 offset:47104
    s_waitcnt lgkmcnt(5)
    v_mfma_f32_32x32x16_bf16 v[48:63], v[140:143], v[20:23], v[48:63]
    ds_read_b128 v[20:23], v83 offset:48128
    s_waitcnt lgkmcnt(5)
    v_mfma_f32_32x32x16_bf16 v[32:47], v[144:147], v[24:27], v[32:47]
    ds_read_b128 v[24:27], v83 offset:49152
    s_waitcnt lgkmcnt(5)
    v_mfma_f32_32x32x16_bf16 v[48:63], v[148:151], v[28:31], v[48:63]
    ds_read_b128 v[28:31], v83 offset:50176
    s_waitcnt lgkmcnt(5)
    v_mfma_f32_32x32x16_bf16 v[32:47], v[152:155], v[8:11], v[32:47]
    s_waitcnt lgkmcnt(4)
    v_mfma_f32_32x32x16_bf16 v[48:63], v[156:159], v[12:15], v[48:63]
    s_waitcnt lgkmcnt(3)
    v_mfma_f32_32x32x16_bf16 v[32:47], v[160:163], v[16:19], v[32:47]
    s_waitcnt lgkmcnt(2)
    v_mfma_f32_32x32x16_bf16 v[48:63], v[164:167], v[20:23], v[48:63]
    s_waitcnt lgkmcnt(1)
    v_mfma_f32_32x32x16_bf16 v[32:47], v[168:171], v[24:27], v[32:47]
    s_waitcnt lgkmcnt(0)
    v_mfma_f32_32x32x16_bf16 v[48:63], v[172:175], v[28:31], v[48:63]
    s_nop 15
    s_nop 3
    v_add_f32 v32, v32, v48
    v_add_f32 v33, v33, v49
    v_add_f32 v34, v34, v50
    v_add_f32 v35, v35, v51
    v_add_f32 v36, v36, v52
    v_add_f32 v37, v37, v53
    v_add_f32 v38, v38, v54
    v_add_f32 v39, v39, v55
    v_add_f32 v40, v40, v56
    v_add_f32 v41, v41, v57
    v_add_f32 v42, v42, v58
    v_add_f32 v43, v43, v59
    v_add_f32 v44, v44, v60
    v_add_f32 v45, v45, v61
    v_add_f32 v46, v46, v62
    v_add_f32 v47, v47, v63
    s_branch fused2_kernel_epi46
fused2_kernel_glo45:
    s_mul_i32 s5, s30, 10240
    v_add_u32 v2, s5, v1
    ds_read_b128 v[8:11], v2 offset:40960
    ds_read_b128 v[12:15], v2 offset:41984
    ds_read_b128 v[16:19], v2 offset:43008
    ds_read_b128 v[20:23], v2 offset:44032
    ds_read_b128 v[24:27], v2 offset:45056
    ds_read_b128 v[28:31], v2 offset:46080
    s_waitcnt lgkmcnt(5)
    v_mfma_f32_32x32x16_bf16 v[32:47], v[176:179], v[8:11], v[32:47]
    ds_read_b128 v[8:11], v2 offset:47104
    s_waitcnt lgkmcnt(5)
    v_mfma_f32_32x32x16_bf16 v[48:63], v[180:183], v[12:15], v[48:63]
    ds_read_b128 v[12:15], v2 offset:48128
    s_waitcnt lgkmcnt(5)
    v_mfma_f32_32x32x16_bf16 v[32:47], v[184:187], v[16:19], v[32:47]
    ds_read_b128 v[16:19], v2 offset:49152
    s_waitcnt lgkmcnt(5)
    v_mfma_f32_32x32x16_bf16 v[48:63], v[188:191], v[20:23], v[48:63]
    ds_read_b128 v[20:23], v2 offset:50176
    s_waitcnt lgkmcnt(5)
    v_mfma_f32_32x32x16_bf16 v[32:47], v[192:195], v[24:27], v[32:47]
    s_waitcnt lgkmcnt(4)
    v_mfma_f32_32x32x16_bf16 v[48:63], v[196:199], v[28:31], v[48:63]
    s_waitcnt lgkmcnt(3)
    v_mfma_f32_32x32x16_bf16 v[32:47], v[200:203], v[8:11], v[32:47]
    s_waitcnt lgkmcnt(2)
    v_mfma_f32_32x32x16_bf16 v[48:63], v[204:207], v[12:15], v[48:63]
    s_waitcnt lgkmcnt(1)
    v_mfma_f32_32x32x16_bf16 v[32:47], v[208:211], v[16:19], v[32:47]
    s_waitcnt lgkmcnt(0)
    v_mfma_f32_32x32x16_bf16 v[48:63], v[212:215], v[20:23], v[48:63]
    s_nop 15
    s_nop 3
    v_add_f32 v32, v32, v48
    v_add_f32 v33, v33, v49
    v_add_f32 v34, v34, v50
    v_add_f32 v35, v35, v51
    v_add_f32 v36, v36, v52
    v_add_f32 v37, v37, v53
    v_add_f32 v38, v38, v54
    v_add_f32 v39, v39, v55
    v_add_f32 v40, v40, v56
    v_add_f32 v41, v41, v57
    v_add_f32 v42, v42, v58
    v_add_f32 v43, v43, v59
    v_add_f32 v44, v44, v60
    v_add_f32 v45, v45, v61
    v_add_f32 v46, v46, v62
    v_add_f32 v47, v47, v63
    s_lshl_b32 s5, s30, 12
    s_add_u32 s5, s5, 81920
    v_add_u32 v2, s5, v1
    s_cmp_eq_u32 s30, 0
    s_cbranch_scc1 fused2_kernel_w047
    ds_write_b128 v2, v[32:35] offset:0
    ds_write_b128 v2, v[36:39] offset:1024
    ds_write_b128 v2, v[40:43] offset:2048
    ds_write_b128 v2, v[44:47] offset:3072
    s_waitcnt lgkmcnt(0)
    s_barrier
    s_endpgm
fused2_kernel_w047:
    v_mov_b32 v64, v216
    v_mov_b32 v65, v217
    v_mov_b32 v66, v218
    v_mov_b32 v67, v219
    v_mov_b32 v68, v220
    v_mov_b32 v69, v221
    v_mov_b32 v70, v222
    v_mov_b32 v71, v223
    v_mov_b32 v72, v224
    v_mov_b32 v73, v225
    v_mov_b32 v74, v226
    v_mov_b32 v75, v227
    v_mov_b32 v76, v228
    v_mov_b32 v77, v229
    v_mov_b32 v78, v230
    v_mov_b32 v79, v231
    s_barrier
    ds_read_b128 v[96:99], v2 offset:4096
    ds_read_b128 v[100:103], v2 offset:5120
    ds_read_b128 v[104:107], v2 offset:6144
    ds_read_b128 v[108:111], v2 offset:7168
    ds_read_b128 v[112:115], v2 offset:8192
    ds_read_b128 v[116:119], v2 offset:9216
    ds_read_b128 v[120:123], v2 offset:10240
    ds_read_b128 v[124:127], v2 offset:11264
    ds_read_b128 v[128:131], v2 offset:12288
    ds_read_b128 v[132:135], v2 offset:13312
    ds_read_b128 v[136:139], v2 offset:14336
    ds_read_b128 v[140:143], v2 offset:15360
    s_waitcnt lgkmcnt(0)
    v_add_f32 v96, v96, v112
    v_add_f32 v32, v32, v128
    v_add_f32 v97, v97, v113
    v_add_f32 v33, v33, v129
    v_add_f32 v98, v98, v114
    v_add_f32 v34, v34, v130
    v_add_f32 v99, v99, v115
    v_add_f32 v35, v35, v131
    v_add_f32 v100, v100, v116
    v_add_f32 v36, v36, v132
    v_add_f32 v101, v101, v117
    v_add_f32 v37, v37, v133
    v_add_f32 v102, v102, v118
    v_add_f32 v38, v38, v134
    v_add_f32 v103, v103, v119
    v_add_f32 v39, v39, v135
    v_add_f32 v104, v104, v120
    v_add_f32 v40, v40, v136
    v_add_f32 v105, v105, v121
    v_add_f32 v41, v41, v137
    v_add_f32 v106, v106, v122
    v_add_f32 v42, v42, v138
    v_add_f32 v107, v107, v123
    v_add_f32 v43, v43, v139
    v_add_f32 v108, v108, v124
    v_add_f32 v44, v44, v140
    v_add_f32 v109, v109, v125
    v_add_f32 v45, v45, v141
    v_add_f32 v110, v110, v126
    v_add_f32 v46, v46, v142
    v_add_f32 v111, v111, v127
    v_add_f32 v47, v47, v143
    v_add_f32 v32, v32, v96
    v_add_f32 v33, v33, v97
    v_add_f32 v34, v34, v98
    v_add_f32 v35, v35, v99
    v_add_f32 v36, v36, v100
    v_add_f32 v37, v37, v101
    v_add_f32 v38, v38, v102
    v_add_f32 v39, v39, v103
    v_add_f32 v40, v40, v104
    v_add_f32 v41, v41, v105
    v_add_f32 v42, v42, v106
    v_add_f32 v43, v43, v107
    v_add_f32 v44, v44, v108
    v_add_f32 v45, v45, v109
    v_add_f32 v46, v46, v110
    v_add_f32 v47, v47, v111
fused2_kernel_epi46:
    v_cvt_pk_bf16_f32 v32, v32, v32
    v_lshlrev_b32 v32, 16, v32
    v_cvt_pk_bf16_f32 v33, v33, v33
    v_lshlrev_b32 v33, 16, v33
    v_cvt_pk_bf16_f32 v34, v34, v34
    v_lshlrev_b32 v34, 16, v34
    v_cvt_pk_bf16_f32 v35, v35, v35
    v_lshlrev_b32 v35, 16, v35
    v_cvt_pk_bf16_f32 v36, v36, v36
    v_lshlrev_b32 v36, 16, v36
    v_cvt_pk_bf16_f32 v37, v37, v37
    v_lshlrev_b32 v37, 16, v37
    v_cvt_pk_bf16_f32 v38, v38, v38
    v_lshlrev_b32 v38, 16, v38
    v_cvt_pk_bf16_f32 v39, v39, v39
    v_lshlrev_b32 v39, 16, v39
    v_cvt_pk_bf16_f32 v40, v40, v40
    v_lshlrev_b32 v40, 16, v40
    v_cvt_pk_bf16_f32 v41, v41, v41
    v_lshlrev_b32 v41, 16, v41
    v_cvt_pk_bf16_f32 v42, v42, v42
    v_lshlrev_b32 v42, 16, v42
    v_cvt_pk_bf16_f32 v43, v43, v43
    v_lshlrev_b32 v43, 16, v43
    v_cvt_pk_bf16_f32 v44, v44, v44
    v_lshlrev_b32 v44, 16, v44
    v_cvt_pk_bf16_f32 v45, v45, v45
    v_lshlrev_b32 v45, 16, v45
    v_cvt_pk_bf16_f32 v46, v46, v46
    v_lshlrev_b32 v46, 16, v46
    v_cvt_pk_bf16_f32 v47, v47, v47
    v_lshlrev_b32 v47, 16, v47
    v_lshlrev_b32 v64, 16, v64
    v_add_f32 v32, v32, v64
    v_lshlrev_b32 v65, 16, v65
    v_add_f32 v33, v33, v65
    v_lshlrev_b32 v66, 16, v66
    v_add_f32 v34, v34, v66
    v_lshlrev_b32 v67, 16, v67
    v_add_f32 v35, v35, v67
    v_lshlrev_b32 v68, 16, v68
    v_add_f32 v36, v36, v68
    v_lshlrev_b32 v69, 16, v69
    v_add_f32 v37, v37, v69
    v_lshlrev_b32 v70, 16, v70
    v_add_f32 v38, v38, v70
    v_lshlrev_b32 v71, 16, v71
    v_add_f32 v39, v39, v71
    v_lshlrev_b32 v72, 16, v72
    v_add_f32 v40, v40, v72
    v_lshlrev_b32 v73, 16, v73
    v_add_f32 v41, v41, v73
    v_lshlrev_b32 v74, 16, v74
    v_add_f32 v42, v42, v74
    v_lshlrev_b32 v75, 16, v75
    v_add_f32 v43, v43, v75
    v_lshlrev_b32 v76, 16, v76
    v_add_f32 v44, v44, v76
    v_lshlrev_b32 v77, 16, v77
    v_add_f32 v45, v45, v77
    v_lshlrev_b32 v78, 16, v78
    v_add_f32 v46, v46, v78
    v_lshlrev_b32 v79, 16, v79
    v_add_f32 v47, v47, v79
    v_mul_u32_u24 v5, 1280, v3
    v_lshl_add_u32 v5, v4, 3, v5
    v_cvt_pk_bf16_f32 v8, v32, v33
    v_cvt_pk_bf16_f32 v9, v34, v35
    v_cvt_pk_bf16_f32 v10, v36, v37
    v_cvt_pk_bf16_f32 v11, v38, v39
    v_cvt_pk_bf16_f32 v12, v40, v41
    v_cvt_pk_bf16_f32 v13, v42, v43
    v_cvt_pk_bf16_f32 v14, v44, v45
    v_cvt_pk_bf16_f32 v15, v46, v47
    s_mul_i32 s28, s3, 40960
    s_lshl_b32 s29, s34, 6
    s_add_u32 s28, s28, s29
    buffer_store_dwordx2 v[8:9], v5, s[72:75], s28 offen offset:0 sc0 sc1
    buffer_store_dwordx2 v[10:11], v5, s[72:75], s28 offen offset:16 sc0 sc1
    buffer_store_dwordx2 v[12:13], v5, s[72:75], s28 offen offset:32 sc0 sc1
    buffer_store_dwordx2 v[14:15], v5, s[72:75], s28 offen offset:48 sc0 sc1
    s_endpgm
fused2_kernel_g0r19:
    s_mov_b32 s29, 0
fused2_kernel_g0l48:
    s_sleep 2
    s_mov_b32 s21, s20
    buffer_load_dwordx4 v[96:99], v4, s[56:59], s21 offen offset:0 sc1
    buffer_load_dwordx4 v[100:103], v4, s[56:59], s21 offen offset:1024 sc1
    buffer_load_dwordx4 v[104:107], v4, s[56:59], s21 offen offset:2048 sc1
    buffer_load_dwordx4 v[108:111], v4, s[56:59], s21 offen offset:3072 sc1
    s_add_u32 s21, s21, 4096
    buffer_load_dwordx4 v[112:115], v4, s[56:59], s21 offen offset:0 sc1
    buffer_load_dwordx4 v[116:119], v4, s[56:59], s21 offen offset:1024 sc1
    buffer_load_dwordx4 v[120:123], v4, s[56:59], s21 offen offset:2048 sc1
    buffer_load_dwordx4 v[124:127], v4, s[56:59], s21 offen offset:3072 sc1
    s_add_u32 s21, s21, 4096
    buffer_load_dwordx4 v[128:131], v4, s[56:59], s21 offen offset:0 sc1
    buffer_load_dwordx4 v[132:135], v4, s[56:59], s21 offen offset:1024 sc1
    buffer_load_dwordx4 v[136:139], v4, s[56:59], s21 offen offset:2048 sc1
    buffer_load_dwordx4 v[140:143], v4, s[56:59], s21 offen offset:3072 sc1
    s_add_u32 s21, s21, 4096
    buffer_load_dwordx4 v[144:147], v4, s[56:59], s21 offen offset:0 sc1
    buffer_load_dwordx4 v[148:151], v4, s[56:59], s21 offen offset:1024 sc1
    buffer_load_dwordx4 v[152:155], v4, s[56:59], s21 offen offset:2048 sc1
    buffer_load_dwordx4 v[156:159], v4, s[56:59], s21 offen offset:3072 sc1
    s_add_u32 s21, s21, 4096
    buffer_load_dwordx4 v[160:163], v4, s[56:59], s21 offen offset:0 sc1
    buffer_load_dwordx4 v[164:167], v4, s[56:59], s21 offen offset:1024 sc1
    buffer_load_dwordx4 v[168:171], v4, s[56:59], s21 offen offset:2048 sc1
    buffer_load_dwordx4 v[172:175], v4, s[56:59], s21 offen offset:3072 sc1
    v_mov_b32 v28, 0
    v_mov_b32 v29, 0
    s_waitcnt vmcnt(19)
    ds_write_b128 v5, v[96:99] offset:0
    v_max3_u32 v28, v28, v96, v97
    v_max3_u32 v29, v29, v98, v99
    s_waitcnt vmcnt(18)
    ds_write_b128 v5, v[100:103] offset:1024
    v_max3_u32 v28, v28, v100, v101
    v_max3_u32 v29, v29, v102, v103
    s_waitcnt vmcnt(17)
    ds_write_b128 v5, v[104:107] offset:2048
    v_max3_u32 v28, v28, v104, v105
    v_max3_u32 v29, v29, v106, v107
    s_waitcnt vmcnt(16)
    ds_write_b128 v5, v[108:111] offset:3072
    v_max3_u32 v28, v28, v108, v109
    v_max3_u32 v29, v29, v110, v111
    s_waitcnt vmcnt(15)
    ds_write_b128 v5, v[112:115] offset:4096
    v_max3_u32 v28, v28, v112, v113
    v_max3_u32 v29, v29, v114, v115
    s_waitcnt vmcnt(14)
    ds_write_b128 v5, v[116:119] offset:5120
    v_max3_u32 v28, v28, v116, v117
    v_max3_u32 v29, v29, v118, v119
    s_waitcnt vmcnt(13)
    ds_write_b128 v5, v[120:123] offset:6144
    v_max3_u32 v28, v28, v120, v121
    v_max3_u32 v29, v29, v122, v123
    s_waitcnt vmcnt(12)
    ds_write_b128 v5, v[124:127] offset:7168
    v_max3_u32 v28, v28, v124, v125
    v_max3_u32 v29, v29, v126, v127
    s_waitcnt vmcnt(11)
    ds_write_b128 v5, v[128:131] offset:8192
    v_max3_u32 v28, v28, v128, v129
    v_max3_u32 v29, v29, v130, v131
    s_waitcnt vmcnt(10)
    ds_write_b128 v5, v[132:135] offset:9216
    v_max3_u32 v28, v28, v132, v133
    v_max3_u32 v29, v29, v134, v135
    s_waitcnt vmcnt(9)
    ds_write_b128 v5, v[136:139] offset:10240
    v_max3_u32 v28, v28, v136, v137
    v_max3_u32 v29, v29, v138, v139
    s_waitcnt vmcnt(8)
    ds_write_b128 v5, v[140:143] offset:11264
    v_max3_u32 v28, v28, v140, v141
    v_max3_u32 v29, v29, v142, v143
    s_waitcnt vmcnt(7)
    ds_write_b128 v5, v[144:147] offset:12288
    v_max3_u32 v28, v28, v144, v145
    v_max3_u32 v29, v29, v146, v147
    s_waitcnt vmcnt(6)
    ds_write_b128 v5, v[148:151] offset:13312
    v_max3_u32 v28, v28, v148, v149
    v_max3_u32 v29, v29, v150, v151
    s_waitcnt vmcnt(5)
    ds_write_b128 v5, v[152:155] offset:14336
    v_max3_u32 v28, v28, v152, v153
    v_max3_u32 v29, v29, v154, v155
    s_waitcnt vmcnt(4)
    ds_write_b128 v5, v[156:159] offset:15360
    v_max3_u32 v28, v28, v156, v157
    v_max3_u32 v29, v29, v158, v159
    s_waitcnt vmcnt(3)
    ds_write_b128 v5, v[160:163] offset:16384
    v_max3_u32 v28, v28, v160, v161
    v_max3_u32 v29, v29, v162, v163
    s_waitcnt vmcnt(2)
    ds_write_b128 v5, v[164:167] offset:17408
    v_max3_u32 v28, v28, v164, v165
    v_max3_u32 v29, v29, v166, v167
    s_waitcnt vmcnt(1)
    ds_write_b128 v5, v[168:171] offset:18432
    v_max3_u32 v28, v28, v168, v169
    v_max3_u32 v29, v29, v170, v171
    s_waitcnt vmcnt(0)
    ds_write_b128 v5, v[172:175] offset:19456
    v_max3_u32 v28, v28, v172, v173
    v_max3_u32 v29, v29, v174, v175
    v_max_u32 v28, v28, v29
    v_cmp_eq_u32 vcc, -1, v28
    s_cbranch_vccz fused2_kernel_g0d20
    s_add_u32 s29, s29, 1
    s_cmp_lt_u32 s29, 0x8000
    s_cbranch_scc1 fused2_kernel_g0l48
    s_branch fused2_kernel_g0d20
fused2_kernel_vr21:
    s_mov_b32 s29, 0
fused2_kernel_vl49:
    s_sleep 2
    s_add_u32 s21, s20, 40960
    buffer_load_dwordx4 v[176:179], v1, s[56:59], s21 offen sc1
    s_add_u32 s21, s21, 1024
    buffer_load_dwordx4 v[180:183], v1, s[56:59], s21 offen sc1
    s_add_u32 s21, s21, 1024
    buffer_load_dwordx4 v[184:187], v1, s[56:59], s21 offen sc1
    s_add_u32 s21, s21, 1024
    buffer_load_dwordx4 v[188:191], v1, s[56:59], s21 offen sc1
    s_add_u32 s21, s21, 1024
    buffer_load_dwordx4 v[192:195], v1, s[56:59], s21 offen sc1
    s_add_u32 s21, s21, 1024
    s_waitcnt vmcnt(0)
    ds_write_b128 v196, v[176:179] offset:0
    ds_write_b128 v196, v[180:183] offset:1024
    ds_write_b128 v196, v[184:187] offset:2048
    ds_write_b128 v196, v[188:191] offset:3072
    ds_write_b128 v196, v[192:195] offset:4096
    s_waitcnt lgkmcnt(0)
    v_max3_u32 v197, v176, v177, v178
    v_max3_u32 v198, v179, v180, v181
    v_max3_u32 v197, v197, v182, v183
    v_max3_u32 v198, v198, v184, v185
    v_max3_u32 v197, v197, v186, v187
    v_max3_u32 v198, v198, v188, v189
    v_max3_u32 v197, v197, v190, v191
    v_max3_u32 v198, v198, v192, v193
    v_max3_u32 v197, v197, v194, v195
    v_max_u32 v197, v197, v198
    v_cmp_eq_u32 vcc, -1, v197
    s_cbranch_vccz fused2_kernel_vd24
    s_add_u32 s29, s29, 1
    s_cmp_lt_u32 s29, 0x8000
    s_cbranch_scc1 fused2_kernel_vl49
    s_branch fused2_kernel_vd24
fused2_kernel_vr22:
    s_mov_b32 s29, 0
fused2_kernel_vl50:
    s_sleep 2
    s_add_u32 s21, s20, 81920
    buffer_load_dwordx4 v[176:179], v1, s[56:59], s21 offen sc1
    s_add_u32 s21, s21, 1024
    buffer_load_dwordx4 v[180:183], v1, s[56:59], s21 offen sc1
    s_add_u32 s21, s21, 1024
    buffer_load_dwordx4 v[184:187], v1, s[56:59], s21 offen sc1
    s_add_u32 s21, s21, 1024
    buffer_load_dwordx4 v[188:191], v1, s[56:59], s21 offen sc1
    s_add_u32 s21, s21, 1024
    buffer_load_dwordx4 v[192:195], v1, s[56:59], s21 offen sc1
    s_add_u32 s21, s21, 1024
    s_waitcnt vmcnt(0)
    ds_write_b128 v196, v[176:179] offset:0
    ds_write_b128 v196, v[180:183] offset:1024
    ds_write_b128 v196, v[184:187] offset:2048
    ds_write_b128 v196, v[188:191] offset:3072
    ds_write_b128 v196, v[192:195] offset:4096
    s_waitcnt lgkmcnt(0)
    v_max3_u32 v197, v176, v177, v178
    v_max3_u32 v198, v179, v180, v181
    v_max3_u32 v197, v197, v182, v183
    v_max3_u32 v198, v198, v184, v185
    v_max3_u32 v197, v197, v186, v187
    v_max3_u32 v198, v198, v188, v189
    v_max3_u32 v197, v197, v190, v191
    v_max3_u32 v198, v198, v192, v193
    v_max3_u32 v197, v197, v194, v195
    v_max_u32 v197, v197, v198
    v_cmp_eq_u32 vcc, -1, v197
    s_cbranch_vccz fused2_kernel_vd25
    s_add_u32 s29, s29, 1
    s_cmp_lt_u32 s29, 0x8000
    s_cbranch_scc1 fused2_kernel_vl50
    s_branch fused2_kernel_vd25
fused2_kernel_vr23:
    s_mov_b32 s29, 0
fused2_kernel_vl51:
    s_sleep 2
    s_add_u32 s21, s20, 122880
    buffer_load_dwordx4 v[176:179], v1, s[56:59], s21 offen sc1
    s_add_u32 s21, s21, 1024
    buffer_load_dwordx4 v[180:183], v1, s[56:59], s21 offen sc1
    s_add_u32 s21, s21, 1024
    buffer_load_dwordx4 v[184:187], v1, s[56:59], s21 offen sc1
    s_add_u32 s21, s21, 1024
    buffer_load_dwordx4 v[188:191], v1, s[56:59], s21 offen sc1
    s_add_u32 s21, s21, 1024
    buffer_load_dwordx4 v[192:195], v1, s[56:59], s21 offen sc1
    s_add_u32 s21, s21, 1024
    s_waitcnt vmcnt(0)
    ds_write_b128 v196, v[176:179] offset:0
    ds_write_b128 v196, v[180:183] offset:1024
    ds_write_b128 v196, v[184:187] offset:2048
    ds_write_b128 v196, v[188:191] offset:3072
    ds_write_b128 v196, v[192:195] offset:4096
    s_waitcnt lgkmcnt(0)
    v_max3_u32 v197, v176, v177, v178
    v_max3_u32 v198, v179, v180, v181
    v_max3_u32 v197, v197, v182, v183
    v_max3_u32 v198, v198, v184, v185
    v_max3_u32 v197, v197, v186, v187
    v_max3_u32 v198, v198, v188, v189
    v_max3_u32 v197, v197, v190, v191
    v_max3_u32 v198, v198, v192, v193
    v_max3_u32 v197, v197, v194, v195
    v_max_u32 v197, v197, v198
    v_cmp_eq_u32 vcc, -1, v197
    s_cbranch_vccz fused2_kernel_vd26
    s_add_u32 s29, s29, 1
    s_cmp_lt_u32 s29, 0x8000
    s_cbranch_scc1 fused2_kernel_vl51
    s_branch fused2_kernel_vd26
fused2_kernel_fb38:
    v_and_b32 v56, 63, v0
    v_lshlrev_b32 v56, 4, v56
    v_lshlrev_b32 v57, 3, v3
    v_mul_u32_u24 v58, 320, v4
    v_lshl_add_u32 v58, v3, 4, v58
    v_mov_b32 v144, 0
    v_mov_b32 v145, 0
    v_mov_b32 v146, 0
    v_mov_b32 v147, 0
    v_mov_b32 v148, 0
    v_mov_b32 v149, 0
    v_mov_b32 v150, 0
    v_mov_b32 v151, 0
    v_mov_b32 v152, 0
    v_mov_b32 v153, 0
    v_mov_b32 v154, 0
    v_mov_b32 v155, 0
    v_mov_b32 v156, 0
    v_mov_b32 v157, 0
    v_mov_b32 v158, 0
    v_mov_b32 v159, 0
    v_mov_b32 v60, 0xff7fffff
    s_mov_b32 s33, 0
fused2_kernel_fbl52:
    s_lshr_b32 s38, s33, 4
    s_mul_i32 s38, s38, 40960
    s_and_b32 s35, s33, 15
    s_lshl_b32 s36, s35, 10
    s_add_u32 s36, s36, s38
    buffer_load_dwordx4 v[24:27], v56, s[56:59], s36 offen sc1
    s_lshl_b32 s36, s35, 8
    s_add_u32 s36, s36, s38
    s_add_u32 s36, s36, 16384
    buffer_load_dwordx2 v[28:29], v57, s[56:59], s36 offen sc1
    s_mul_i32 s36, s35, 1280
    s_add_u32 s36, s36, s38
    s_add_u32 s36, s36, 20480
    s_mov_b64 exec, s[22:23]
    buffer_load_dwordx4 v[40:43], v58, s[56:59], s36 offen sc1
    buffer_load_dwordx4 v[44:47], v58, s[56:59], s36 offen offset:640 sc1
    s_mov_b64 exec, -1
    s_waitcnt vmcnt(0)
    v_mfma_f32_32x32x16_bf16 v[64:79], v[24:27], v[8:11], 0
    v_mfma_f32_32x32x8_bf16 v[64:79], v[28:29], v[12:13], v[64:79]
    s_nop 15
    s_nop 7
    v_max3_f32 v80, v64, v65, v66
    v_max3_f32 v80, v80, v67, v68
    v_max3_f32 v80, v80, v69, v70
    v_max3_f32 v80, v80, v71, v72
    v_max3_f32 v80, v80, v73, v74
    v_max3_f32 v80, v80, v75, v76
    v_max3_f32 v80, v80, v77, v78
    v_max3_f32 v80, v80, v79, v60
    v_mov_b32 v81, v80
    s_nop 1
    v_permlane32_swap_b32 v80, v81
    s_nop 1
    v_max_f32 v80, v80, v81
    v_sub_f32 v81, v60, v80
    v_exp_f32 v81, v81
    v_mov_b32 v60, v80
    v_sub_f32 v64, v64, v80
    v_mul_f32 v144, v144, v81
    v_sub_f32 v65, v65, v80
    v_mul_f32 v145, v145, v81
    v_sub_f32 v66, v66, v80
    v_mul_f32 v146, v146, v81
    v_sub_f32 v67, v67, v80
    v_mul_f32 v147, v147, v81
    v_sub_f32 v68, v68, v80
    v_mul_f32 v148, v148, v81
    v_sub_f32 v69, v69, v80
    v_mul_f32 v149, v149, v81
    v_sub_f32 v70, v70, v80
    v_mul_f32 v150, v150, v81
    v_sub_f32 v71, v71, v80
    v_mul_f32 v151, v151, v81
    v_sub_f32 v72, v72, v80
    v_mul_f32 v152, v152, v81
    v_sub_f32 v73, v73, v80
    v_mul_f32 v153, v153, v81
    v_sub_f32 v74, v74, v80
    v_mul_f32 v154, v154, v81
    v_sub_f32 v75, v75, v80
    v_mul_f32 v155, v155, v81
    v_sub_f32 v76, v76, v80
    v_mul_f32 v156, v156, v81
    v_sub_f32 v77, v77, v80
    v_mul_f32 v157, v157, v81
    v_sub_f32 v78, v78, v80
    v_mul_f32 v158, v158, v81
    v_sub_f32 v79, v79, v80
    v_mul_f32 v159, v159, v81
    v_exp_f32 v64, v64
    v_exp_f32 v65, v65
    v_exp_f32 v66, v66
    v_exp_f32 v67, v67
    v_exp_f32 v68, v68
    v_exp_f32 v69, v69
    v_exp_f32 v70, v70
    v_exp_f32 v71, v71
    v_exp_f32 v72, v72
    v_exp_f32 v73, v73
    v_exp_f32 v74, v74
    v_exp_f32 v75, v75
    v_exp_f32 v76, v76
    v_exp_f32 v77, v77
    v_exp_f32 v78, v78
    v_exp_f32 v79, v79
    s_nop 0
    v_cvt_pk_bf16_f32 v128, v64, v65
    v_cvt_pk_bf16_f32 v129, v66, v67
    v_cvt_pk_bf16_f32 v130, v68, v69
    v_cvt_pk_bf16_f32 v131, v70, v71
    v_cvt_pk_bf16_f32 v132, v72, v73
    v_cvt_pk_bf16_f32 v133, v74, v75
    v_cvt_pk_bf16_f32 v134, v76, v77
    v_cvt_pk_bf16_f32 v135, v78, v79
    s_nop 1
    v_mfma_f32_32x32x16_bf16 v[144:159], v[40:43], v[128:131], v[144:159]
    v_mfma_f32_32x32x16_bf16 v[144:159], v[44:47], v[132:135], v[144:159]
    s_nop 15
    s_nop 7
    s_add_u32 s33, s33, 1
    s_cmp_lt_u32 s33, 64
    s_cbranch_scc1 fused2_kernel_fbl52
    v_mov_b32 v60, v152
    v_mov_b32 v61, v152
    s_nop 1
    v_permlane32_swap_b32 v60, v61
    s_nop 1
    v_mov_b32 v160, 0
    v_mov_b32 v161, 0
    v_mov_b32 v162, 0
    v_mov_b32 v163, 0
    v_mov_b32 v164, 0
    v_mov_b32 v165, 0
    v_mov_b32 v166, 0
    v_mov_b32 v167, 0
    v_mov_b32 v168, 0
    v_mov_b32 v169, 0
    v_mov_b32 v170, 0
    v_mov_b32 v171, 0
    v_mov_b32 v172, 0
    v_mov_b32 v173, 0
    v_mov_b32 v174, 0
    v_mov_b32 v175, 0
    v_mov_b32 v60, 0xff7fffff
    s_mov_b32 s33, 0
fused2_kernel_fbl53:
    s_lshr_b32 s38, s33, 4
    s_mul_i32 s38, s38, 40960
    s_and_b32 s35, s33, 15
    s_lshl_b32 s36, s35, 10
    s_add_u32 s36, s36, s38
    buffer_load_dwordx4 v[24:27], v56, s[56:59], s36 offen sc1
    s_lshl_b32 s36, s35, 8
    s_add_u32 s36, s36, s38
    s_add_u32 s36, s36, 16384
    buffer_load_dwordx2 v[28:29], v57, s[56:59], s36 offen sc1
    s_mul_i32 s36, s35, 1280
    s_add_u32 s36, s36, s38
    s_add_u32 s36, s36, 20480
    s_mov_b64 exec, s[22:23]
    buffer_load_dwordx4 v[40:43], v58, s[56:59], s36 offen sc1
    buffer_load_dwordx4 v[44:47], v58, s[56:59], s36 offen offset:640 sc1
    s_mov_b64 exec, -1
    s_waitcnt vmcnt(0)
    v_mfma_f32_32x32x16_bf16 v[64:79], v[24:27], v[16:19], 0
    v_mfma_f32_32x32x8_bf16 v[64:79], v[28:29], v[20:21], v[64:79]
    s_nop 15
    s_nop 7
    v_max3_f32 v80, v64, v65, v66
    v_max3_f32 v80, v80, v67, v68
    v_max3_f32 v80, v80, v69, v70
    v_max3_f32 v80, v80, v71, v72
    v_max3_f32 v80, v80, v73, v74
    v_max3_f32 v80, v80, v75, v76
    v_max3_f32 v80, v80, v77, v78
    v_max3_f32 v80, v80, v79, v60
    v_mov_b32 v81, v80
    s_nop 1
    v_permlane32_swap_b32 v80, v81
    s_nop 1
    v_max_f32 v80, v80, v81
    v_sub_f32 v81, v60, v80
    v_exp_f32 v81, v81
    v_mov_b32 v60, v80
    v_sub_f32 v64, v64, v80
    v_mul_f32 v160, v160, v81
    v_sub_f32 v65, v65, v80
    v_mul_f32 v161, v161, v81
    v_sub_f32 v66, v66, v80
    v_mul_f32 v162, v162, v81
    v_sub_f32 v67, v67, v80
    v_mul_f32 v163, v163, v81
    v_sub_f32 v68, v68, v80
    v_mul_f32 v164, v164, v81
    v_sub_f32 v69, v69, v80
    v_mul_f32 v165, v165, v81
    v_sub_f32 v70, v70, v80
    v_mul_f32 v166, v166, v81
    v_sub_f32 v71, v71, v80
    v_mul_f32 v167, v167, v81
    v_sub_f32 v72, v72, v80
    v_mul_f32 v168, v168, v81
    v_sub_f32 v73, v73, v80
    v_mul_f32 v169, v169, v81
    v_sub_f32 v74, v74, v80
    v_mul_f32 v170, v170, v81
    v_sub_f32 v75, v75, v80
    v_mul_f32 v171, v171, v81
    v_sub_f32 v76, v76, v80
    v_mul_f32 v172, v172, v81
    v_sub_f32 v77, v77, v80
    v_mul_f32 v173, v173, v81
    v_sub_f32 v78, v78, v80
    v_mul_f32 v174, v174, v81
    v_sub_f32 v79, v79, v80
    v_mul_f32 v175, v175, v81
    v_exp_f32 v64, v64
    v_exp_f32 v65, v65
    v_exp_f32 v66, v66
    v_exp_f32 v67, v67
    v_exp_f32 v68, v68
    v_exp_f32 v69, v69
    v_exp_f32 v70, v70
    v_exp_f32 v71, v71
    v_exp_f32 v72, v72
    v_exp_f32 v73, v73
    v_exp_f32 v74, v74
    v_exp_f32 v75, v75
    v_exp_f32 v76, v76
    v_exp_f32 v77, v77
    v_exp_f32 v78, v78
    v_exp_f32 v79, v79
    s_nop 0
    v_cvt_pk_bf16_f32 v128, v64, v65
    v_cvt_pk_bf16_f32 v129, v66, v67
    v_cvt_pk_bf16_f32 v130, v68, v69
    v_cvt_pk_bf16_f32 v131, v70, v71
    v_cvt_pk_bf16_f32 v132, v72, v73
    v_cvt_pk_bf16_f32 v133, v74, v75
    v_cvt_pk_bf16_f32 v134, v76, v77
    v_cvt_pk_bf16_f32 v135, v78, v79
    s_nop 1
    v_mfma_f32_32x32x16_bf16 v[160:175], v[40:43], v[128:131], v[160:175]
    v_mfma_f32_32x32x16_bf16 v[160:175], v[44:47], v[132:135], v[160:175]
    s_nop 15
    s_nop 7
    s_add_u32 s33, s33, 1
    s_cmp_lt_u32 s33, 64
    s_cbranch_scc1 fused2_kernel_fbl53
    v_mov_b32 v62, v168
    v_mov_b32 v63, v168
    s_nop 1
    v_permlane32_swap_b32 v62, v63
    s_nop 1
    s_branch fused2_kernel_fin39
fused2_kernel_end:
    s_endpgm
.section .rodata,"a"
.p2align 6
.amdhsa_kernel pc_kernel
  .amdhsa_next_free_vgpr 128
  .amdhsa_next_free_sgpr 100
  .amdhsa_accum_offset 128
  .amdhsa_group_segment_fixed_size 0
  .amdhsa_kernarg_size 120
  .amdhsa_user_sgpr_count 2
  .amdhsa_user_sgpr_kernarg_segment_ptr 1
  .amdhsa_system_sgpr_workgroup_id_x 1
  .amdhsa_float_denorm_mode_32 3
.end_amdhsa_kernel

.p2align 6
.amdhsa_kernel fused1_kernel
  .amdhsa_next_free_vgpr 256
  .amdhsa_next_free_sgpr 100
  .amdhsa_accum_offset 256
  .amdhsa_group_segment_fixed_size 0
  .amdhsa_kernarg_size 120
  .amdhsa_user_sgpr_count 2
  .amdhsa_user_sgpr_kernarg_segment_ptr 1
  .amdhsa_system_sgpr_workgroup_id_x 1
  .amdhsa_float_denorm_mode_32 3
.end_amdhsa_kernel

.p2align 6
.amdhsa_kernel conv2_kernel
  .amdhsa_next_free_vgpr 128
  .amdhsa_next_free_sgpr 100
  .amdhsa_accum_offset 128
  .amdhsa_group_segment_fixed_size 0
  .amdhsa_kernarg_size 120
  .amdhsa_user_sgpr_count 2
  .amdhsa_user_sgpr_kernarg_segment_ptr 1
  .amdhsa_system_sgpr_workgroup_id_x 1
  .amdhsa_float_denorm_mode_32 3
.end_amdhsa_kernel

.p2align 6
.amdhsa_kernel fused2_kernel
  .amdhsa_next_free_vgpr 256
  .amdhsa_next_free_sgpr 100
  .amdhsa_accum_offset 256
  .amdhsa_group_segment_fixed_size 0
  .amdhsa_kernarg_size 120
  .amdhsa_user_sgpr_count 2
  .amdhsa_user_sgpr_kernarg_segment_ptr 1
  .amdhsa_system_sgpr_workgroup_id_x 1
  .amdhsa_float_denorm_mode_32 3
.end_amdhsa_kernel
```
